```python
import torch

def _softmax(x, axis=-1):
    return torch.softmax(x, dim=axis)
def _gelu(x):
    return torch.nn.functional.gelu(x, approximate="tanh")
def _silu(x):
    return torch.nn.functional.silu(x)
def _sigmoid(x):
    return torch.sigmoid(x)
def _layernorm(x, axis=-1, eps=1e-5):
    m = x.mean(dim=axis, keepdim=True)
    v = x.var(dim=axis, keepdim=True, unbiased=False)
    return (x - m) / torch.sqrt(v + eps)
def _scatter_add(tgt, idx, src, axis=0):
    return tgt.clone().index_add_(axis, idx, src)
def _segment_sum(src, seg, n):
    out = torch.zeros((n,) + src.shape[1:], dtype=src.dtype)
    return out.index_add_(0, seg, src)
def _pad(x, pw):
    flat = tuple(v for pair in reversed(pw) for v in pair)
    return torch.nn.functional.pad(x, flat)

kernel_name = 'standalone__mha_softmax__near_ridge'

def setup_inputs():

    _w = (lambda a: (lambda t: t.to(torch.bfloat16) if t.is_floating_point() else t)(torch.as_tensor(a)))
    B, H, Sq, Sk, D = 16, 32, 304, 1024, 128
    return {
        "q": _w((lambda *s: torch.randn(*s, dtype=torch.bfloat16) * 0.8)(B, H, Sq, D)),
        "k": _w((lambda *s: torch.randn(*s, dtype=torch.bfloat16) * 0.8)(B, H, Sk, D)),
        "v": _w((lambda *s: torch.randn(*s, dtype=torch.bfloat16) * 0.05)(B, H, Sk, D)),
    }

def reference(q, k, v):
    scale = q.shape[-1] ** -0.5
    scores = torch.einsum("bhqd,bhkd->bhqk", q, k) * scale
    p = _softmax(scores, axis=-1)
    return torch.einsum("bhqk,bhkd->bhqd", p, v)
```

```asm
; @launch grid=(256,1,1) block=(256,1,1) lds=163840
.amdgcn_target "amdgcn-amd-amdhsa--gfx950"
.text
.globl standalone__mha_softmax__near_ridge_kernel
.p2align 8
.type standalone__mha_softmax__near_ridge_kernel,@function
standalone__mha_softmax__near_ridge_kernel:
    s_cmp_ge_u32 s2, 256
    s_cbranch_scc1 L_end
    s_load_dwordx8 s[4:11], s[0:1], 0
    v_lshrrev_b32 v244, 6, v0
    v_and_b32 v0, 63, v0
    v_readfirstlane_b32 s32, v244
    s_getpc_b64 s[46:47]
L_pc:
    s_lshr_b32 s41, s2, 3
    s_lshl_b32 s41, s41, 2
    s_add_u32 s41, s41, s32
    s_and_b32 s41, s41, 127
    s_lshl_b32 s41, s41, 10
    s_min_u32 s41, s41, L_slow-L_pc-512
    v_lshl_add_u32 v250, v0, 4, s41
    global_load_dwordx4 a[208:211], v250, s[46:47]
    v_and_b32 v244, 15, v0
    v_lshrrev_b32 v245, 4, v0
    s_lshl_b32 s29, s32, 12
    s_mul_i32 s100, s32, 20480
    s_lshl_b32 s99, s32, 13
    s_add_u32 s99, s99, 131072
    s_lshl_b32 s44, s2, 1
    s_mul_i32 s41, s44, 77824
    s_lshl_b32 s43, s44, 18
    s_mov_b32 s15, 0x00020000
    s_mov_b32 s19, 0x00020000
    s_mov_b32 s23, 0x00020000
    s_mov_b32 s27, 0x00020000
    s_mov_b32 s95, 0x00020000
    s_getreg_b32 s33, hwreg(HW_REG_XCC_ID)
    s_and_b32 s33, s33, 1
    v_lshlrev_b32 v246, 8, v245
    v_add_u32 v247, 0, v245
    v_xor_b32 v247, v247, v244
    v_lshl_add_u32 v13, v247, 4, v246
    v_add_u32 v247, 4, v245
    v_xor_b32 v247, v247, v244
    v_lshl_add_u32 v14, v247, 4, v246
    v_add_u32 v247, 8, v245
    v_xor_b32 v247, v247, v244
    v_lshl_add_u32 v15, v247, 4, v246
    v_add_u32 v247, 12, v245
    v_xor_b32 v247, v247, v244
    v_lshl_add_u32 v16, v247, 4, v246
    s_waitcnt lgkmcnt(0)
    s_add_u32 s20, s4, s41
    s_addc_u32 s21, s5, 0
    s_and_b32 s21, s21, 0xffff
    s_mov_b32 s22, 77824
    s_add_u32 m0, s29, 32768
    s_add_u32 s42, s100, 0
    buffer_load_dwordx4 v13, s[20:23], s42 offen offset:0 nt lds
    buffer_load_dwordx4 v14, s[20:23], s42 offen offset:1024 nt lds
    buffer_load_dwordx4 v15, s[20:23], s42 offen offset:2048 nt lds
    buffer_load_dwordx4 v16, s[20:23], s42 offen offset:3072 nt lds
    s_mov_b32 s28, s29
    s_add_u32 s12, s6, s43
    s_addc_u32 s13, s7, 0
    s_and_b32 s13, s13, 0xffff
    s_mov_b32 s14, 524288
    s_cmp_lg_u32 s33, 0
    s_cbranch_scc1 L_y1
    s_waitcnt vmcnt(0)
L_y1:
    s_and_b32 m0, s28, 0xffff
    s_nop 0
    buffer_load_dwordx4 v13, s[12:15], s28 offen offset:0 nt lds
    buffer_load_dwordx4 v14, s[12:15], s28 offen offset:1024 nt lds
    buffer_load_dwordx4 v15, s[12:15], s28 offen offset:2048 nt lds
    buffer_load_dwordx4 v16, s[12:15], s28 offen offset:3072 nt lds
    v_add_u32 v247, 0, v245
    v_lshlrev_b32 v247, 1, v247
    v_xor_b32 v247, v247, v244
    v_lshl_add_u32 v17, v247, 4, v246
    v_add_u32 v247, 4, v245
    v_lshlrev_b32 v247, 1, v247
    v_xor_b32 v247, v247, v244
    v_lshl_add_u32 v18, v247, 4, v246
    s_mov_b32 s34, 0x3e0293ee
    s_mov_b32 s35, 0x3e0293ee
    s_mov_b32 s36, 0x5f800000
    s_mov_b32 s37, 0xffff0000
    s_add_u32 s16, s8, s43
    s_addc_u32 s17, s9, 0
    s_and_b32 s17, s17, 0xffff
    s_mov_b32 s18, 524288
    v_add_u32 v247, 0, v245
    v_xor_b32 v247, v247, v244
    v_lshlrev_b32 v247, 4, v247
    v_lshl_add_u32 v1, v244, 8, v247
    v_add_u32 v247, 4, v245
    v_xor_b32 v247, v247, v244
    v_lshlrev_b32 v247, 4, v247
    v_lshl_add_u32 v2, v244, 8, v247
    v_add_u32 v247, 8, v245
    v_xor_b32 v247, v247, v244
    v_lshlrev_b32 v247, 4, v247
    v_lshl_add_u32 v3, v244, 8, v247
    v_add_u32 v247, 12, v245
    v_xor_b32 v247, v247, v244
    v_lshlrev_b32 v247, 4, v247
    v_lshl_add_u32 v4, v244, 8, v247
    v_mul_u32_u24 v247, 272, v244
    v_lshl_add_u32 v247, v245, 3, v247
    v_add_u32 v24, s99, v247
    v_mul_u32_u24 v247, 272, v245
    v_lshl_add_u32 v247, v244, 4, v247
    v_add_u32 v25, s99, v247
    v_lshlrev_b32 v26, 4, v0
    v_and_b32 v247, 1, v245
    v_lshlrev_b32 v247, 5, v247
    v_lshl_add_u32 v247, v244, 8, v247
    v_lshrrev_b32 v248, 1, v245
    v_lshl_add_u32 v27, v248, 4, v247
    v_bfe_u32 v246, v0, 2, 2
    v_lshl_add_u32 v247, v245, 2, v246
    v_and_b32 v248, 7, v247
    v_lshlrev_b32 v247, 8, v247
    v_and_b32 v249, 3, v0
    v_lshl_add_u32 v247, v249, 3, v247
    v_add_u32 v247, 65536, v247
    v_xor_b32 v249, 0, v248
    v_lshl_add_u32 v5, v249, 5, v247
    v_xor_b32 v249, 1, v248
    v_lshl_add_u32 v6, v249, 5, v247
    v_xor_b32 v249, 2, v248
    v_lshl_add_u32 v7, v249, 5, v247
    v_xor_b32 v249, 3, v248
    v_lshl_add_u32 v8, v249, 5, v247
    v_xor_b32 v249, 4, v248
    v_lshl_add_u32 v9, v249, 5, v247
    v_xor_b32 v249, 5, v248
    v_lshl_add_u32 v10, v249, 5, v247
    v_xor_b32 v249, 6, v248
    v_lshl_add_u32 v11, v249, 5, v247
    v_xor_b32 v249, 7, v248
    v_lshl_add_u32 v12, v249, 5, v247
    s_add_u32 s24, s10, s41
    s_addc_u32 s25, s11, 0
    s_and_b32 s25, s25, 0xffff
    s_mov_b32 s26, 77824
    s_add_u32 s41, s41, 77824
    s_add_u32 s92, s10, s41
    s_addc_u32 s93, s11, 0
    s_and_b32 s93, s93, 0xffff
    s_mov_b32 s94, 77824
    s_mov_b64 s[38:39], 0
    s_mov_b64 s[90:91], 0
    s_mov_b32 s30, 4
    s_mov_b32 s40, 0
    s_mov_b64 vcc, 0
    s_add_u32 s43, s29, 65536
    s_cmp_eq_u32 s32, 3
    s_cbranch_scc1 L_wave3
    s_cmp_lg_u32 s33, 0
    s_cbranch_scc1 L_y2
    s_waitcnt vmcnt(0)
L_y2:
    s_add_u32 m0, s29, 49152
    s_add_u32 s42, s100, 4096
    buffer_load_dwordx4 v13, s[20:23], s42 offen offset:0 nt lds
    buffer_load_dwordx4 v14, s[20:23], s42 offen offset:1024 nt lds
    buffer_load_dwordx4 v15, s[20:23], s42 offen offset:2048 nt lds
    buffer_load_dwordx4 v16, s[20:23], s42 offen offset:3072 nt lds
    v_add_u32 v252, s29, v1
    v_add_u32 v253, s29, v2
    v_add_u32 v254, s29, v3
    v_add_u32 v255, s29, v4
    s_waitcnt vmcnt(8)
    ds_read_b128 v[160:163], v252 offset:32768
    ds_read_b128 v[164:167], v253 offset:32768
    ds_read_b128 v[168:171], v254 offset:32768
    ds_read_b128 v[172:175], v255 offset:32768
    s_cmp_lg_u32 s33, 0
    s_cbranch_scc1 L_y3
    s_waitcnt vmcnt(0)
L_y3:
    s_add_u32 m0, s29, 65536
    s_nop 0
    buffer_load_dwordx4 v17, s[16:19], s28 offen offset:0 nt lds
    buffer_load_dwordx4 v18, s[16:19], s28 offen offset:1024 nt lds
    buffer_load_dwordx4 v17, s[16:19], s28 offen offset:2048 nt lds
    buffer_load_dwordx4 v18, s[16:19], s28 offen offset:3072 nt lds
    s_add_u32 s28, s28, 16384
    s_waitcnt lgkmcnt(3)
    v_lshlrev_b32 v244, 16, v160
    v_lshlrev_b32 v246, 16, v161
    v_lshlrev_b32 v248, 16, v162
    v_lshlrev_b32 v250, 16, v163
    v_and_b32 v245, s37, v160
    v_and_b32 v247, s37, v161
    v_and_b32 v249, s37, v162
    v_and_b32 v251, s37, v163
    v_pk_mul_f32 v[244:245], v[244:245], s[34:35]
    v_pk_mul_f32 v[246:247], v[246:247], s[34:35]
    v_pk_mul_f32 v[248:249], v[248:249], s[34:35]
    v_pk_mul_f32 v[250:251], v[250:251], s[34:35]
    v_cvt_pk_bf16_f32 v244, v244, v245
    v_cvt_pk_bf16_f32 v246, v246, v247
    v_cvt_pk_bf16_f32 v248, v248, v249
    v_cvt_pk_bf16_f32 v250, v250, v251
    v_accvgpr_write_b32 a0, v244
    v_accvgpr_write_b32 a1, v246
    v_accvgpr_write_b32 a2, v248
    v_accvgpr_write_b32 a3, v250
    s_waitcnt lgkmcnt(2)
    v_lshlrev_b32 v244, 16, v164
    v_lshlrev_b32 v246, 16, v165
    v_lshlrev_b32 v248, 16, v166
    v_lshlrev_b32 v250, 16, v167
    v_and_b32 v245, s37, v164
    v_and_b32 v247, s37, v165
    v_and_b32 v249, s37, v166
    v_and_b32 v251, s37, v167
    v_pk_mul_f32 v[244:245], v[244:245], s[34:35]
    v_pk_mul_f32 v[246:247], v[246:247], s[34:35]
    v_pk_mul_f32 v[248:249], v[248:249], s[34:35]
    v_pk_mul_f32 v[250:251], v[250:251], s[34:35]
    v_cvt_pk_bf16_f32 v244, v244, v245
    v_cvt_pk_bf16_f32 v246, v246, v247
    v_cvt_pk_bf16_f32 v248, v248, v249
    v_cvt_pk_bf16_f32 v250, v250, v251
    v_accvgpr_write_b32 a4, v244
    v_accvgpr_write_b32 a5, v246
    v_accvgpr_write_b32 a6, v248
    v_accvgpr_write_b32 a7, v250
    s_waitcnt lgkmcnt(1)
    v_lshlrev_b32 v244, 16, v168
    v_lshlrev_b32 v246, 16, v169
    v_lshlrev_b32 v248, 16, v170
    v_lshlrev_b32 v250, 16, v171
    v_and_b32 v245, s37, v168
    v_and_b32 v247, s37, v169
    v_and_b32 v249, s37, v170
    v_and_b32 v251, s37, v171
    v_pk_mul_f32 v[244:245], v[244:245], s[34:35]
    v_pk_mul_f32 v[246:247], v[246:247], s[34:35]
    v_pk_mul_f32 v[248:249], v[248:249], s[34:35]
    v_pk_mul_f32 v[250:251], v[250:251], s[34:35]
    v_cvt_pk_bf16_f32 v244, v244, v245
    v_cvt_pk_bf16_f32 v246, v246, v247
    v_cvt_pk_bf16_f32 v248, v248, v249
    v_cvt_pk_bf16_f32 v250, v250, v251
    v_accvgpr_write_b32 a8, v244
    v_accvgpr_write_b32 a9, v246
    v_accvgpr_write_b32 a10, v248
    v_accvgpr_write_b32 a11, v250
    s_waitcnt lgkmcnt(0)
    v_lshlrev_b32 v244, 16, v172
    v_lshlrev_b32 v246, 16, v173
    v_lshlrev_b32 v248, 16, v174
    v_lshlrev_b32 v250, 16, v175
    v_and_b32 v245, s37, v172
    v_and_b32 v247, s37, v173
    v_and_b32 v249, s37, v174
    v_and_b32 v251, s37, v175
    v_pk_mul_f32 v[244:245], v[244:245], s[34:35]
    v_pk_mul_f32 v[246:247], v[246:247], s[34:35]
    v_pk_mul_f32 v[248:249], v[248:249], s[34:35]
    v_pk_mul_f32 v[250:251], v[250:251], s[34:35]
    v_cvt_pk_bf16_f32 v244, v244, v245
    v_cvt_pk_bf16_f32 v246, v246, v247
    v_cvt_pk_bf16_f32 v248, v248, v249
    v_cvt_pk_bf16_f32 v250, v250, v251
    v_accvgpr_write_b32 a12, v244
    v_accvgpr_write_b32 a13, v246
    v_accvgpr_write_b32 a14, v248
    v_accvgpr_write_b32 a15, v250
    s_waitcnt vmcnt(8)
    s_barrier
    ds_read_b128 a[80:83], v1 offset:0
    ds_read_b128 a[84:87], v2 offset:0
    ds_read_b128 a[88:91], v3 offset:0
    ds_read_b128 a[92:95], v4 offset:0
    ds_read_b128 a[96:99], v1 offset:4096
    ds_read_b128 a[100:103], v2 offset:4096
    ds_read_b128 a[104:107], v3 offset:4096
    ds_read_b128 a[108:111], v4 offset:4096
    ds_read_b128 a[112:115], v1 offset:8192
    ds_read_b128 a[116:119], v2 offset:8192
    ds_read_b128 a[120:123], v3 offset:8192
    ds_read_b128 a[124:127], v4 offset:8192
    ds_read_b128 a[128:131], v1 offset:12288
    ds_read_b128 a[132:135], v2 offset:12288
    ds_read_b128 a[136:139], v3 offset:12288
    ds_read_b128 a[140:143], v4 offset:12288
    s_cmp_lg_u32 s33, 0
    s_cbranch_scc1 L_y4
    s_waitcnt vmcnt(0)
L_y4:
    s_add_u32 m0, s29, 98304
    s_add_u32 s42, s100, 8192
    buffer_load_dwordx4 v13, s[20:23], s42 offen offset:0 nt lds
    buffer_load_dwordx4 v14, s[20:23], s42 offen offset:1024 nt lds
    buffer_load_dwordx4 v15, s[20:23], s42 offen offset:2048 nt lds
    buffer_load_dwordx4 v16, s[20:23], s42 offen offset:3072 nt lds
    s_waitcnt lgkmcnt(15)
    v_mfma_f32_16x16x32_bf16 v[192:195], a[80:83], a[0:3], 0
    s_waitcnt lgkmcnt(14)
    v_mfma_f32_16x16x32_bf16 v[192:195], a[84:87], a[4:7], v[192:195]
    s_waitcnt lgkmcnt(13)
    v_mfma_f32_16x16x32_bf16 v[192:195], a[88:91], a[8:11], v[192:195]
    s_waitcnt lgkmcnt(12)
    v_mfma_f32_16x16x32_bf16 v[192:195], a[92:95], a[12:15], v[192:195]
    s_nop 7
    v_max3_f32 v244, v192, v193, v194
    v_max_f32 v244, v244, v195
    v_mov_b32 v245, v244
    s_nop 1
    v_permlane16_swap_b32 v244, v245
    v_max_f32 v244, v244, v245
    v_mov_b32 v245, v244
    s_nop 1
    v_permlane32_swap_b32 v244, v245
    v_min_f32 v192, -v244, -v245
    v_min_f32 v193, -v244, -v245
    v_min_f32 v194, -v244, -v245
    v_min_f32 v195, -v244, -v245
    s_nop 1
    v_mfma_f32_16x16x32_bf16 v[212:215], a[80:83], a[0:3], v[192:195]
    v_mfma_f32_16x16x32_bf16 v[212:215], a[84:87], a[4:7], v[212:215]
    v_mfma_f32_16x16x32_bf16 v[212:215], a[88:91], a[8:11], v[212:215]
    v_mfma_f32_16x16x32_bf16 v[212:215], a[92:95], a[12:15], v[212:215]
    s_waitcnt lgkmcnt(0)
    v_mfma_f32_16x16x32_bf16 v[216:219], a[96:99], a[0:3], v[192:195]
    v_mfma_f32_16x16x32_bf16 v[216:219], a[100:103], a[4:7], v[216:219]
    v_mfma_f32_16x16x32_bf16 v[216:219], a[104:107], a[8:11], v[216:219]
    v_mfma_f32_16x16x32_bf16 v[216:219], a[108:111], a[12:15], v[216:219]
    s_nop 2
    v_exp_f32 v212, v212
    v_mfma_f32_16x16x32_bf16 v[220:223], a[112:115], a[0:3], v[192:195]
    v_mov_b32 v19, v212
    v_mfma_f32_16x16x32_bf16 v[220:223], a[116:119], a[4:7], v[220:223]
    v_exp_f32 v213, v213
    v_mfma_f32_16x16x32_bf16 v[220:223], a[120:123], a[8:11], v[220:223]
    v_add_f32 v19, v19, v213
    v_cvt_pk_bf16_f32 v212, v212, v213
    v_mfma_f32_16x16x32_bf16 v[220:223], a[124:127], a[12:15], v[220:223]
    v_exp_f32 v214, v214
    v_mfma_f32_16x16x32_bf16 v[224:227], a[128:131], a[0:3], v[192:195]
    v_add_f32 v19, v19, v214
    v_mfma_f32_16x16x32_bf16 v[224:227], a[132:135], a[4:7], v[224:227]
    v_exp_f32 v215, v215
    v_mfma_f32_16x16x32_bf16 v[224:227], a[136:139], a[8:11], v[224:227]
    v_add_f32 v19, v19, v215
    v_cvt_pk_bf16_f32 v213, v214, v215
    v_mfma_f32_16x16x32_bf16 v[224:227], a[140:143], a[12:15], v[224:227]
    v_exp_f32 v216, v216
    s_nop 0
    v_add_f32 v19, v19, v216
    v_exp_f32 v217, v217
    s_nop 0
    v_add_f32 v19, v19, v217
    v_cvt_pk_bf16_f32 v214, v216, v217
    v_exp_f32 v218, v218
    s_nop 0
    v_add_f32 v19, v19, v218
    v_exp_f32 v219, v219
    s_nop 0
    v_add_f32 v19, v19, v219
    v_cvt_pk_bf16_f32 v215, v218, v219
    v_exp_f32 v220, v220
    s_nop 0
    v_add_f32 v19, v19, v220
    v_add_u32 v252, s29, v1
    v_add_u32 v253, s29, v2
    v_add_u32 v254, s29, v3
    v_add_u32 v255, s29, v4
    s_waitcnt vmcnt(8)
    ds_read_b128 v[160:163], v252 offset:49152
    ds_read_b128 v[164:167], v253 offset:49152
    ds_read_b128 v[168:171], v254 offset:49152
    ds_read_b128 v[172:175], v255 offset:49152
    s_cmp_lg_u32 s33, 0
    s_cbranch_scc1 L_y5
    s_waitcnt vmcnt(0)
L_y5:
    s_add_u32 m0, s29, 114688
    s_add_u32 s42, s100, 12288
    buffer_load_dwordx4 v13, s[20:23], s42 offen offset:0 nt lds
    buffer_load_dwordx4 v14, s[20:23], s42 offen offset:1024 nt lds
    buffer_load_dwordx4 v15, s[20:23], s42 offen offset:2048 nt lds
    buffer_load_dwordx4 v16, s[20:23], s42 offen offset:3072 nt lds
    s_waitcnt lgkmcnt(3)
    v_lshlrev_b32 v244, 16, v160
    v_lshlrev_b32 v246, 16, v161
    v_lshlrev_b32 v248, 16, v162
    v_lshlrev_b32 v250, 16, v163
    v_and_b32 v245, s37, v160
    v_and_b32 v247, s37, v161
    v_and_b32 v249, s37, v162
    v_and_b32 v251, s37, v163
    v_pk_mul_f32 v[244:245], v[244:245], s[34:35]
    v_pk_mul_f32 v[246:247], v[246:247], s[34:35]
    v_pk_mul_f32 v[248:249], v[248:249], s[34:35]
    v_pk_mul_f32 v[250:251], v[250:251], s[34:35]
    v_cvt_pk_bf16_f32 v244, v244, v245
    v_cvt_pk_bf16_f32 v246, v246, v247
    v_cvt_pk_bf16_f32 v248, v248, v249
    v_cvt_pk_bf16_f32 v250, v250, v251
    v_accvgpr_write_b32 a16, v244
    v_accvgpr_write_b32 a17, v246
    v_accvgpr_write_b32 a18, v248
    v_accvgpr_write_b32 a19, v250
    s_waitcnt lgkmcnt(2)
    v_lshlrev_b32 v244, 16, v164
    v_lshlrev_b32 v246, 16, v165
    v_lshlrev_b32 v248, 16, v166
    v_lshlrev_b32 v250, 16, v167
    v_and_b32 v245, s37, v164
    v_and_b32 v247, s37, v165
    v_and_b32 v249, s37, v166
    v_and_b32 v251, s37, v167
    v_pk_mul_f32 v[244:245], v[244:245], s[34:35]
    v_pk_mul_f32 v[246:247], v[246:247], s[34:35]
    v_pk_mul_f32 v[248:249], v[248:249], s[34:35]
    v_pk_mul_f32 v[250:251], v[250:251], s[34:35]
    v_cvt_pk_bf16_f32 v244, v244, v245
    v_cvt_pk_bf16_f32 v246, v246, v247
    v_cvt_pk_bf16_f32 v248, v248, v249
    v_cvt_pk_bf16_f32 v250, v250, v251
    v_accvgpr_write_b32 a20, v244
    v_accvgpr_write_b32 a21, v246
    v_accvgpr_write_b32 a22, v248
    v_accvgpr_write_b32 a23, v250
    s_waitcnt lgkmcnt(1)
    v_lshlrev_b32 v244, 16, v168
    v_lshlrev_b32 v246, 16, v169
    v_lshlrev_b32 v248, 16, v170
    v_lshlrev_b32 v250, 16, v171
    v_and_b32 v245, s37, v168
    v_and_b32 v247, s37, v169
    v_and_b32 v249, s37, v170
    v_and_b32 v251, s37, v171
    v_pk_mul_f32 v[244:245], v[244:245], s[34:35]
    v_pk_mul_f32 v[246:247], v[246:247], s[34:35]
    v_pk_mul_f32 v[248:249], v[248:249], s[34:35]
    v_pk_mul_f32 v[250:251], v[250:251], s[34:35]
    v_cvt_pk_bf16_f32 v244, v244, v245
    v_cvt_pk_bf16_f32 v246, v246, v247
    v_cvt_pk_bf16_f32 v248, v248, v249
    v_cvt_pk_bf16_f32 v250, v250, v251
    v_accvgpr_write_b32 a24, v244
    v_accvgpr_write_b32 a25, v246
    v_accvgpr_write_b32 a26, v248
    v_accvgpr_write_b32 a27, v250
    s_waitcnt lgkmcnt(0)
    v_lshlrev_b32 v244, 16, v172
    v_lshlrev_b32 v246, 16, v173
    v_lshlrev_b32 v248, 16, v174
    v_lshlrev_b32 v250, 16, v175
    v_and_b32 v245, s37, v172
    v_and_b32 v247, s37, v173
    v_and_b32 v249, s37, v174
    v_and_b32 v251, s37, v175
    v_pk_mul_f32 v[244:245], v[244:245], s[34:35]
    v_pk_mul_f32 v[246:247], v[246:247], s[34:35]
    v_pk_mul_f32 v[248:249], v[248:249], s[34:35]
    v_pk_mul_f32 v[250:251], v[250:251], s[34:35]
    v_cvt_pk_bf16_f32 v244, v244, v245
    v_cvt_pk_bf16_f32 v246, v246, v247
    v_cvt_pk_bf16_f32 v248, v248, v249
    v_cvt_pk_bf16_f32 v250, v250, v251
    v_accvgpr_write_b32 a28, v244
    v_accvgpr_write_b32 a29, v246
    v_accvgpr_write_b32 a30, v248
    v_accvgpr_write_b32 a31, v250
    v_mfma_f32_16x16x32_bf16 v[196:199], a[80:83], a[16:19], 0
    v_mfma_f32_16x16x32_bf16 v[196:199], a[84:87], a[20:23], v[196:199]
    v_mfma_f32_16x16x32_bf16 v[196:199], a[88:91], a[24:27], v[196:199]
    v_mfma_f32_16x16x32_bf16 v[196:199], a[92:95], a[28:31], v[196:199]
    s_nop 7
    v_max3_f32 v244, v196, v197, v198
    v_max_f32 v244, v244, v199
    v_mov_b32 v245, v244
    s_nop 1
    v_permlane16_swap_b32 v244, v245
    v_max_f32 v244, v244, v245
    v_mov_b32 v245, v244
    s_nop 1
    v_permlane32_swap_b32 v244, v245
    v_min_f32 v196, -v244, -v245
    v_min_f32 v197, -v244, -v245
    v_min_f32 v198, -v244, -v245
    v_min_f32 v199, -v244, -v245
    s_nop 1
    v_mfma_f32_16x16x32_bf16 v[228:231], a[80:83], a[16:19], v[196:199]
    v_exp_f32 v221, v221
    v_mfma_f32_16x16x32_bf16 v[228:231], a[84:87], a[20:23], v[228:231]
    v_add_f32 v19, v19, v221
    v_cvt_pk_bf16_f32 v216, v220, v221
    v_mfma_f32_16x16x32_bf16 v[228:231], a[88:91], a[24:27], v[228:231]
    v_exp_f32 v222, v222
    v_mfma_f32_16x16x32_bf16 v[228:231], a[92:95], a[28:31], v[228:231]
    v_add_f32 v19, v19, v222
    v_mfma_f32_16x16x32_bf16 v[232:235], a[96:99], a[16:19], v[196:199]
    v_exp_f32 v223, v223
    v_mfma_f32_16x16x32_bf16 v[232:235], a[100:103], a[20:23], v[232:235]
    v_add_f32 v19, v19, v223
    v_cvt_pk_bf16_f32 v217, v222, v223
    v_mfma_f32_16x16x32_bf16 v[232:235], a[104:107], a[24:27], v[232:235]
    v_exp_f32 v224, v224
    v_mfma_f32_16x16x32_bf16 v[232:235], a[108:111], a[28:31], v[232:235]
    v_add_f32 v19, v19, v224
    v_mfma_f32_16x16x32_bf16 v[236:239], a[112:115], a[16:19], v[196:199]
    v_exp_f32 v225, v225
    v_mfma_f32_16x16x32_bf16 v[236:239], a[116:119], a[20:23], v[236:239]
    v_add_f32 v19, v19, v225
    v_cvt_pk_bf16_f32 v218, v224, v225
    v_mfma_f32_16x16x32_bf16 v[236:239], a[120:123], a[24:27], v[236:239]
    v_exp_f32 v226, v226
    v_mfma_f32_16x16x32_bf16 v[236:239], a[124:127], a[28:31], v[236:239]
    v_add_f32 v19, v19, v226
    v_mfma_f32_16x16x32_bf16 v[240:243], a[128:131], a[16:19], v[196:199]
    v_exp_f32 v227, v227
    v_mfma_f32_16x16x32_bf16 v[240:243], a[132:135], a[20:23], v[240:243]
    v_add_f32 v19, v19, v227
    v_cvt_pk_bf16_f32 v219, v226, v227
    v_mfma_f32_16x16x32_bf16 v[240:243], a[136:139], a[24:27], v[240:243]
    v_exp_f32 v228, v228
    v_mfma_f32_16x16x32_bf16 v[240:243], a[140:143], a[28:31], v[240:243]
    v_mov_b32 v20, v228
    s_waitcnt vmcnt(8)
    s_barrier
    ds_read_b64_tr_b16 a[144:145], v5 offset:0
    ds_read_b64_tr_b16 a[146:147], v5 offset:4096
    ds_read_b64_tr_b16 a[176:177], v5 offset:8192
    ds_read_b64_tr_b16 a[178:179], v5 offset:12288
    ds_read_b64_tr_b16 a[148:149], v6 offset:0
    ds_read_b64_tr_b16 a[150:151], v6 offset:4096
    ds_read_b64_tr_b16 a[180:181], v6 offset:8192
    ds_read_b64_tr_b16 a[182:183], v6 offset:12288
    ds_read_b64_tr_b16 a[152:153], v7 offset:0
    ds_read_b64_tr_b16 a[154:155], v7 offset:4096
    ds_read_b64_tr_b16 a[184:185], v7 offset:8192
    ds_read_b64_tr_b16 a[186:187], v7 offset:12288
    ds_read_b64_tr_b16 a[156:157], v8 offset:0
    ds_read_b64_tr_b16 a[158:159], v8 offset:4096
    ds_read_b64_tr_b16 a[188:189], v8 offset:8192
    ds_read_b64_tr_b16 a[190:191], v8 offset:12288
    ds_read_b64_tr_b16 a[160:161], v9 offset:0
    ds_read_b64_tr_b16 a[162:163], v9 offset:4096
    ds_read_b64_tr_b16 a[192:193], v9 offset:8192
    ds_read_b64_tr_b16 a[194:195], v9 offset:12288
    ds_read_b64_tr_b16 a[164:165], v10 offset:0
    ds_read_b64_tr_b16 a[166:167], v10 offset:4096
    ds_read_b64_tr_b16 a[196:197], v10 offset:8192
    ds_read_b64_tr_b16 a[198:199], v10 offset:12288
    ds_read_b64_tr_b16 a[168:169], v11 offset:0
    ds_read_b64_tr_b16 a[170:171], v11 offset:4096
    ds_read_b64_tr_b16 a[200:201], v11 offset:8192
    ds_read_b64_tr_b16 a[202:203], v11 offset:12288
    ds_read_b64_tr_b16 a[172:173], v12 offset:0
    ds_read_b64_tr_b16 a[174:175], v12 offset:4096
    ds_read_b64_tr_b16 a[204:205], v12 offset:8192
    ds_read_b64_tr_b16 a[206:207], v12 offset:12288
    s_cmp_lg_u32 s33, 0
    s_cbranch_scc1 L_y6
    s_waitcnt vmcnt(0)
L_y6:
    s_add_u32 m0, s99, 0
    s_add_u32 s42, s100, 16384
    buffer_load_dwordx4 v13, s[20:23], s42 offen offset:0 nt lds
    buffer_load_dwordx4 v14, s[20:23], s42 offen offset:1024 nt lds
    buffer_load_dwordx4 v15, s[20:23], s42 offen offset:2048 nt lds
    buffer_load_dwordx4 v16, s[20:23], s42 offen offset:3072 nt lds
    s_waitcnt lgkmcnt(15)
    v_mfma_f32_16x16x32_bf16 v[32:35], a[144:147], v[212:215], 0
    v_exp_f32 v229, v229
    v_mfma_f32_16x16x32_bf16 v[32:35], a[176:179], v[216:219], v[32:35]
    v_add_f32 v20, v20, v229
    v_cvt_pk_bf16_f32 v228, v228, v229
    v_mfma_f32_16x16x32_bf16 v[36:39], a[148:151], v[212:215], 0
    v_exp_f32 v230, v230
    v_mfma_f32_16x16x32_bf16 v[36:39], a[180:183], v[216:219], v[36:39]
    v_add_f32 v20, v20, v230
    v_mfma_f32_16x16x32_bf16 v[40:43], a[152:155], v[212:215], 0
    v_exp_f32 v231, v231
    v_mfma_f32_16x16x32_bf16 v[40:43], a[184:187], v[216:219], v[40:43]
    v_add_f32 v20, v20, v231
    v_cvt_pk_bf16_f32 v229, v230, v231
    v_mfma_f32_16x16x32_bf16 v[44:47], a[156:159], v[212:215], 0
    v_exp_f32 v232, v232
    v_mfma_f32_16x16x32_bf16 v[44:47], a[188:191], v[216:219], v[44:47]
    v_add_f32 v20, v20, v232
    s_waitcnt lgkmcnt(0)
    v_mfma_f32_16x16x32_bf16 v[48:51], a[160:163], v[212:215], 0
    v_exp_f32 v233, v233
    v_mfma_f32_16x16x32_bf16 v[48:51], a[192:195], v[216:219], v[48:51]
    v_add_f32 v20, v20, v233
    v_cvt_pk_bf16_f32 v230, v232, v233
    v_mfma_f32_16x16x32_bf16 v[52:55], a[164:167], v[212:215], 0
    v_exp_f32 v234, v234
    v_mfma_f32_16x16x32_bf16 v[52:55], a[196:199], v[216:219], v[52:55]
    v_add_f32 v20, v20, v234
    v_mfma_f32_16x16x32_bf16 v[56:59], a[168:171], v[212:215], 0
    v_exp_f32 v235, v235
    v_mfma_f32_16x16x32_bf16 v[56:59], a[200:203], v[216:219], v[56:59]
    v_add_f32 v20, v20, v235
    v_cvt_pk_bf16_f32 v231, v234, v235
    v_mfma_f32_16x16x32_bf16 v[60:63], a[172:175], v[212:215], 0
    v_exp_f32 v236, v236
    v_mfma_f32_16x16x32_bf16 v[60:63], a[204:207], v[216:219], v[60:63]
    v_add_f32 v20, v20, v236
    v_add_u32 v252, s43, v1
    v_add_u32 v253, s43, v2
    v_add_u32 v254, s43, v3
    v_add_u32 v255, s43, v4
    s_waitcnt vmcnt(8)
    ds_read_b128 v[160:163], v252 offset:32768
    ds_read_b128 v[164:167], v253 offset:32768
    ds_read_b128 v[168:171], v254 offset:32768
    ds_read_b128 v[172:175], v255 offset:32768
    s_cmp_lg_u32 s33, 0
    s_cbranch_scc1 L_y7
    s_waitcnt vmcnt(0)
L_y7:
    s_and_b32 m0, s28, 0xffff
    s_nop 0
    buffer_load_dwordx4 v13, s[12:15], s28 offen offset:0 nt lds
    buffer_load_dwordx4 v14, s[12:15], s28 offen offset:1024 nt lds
    buffer_load_dwordx4 v15, s[12:15], s28 offen offset:2048 nt lds
    buffer_load_dwordx4 v16, s[12:15], s28 offen offset:3072 nt lds
    s_waitcnt lgkmcnt(3)
    v_lshlrev_b32 v244, 16, v160
    v_lshlrev_b32 v246, 16, v161
    v_lshlrev_b32 v248, 16, v162
    v_lshlrev_b32 v250, 16, v163
    v_and_b32 v245, s37, v160
    v_and_b32 v247, s37, v161
    v_and_b32 v249, s37, v162
    v_and_b32 v251, s37, v163
    v_pk_mul_f32 v[244:245], v[244:245], s[34:35]
    v_pk_mul_f32 v[246:247], v[246:247], s[34:35]
    v_pk_mul_f32 v[248:249], v[248:249], s[34:35]
    v_pk_mul_f32 v[250:251], v[250:251], s[34:35]
    v_cvt_pk_bf16_f32 v244, v244, v245
    v_cvt_pk_bf16_f32 v246, v246, v247
    v_cvt_pk_bf16_f32 v248, v248, v249
    v_cvt_pk_bf16_f32 v250, v250, v251
    v_accvgpr_write_b32 a32, v244
    v_accvgpr_write_b32 a33, v246
    v_accvgpr_write_b32 a34, v248
    v_accvgpr_write_b32 a35, v250
    s_waitcnt lgkmcnt(2)
    v_lshlrev_b32 v244, 16, v164
    v_lshlrev_b32 v246, 16, v165
    v_lshlrev_b32 v248, 16, v166
    v_lshlrev_b32 v250, 16, v167
    v_and_b32 v245, s37, v164
    v_and_b32 v247, s37, v165
    v_and_b32 v249, s37, v166
    v_and_b32 v251, s37, v167
    v_pk_mul_f32 v[244:245], v[244:245], s[34:35]
    v_pk_mul_f32 v[246:247], v[246:247], s[34:35]
    v_pk_mul_f32 v[248:249], v[248:249], s[34:35]
    v_pk_mul_f32 v[250:251], v[250:251], s[34:35]
    v_cvt_pk_bf16_f32 v244, v244, v245
    v_cvt_pk_bf16_f32 v246, v246, v247
    v_cvt_pk_bf16_f32 v248, v248, v249
    v_cvt_pk_bf16_f32 v250, v250, v251
    v_accvgpr_write_b32 a36, v244
    v_accvgpr_write_b32 a37, v246
    v_accvgpr_write_b32 a38, v248
    v_accvgpr_write_b32 a39, v250
    s_waitcnt lgkmcnt(1)
    v_lshlrev_b32 v244, 16, v168
    v_lshlrev_b32 v246, 16, v169
    v_lshlrev_b32 v248, 16, v170
    v_lshlrev_b32 v250, 16, v171
    v_and_b32 v245, s37, v168
    v_and_b32 v247, s37, v169
    v_and_b32 v249, s37, v170
    v_and_b32 v251, s37, v171
    v_pk_mul_f32 v[244:245], v[244:245], s[34:35]
    v_pk_mul_f32 v[246:247], v[246:247], s[34:35]
    v_pk_mul_f32 v[248:249], v[248:249], s[34:35]
    v_pk_mul_f32 v[250:251], v[250:251], s[34:35]
    v_cvt_pk_bf16_f32 v244, v244, v245
    v_cvt_pk_bf16_f32 v246, v246, v247
    v_cvt_pk_bf16_f32 v248, v248, v249
    v_cvt_pk_bf16_f32 v250, v250, v251
    v_accvgpr_write_b32 a40, v244
    v_accvgpr_write_b32 a41, v246
    v_accvgpr_write_b32 a42, v248
    v_accvgpr_write_b32 a43, v250
    s_waitcnt lgkmcnt(0)
    v_lshlrev_b32 v244, 16, v172
    v_lshlrev_b32 v246, 16, v173
    v_lshlrev_b32 v248, 16, v174
    v_lshlrev_b32 v250, 16, v175
    v_and_b32 v245, s37, v172
    v_and_b32 v247, s37, v173
    v_and_b32 v249, s37, v174
    v_and_b32 v251, s37, v175
    v_pk_mul_f32 v[244:245], v[244:245], s[34:35]
    v_pk_mul_f32 v[246:247], v[246:247], s[34:35]
    v_pk_mul_f32 v[248:249], v[248:249], s[34:35]
    v_pk_mul_f32 v[250:251], v[250:251], s[34:35]
    v_cvt_pk_bf16_f32 v244, v244, v245
    v_cvt_pk_bf16_f32 v246, v246, v247
    v_cvt_pk_bf16_f32 v248, v248, v249
    v_cvt_pk_bf16_f32 v250, v250, v251
    v_accvgpr_write_b32 a44, v244
    v_accvgpr_write_b32 a45, v246
    v_accvgpr_write_b32 a46, v248
    v_accvgpr_write_b32 a47, v250
    v_mfma_f32_16x16x32_bf16 v[200:203], a[80:83], a[32:35], 0
    v_mfma_f32_16x16x32_bf16 v[200:203], a[84:87], a[36:39], v[200:203]
    v_mfma_f32_16x16x32_bf16 v[200:203], a[88:91], a[40:43], v[200:203]
    v_mfma_f32_16x16x32_bf16 v[200:203], a[92:95], a[44:47], v[200:203]
    s_nop 7
    v_max3_f32 v244, v200, v201, v202
    v_max_f32 v244, v244, v203
    v_mov_b32 v245, v244
    s_nop 1
    v_permlane16_swap_b32 v244, v245
    v_max_f32 v244, v244, v245
    v_mov_b32 v245, v244
    s_nop 1
    v_permlane32_swap_b32 v244, v245
    v_min_f32 v200, -v244, -v245
    v_min_f32 v201, -v244, -v245
    v_min_f32 v202, -v244, -v245
    v_min_f32 v203, -v244, -v245
    s_nop 1
    v_mfma_f32_16x16x32_bf16 v[212:215], a[80:83], a[32:35], v[200:203]
    v_exp_f32 v237, v237
    v_mfma_f32_16x16x32_bf16 v[212:215], a[84:87], a[36:39], v[212:215]
    v_add_f32 v20, v20, v237
    v_cvt_pk_bf16_f32 v232, v236, v237
    v_mfma_f32_16x16x32_bf16 v[212:215], a[88:91], a[40:43], v[212:215]
    v_exp_f32 v238, v238
    v_mfma_f32_16x16x32_bf16 v[212:215], a[92:95], a[44:47], v[212:215]
    v_add_f32 v20, v20, v238
    v_mfma_f32_16x16x32_bf16 v[216:219], a[96:99], a[32:35], v[200:203]
    v_exp_f32 v239, v239
    v_mfma_f32_16x16x32_bf16 v[216:219], a[100:103], a[36:39], v[216:219]
    v_add_f32 v20, v20, v239
    v_cvt_pk_bf16_f32 v233, v238, v239
    v_mfma_f32_16x16x32_bf16 v[216:219], a[104:107], a[40:43], v[216:219]
    v_exp_f32 v240, v240
    v_mfma_f32_16x16x32_bf16 v[216:219], a[108:111], a[44:47], v[216:219]
    v_add_f32 v20, v20, v240
    v_mfma_f32_16x16x32_bf16 v[220:223], a[112:115], a[32:35], v[200:203]
    v_exp_f32 v241, v241
    v_mfma_f32_16x16x32_bf16 v[220:223], a[116:119], a[36:39], v[220:223]
    v_add_f32 v20, v20, v241
    v_cvt_pk_bf16_f32 v234, v240, v241
    v_mfma_f32_16x16x32_bf16 v[220:223], a[120:123], a[40:43], v[220:223]
    v_exp_f32 v242, v242
    v_mfma_f32_16x16x32_bf16 v[220:223], a[124:127], a[44:47], v[220:223]
    v_add_f32 v20, v20, v242
    v_mfma_f32_16x16x32_bf16 v[224:227], a[128:131], a[32:35], v[200:203]
    v_exp_f32 v243, v243
    v_mfma_f32_16x16x32_bf16 v[224:227], a[132:135], a[36:39], v[224:227]
    v_add_f32 v20, v20, v243
    v_cvt_pk_bf16_f32 v235, v242, v243
    v_mfma_f32_16x16x32_bf16 v[224:227], a[136:139], a[40:43], v[224:227]
    v_exp_f32 v212, v212
    v_mfma_f32_16x16x32_bf16 v[224:227], a[140:143], a[44:47], v[224:227]
    v_mov_b32 v21, v212
    v_mfma_f32_16x16x32_bf16 v[64:67], a[144:147], v[228:231], 0
    v_exp_f32 v213, v213
    v_mfma_f32_16x16x32_bf16 v[64:67], a[176:179], v[232:235], v[64:67]
    v_add_f32 v21, v21, v213
    v_cvt_pk_bf16_f32 v212, v212, v213
    v_mfma_f32_16x16x32_bf16 v[68:71], a[148:151], v[228:231], 0
    v_exp_f32 v214, v214
    v_mfma_f32_16x16x32_bf16 v[68:71], a[180:183], v[232:235], v[68:71]
    v_add_f32 v21, v21, v214
    v_mfma_f32_16x16x32_bf16 v[72:75], a[152:155], v[228:231], 0
    v_exp_f32 v215, v215
    v_mfma_f32_16x16x32_bf16 v[72:75], a[184:187], v[232:235], v[72:75]
    v_add_f32 v21, v21, v215
    v_cvt_pk_bf16_f32 v213, v214, v215
    v_mfma_f32_16x16x32_bf16 v[76:79], a[156:159], v[228:231], 0
    v_exp_f32 v216, v216
    v_mfma_f32_16x16x32_bf16 v[76:79], a[188:191], v[232:235], v[76:79]
    v_add_f32 v21, v21, v216
    v_mfma_f32_16x16x32_bf16 v[80:83], a[160:163], v[228:231], 0
    v_exp_f32 v217, v217
    v_mfma_f32_16x16x32_bf16 v[80:83], a[192:195], v[232:235], v[80:83]
    v_add_f32 v21, v21, v217
    v_cvt_pk_bf16_f32 v214, v216, v217
    v_mfma_f32_16x16x32_bf16 v[84:87], a[164:167], v[228:231], 0
    v_exp_f32 v218, v218
    v_mfma_f32_16x16x32_bf16 v[84:87], a[196:199], v[232:235], v[84:87]
    v_add_f32 v21, v21, v218
    v_mfma_f32_16x16x32_bf16 v[88:91], a[168:171], v[228:231], 0
    v_exp_f32 v219, v219
    v_mfma_f32_16x16x32_bf16 v[88:91], a[200:203], v[232:235], v[88:91]
    v_add_f32 v21, v21, v219
    v_cvt_pk_bf16_f32 v215, v218, v219
    v_mfma_f32_16x16x32_bf16 v[92:95], a[172:175], v[228:231], 0
    v_exp_f32 v220, v220
    v_mfma_f32_16x16x32_bf16 v[92:95], a[204:207], v[232:235], v[92:95]
    v_add_f32 v21, v21, v220
    v_add_u32 v252, s43, v1
    v_add_u32 v253, s43, v2
    v_add_u32 v254, s43, v3
    v_add_u32 v255, s43, v4
    s_waitcnt vmcnt(8)
    ds_read_b128 v[160:163], v252 offset:49152
    ds_read_b128 v[164:167], v253 offset:49152
    ds_read_b128 v[168:171], v254 offset:49152
    ds_read_b128 v[172:175], v255 offset:49152
    s_add_u32 m0, s29, 81920
    s_nop 0
    buffer_load_dwordx4 v17, s[16:19], s28 offen offset:0 nt lds
    buffer_load_dwordx4 v18, s[16:19], s28 offen offset:1024 nt lds
    buffer_load_dwordx4 v17, s[16:19], s28 offen offset:2048 nt lds
    buffer_load_dwordx4 v18, s[16:19], s28 offen offset:3072 nt lds
    s_add_u32 s28, s28, 16384
    s_waitcnt lgkmcnt(3)
    v_lshlrev_b32 v244, 16, v160
    v_lshlrev_b32 v246, 16, v161
    v_lshlrev_b32 v248, 16, v162
    v_lshlrev_b32 v250, 16, v163
    v_and_b32 v245, s37, v160
    v_and_b32 v247, s37, v161
    v_and_b32 v249, s37, v162
    v_and_b32 v251, s37, v163
    v_pk_mul_f32 v[244:245], v[244:245], s[34:35]
    v_pk_mul_f32 v[246:247], v[246:247], s[34:35]
    v_pk_mul_f32 v[248:249], v[248:249], s[34:35]
    v_pk_mul_f32 v[250:251], v[250:251], s[34:35]
    v_cvt_pk_bf16_f32 v244, v244, v245
    v_cvt_pk_bf16_f32 v246, v246, v247
    v_cvt_pk_bf16_f32 v248, v248, v249
    v_cvt_pk_bf16_f32 v250, v250, v251
    v_accvgpr_write_b32 a48, v244
    v_accvgpr_write_b32 a49, v246
    v_accvgpr_write_b32 a50, v248
    v_accvgpr_write_b32 a51, v250
    s_waitcnt lgkmcnt(2)
    v_lshlrev_b32 v244, 16, v164
    v_lshlrev_b32 v246, 16, v165
    v_lshlrev_b32 v248, 16, v166
    v_lshlrev_b32 v250, 16, v167
    v_and_b32 v245, s37, v164
    v_and_b32 v247, s37, v165
    v_and_b32 v249, s37, v166
    v_and_b32 v251, s37, v167
    v_pk_mul_f32 v[244:245], v[244:245], s[34:35]
    v_pk_mul_f32 v[246:247], v[246:247], s[34:35]
    v_pk_mul_f32 v[248:249], v[248:249], s[34:35]
    v_pk_mul_f32 v[250:251], v[250:251], s[34:35]
    v_cvt_pk_bf16_f32 v244, v244, v245
    v_cvt_pk_bf16_f32 v246, v246, v247
    v_cvt_pk_bf16_f32 v248, v248, v249
    v_cvt_pk_bf16_f32 v250, v250, v251
    v_accvgpr_write_b32 a52, v244
    v_accvgpr_write_b32 a53, v246
    v_accvgpr_write_b32 a54, v248
    v_accvgpr_write_b32 a55, v250
    s_waitcnt lgkmcnt(1)
    v_lshlrev_b32 v244, 16, v168
    v_lshlrev_b32 v246, 16, v169
    v_lshlrev_b32 v248, 16, v170
    v_lshlrev_b32 v250, 16, v171
    v_and_b32 v245, s37, v168
    v_and_b32 v247, s37, v169
    v_and_b32 v249, s37, v170
    v_and_b32 v251, s37, v171
    v_pk_mul_f32 v[244:245], v[244:245], s[34:35]
    v_pk_mul_f32 v[246:247], v[246:247], s[34:35]
    v_pk_mul_f32 v[248:249], v[248:249], s[34:35]
    v_pk_mul_f32 v[250:251], v[250:251], s[34:35]
    v_cvt_pk_bf16_f32 v244, v244, v245
    v_cvt_pk_bf16_f32 v246, v246, v247
    v_cvt_pk_bf16_f32 v248, v248, v249
    v_cvt_pk_bf16_f32 v250, v250, v251
    v_accvgpr_write_b32 a56, v244
    v_accvgpr_write_b32 a57, v246
    v_accvgpr_write_b32 a58, v248
    v_accvgpr_write_b32 a59, v250
    s_waitcnt lgkmcnt(0)
    v_lshlrev_b32 v244, 16, v172
    v_lshlrev_b32 v246, 16, v173
    v_lshlrev_b32 v248, 16, v174
    v_lshlrev_b32 v250, 16, v175
    v_and_b32 v245, s37, v172
    v_and_b32 v247, s37, v173
    v_and_b32 v249, s37, v174
    v_and_b32 v251, s37, v175
    v_pk_mul_f32 v[244:245], v[244:245], s[34:35]
    v_pk_mul_f32 v[246:247], v[246:247], s[34:35]
    v_pk_mul_f32 v[248:249], v[248:249], s[34:35]
    v_pk_mul_f32 v[250:251], v[250:251], s[34:35]
    v_cvt_pk_bf16_f32 v244, v244, v245
    v_cvt_pk_bf16_f32 v246, v246, v247
    v_cvt_pk_bf16_f32 v248, v248, v249
    v_cvt_pk_bf16_f32 v250, v250, v251
    v_accvgpr_write_b32 a60, v244
    v_accvgpr_write_b32 a61, v246
    v_accvgpr_write_b32 a62, v248
    v_accvgpr_write_b32 a63, v250
    v_mfma_f32_16x16x32_bf16 v[204:207], a[80:83], a[48:51], 0
    v_mfma_f32_16x16x32_bf16 v[204:207], a[84:87], a[52:55], v[204:207]
    v_mfma_f32_16x16x32_bf16 v[204:207], a[88:91], a[56:59], v[204:207]
    v_mfma_f32_16x16x32_bf16 v[204:207], a[92:95], a[60:63], v[204:207]
    s_nop 7
    v_max3_f32 v244, v204, v205, v206
    v_max_f32 v244, v244, v207
    v_mov_b32 v245, v244
    s_nop 1
    v_permlane16_swap_b32 v244, v245
    v_max_f32 v244, v244, v245
    v_mov_b32 v245, v244
    s_nop 1
    v_permlane32_swap_b32 v244, v245
    v_min_f32 v204, -v244, -v245
    v_min_f32 v205, -v244, -v245
    v_min_f32 v206, -v244, -v245
    v_min_f32 v207, -v244, -v245
    s_nop 1
    v_mfma_f32_16x16x32_bf16 v[228:231], a[80:83], a[48:51], v[204:207]
    v_exp_f32 v221, v221
    v_mfma_f32_16x16x32_bf16 v[228:231], a[84:87], a[52:55], v[228:231]
    v_add_f32 v21, v21, v221
    v_cvt_pk_bf16_f32 v216, v220, v221
    v_mfma_f32_16x16x32_bf16 v[228:231], a[88:91], a[56:59], v[228:231]
    v_exp_f32 v222, v222
    v_mfma_f32_16x16x32_bf16 v[228:231], a[92:95], a[60:63], v[228:231]
    v_add_f32 v21, v21, v222
    v_mfma_f32_16x16x32_bf16 v[232:235], a[96:99], a[48:51], v[204:207]
    v_exp_f32 v223, v223
    v_mfma_f32_16x16x32_bf16 v[232:235], a[100:103], a[52:55], v[232:235]
    v_add_f32 v21, v21, v223
    v_cvt_pk_bf16_f32 v217, v222, v223
    v_mfma_f32_16x16x32_bf16 v[232:235], a[104:107], a[56:59], v[232:235]
    v_exp_f32 v224, v224
    v_mfma_f32_16x16x32_bf16 v[232:235], a[108:111], a[60:63], v[232:235]
    v_add_f32 v21, v21, v224
    v_mfma_f32_16x16x32_bf16 v[236:239], a[112:115], a[48:51], v[204:207]
    v_exp_f32 v225, v225
    v_mfma_f32_16x16x32_bf16 v[236:239], a[116:119], a[52:55], v[236:239]
    v_add_f32 v21, v21, v225
    v_cvt_pk_bf16_f32 v218, v224, v225
    v_mfma_f32_16x16x32_bf16 v[236:239], a[120:123], a[56:59], v[236:239]
    v_exp_f32 v226, v226
    v_mfma_f32_16x16x32_bf16 v[236:239], a[124:127], a[60:63], v[236:239]
    v_add_f32 v21, v21, v226
    v_mfma_f32_16x16x32_bf16 v[240:243], a[128:131], a[48:51], v[204:207]
    v_exp_f32 v227, v227
    v_mfma_f32_16x16x32_bf16 v[240:243], a[132:135], a[52:55], v[240:243]
    v_add_f32 v21, v21, v227
    v_cvt_pk_bf16_f32 v219, v226, v227
    v_mfma_f32_16x16x32_bf16 v[240:243], a[136:139], a[56:59], v[240:243]
    v_exp_f32 v228, v228
    v_mfma_f32_16x16x32_bf16 v[240:243], a[140:143], a[60:63], v[240:243]
    v_mov_b32 v22, v228
    v_mfma_f32_16x16x32_bf16 v[96:99], a[144:147], v[212:215], 0
    v_exp_f32 v229, v229
    v_mfma_f32_16x16x32_bf16 v[96:99], a[176:179], v[216:219], v[96:99]
    v_add_f32 v22, v22, v229
    v_cvt_pk_bf16_f32 v228, v228, v229
    v_mfma_f32_16x16x32_bf16 v[100:103], a[148:151], v[212:215], 0
    v_exp_f32 v230, v230
    v_mfma_f32_16x16x32_bf16 v[100:103], a[180:183], v[216:219], v[100:103]
    v_add_f32 v22, v22, v230
    v_mfma_f32_16x16x32_bf16 v[104:107], a[152:155], v[212:215], 0
    v_exp_f32 v231, v231
    v_mfma_f32_16x16x32_bf16 v[104:107], a[184:187], v[216:219], v[104:107]
    v_add_f32 v22, v22, v231
    v_cvt_pk_bf16_f32 v229, v230, v231
    v_mfma_f32_16x16x32_bf16 v[108:111], a[156:159], v[212:215], 0
    v_exp_f32 v232, v232
    v_mfma_f32_16x16x32_bf16 v[108:111], a[188:191], v[216:219], v[108:111]
    v_add_f32 v22, v22, v232
    v_mfma_f32_16x16x32_bf16 v[112:115], a[160:163], v[212:215], 0
    v_exp_f32 v233, v233
    v_mfma_f32_16x16x32_bf16 v[112:115], a[192:195], v[216:219], v[112:115]
    v_add_f32 v22, v22, v233
    v_cvt_pk_bf16_f32 v230, v232, v233
    v_mfma_f32_16x16x32_bf16 v[116:119], a[164:167], v[212:215], 0
    v_exp_f32 v234, v234
    v_mfma_f32_16x16x32_bf16 v[116:119], a[196:199], v[216:219], v[116:119]
    v_add_f32 v22, v22, v234
    v_mfma_f32_16x16x32_bf16 v[120:123], a[168:171], v[212:215], 0
    v_exp_f32 v235, v235
    v_mfma_f32_16x16x32_bf16 v[120:123], a[200:203], v[216:219], v[120:123]
    v_add_f32 v22, v22, v235
    v_cvt_pk_bf16_f32 v231, v234, v235
    v_mfma_f32_16x16x32_bf16 v[124:127], a[172:175], v[212:215], 0
    v_exp_f32 v236, v236
    v_mfma_f32_16x16x32_bf16 v[124:127], a[204:207], v[216:219], v[124:127]
    v_add_f32 v22, v22, v236
    v_add_u32 v252, s99, v1
    v_add_u32 v253, s99, v2
    v_add_u32 v254, s99, v3
    v_add_u32 v255, s99, v4
    s_waitcnt vmcnt(8)
    ds_read_b128 v[160:163], v252 offset:0
    ds_read_b128 v[164:167], v253 offset:0
    ds_read_b128 v[168:171], v254 offset:0
    ds_read_b128 v[172:175], v255 offset:0
    s_and_b32 m0, s28, 0xffff
    s_nop 0
    buffer_load_dwordx4 v13, s[12:15], s28 offen offset:0 nt lds
    buffer_load_dwordx4 v14, s[12:15], s28 offen offset:1024 nt lds
    buffer_load_dwordx4 v15, s[12:15], s28 offen offset:2048 nt lds
    buffer_load_dwordx4 v16, s[12:15], s28 offen offset:3072 nt lds
    s_waitcnt lgkmcnt(3)
    v_lshlrev_b32 v244, 16, v160
    v_lshlrev_b32 v246, 16, v161
    v_lshlrev_b32 v248, 16, v162
    v_lshlrev_b32 v250, 16, v163
    v_and_b32 v245, s37, v160
    v_and_b32 v247, s37, v161
    v_and_b32 v249, s37, v162
    v_and_b32 v251, s37, v163
    v_pk_mul_f32 v[244:245], v[244:245], s[34:35]
    v_pk_mul_f32 v[246:247], v[246:247], s[34:35]
    v_pk_mul_f32 v[248:249], v[248:249], s[34:35]
    v_pk_mul_f32 v[250:251], v[250:251], s[34:35]
    v_cvt_pk_bf16_f32 v244, v244, v245
    v_cvt_pk_bf16_f32 v246, v246, v247
    v_cvt_pk_bf16_f32 v248, v248, v249
    v_cvt_pk_bf16_f32 v250, v250, v251
    v_accvgpr_write_b32 a64, v244
    v_accvgpr_write_b32 a65, v246
    v_accvgpr_write_b32 a66, v248
    v_accvgpr_write_b32 a67, v250
    s_waitcnt lgkmcnt(2)
    v_lshlrev_b32 v244, 16, v164
    v_lshlrev_b32 v246, 16, v165
    v_lshlrev_b32 v248, 16, v166
    v_lshlrev_b32 v250, 16, v167
    v_and_b32 v245, s37, v164
    v_and_b32 v247, s37, v165
    v_and_b32 v249, s37, v166
    v_and_b32 v251, s37, v167
    v_pk_mul_f32 v[244:245], v[244:245], s[34:35]
    v_pk_mul_f32 v[246:247], v[246:247], s[34:35]
    v_pk_mul_f32 v[248:249], v[248:249], s[34:35]
    v_pk_mul_f32 v[250:251], v[250:251], s[34:35]
    v_cvt_pk_bf16_f32 v244, v244, v245
    v_cvt_pk_bf16_f32 v246, v246, v247
    v_cvt_pk_bf16_f32 v248, v248, v249
    v_cvt_pk_bf16_f32 v250, v250, v251
    v_accvgpr_write_b32 a68, v244
    v_accvgpr_write_b32 a69, v246
    v_accvgpr_write_b32 a70, v248
    v_accvgpr_write_b32 a71, v250
    s_waitcnt lgkmcnt(1)
    v_lshlrev_b32 v244, 16, v168
    v_lshlrev_b32 v246, 16, v169
    v_lshlrev_b32 v248, 16, v170
    v_lshlrev_b32 v250, 16, v171
    v_and_b32 v245, s37, v168
    v_and_b32 v247, s37, v169
    v_and_b32 v249, s37, v170
    v_and_b32 v251, s37, v171
    v_pk_mul_f32 v[244:245], v[244:245], s[34:35]
    v_pk_mul_f32 v[246:247], v[246:247], s[34:35]
    v_pk_mul_f32 v[248:249], v[248:249], s[34:35]
    v_pk_mul_f32 v[250:251], v[250:251], s[34:35]
    v_cvt_pk_bf16_f32 v244, v244, v245
    v_cvt_pk_bf16_f32 v246, v246, v247
    v_cvt_pk_bf16_f32 v248, v248, v249
    v_cvt_pk_bf16_f32 v250, v250, v251
    v_accvgpr_write_b32 a72, v244
    v_accvgpr_write_b32 a73, v246
    v_accvgpr_write_b32 a74, v248
    v_accvgpr_write_b32 a75, v250
    s_waitcnt lgkmcnt(0)
    v_lshlrev_b32 v244, 16, v172
    v_lshlrev_b32 v246, 16, v173
    v_lshlrev_b32 v248, 16, v174
    v_lshlrev_b32 v250, 16, v175
    v_and_b32 v245, s37, v172
    v_and_b32 v247, s37, v173
    v_and_b32 v249, s37, v174
    v_and_b32 v251, s37, v175
    v_pk_mul_f32 v[244:245], v[244:245], s[34:35]
    v_pk_mul_f32 v[246:247], v[246:247], s[34:35]
    v_pk_mul_f32 v[248:249], v[248:249], s[34:35]
    v_pk_mul_f32 v[250:251], v[250:251], s[34:35]
    v_cvt_pk_bf16_f32 v244, v244, v245
    v_cvt_pk_bf16_f32 v246, v246, v247
    v_cvt_pk_bf16_f32 v248, v248, v249
    v_cvt_pk_bf16_f32 v250, v250, v251
    v_accvgpr_write_b32 a76, v244
    v_accvgpr_write_b32 a77, v246
    v_accvgpr_write_b32 a78, v248
    v_accvgpr_write_b32 a79, v250
    v_mfma_f32_16x16x32_bf16 v[208:211], a[80:83], a[64:67], 0
    v_mfma_f32_16x16x32_bf16 v[208:211], a[84:87], a[68:71], v[208:211]
    v_mfma_f32_16x16x32_bf16 v[208:211], a[88:91], a[72:75], v[208:211]
    v_mfma_f32_16x16x32_bf16 v[208:211], a[92:95], a[76:79], v[208:211]
    s_nop 7
    v_max3_f32 v244, v208, v209, v210
    v_max_f32 v244, v244, v211
    v_mov_b32 v245, v244
    s_nop 1
    v_permlane16_swap_b32 v244, v245
    v_max_f32 v244, v244, v245
    v_mov_b32 v245, v244
    s_nop 1
    v_permlane32_swap_b32 v244, v245
    v_min_f32 v208, -v244, -v245
    v_min_f32 v209, -v244, -v245
    v_min_f32 v210, -v244, -v245
    v_min_f32 v211, -v244, -v245
    s_cmp_lg_u32 s32, 3
    s_cbranch_scc1 L_nda
    v_mov_b32 v208, 0xf149f2ca
    v_mov_b32 v209, 0xf149f2ca
    v_mov_b32 v210, 0xf149f2ca
    v_mov_b32 v211, 0xf149f2ca
L_nda:
    s_nop 1
    v_mov_b64 v[160:161], 0
    v_mov_b64 v[162:163], 0
    v_mov_b64 v[164:165], 0
    v_mov_b64 v[166:167], 0
    v_mov_b64 v[168:169], 0
    v_mov_b64 v[170:171], 0
    v_mov_b64 v[172:173], 0
    v_mov_b64 v[174:175], 0
    v_mov_b64 v[176:177], 0
    v_mov_b64 v[178:179], 0
    v_mov_b64 v[180:181], 0
    v_mov_b64 v[182:183], 0
    v_mov_b64 v[184:185], 0
    v_mov_b64 v[186:187], 0
    v_mov_b64 v[188:189], 0
    v_mov_b64 v[190:191], 0
    v_mfma_f32_16x16x32_bf16 v[212:215], a[80:83], a[64:67], v[208:211]
    v_exp_f32 v237, v237
    v_mfma_f32_16x16x32_bf16 v[212:215], a[84:87], a[68:71], v[212:215]
    v_add_f32 v22, v22, v237
    v_cvt_pk_bf16_f32 v232, v236, v237
    v_mfma_f32_16x16x32_bf16 v[212:215], a[88:91], a[72:75], v[212:215]
    v_exp_f32 v238, v238
    v_mfma_f32_16x16x32_bf16 v[212:215], a[92:95], a[76:79], v[212:215]
    v_add_f32 v22, v22, v238
    v_mfma_f32_16x16x32_bf16 v[216:219], a[96:99], a[64:67], v[208:211]
    v_exp_f32 v239, v239
    v_mfma_f32_16x16x32_bf16 v[216:219], a[100:103], a[68:71], v[216:219]
    v_add_f32 v22, v22, v239
    v_cvt_pk_bf16_f32 v233, v238, v239
    v_mfma_f32_16x16x32_bf16 v[216:219], a[104:107], a[72:75], v[216:219]
    v_exp_f32 v240, v240
    v_mfma_f32_16x16x32_bf16 v[216:219], a[108:111], a[76:79], v[216:219]
    v_add_f32 v22, v22, v240
    v_mfma_f32_16x16x32_bf16 v[220:223], a[112:115], a[64:67], v[208:211]
    v_exp_f32 v241, v241
    v_mfma_f32_16x16x32_bf16 v[220:223], a[116:119], a[68:71], v[220:223]
    v_add_f32 v22, v22, v241
    v_cvt_pk_bf16_f32 v234, v240, v241
    v_mfma_f32_16x16x32_bf16 v[220:223], a[120:123], a[72:75], v[220:223]
    v_exp_f32 v242, v242
    v_mfma_f32_16x16x32_bf16 v[220:223], a[124:127], a[76:79], v[220:223]
    v_add_f32 v22, v22, v242
    v_mfma_f32_16x16x32_bf16 v[224:227], a[128:131], a[64:67], v[208:211]
    v_exp_f32 v243, v243
    v_mfma_f32_16x16x32_bf16 v[224:227], a[132:135], a[68:71], v[224:227]
    v_add_f32 v22, v22, v243
    v_cvt_pk_bf16_f32 v235, v242, v243
    v_mfma_f32_16x16x32_bf16 v[224:227], a[136:139], a[72:75], v[224:227]
    v_exp_f32 v212, v212
    v_mfma_f32_16x16x32_bf16 v[224:227], a[140:143], a[76:79], v[224:227]
    v_mov_b32 v23, v212
    s_waitcnt vmcnt(8)
    s_barrier
    v_mfma_f32_16x16x32_bf16 v[128:131], a[144:147], v[228:231], 0
    ds_read_b128 a[80:83], v1 offset:16384
    s_add_u32 m0, s29, 98304
    v_exp_f32 v213, v213
    v_mfma_f32_16x16x32_bf16 v[128:131], a[176:179], v[232:235], v[128:131]
    ds_read_b128 a[84:87], v2 offset:16384
    v_add_f32 v23, v23, v213
    v_cvt_pk_bf16_f32 v212, v212, v213
    v_mfma_f32_16x16x32_bf16 v[132:135], a[148:151], v[228:231], 0
    ds_read_b128 a[88:91], v3 offset:16384
    buffer_load_dwordx4 v17, s[16:19], s28 offen offset:0 nt lds
    v_exp_f32 v214, v214
    v_mfma_f32_16x16x32_bf16 v[132:135], a[180:183], v[232:235], v[132:135]
    ds_read_b128 a[92:95], v4 offset:16384
    v_add_f32 v23, v23, v214
    v_mfma_f32_16x16x32_bf16 v[136:139], a[152:155], v[228:231], 0
    ds_read_b128 a[96:99], v1 offset:20480
    v_exp_f32 v215, v215
    v_mfma_f32_16x16x32_bf16 v[136:139], a[184:187], v[232:235], v[136:139]
    ds_read_b128 a[100:103], v2 offset:20480
    v_add_f32 v23, v23, v215
    v_cvt_pk_bf16_f32 v213, v214, v215
    v_mfma_f32_16x16x32_bf16 v[140:143], a[156:159], v[228:231], 0
    ds_read_b128 a[104:107], v3 offset:20480
    buffer_load_dwordx4 v18, s[16:19], s28 offen offset:1024 nt lds
    v_exp_f32 v216, v216
    v_mfma_f32_16x16x32_bf16 v[140:143], a[188:191], v[232:235], v[140:143]
    ds_read_b128 a[108:111], v4 offset:20480
    v_add_f32 v23, v23, v216
    v_mfma_f32_16x16x32_bf16 v[144:147], a[160:163], v[228:231], 0
    ds_read_b128 a[112:115], v1 offset:24576
    v_exp_f32 v217, v217
    v_mfma_f32_16x16x32_bf16 v[144:147], a[192:195], v[232:235], v[144:147]
    ds_read_b128 a[116:119], v2 offset:24576
    v_add_f32 v23, v23, v217
    v_cvt_pk_bf16_f32 v214, v216, v217
    v_mfma_f32_16x16x32_bf16 v[148:151], a[164:167], v[228:231], 0
    ds_read_b128 a[120:123], v3 offset:24576
    buffer_load_dwordx4 v17, s[16:19], s28 offen offset:2048 nt lds
    v_exp_f32 v218, v218
    v_mfma_f32_16x16x32_bf16 v[148:151], a[196:199], v[232:235], v[148:151]
    ds_read_b128 a[124:127], v4 offset:24576
    v_add_f32 v23, v23, v218
    v_mfma_f32_16x16x32_bf16 v[152:155], a[168:171], v[228:231], 0
    ds_read_b128 a[128:131], v1 offset:28672
    v_exp_f32 v219, v219
    v_mfma_f32_16x16x32_bf16 v[152:155], a[200:203], v[232:235], v[152:155]
    ds_read_b128 a[132:135], v2 offset:28672
    v_add_f32 v23, v23, v219
    v_cvt_pk_bf16_f32 v215, v218, v219
    v_mfma_f32_16x16x32_bf16 v[156:159], a[172:175], v[228:231], 0
    ds_read_b128 a[136:139], v3 offset:28672
    buffer_load_dwordx4 v18, s[16:19], s28 offen offset:3072 nt lds
    s_add_u32 s28, s28, 16384
    v_exp_f32 v220, v220
    v_mfma_f32_16x16x32_bf16 v[156:159], a[204:207], v[232:235], v[156:159]
    ds_read_b128 a[140:143], v4 offset:28672
    v_add_f32 v23, v23, v220
    s_add_u32 s20, s4, s41
    s_addc_u32 s21, s5, 0
    s_and_b32 s21, s21, 0xffff
    s_mov_b32 s22, 77824
    s_waitcnt vmcnt(8)
    s_barrier
    s_branch L_b1
.p2align 6
L_qa3:
    s_waitcnt lgkmcnt(4)
    v_mfma_f32_16x16x32_bf16 v[212:215], a[80:83], a[0:3], v[192:195]
    v_exp_f32 v237, v237
    v_mfma_f32_16x16x32_bf16 v[212:215], a[84:87], a[4:7], v[212:215]
    v_add_f32 v23, v23, v237
    v_cvt_pk_bf16_f32 v232, v236, v237
    v_mfma_f32_16x16x32_bf16 v[212:215], a[88:91], a[8:11], v[212:215]
    s_add_u32 m0, s99, 0
    s_add_u32 s42, s100, 8192
    v_exp_f32 v238, v238
    v_mfma_f32_16x16x32_bf16 v[212:215], a[92:95], a[12:15], v[212:215]
    buffer_load_dwordx4 v16, s[20:23], s42 offen offset:3072 nt lds
    v_add_f32 v23, v23, v238
    v_mfma_f32_16x16x32_bf16 v[216:219], a[96:99], a[0:3], v[192:195]
    v_exp_f32 v239, v239
    v_mfma_f32_16x16x32_bf16 v[216:219], a[100:103], a[4:7], v[216:219]
    v_add_f32 v23, v23, v239
    v_cvt_pk_bf16_f32 v233, v238, v239
    v_mfma_f32_16x16x32_bf16 v[216:219], a[104:107], a[8:11], v[216:219]
    v_exp_f32 v240, v240
    v_mfma_f32_16x16x32_bf16 v[216:219], a[108:111], a[12:15], v[216:219]
    v_add_f32 v23, v23, v240
    v_mfma_f32_16x16x32_bf16 v[220:223], a[112:115], a[0:3], v[192:195]
    s_add_u32 m0, s99, 4096
    s_add_u32 s42, s100, 12288
    v_exp_f32 v241, v241
    v_mfma_f32_16x16x32_bf16 v[220:223], a[116:119], a[4:7], v[220:223]
    buffer_load_dwordx4 v13, s[20:23], s42 offen offset:0 nt lds
    v_add_f32 v23, v23, v241
    v_cvt_pk_bf16_f32 v234, v240, v241
    v_mfma_f32_16x16x32_bf16 v[220:223], a[120:123], a[8:11], v[220:223]
    v_exp_f32 v242, v242
    v_mfma_f32_16x16x32_bf16 v[220:223], a[124:127], a[12:15], v[220:223]
    v_add_f32 v23, v23, v242
    s_waitcnt lgkmcnt(0)
    v_mfma_f32_16x16x32_bf16 v[224:227], a[128:131], a[0:3], v[192:195]
    v_exp_f32 v243, v243
    v_mfma_f32_16x16x32_bf16 v[224:227], a[132:135], a[4:7], v[224:227]
    v_add_f32 v23, v23, v243
    v_cvt_pk_bf16_f32 v235, v242, v243
    v_mfma_f32_16x16x32_bf16 v[224:227], a[136:139], a[8:11], v[224:227]
    v_exp_f32 v212, v212
    v_mfma_f32_16x16x32_bf16 v[224:227], a[140:143], a[12:15], v[224:227]
    buffer_load_dwordx4 v14, s[20:23], s42 offen offset:1024 nt lds
    v_add_f32 v19, v19, v212
    s_branch L_b0g1
L_qa2:
    s_waitcnt lgkmcnt(4)
    v_mfma_f32_16x16x32_bf16 v[212:215], a[80:83], a[0:3], v[192:195]
    v_exp_f32 v237, v237
    v_add_u32 v244, s99, v1
    v_add_u32 v245, s99, v2
    v_mfma_f32_16x16x32_bf16 v[212:215], a[84:87], a[4:7], v[212:215]
    v_add_f32 v23, v23, v237
    v_cvt_pk_bf16_f32 v232, v236, v237
    v_add_u32 v246, s99, v3
    v_add_u32 v247, s99, v4
    v_mfma_f32_16x16x32_bf16 v[212:215], a[88:91], a[8:11], v[212:215]
    ds_read_b128 a[224:227], v244 offset:4096
    ds_read_b128 a[228:231], v245 offset:4096
    s_add_u32 m0, s99, 0
    s_add_u32 s42, s100, 16384
    v_exp_f32 v238, v238
    v_mfma_f32_16x16x32_bf16 v[212:215], a[92:95], a[12:15], v[212:215]
    buffer_load_dwordx4 v14, s[20:23], s42 offen offset:1024 nt lds
    v_add_f32 v23, v23, v238
    v_mfma_f32_16x16x32_bf16 v[216:219], a[96:99], a[0:3], v[192:195]
    ds_read_b128 a[232:235], v246 offset:4096
    v_exp_f32 v239, v239
    v_mfma_f32_16x16x32_bf16 v[216:219], a[100:103], a[4:7], v[216:219]
    ds_read_b128 a[236:239], v247 offset:4096
    v_add_f32 v23, v23, v239
    v_cvt_pk_bf16_f32 v233, v238, v239
    v_mfma_f32_16x16x32_bf16 v[216:219], a[104:107], a[8:11], v[216:219]
    v_exp_f32 v240, v240
    v_mfma_f32_16x16x32_bf16 v[216:219], a[108:111], a[12:15], v[216:219]
    v_add_f32 v23, v23, v240
    v_mfma_f32_16x16x32_bf16 v[220:223], a[112:115], a[0:3], v[192:195]
    v_exp_f32 v241, v241
    v_mfma_f32_16x16x32_bf16 v[220:223], a[116:119], a[4:7], v[220:223]
    buffer_load_dwordx4 v15, s[20:23], s42 offen offset:2048 nt lds
    v_add_f32 v23, v23, v241
    v_cvt_pk_bf16_f32 v234, v240, v241
    v_mfma_f32_16x16x32_bf16 v[220:223], a[120:123], a[8:11], v[220:223]
    v_exp_f32 v242, v242
    v_mfma_f32_16x16x32_bf16 v[220:223], a[124:127], a[12:15], v[220:223]
    v_add_f32 v23, v23, v242
    s_waitcnt lgkmcnt(2)
    v_mfma_f32_16x16x32_bf16 v[224:227], a[128:131], a[0:3], v[192:195]
    v_exp_f32 v243, v243
    v_mfma_f32_16x16x32_bf16 v[224:227], a[132:135], a[4:7], v[224:227]
    v_add_f32 v23, v23, v243
    v_cvt_pk_bf16_f32 v235, v242, v243
    v_accvgpr_read_b32 v245, a224
    v_accvgpr_read_b32 v247, a225
    v_accvgpr_read_b32 v249, a226
    v_accvgpr_read_b32 v251, a227
    v_lshlrev_b32 v244, 16, v245
    v_lshlrev_b32 v246, 16, v247
    v_lshlrev_b32 v248, 16, v249
    v_lshlrev_b32 v250, 16, v251
    v_and_b32 v245, s37, v245
    v_and_b32 v247, s37, v247
    v_and_b32 v249, s37, v249
    v_and_b32 v251, s37, v251
    v_pk_mul_f32 v[244:245], v[244:245], s[34:35]
    v_pk_mul_f32 v[246:247], v[246:247], s[34:35]
    v_pk_mul_f32 v[248:249], v[248:249], s[34:35]
    v_pk_mul_f32 v[250:251], v[250:251], s[34:35]
    v_cvt_pk_bf16_f32 v244, v244, v245
    v_cvt_pk_bf16_f32 v246, v246, v247
    v_cvt_pk_bf16_f32 v248, v248, v249
    v_cvt_pk_bf16_f32 v250, v250, v251
    v_accvgpr_write_b32 a224, v244
    v_accvgpr_write_b32 a225, v246
    v_accvgpr_write_b32 a226, v248
    v_accvgpr_write_b32 a227, v250
    v_accvgpr_read_b32 v245, a228
    v_accvgpr_read_b32 v247, a229
    v_accvgpr_read_b32 v249, a230
    v_accvgpr_read_b32 v251, a231
    v_lshlrev_b32 v244, 16, v245
    v_lshlrev_b32 v246, 16, v247
    v_lshlrev_b32 v248, 16, v249
    v_lshlrev_b32 v250, 16, v251
    v_and_b32 v245, s37, v245
    v_and_b32 v247, s37, v247
    v_and_b32 v249, s37, v249
    v_and_b32 v251, s37, v251
    v_pk_mul_f32 v[244:245], v[244:245], s[34:35]
    v_pk_mul_f32 v[246:247], v[246:247], s[34:35]
    v_pk_mul_f32 v[248:249], v[248:249], s[34:35]
    v_pk_mul_f32 v[250:251], v[250:251], s[34:35]
    v_cvt_pk_bf16_f32 v244, v244, v245
    v_cvt_pk_bf16_f32 v246, v246, v247
    v_cvt_pk_bf16_f32 v248, v248, v249
    v_cvt_pk_bf16_f32 v250, v250, v251
    v_accvgpr_write_b32 a228, v244
    v_accvgpr_write_b32 a229, v246
    v_accvgpr_write_b32 a230, v248
    v_accvgpr_write_b32 a231, v250
    s_waitcnt lgkmcnt(0)
    v_accvgpr_read_b32 v245, a232
    v_accvgpr_read_b32 v247, a233
    v_accvgpr_read_b32 v249, a234
    v_accvgpr_read_b32 v251, a235
    v_lshlrev_b32 v244, 16, v245
    v_lshlrev_b32 v246, 16, v247
    v_lshlrev_b32 v248, 16, v249
    v_lshlrev_b32 v250, 16, v251
    v_and_b32 v245, s37, v245
    v_and_b32 v247, s37, v247
    v_and_b32 v249, s37, v249
    v_and_b32 v251, s37, v251
    v_pk_mul_f32 v[244:245], v[244:245], s[34:35]
    v_pk_mul_f32 v[246:247], v[246:247], s[34:35]
    v_pk_mul_f32 v[248:249], v[248:249], s[34:35]
    v_pk_mul_f32 v[250:251], v[250:251], s[34:35]
    v_cvt_pk_bf16_f32 v244, v244, v245
    v_cvt_pk_bf16_f32 v246, v246, v247
    v_cvt_pk_bf16_f32 v248, v248, v249
    v_cvt_pk_bf16_f32 v250, v250, v251
    v_accvgpr_write_b32 a232, v244
    v_accvgpr_write_b32 a233, v246
    v_accvgpr_write_b32 a234, v248
    v_accvgpr_write_b32 a235, v250
    v_accvgpr_read_b32 v245, a236
    v_accvgpr_read_b32 v247, a237
    v_accvgpr_read_b32 v249, a238
    v_accvgpr_read_b32 v251, a239
    v_lshlrev_b32 v244, 16, v245
    v_lshlrev_b32 v246, 16, v247
    v_lshlrev_b32 v248, 16, v249
    v_lshlrev_b32 v250, 16, v251
    v_and_b32 v245, s37, v245
    v_and_b32 v247, s37, v247
    v_and_b32 v249, s37, v249
    v_and_b32 v251, s37, v251
    v_pk_mul_f32 v[244:245], v[244:245], s[34:35]
    v_pk_mul_f32 v[246:247], v[246:247], s[34:35]
    v_pk_mul_f32 v[248:249], v[248:249], s[34:35]
    v_pk_mul_f32 v[250:251], v[250:251], s[34:35]
    v_cvt_pk_bf16_f32 v244, v244, v245
    v_cvt_pk_bf16_f32 v246, v246, v247
    v_cvt_pk_bf16_f32 v248, v248, v249
    v_cvt_pk_bf16_f32 v250, v250, v251
    v_accvgpr_write_b32 a236, v244
    v_accvgpr_write_b32 a237, v246
    v_accvgpr_write_b32 a238, v248
    v_accvgpr_write_b32 a239, v250
    v_mfma_f32_16x16x32_bf16 v[224:227], a[136:139], a[8:11], v[224:227]
    v_exp_f32 v212, v212
    v_mfma_f32_16x16x32_bf16 v[224:227], a[140:143], a[12:15], v[224:227]
    buffer_load_dwordx4 v16, s[20:23], s42 offen offset:3072 nt lds
    v_add_f32 v19, v19, v212
    s_branch L_b0g1
L_qb3:
    s_waitcnt lgkmcnt(4)
    v_mfma_f32_16x16x32_bf16 v[212:215], a[80:83], a[0:3], v[192:195]
    v_exp_f32 v237, v237
    v_mfma_f32_16x16x32_bf16 v[212:215], a[84:87], a[4:7], v[212:215]
    v_add_f32 v23, v23, v237
    v_cvt_pk_bf16_f32 v232, v236, v237
    v_mfma_f32_16x16x32_bf16 v[212:215], a[88:91], a[8:11], v[212:215]
    s_add_u32 s101, s100, 12288
    v_exp_f32 v238, v238
    v_mfma_f32_16x16x32_bf16 v[212:215], a[92:95], a[12:15], v[212:215]
    buffer_store_dwordx4 a[224:227], v26, s[24:27], s101 offen offset:0 sc1
    v_add_f32 v23, v23, v238
    v_mfma_f32_16x16x32_bf16 v[216:219], a[96:99], a[0:3], v[192:195]
    v_exp_f32 v239, v239
    v_mfma_f32_16x16x32_bf16 v[216:219], a[100:103], a[4:7], v[216:219]
    v_add_f32 v23, v23, v239
    v_cvt_pk_bf16_f32 v233, v238, v239
    v_mfma_f32_16x16x32_bf16 v[216:219], a[104:107], a[8:11], v[216:219]
    v_exp_f32 v240, v240
    v_mfma_f32_16x16x32_bf16 v[216:219], a[108:111], a[12:15], v[216:219]
    v_add_f32 v23, v23, v240
    v_mfma_f32_16x16x32_bf16 v[220:223], a[112:115], a[0:3], v[192:195]
    v_exp_f32 v241, v241
    v_mfma_f32_16x16x32_bf16 v[220:223], a[116:119], a[4:7], v[220:223]
    buffer_store_dwordx4 a[228:231], v26, s[24:27], s101 offen offset:1024 sc1
    v_add_f32 v23, v23, v241
    v_cvt_pk_bf16_f32 v234, v240, v241
    v_mfma_f32_16x16x32_bf16 v[220:223], a[120:123], a[8:11], v[220:223]
    v_exp_f32 v242, v242
    v_mfma_f32_16x16x32_bf16 v[220:223], a[124:127], a[12:15], v[220:223]
    v_add_f32 v23, v23, v242
    s_waitcnt lgkmcnt(0)
    v_mfma_f32_16x16x32_bf16 v[224:227], a[128:131], a[0:3], v[192:195]
    v_exp_f32 v243, v243
    v_mfma_f32_16x16x32_bf16 v[224:227], a[132:135], a[4:7], v[224:227]
    v_add_f32 v23, v23, v243
    v_cvt_pk_bf16_f32 v235, v242, v243
    v_mfma_f32_16x16x32_bf16 v[224:227], a[136:139], a[8:11], v[224:227]
    v_exp_f32 v212, v212
    v_mfma_f32_16x16x32_bf16 v[224:227], a[140:143], a[12:15], v[224:227]
    v_add_f32 v19, v19, v212
    s_branch L_b0g1
L_qb2:
    s_waitcnt lgkmcnt(4)
    v_mfma_f32_16x16x32_bf16 v[212:215], a[80:83], a[0:3], v[192:195]
    v_exp_f32 v237, v237
    v_mfma_f32_16x16x32_bf16 v[212:215], a[84:87], a[4:7], v[212:215]
    v_add_f32 v23, v23, v237
    v_cvt_pk_bf16_f32 v232, v236, v237
    v_mfma_f32_16x16x32_bf16 v[212:215], a[88:91], a[8:11], v[212:215]
    s_add_u32 s101, s100, 12288
    v_exp_f32 v238, v238
    v_mfma_f32_16x16x32_bf16 v[212:215], a[92:95], a[12:15], v[212:215]
    buffer_store_dwordx4 a[232:235], v26, s[24:27], s101 offen offset:2048 sc1
    v_add_f32 v23, v23, v238
    v_mfma_f32_16x16x32_bf16 v[216:219], a[96:99], a[0:3], v[192:195]
    v_exp_f32 v239, v239
    v_mfma_f32_16x16x32_bf16 v[216:219], a[100:103], a[4:7], v[216:219]
    v_add_f32 v23, v23, v239
    v_cvt_pk_bf16_f32 v233, v238, v239
    v_mfma_f32_16x16x32_bf16 v[216:219], a[104:107], a[8:11], v[216:219]
    v_exp_f32 v240, v240
    v_mfma_f32_16x16x32_bf16 v[216:219], a[108:111], a[12:15], v[216:219]
    v_add_f32 v23, v23, v240
    v_mfma_f32_16x16x32_bf16 v[220:223], a[112:115], a[0:3], v[192:195]
    v_exp_f32 v241, v241
    v_mfma_f32_16x16x32_bf16 v[220:223], a[116:119], a[4:7], v[220:223]
    buffer_store_dwordx4 a[236:239], v26, s[24:27], s101 offen offset:3072 sc1
    v_add_f32 v23, v23, v241
    v_cvt_pk_bf16_f32 v234, v240, v241
    v_mfma_f32_16x16x32_bf16 v[220:223], a[120:123], a[8:11], v[220:223]
    v_exp_f32 v242, v242
    v_mfma_f32_16x16x32_bf16 v[220:223], a[124:127], a[12:15], v[220:223]
    v_add_f32 v23, v23, v242
    s_waitcnt lgkmcnt(0)
    v_mfma_f32_16x16x32_bf16 v[224:227], a[128:131], a[0:3], v[192:195]
    v_exp_f32 v243, v243
    v_mfma_f32_16x16x32_bf16 v[224:227], a[132:135], a[4:7], v[224:227]
    v_add_f32 v23, v23, v243
    v_cvt_pk_bf16_f32 v235, v242, v243
    v_mfma_f32_16x16x32_bf16 v[224:227], a[136:139], a[8:11], v[224:227]
    s_add_u32 s101, s100, 16384
    v_exp_f32 v212, v212
    v_mfma_f32_16x16x32_bf16 v[224:227], a[140:143], a[12:15], v[224:227]
    buffer_store_dwordx4 a[240:243], v26, s[24:27], s101 offen offset:0 sc1
    v_add_f32 v19, v19, v212
    s_branch L_b0g1
L_qb1:
    s_waitcnt lgkmcnt(4)
    v_mfma_f32_16x16x32_bf16 v[212:215], a[80:83], a[0:3], v[192:195]
    v_exp_f32 v237, v237
    v_mfma_f32_16x16x32_bf16 v[212:215], a[84:87], a[4:7], v[212:215]
    v_add_f32 v23, v23, v237
    v_cvt_pk_bf16_f32 v232, v236, v237
    v_mfma_f32_16x16x32_bf16 v[212:215], a[88:91], a[8:11], v[212:215]
    s_add_u32 s101, s100, 16384
    v_exp_f32 v238, v238
    v_mfma_f32_16x16x32_bf16 v[212:215], a[92:95], a[12:15], v[212:215]
    buffer_store_dwordx4 a[244:247], v26, s[24:27], s101 offen offset:1024 sc1
    v_add_f32 v23, v23, v238
    v_mfma_f32_16x16x32_bf16 v[216:219], a[96:99], a[0:3], v[192:195]
    v_exp_f32 v239, v239
    v_mfma_f32_16x16x32_bf16 v[216:219], a[100:103], a[4:7], v[216:219]
    v_add_f32 v23, v23, v239
    v_cvt_pk_bf16_f32 v233, v238, v239
    v_mfma_f32_16x16x32_bf16 v[216:219], a[104:107], a[8:11], v[216:219]
    v_exp_f32 v240, v240
    v_mfma_f32_16x16x32_bf16 v[216:219], a[108:111], a[12:15], v[216:219]
    v_add_f32 v23, v23, v240
    v_mfma_f32_16x16x32_bf16 v[220:223], a[112:115], a[0:3], v[192:195]
    v_exp_f32 v241, v241
    v_mfma_f32_16x16x32_bf16 v[220:223], a[116:119], a[4:7], v[220:223]
    buffer_store_dwordx4 a[248:251], v26, s[24:27], s101 offen offset:2048 sc1
    v_add_f32 v23, v23, v241
    v_cvt_pk_bf16_f32 v234, v240, v241
    v_mfma_f32_16x16x32_bf16 v[220:223], a[120:123], a[8:11], v[220:223]
    v_exp_f32 v242, v242
    v_mfma_f32_16x16x32_bf16 v[220:223], a[124:127], a[12:15], v[220:223]
    v_add_f32 v23, v23, v242
    s_waitcnt lgkmcnt(0)
    v_mfma_f32_16x16x32_bf16 v[224:227], a[128:131], a[0:3], v[192:195]
    v_exp_f32 v243, v243
    v_mfma_f32_16x16x32_bf16 v[224:227], a[132:135], a[4:7], v[224:227]
    v_add_f32 v23, v23, v243
    v_cvt_pk_bf16_f32 v235, v242, v243
    v_mfma_f32_16x16x32_bf16 v[224:227], a[136:139], a[8:11], v[224:227]
    v_exp_f32 v212, v212
    v_mfma_f32_16x16x32_bf16 v[224:227], a[140:143], a[12:15], v[224:227]
    buffer_store_dwordx4 a[252:255], v26, s[24:27], s101 offen offset:3072 sc1
    v_add_f32 v19, v19, v212
    s_branch L_b0g1
L_qa1:
    s_waitcnt lgkmcnt(4)
    v_mfma_f32_16x16x32_bf16 v[212:215], a[80:83], a[0:3], v[192:195]
    v_exp_f32 v237, v237
    v_mfma_f32_16x16x32_bf16 v[212:215], a[84:87], a[4:7], v[212:215]
    v_add_f32 v23, v23, v237
    v_cvt_pk_bf16_f32 v232, v236, v237
    v_mfma_f32_16x16x32_bf16 v[212:215], a[88:91], a[8:11], v[212:215]
    s_add_u32 m0, s99, 4096
    s_add_u32 s42, s100, 0
    v_exp_f32 v238, v238
    v_mfma_f32_16x16x32_bf16 v[212:215], a[92:95], a[12:15], v[212:215]
    buffer_load_dwordx4 v16, s[20:23], s42 offen offset:3072 nt lds
    v_add_f32 v23, v23, v238
    v_mfma_f32_16x16x32_bf16 v[216:219], a[96:99], a[0:3], v[192:195]
    v_exp_f32 v239, v239
    v_mfma_f32_16x16x32_bf16 v[216:219], a[100:103], a[4:7], v[216:219]
    v_add_f32 v23, v23, v239
    v_cvt_pk_bf16_f32 v233, v238, v239
    v_mfma_f32_16x16x32_bf16 v[216:219], a[104:107], a[8:11], v[216:219]
    v_exp_f32 v240, v240
    v_mfma_f32_16x16x32_bf16 v[216:219], a[108:111], a[12:15], v[216:219]
    v_add_f32 v23, v23, v240
    v_mfma_f32_16x16x32_bf16 v[220:223], a[112:115], a[0:3], v[192:195]
    s_add_u32 m0, s99, 0
    s_add_u32 s42, s100, 4096
    v_exp_f32 v241, v241
    v_mfma_f32_16x16x32_bf16 v[220:223], a[116:119], a[4:7], v[220:223]
    buffer_load_dwordx4 v13, s[20:23], s42 offen offset:0 nt lds
    v_add_f32 v23, v23, v241
    v_cvt_pk_bf16_f32 v234, v240, v241
    v_mfma_f32_16x16x32_bf16 v[220:223], a[120:123], a[8:11], v[220:223]
    v_exp_f32 v242, v242
    v_mfma_f32_16x16x32_bf16 v[220:223], a[124:127], a[12:15], v[220:223]
    v_add_f32 v23, v23, v242
    s_waitcnt lgkmcnt(0)
    v_mfma_f32_16x16x32_bf16 v[224:227], a[128:131], a[0:3], v[192:195]
    v_exp_f32 v243, v243
    v_mfma_f32_16x16x32_bf16 v[224:227], a[132:135], a[4:7], v[224:227]
    v_add_f32 v23, v23, v243
    v_cvt_pk_bf16_f32 v235, v242, v243
    v_mfma_f32_16x16x32_bf16 v[224:227], a[136:139], a[8:11], v[224:227]
    v_exp_f32 v212, v212
    v_mfma_f32_16x16x32_bf16 v[224:227], a[140:143], a[12:15], v[224:227]
    buffer_load_dwordx4 v14, s[20:23], s42 offen offset:1024 nt lds
    v_add_f32 v19, v19, v212
L_b0g1:
    v_mfma_f32_16x16x32_bf16 v[160:163], a[144:147], v[228:231], v[160:163]
    v_exp_f32 v213, v213
    v_mfma_f32_16x16x32_bf16 v[160:163], a[176:179], v[232:235], v[160:163]
    ds_read_b64_tr_b16 a[144:145], v5 offset:0
    ds_read_b64_tr_b16 a[146:147], v5 offset:4096
    v_add_f32 v19, v19, v213
    v_cvt_pk_bf16_f32 v212, v212, v213
    v_mfma_f32_16x16x32_bf16 v[164:167], a[148:151], v[228:231], v[164:167]
    v_exp_f32 v214, v214
    v_mfma_f32_16x16x32_bf16 v[164:167], a[180:183], v[232:235], v[164:167]
    ds_read_b64_tr_b16 a[176:177], v5 offset:8192
    ds_read_b64_tr_b16 a[178:179], v5 offset:12288
    v_add_f32 v19, v19, v214
    v_mfma_f32_16x16x32_bf16 v[168:171], a[152:155], v[228:231], v[168:171]
    v_exp_f32 v215, v215
    v_mfma_f32_16x16x32_bf16 v[168:171], a[184:187], v[232:235], v[168:171]
    ds_read_b64_tr_b16 a[148:149], v6 offset:0
    ds_read_b64_tr_b16 a[150:151], v6 offset:4096
    v_add_f32 v19, v19, v215
    v_cvt_pk_bf16_f32 v213, v214, v215
    v_mfma_f32_16x16x32_bf16 v[172:175], a[156:159], v[228:231], v[172:175]
    v_exp_f32 v216, v216
    v_mfma_f32_16x16x32_bf16 v[172:175], a[188:191], v[232:235], v[172:175]
    ds_read_b64_tr_b16 a[180:181], v6 offset:8192
    ds_read_b64_tr_b16 a[182:183], v6 offset:12288
    v_add_f32 v19, v19, v216
    v_mfma_f32_16x16x32_bf16 v[176:179], a[160:163], v[228:231], v[176:179]
    v_exp_f32 v217, v217
    v_mfma_f32_16x16x32_bf16 v[176:179], a[192:195], v[232:235], v[176:179]
    ds_read_b64_tr_b16 a[152:153], v7 offset:0
    ds_read_b64_tr_b16 a[154:155], v7 offset:4096
    v_add_f32 v19, v19, v217
    v_cvt_pk_bf16_f32 v214, v216, v217
    v_mfma_f32_16x16x32_bf16 v[180:183], a[164:167], v[228:231], v[180:183]
    v_exp_f32 v218, v218
    v_mfma_f32_16x16x32_bf16 v[180:183], a[196:199], v[232:235], v[180:183]
    ds_read_b64_tr_b16 a[184:185], v7 offset:8192
    ds_read_b64_tr_b16 a[186:187], v7 offset:12288
    v_add_f32 v19, v19, v218
    v_mfma_f32_16x16x32_bf16 v[184:187], a[168:171], v[228:231], v[184:187]
    v_exp_f32 v219, v219
    v_mfma_f32_16x16x32_bf16 v[184:187], a[200:203], v[232:235], v[184:187]
    ds_read_b64_tr_b16 a[156:157], v8 offset:0
    ds_read_b64_tr_b16 a[158:159], v8 offset:4096
    v_add_f32 v19, v19, v219
    v_cvt_pk_bf16_f32 v215, v218, v219
    v_mfma_f32_16x16x32_bf16 v[188:191], a[172:175], v[228:231], v[188:191]
    v_exp_f32 v220, v220
    v_mfma_f32_16x16x32_bf16 v[188:191], a[204:207], v[232:235], v[188:191]
    ds_read_b64_tr_b16 a[188:189], v8 offset:8192
    ds_read_b64_tr_b16 a[190:191], v8 offset:12288
    v_add_f32 v19, v19, v220
    v_mfma_f32_16x16x32_bf16 v[228:231], a[80:83], a[16:19], v[196:199]
    v_exp_f32 v221, v221
    v_mfma_f32_16x16x32_bf16 v[228:231], a[84:87], a[20:23], v[228:231]
    ds_read_b64_tr_b16 a[160:161], v9 offset:0
    ds_read_b64_tr_b16 a[162:163], v9 offset:4096
    v_add_f32 v19, v19, v221
    v_cvt_pk_bf16_f32 v216, v220, v221
    v_mfma_f32_16x16x32_bf16 v[228:231], a[88:91], a[24:27], v[228:231]
    v_exp_f32 v222, v222
    v_mfma_f32_16x16x32_bf16 v[228:231], a[92:95], a[28:31], v[228:231]
    ds_read_b64_tr_b16 a[192:193], v9 offset:8192
    ds_read_b64_tr_b16 a[194:195], v9 offset:12288
    v_add_f32 v19, v19, v222
    v_mfma_f32_16x16x32_bf16 v[232:235], a[96:99], a[16:19], v[196:199]
    v_exp_f32 v223, v223
    v_mfma_f32_16x16x32_bf16 v[232:235], a[100:103], a[20:23], v[232:235]
    ds_read_b64_tr_b16 a[164:165], v10 offset:0
    ds_read_b64_tr_b16 a[166:167], v10 offset:4096
    v_add_f32 v19, v19, v223
    v_cvt_pk_bf16_f32 v217, v222, v223
    v_mfma_f32_16x16x32_bf16 v[232:235], a[104:107], a[24:27], v[232:235]
    v_exp_f32 v224, v224
    v_mfma_f32_16x16x32_bf16 v[232:235], a[108:111], a[28:31], v[232:235]
    ds_read_b64_tr_b16 a[196:197], v10 offset:8192
    ds_read_b64_tr_b16 a[198:199], v10 offset:12288
    v_add_f32 v19, v19, v224
    v_mfma_f32_16x16x32_bf16 v[236:239], a[112:115], a[16:19], v[196:199]
    v_exp_f32 v225, v225
    v_mfma_f32_16x16x32_bf16 v[236:239], a[116:119], a[20:23], v[236:239]
    ds_read_b64_tr_b16 a[168:169], v11 offset:0
    ds_read_b64_tr_b16 a[170:171], v11 offset:4096
    v_add_f32 v19, v19, v225
    v_cvt_pk_bf16_f32 v218, v224, v225
    v_mfma_f32_16x16x32_bf16 v[236:239], a[120:123], a[24:27], v[236:239]
    v_exp_f32 v226, v226
    v_mfma_f32_16x16x32_bf16 v[236:239], a[124:127], a[28:31], v[236:239]
    ds_read_b64_tr_b16 a[200:201], v11 offset:8192
    ds_read_b64_tr_b16 a[202:203], v11 offset:12288
    v_add_f32 v19, v19, v226
    v_mfma_f32_16x16x32_bf16 v[240:243], a[128:131], a[16:19], v[196:199]
    v_exp_f32 v227, v227
    v_mfma_f32_16x16x32_bf16 v[240:243], a[132:135], a[20:23], v[240:243]
    ds_read_b64_tr_b16 a[172:173], v12 offset:0
    ds_read_b64_tr_b16 a[174:175], v12 offset:4096
    v_add_f32 v19, v19, v227
    v_cvt_pk_bf16_f32 v219, v226, v227
    v_mfma_f32_16x16x32_bf16 v[240:243], a[136:139], a[24:27], v[240:243]
    v_exp_f32 v228, v228
    v_mfma_f32_16x16x32_bf16 v[240:243], a[140:143], a[28:31], v[240:243]
    ds_read_b64_tr_b16 a[204:205], v12 offset:8192
    ds_read_b64_tr_b16 a[206:207], v12 offset:12288
    v_add_f32 v20, v20, v228
    s_waitcnt lgkmcnt(8)
    v_mfma_f32_16x16x32_bf16 v[32:35], a[144:147], v[212:215], v[32:35]
    v_exp_f32 v229, v229
    v_mfma_f32_16x16x32_bf16 v[32:35], a[176:179], v[216:219], v[32:35]
    v_add_f32 v20, v20, v229
    v_cvt_pk_bf16_f32 v228, v228, v229
    v_mfma_f32_16x16x32_bf16 v[36:39], a[148:151], v[212:215], v[36:39]
    v_exp_f32 v230, v230
    v_mfma_f32_16x16x32_bf16 v[36:39], a[180:183], v[216:219], v[36:39]
    s_and_b32 m0, s28, 0xffff
    v_add_f32 v20, v20, v230
    v_mfma_f32_16x16x32_bf16 v[40:43], a[152:155], v[212:215], v[40:43]
    v_exp_f32 v231, v231
    v_mfma_f32_16x16x32_bf16 v[40:43], a[184:187], v[216:219], v[40:43]
    v_add_f32 v20, v20, v231
    v_cvt_pk_bf16_f32 v229, v230, v231
    v_mfma_f32_16x16x32_bf16 v[44:47], a[156:159], v[212:215], v[44:47]
    v_exp_f32 v232, v232
    v_mfma_f32_16x16x32_bf16 v[44:47], a[188:191], v[216:219], v[44:47]
    buffer_load_dwordx4 v13, s[12:15], s28 offen offset:0 nt lds
    v_add_f32 v20, v20, v232
    v_mfma_f32_16x16x32_bf16 v[48:51], a[160:163], v[212:215], v[48:51]
    v_exp_f32 v233, v233
    v_mfma_f32_16x16x32_bf16 v[48:51], a[192:195], v[216:219], v[48:51]
    v_add_f32 v20, v20, v233
    v_cvt_pk_bf16_f32 v230, v232, v233
    v_mfma_f32_16x16x32_bf16 v[52:55], a[164:167], v[212:215], v[52:55]
    v_exp_f32 v234, v234
    v_mfma_f32_16x16x32_bf16 v[52:55], a[196:199], v[216:219], v[52:55]
    v_add_f32 v20, v20, v234
    s_waitcnt lgkmcnt(0)
    v_mfma_f32_16x16x32_bf16 v[56:59], a[168:171], v[212:215], v[56:59]
    v_exp_f32 v235, v235
    v_mfma_f32_16x16x32_bf16 v[56:59], a[200:203], v[216:219], v[56:59]
    v_add_f32 v20, v20, v235
    v_cvt_pk_bf16_f32 v231, v234, v235
    v_mfma_f32_16x16x32_bf16 v[60:63], a[172:175], v[212:215], v[60:63]
    v_exp_f32 v236, v236
    v_mfma_f32_16x16x32_bf16 v[60:63], a[204:207], v[216:219], v[60:63]
    buffer_load_dwordx4 v14, s[12:15], s28 offen offset:1024 nt lds
    v_add_f32 v20, v20, v236
    v_mfma_f32_16x16x32_bf16 v[212:215], a[80:83], a[32:35], v[200:203]
    v_exp_f32 v237, v237
    v_mfma_f32_16x16x32_bf16 v[212:215], a[84:87], a[36:39], v[212:215]
    v_add_f32 v20, v20, v237
    v_cvt_pk_bf16_f32 v232, v236, v237
    v_mfma_f32_16x16x32_bf16 v[212:215], a[88:91], a[40:43], v[212:215]
    v_exp_f32 v238, v238
    v_mfma_f32_16x16x32_bf16 v[212:215], a[92:95], a[44:47], v[212:215]
    buffer_load_dwordx4 v15, s[12:15], s28 offen offset:2048 nt lds
    v_add_f32 v20, v20, v238
    v_mfma_f32_16x16x32_bf16 v[216:219], a[96:99], a[32:35], v[200:203]
    v_exp_f32 v239, v239
    v_mfma_f32_16x16x32_bf16 v[216:219], a[100:103], a[36:39], v[216:219]
    v_add_f32 v20, v20, v239
    v_cvt_pk_bf16_f32 v233, v238, v239
    v_mfma_f32_16x16x32_bf16 v[216:219], a[104:107], a[40:43], v[216:219]
    v_exp_f32 v240, v240
    v_mfma_f32_16x16x32_bf16 v[216:219], a[108:111], a[44:47], v[216:219]
    buffer_load_dwordx4 v16, s[12:15], s28 offen offset:3072 nt lds
    v_add_f32 v20, v20, v240
    v_mfma_f32_16x16x32_bf16 v[220:223], a[112:115], a[32:35], v[200:203]
    v_exp_f32 v241, v241
    v_mfma_f32_16x16x32_bf16 v[220:223], a[116:119], a[36:39], v[220:223]
    v_add_f32 v20, v20, v241
    v_cvt_pk_bf16_f32 v234, v240, v241
    v_mfma_f32_16x16x32_bf16 v[220:223], a[120:123], a[40:43], v[220:223]
    v_exp_f32 v242, v242
    v_mfma_f32_16x16x32_bf16 v[220:223], a[124:127], a[44:47], v[220:223]
    s_add_u32 m0, m0, 65536
    v_add_f32 v20, v20, v242
    v_mfma_f32_16x16x32_bf16 v[224:227], a[128:131], a[32:35], v[200:203]
    v_exp_f32 v243, v243
    v_mfma_f32_16x16x32_bf16 v[224:227], a[132:135], a[36:39], v[224:227]
    v_add_f32 v20, v20, v243
    v_cvt_pk_bf16_f32 v235, v242, v243
    v_mfma_f32_16x16x32_bf16 v[224:227], a[136:139], a[40:43], v[224:227]
    v_exp_f32 v212, v212
    v_mfma_f32_16x16x32_bf16 v[224:227], a[140:143], a[44:47], v[224:227]
    buffer_load_dwordx4 v17, s[16:19], s28 offen offset:0 nt lds
    v_add_f32 v21, v21, v212
    v_mfma_f32_16x16x32_bf16 v[64:67], a[144:147], v[228:231], v[64:67]
    v_exp_f32 v213, v213
    v_mfma_f32_16x16x32_bf16 v[64:67], a[176:179], v[232:235], v[64:67]
    v_add_f32 v21, v21, v213
    v_cvt_pk_bf16_f32 v212, v212, v213
    v_mfma_f32_16x16x32_bf16 v[68:71], a[148:151], v[228:231], v[68:71]
    v_exp_f32 v214, v214
    v_mfma_f32_16x16x32_bf16 v[68:71], a[180:183], v[232:235], v[68:71]
    buffer_load_dwordx4 v18, s[16:19], s28 offen offset:1024 nt lds
    v_add_f32 v21, v21, v214
    v_mfma_f32_16x16x32_bf16 v[72:75], a[152:155], v[228:231], v[72:75]
    v_exp_f32 v215, v215
    v_mfma_f32_16x16x32_bf16 v[72:75], a[184:187], v[232:235], v[72:75]
    v_add_f32 v21, v21, v215
    v_cvt_pk_bf16_f32 v213, v214, v215
    v_mfma_f32_16x16x32_bf16 v[76:79], a[156:159], v[228:231], v[76:79]
    v_exp_f32 v216, v216
    v_mfma_f32_16x16x32_bf16 v[76:79], a[188:191], v[232:235], v[76:79]
    buffer_load_dwordx4 v17, s[16:19], s28 offen offset:2048 nt lds
    v_add_f32 v21, v21, v216
    v_mfma_f32_16x16x32_bf16 v[80:83], a[160:163], v[228:231], v[80:83]
    v_exp_f32 v217, v217
    v_mfma_f32_16x16x32_bf16 v[80:83], a[192:195], v[232:235], v[80:83]
    v_add_f32 v21, v21, v217
    v_cvt_pk_bf16_f32 v214, v216, v217
    v_mfma_f32_16x16x32_bf16 v[84:87], a[164:167], v[228:231], v[84:87]
    v_exp_f32 v218, v218
    v_mfma_f32_16x16x32_bf16 v[84:87], a[196:199], v[232:235], v[84:87]
    buffer_load_dwordx4 v18, s[16:19], s28 offen offset:3072 nt lds
    v_add_f32 v21, v21, v218
    v_mfma_f32_16x16x32_bf16 v[88:91], a[168:171], v[228:231], v[88:91]
    v_exp_f32 v219, v219
    v_mfma_f32_16x16x32_bf16 v[88:91], a[200:203], v[232:235], v[88:91]
    v_add_f32 v21, v21, v219
    v_cvt_pk_bf16_f32 v215, v218, v219
    v_mfma_f32_16x16x32_bf16 v[92:95], a[172:175], v[228:231], v[92:95]
    v_exp_f32 v220, v220
    v_mfma_f32_16x16x32_bf16 v[92:95], a[204:207], v[232:235], v[92:95]
    s_add_u32 s28, s28, 16384
    v_add_f32 v21, v21, v220
    v_mfma_f32_16x16x32_bf16 v[228:231], a[80:83], a[48:51], v[204:207]
    v_exp_f32 v221, v221
    v_mfma_f32_16x16x32_bf16 v[228:231], a[84:87], a[52:55], v[228:231]
    v_add_f32 v21, v21, v221
    v_cvt_pk_bf16_f32 v216, v220, v221
    v_mfma_f32_16x16x32_bf16 v[228:231], a[88:91], a[56:59], v[228:231]
    v_exp_f32 v222, v222
    v_mfma_f32_16x16x32_bf16 v[228:231], a[92:95], a[60:63], v[228:231]
    v_add_f32 v21, v21, v222
    v_mfma_f32_16x16x32_bf16 v[232:235], a[96:99], a[48:51], v[204:207]
    v_exp_f32 v223, v223
    v_mfma_f32_16x16x32_bf16 v[232:235], a[100:103], a[52:55], v[232:235]
    v_add_f32 v21, v21, v223
    v_cvt_pk_bf16_f32 v217, v222, v223
    v_mfma_f32_16x16x32_bf16 v[232:235], a[104:107], a[56:59], v[232:235]
    v_exp_f32 v224, v224
    v_mfma_f32_16x16x32_bf16 v[232:235], a[108:111], a[60:63], v[232:235]
    v_add_f32 v21, v21, v224
    v_mfma_f32_16x16x32_bf16 v[236:239], a[112:115], a[48:51], v[204:207]
    v_exp_f32 v225, v225
    v_mfma_f32_16x16x32_bf16 v[236:239], a[116:119], a[52:55], v[236:239]
    v_add_f32 v21, v21, v225
    v_cvt_pk_bf16_f32 v218, v224, v225
    v_mfma_f32_16x16x32_bf16 v[236:239], a[120:123], a[56:59], v[236:239]
    v_exp_f32 v226, v226
    v_mfma_f32_16x16x32_bf16 v[236:239], a[124:127], a[60:63], v[236:239]
    v_add_f32 v21, v21, v226
    v_mfma_f32_16x16x32_bf16 v[240:243], a[128:131], a[48:51], v[204:207]
    v_exp_f32 v227, v227
    v_mfma_f32_16x16x32_bf16 v[240:243], a[132:135], a[52:55], v[240:243]
    v_add_f32 v21, v21, v227
    v_cvt_pk_bf16_f32 v219, v226, v227
    v_mfma_f32_16x16x32_bf16 v[240:243], a[136:139], a[56:59], v[240:243]
    v_exp_f32 v228, v228
    v_mfma_f32_16x16x32_bf16 v[240:243], a[140:143], a[60:63], v[240:243]
    v_add_f32 v22, v22, v228
    v_mfma_f32_16x16x32_bf16 v[96:99], a[144:147], v[212:215], v[96:99]
    v_exp_f32 v229, v229
    v_mfma_f32_16x16x32_bf16 v[96:99], a[176:179], v[216:219], v[96:99]
    v_add_f32 v22, v22, v229
    v_cvt_pk_bf16_f32 v228, v228, v229
    v_mfma_f32_16x16x32_bf16 v[100:103], a[148:151], v[212:215], v[100:103]
    v_exp_f32 v230, v230
    v_mfma_f32_16x16x32_bf16 v[100:103], a[180:183], v[216:219], v[100:103]
    v_add_f32 v22, v22, v230
    v_mfma_f32_16x16x32_bf16 v[104:107], a[152:155], v[212:215], v[104:107]
    v_exp_f32 v231, v231
    v_mfma_f32_16x16x32_bf16 v[104:107], a[184:187], v[216:219], v[104:107]
    v_add_f32 v22, v22, v231
    v_cvt_pk_bf16_f32 v229, v230, v231
    v_mfma_f32_16x16x32_bf16 v[108:111], a[156:159], v[212:215], v[108:111]
    v_exp_f32 v232, v232
    v_mfma_f32_16x16x32_bf16 v[108:111], a[188:191], v[216:219], v[108:111]
    v_add_f32 v22, v22, v232
    v_mfma_f32_16x16x32_bf16 v[112:115], a[160:163], v[212:215], v[112:115]
    v_exp_f32 v233, v233
    v_mfma_f32_16x16x32_bf16 v[112:115], a[192:195], v[216:219], v[112:115]
    v_add_f32 v22, v22, v233
    v_cvt_pk_bf16_f32 v230, v232, v233
    v_mfma_f32_16x16x32_bf16 v[116:119], a[164:167], v[212:215], v[116:119]
    v_exp_f32 v234, v234
    v_mfma_f32_16x16x32_bf16 v[116:119], a[196:199], v[216:219], v[116:119]
    v_add_f32 v22, v22, v234
    v_mfma_f32_16x16x32_bf16 v[120:123], a[168:171], v[212:215], v[120:123]
    v_exp_f32 v235, v235
    v_mfma_f32_16x16x32_bf16 v[120:123], a[200:203], v[216:219], v[120:123]
    v_add_f32 v22, v22, v235
    v_cvt_pk_bf16_f32 v231, v234, v235
    v_mfma_f32_16x16x32_bf16 v[124:127], a[172:175], v[212:215], v[124:127]
    v_exp_f32 v236, v236
    v_mfma_f32_16x16x32_bf16 v[124:127], a[204:207], v[216:219], v[124:127]
    v_add_f32 v22, v22, v236
    s_waitcnt vmcnt(8)
    s_barrier
    v_mfma_f32_16x16x32_bf16 v[212:215], a[80:83], a[64:67], v[208:211]
    v_exp_f32 v237, v237
    v_mfma_f32_16x16x32_bf16 v[212:215], a[84:87], a[68:71], v[212:215]
    ds_read_b128 a[80:83], v1 offset:16384
    v_add_f32 v22, v22, v237
    v_cvt_pk_bf16_f32 v232, v236, v237
    v_mfma_f32_16x16x32_bf16 v[212:215], a[88:91], a[72:75], v[212:215]
    v_exp_f32 v238, v238
    v_mfma_f32_16x16x32_bf16 v[212:215], a[92:95], a[76:79], v[212:215]
    ds_read_b128 a[84:87], v2 offset:16384
    v_add_f32 v22, v22, v238
    v_mfma_f32_16x16x32_bf16 v[216:219], a[96:99], a[64:67], v[208:211]
    v_exp_f32 v239, v239
    v_mfma_f32_16x16x32_bf16 v[216:219], a[100:103], a[68:71], v[216:219]
    ds_read_b128 a[88:91], v3 offset:16384
    v_add_f32 v22, v22, v239
    v_cvt_pk_bf16_f32 v233, v238, v239
    v_mfma_f32_16x16x32_bf16 v[216:219], a[104:107], a[72:75], v[216:219]
    v_exp_f32 v240, v240
    v_mfma_f32_16x16x32_bf16 v[216:219], a[108:111], a[76:79], v[216:219]
    ds_read_b128 a[92:95], v4 offset:16384
    v_add_f32 v22, v22, v240
    v_mfma_f32_16x16x32_bf16 v[220:223], a[112:115], a[64:67], v[208:211]
    v_exp_f32 v241, v241
    v_mfma_f32_16x16x32_bf16 v[220:223], a[116:119], a[68:71], v[220:223]
    ds_read_b128 a[96:99], v1 offset:20480
    v_add_f32 v22, v22, v241
    v_cvt_pk_bf16_f32 v234, v240, v241
    v_mfma_f32_16x16x32_bf16 v[220:223], a[120:123], a[72:75], v[220:223]
    v_exp_f32 v242, v242
    v_mfma_f32_16x16x32_bf16 v[220:223], a[124:127], a[76:79], v[220:223]
    ds_read_b128 a[100:103], v2 offset:20480
    v_add_f32 v22, v22, v242
    v_mfma_f32_16x16x32_bf16 v[224:227], a[128:131], a[64:67], v[208:211]
    v_exp_f32 v243, v243
    v_mfma_f32_16x16x32_bf16 v[224:227], a[132:135], a[68:71], v[224:227]
    ds_read_b128 a[104:107], v3 offset:20480
    v_add_f32 v22, v22, v243
    v_cvt_pk_bf16_f32 v235, v242, v243
    v_mfma_f32_16x16x32_bf16 v[224:227], a[136:139], a[72:75], v[224:227]
    v_exp_f32 v212, v212
    v_mfma_f32_16x16x32_bf16 v[224:227], a[140:143], a[76:79], v[224:227]
    ds_read_b128 a[108:111], v4 offset:20480
    v_add_f32 v23, v23, v212
    v_mfma_f32_16x16x32_bf16 v[128:131], a[144:147], v[228:231], v[128:131]
    v_exp_f32 v213, v213
    v_mfma_f32_16x16x32_bf16 v[128:131], a[176:179], v[232:235], v[128:131]
    ds_read_b128 a[112:115], v1 offset:24576
    v_add_f32 v23, v23, v213
    v_cvt_pk_bf16_f32 v212, v212, v213
    v_mfma_f32_16x16x32_bf16 v[132:135], a[148:151], v[228:231], v[132:135]
    v_exp_f32 v214, v214
    v_mfma_f32_16x16x32_bf16 v[132:135], a[180:183], v[232:235], v[132:135]
    ds_read_b128 a[116:119], v2 offset:24576
    v_add_f32 v23, v23, v214
    v_mfma_f32_16x16x32_bf16 v[136:139], a[152:155], v[228:231], v[136:139]
    v_exp_f32 v215, v215
    v_mfma_f32_16x16x32_bf16 v[136:139], a[184:187], v[232:235], v[136:139]
    ds_read_b128 a[120:123], v3 offset:24576
    v_add_f32 v23, v23, v215
    v_cvt_pk_bf16_f32 v213, v214, v215
    v_mfma_f32_16x16x32_bf16 v[140:143], a[156:159], v[228:231], v[140:143]
    v_exp_f32 v216, v216
    v_mfma_f32_16x16x32_bf16 v[140:143], a[188:191], v[232:235], v[140:143]
    ds_read_b128 a[124:127], v4 offset:24576
    v_add_f32 v23, v23, v216
    v_mfma_f32_16x16x32_bf16 v[144:147], a[160:163], v[228:231], v[144:147]
    v_exp_f32 v217, v217
    v_mfma_f32_16x16x32_bf16 v[144:147], a[192:195], v[232:235], v[144:147]
    ds_read_b128 a[128:131], v1 offset:28672
    v_add_f32 v23, v23, v217
    v_cvt_pk_bf16_f32 v214, v216, v217
    v_mfma_f32_16x16x32_bf16 v[148:151], a[164:167], v[228:231], v[148:151]
    v_exp_f32 v218, v218
    v_mfma_f32_16x16x32_bf16 v[148:151], a[196:199], v[232:235], v[148:151]
    ds_read_b128 a[132:135], v2 offset:28672
    v_add_f32 v23, v23, v218
    v_mfma_f32_16x16x32_bf16 v[152:155], a[168:171], v[228:231], v[152:155]
    v_exp_f32 v219, v219
    v_mfma_f32_16x16x32_bf16 v[152:155], a[200:203], v[232:235], v[152:155]
    ds_read_b128 a[136:139], v3 offset:28672
    v_add_f32 v23, v23, v219
    v_cvt_pk_bf16_f32 v215, v218, v219
    v_mfma_f32_16x16x32_bf16 v[156:159], a[172:175], v[228:231], v[156:159]
    v_exp_f32 v220, v220
    v_mfma_f32_16x16x32_bf16 v[156:159], a[204:207], v[232:235], v[156:159]
    ds_read_b128 a[140:143], v4 offset:28672
    v_add_f32 v23, v23, v220
L_b1:
    s_waitcnt lgkmcnt(4)
    v_mfma_f32_16x16x32_bf16 v[228:231], a[80:83], a[0:3], v[192:195]
    v_exp_f32 v221, v221
    v_mfma_f32_16x16x32_bf16 v[228:231], a[84:87], a[4:7], v[228:231]
    v_add_f32 v23, v23, v221
    v_cvt_pk_bf16_f32 v216, v220, v221
    v_mfma_f32_16x16x32_bf16 v[228:231], a[88:91], a[8:11], v[228:231]
    v_exp_f32 v222, v222
    v_mfma_f32_16x16x32_bf16 v[228:231], a[92:95], a[12:15], v[228:231]
    v_add_f32 v23, v23, v222
    v_mfma_f32_16x16x32_bf16 v[232:235], a[96:99], a[0:3], v[192:195]
    v_exp_f32 v223, v223
    v_mfma_f32_16x16x32_bf16 v[232:235], a[100:103], a[4:7], v[232:235]
    v_add_f32 v23, v23, v223
    v_cvt_pk_bf16_f32 v217, v222, v223
    v_mfma_f32_16x16x32_bf16 v[232:235], a[104:107], a[8:11], v[232:235]
    v_exp_f32 v224, v224
    v_mfma_f32_16x16x32_bf16 v[232:235], a[108:111], a[12:15], v[232:235]
    v_add_f32 v23, v23, v224
    v_mfma_f32_16x16x32_bf16 v[236:239], a[112:115], a[0:3], v[192:195]
    v_exp_f32 v225, v225
    v_mfma_f32_16x16x32_bf16 v[236:239], a[116:119], a[4:7], v[236:239]
    v_add_f32 v23, v23, v225
    v_cvt_pk_bf16_f32 v218, v224, v225
    v_mfma_f32_16x16x32_bf16 v[236:239], a[120:123], a[8:11], v[236:239]
    v_exp_f32 v226, v226
    v_mfma_f32_16x16x32_bf16 v[236:239], a[124:127], a[12:15], v[236:239]
    v_add_f32 v23, v23, v226
    s_waitcnt lgkmcnt(0)
    v_mfma_f32_16x16x32_bf16 v[240:243], a[128:131], a[0:3], v[192:195]
    v_exp_f32 v227, v227
    v_mfma_f32_16x16x32_bf16 v[240:243], a[132:135], a[4:7], v[240:243]
    v_add_f32 v23, v23, v227
    v_cvt_pk_bf16_f32 v219, v226, v227
    v_mfma_f32_16x16x32_bf16 v[240:243], a[136:139], a[8:11], v[240:243]
    v_exp_f32 v228, v228
    v_mfma_f32_16x16x32_bf16 v[240:243], a[140:143], a[12:15], v[240:243]
    v_add_f32 v19, v19, v228
L_b1g1:
    v_mfma_f32_16x16x32_bf16 v[160:163], a[144:147], v[212:215], v[160:163]
    v_exp_f32 v229, v229
    v_mfma_f32_16x16x32_bf16 v[160:163], a[176:179], v[216:219], v[160:163]
    ds_read_b64_tr_b16 a[144:145], v5 offset:16384
    ds_read_b64_tr_b16 a[146:147], v5 offset:20480
    v_add_f32 v19, v19, v229
    v_cvt_pk_bf16_f32 v228, v228, v229
    v_mfma_f32_16x16x32_bf16 v[164:167], a[148:151], v[212:215], v[164:167]
    v_exp_f32 v230, v230
    v_mfma_f32_16x16x32_bf16 v[164:167], a[180:183], v[216:219], v[164:167]
    ds_read_b64_tr_b16 a[176:177], v5 offset:24576
    ds_read_b64_tr_b16 a[178:179], v5 offset:28672
    v_add_f32 v19, v19, v230
    v_mfma_f32_16x16x32_bf16 v[168:171], a[152:155], v[212:215], v[168:171]
    v_exp_f32 v231, v231
    v_mfma_f32_16x16x32_bf16 v[168:171], a[184:187], v[216:219], v[168:171]
    ds_read_b64_tr_b16 a[148:149], v6 offset:16384
    ds_read_b64_tr_b16 a[150:151], v6 offset:20480
    v_add_f32 v19, v19, v231
    v_cvt_pk_bf16_f32 v229, v230, v231
    v_mfma_f32_16x16x32_bf16 v[172:175], a[156:159], v[212:215], v[172:175]
    v_exp_f32 v232, v232
    v_mfma_f32_16x16x32_bf16 v[172:175], a[188:191], v[216:219], v[172:175]
    ds_read_b64_tr_b16 a[180:181], v6 offset:24576
    ds_read_b64_tr_b16 a[182:183], v6 offset:28672
    v_add_f32 v19, v19, v232
    v_mfma_f32_16x16x32_bf16 v[176:179], a[160:163], v[212:215], v[176:179]
    v_exp_f32 v233, v233
    v_mfma_f32_16x16x32_bf16 v[176:179], a[192:195], v[216:219], v[176:179]
    ds_read_b64_tr_b16 a[152:153], v7 offset:16384
    ds_read_b64_tr_b16 a[154:155], v7 offset:20480
    v_add_f32 v19, v19, v233
    v_cvt_pk_bf16_f32 v230, v232, v233
    v_mfma_f32_16x16x32_bf16 v[180:183], a[164:167], v[212:215], v[180:183]
    v_exp_f32 v234, v234
    v_mfma_f32_16x16x32_bf16 v[180:183], a[196:199], v[216:219], v[180:183]
    ds_read_b64_tr_b16 a[184:185], v7 offset:24576
    ds_read_b64_tr_b16 a[186:187], v7 offset:28672
    v_add_f32 v19, v19, v234
    v_mfma_f32_16x16x32_bf16 v[184:187], a[168:171], v[212:215], v[184:187]
    v_exp_f32 v235, v235
    v_mfma_f32_16x16x32_bf16 v[184:187], a[200:203], v[216:219], v[184:187]
    ds_read_b64_tr_b16 a[156:157], v8 offset:16384
    ds_read_b64_tr_b16 a[158:159], v8 offset:20480
    v_add_f32 v19, v19, v235
    v_cvt_pk_bf16_f32 v231, v234, v235
    v_mfma_f32_16x16x32_bf16 v[188:191], a[172:175], v[212:215], v[188:191]
    v_exp_f32 v236, v236
    v_mfma_f32_16x16x32_bf16 v[188:191], a[204:207], v[216:219], v[188:191]
    ds_read_b64_tr_b16 a[188:189], v8 offset:24576
    ds_read_b64_tr_b16 a[190:191], v8 offset:28672
    v_add_f32 v19, v19, v236
    v_mfma_f32_16x16x32_bf16 v[212:215], a[80:83], a[16:19], v[196:199]
    v_exp_f32 v237, v237
    v_mfma_f32_16x16x32_bf16 v[212:215], a[84:87], a[20:23], v[212:215]
    ds_read_b64_tr_b16 a[160:161], v9 offset:16384
    ds_read_b64_tr_b16 a[162:163], v9 offset:20480
    v_add_f32 v19, v19, v237
    v_cvt_pk_bf16_f32 v232, v236, v237
    v_mfma_f32_16x16x32_bf16 v[212:215], a[88:91], a[24:27], v[212:215]
    v_exp_f32 v238, v238
    v_mfma_f32_16x16x32_bf16 v[212:215], a[92:95], a[28:31], v[212:215]
    ds_read_b64_tr_b16 a[192:193], v9 offset:24576
    ds_read_b64_tr_b16 a[194:195], v9 offset:28672
    v_add_f32 v19, v19, v238
    v_mfma_f32_16x16x32_bf16 v[216:219], a[96:99], a[16:19], v[196:199]
    v_exp_f32 v239, v239
    v_mfma_f32_16x16x32_bf16 v[216:219], a[100:103], a[20:23], v[216:219]
    ds_read_b64_tr_b16 a[164:165], v10 offset:16384
    ds_read_b64_tr_b16 a[166:167], v10 offset:20480
    v_add_f32 v19, v19, v239
    v_cvt_pk_bf16_f32 v233, v238, v239
    v_mfma_f32_16x16x32_bf16 v[216:219], a[104:107], a[24:27], v[216:219]
    v_exp_f32 v240, v240
    v_mfma_f32_16x16x32_bf16 v[216:219], a[108:111], a[28:31], v[216:219]
    ds_read_b64_tr_b16 a[196:197], v10 offset:24576
    ds_read_b64_tr_b16 a[198:199], v10 offset:28672
    v_add_f32 v19, v19, v240
    v_mfma_f32_16x16x32_bf16 v[220:223], a[112:115], a[16:19], v[196:199]
    v_exp_f32 v241, v241
    v_mfma_f32_16x16x32_bf16 v[220:223], a[116:119], a[20:23], v[220:223]
    ds_read_b64_tr_b16 a[168:169], v11 offset:16384
    ds_read_b64_tr_b16 a[170:171], v11 offset:20480
    v_add_f32 v19, v19, v241
    v_cvt_pk_bf16_f32 v234, v240, v241
    v_mfma_f32_16x16x32_bf16 v[220:223], a[120:123], a[24:27], v[220:223]
    v_exp_f32 v242, v242
    v_mfma_f32_16x16x32_bf16 v[220:223], a[124:127], a[28:31], v[220:223]
    ds_read_b64_tr_b16 a[200:201], v11 offset:24576
    ds_read_b64_tr_b16 a[202:203], v11 offset:28672
    v_add_f32 v19, v19, v242
    v_mfma_f32_16x16x32_bf16 v[224:227], a[128:131], a[16:19], v[196:199]
    v_exp_f32 v243, v243
    v_mfma_f32_16x16x32_bf16 v[224:227], a[132:135], a[20:23], v[224:227]
    ds_read_b64_tr_b16 a[172:173], v12 offset:16384
    ds_read_b64_tr_b16 a[174:175], v12 offset:20480
    v_add_f32 v19, v19, v243
    v_cvt_pk_bf16_f32 v235, v242, v243
    v_mfma_f32_16x16x32_bf16 v[224:227], a[136:139], a[24:27], v[224:227]
    v_exp_f32 v212, v212
    v_mfma_f32_16x16x32_bf16 v[224:227], a[140:143], a[28:31], v[224:227]
    ds_read_b64_tr_b16 a[204:205], v12 offset:24576
    ds_read_b64_tr_b16 a[206:207], v12 offset:28672
    v_add_f32 v20, v20, v212
    s_waitcnt lgkmcnt(8)
    v_mfma_f32_16x16x32_bf16 v[32:35], a[144:147], v[228:231], v[32:35]
    v_exp_f32 v213, v213
    v_mfma_f32_16x16x32_bf16 v[32:35], a[176:179], v[232:235], v[32:35]
    v_add_f32 v20, v20, v213
    v_cvt_pk_bf16_f32 v212, v212, v213
    v_mfma_f32_16x16x32_bf16 v[36:39], a[148:151], v[228:231], v[36:39]
    v_exp_f32 v214, v214
    v_mfma_f32_16x16x32_bf16 v[36:39], a[180:183], v[232:235], v[36:39]
    s_and_b32 m0, s28, 0xffff
    v_add_f32 v20, v20, v214
    v_mfma_f32_16x16x32_bf16 v[40:43], a[152:155], v[228:231], v[40:43]
    v_exp_f32 v215, v215
    v_mfma_f32_16x16x32_bf16 v[40:43], a[184:187], v[232:235], v[40:43]
    v_add_f32 v20, v20, v215
    v_cvt_pk_bf16_f32 v213, v214, v215
    v_mfma_f32_16x16x32_bf16 v[44:47], a[156:159], v[228:231], v[44:47]
    v_exp_f32 v216, v216
    v_mfma_f32_16x16x32_bf16 v[44:47], a[188:191], v[232:235], v[44:47]
    buffer_load_dwordx4 v13, s[12:15], s28 offen offset:0 nt lds
    v_add_f32 v20, v20, v216
    v_mfma_f32_16x16x32_bf16 v[48:51], a[160:163], v[228:231], v[48:51]
    v_exp_f32 v217, v217
    v_mfma_f32_16x16x32_bf16 v[48:51], a[192:195], v[232:235], v[48:51]
    v_add_f32 v20, v20, v217
    v_cvt_pk_bf16_f32 v214, v216, v217
    v_mfma_f32_16x16x32_bf16 v[52:55], a[164:167], v[228:231], v[52:55]
    v_exp_f32 v218, v218
    v_mfma_f32_16x16x32_bf16 v[52:55], a[196:199], v[232:235], v[52:55]
    v_add_f32 v20, v20, v218
    s_waitcnt lgkmcnt(0)
    v_mfma_f32_16x16x32_bf16 v[56:59], a[168:171], v[228:231], v[56:59]
    v_exp_f32 v219, v219
    v_mfma_f32_16x16x32_bf16 v[56:59], a[200:203], v[232:235], v[56:59]
    v_add_f32 v20, v20, v219
    v_cvt_pk_bf16_f32 v215, v218, v219
    v_mfma_f32_16x16x32_bf16 v[60:63], a[172:175], v[228:231], v[60:63]
    v_exp_f32 v220, v220
    v_mfma_f32_16x16x32_bf16 v[60:63], a[204:207], v[232:235], v[60:63]
    buffer_load_dwordx4 v14, s[12:15], s28 offen offset:1024 nt lds
    v_add_f32 v20, v20, v220
    v_mfma_f32_16x16x32_bf16 v[228:231], a[80:83], a[32:35], v[200:203]
    v_exp_f32 v221, v221
    v_mfma_f32_16x16x32_bf16 v[228:231], a[84:87], a[36:39], v[228:231]
    v_add_f32 v20, v20, v221
    v_cvt_pk_bf16_f32 v216, v220, v221
    v_mfma_f32_16x16x32_bf16 v[228:231], a[88:91], a[40:43], v[228:231]
    v_exp_f32 v222, v222
    v_mfma_f32_16x16x32_bf16 v[228:231], a[92:95], a[44:47], v[228:231]
    buffer_load_dwordx4 v15, s[12:15], s28 offen offset:2048 nt lds
    v_add_f32 v20, v20, v222
    v_mfma_f32_16x16x32_bf16 v[232:235], a[96:99], a[32:35], v[200:203]
    v_exp_f32 v223, v223
    v_mfma_f32_16x16x32_bf16 v[232:235], a[100:103], a[36:39], v[232:235]
    v_add_f32 v20, v20, v223
    v_cvt_pk_bf16_f32 v217, v222, v223
    v_mfma_f32_16x16x32_bf16 v[232:235], a[104:107], a[40:43], v[232:235]
    v_exp_f32 v224, v224
    v_mfma_f32_16x16x32_bf16 v[232:235], a[108:111], a[44:47], v[232:235]
    buffer_load_dwordx4 v16, s[12:15], s28 offen offset:3072 nt lds
    v_add_f32 v20, v20, v224
    v_mfma_f32_16x16x32_bf16 v[236:239], a[112:115], a[32:35], v[200:203]
    v_exp_f32 v225, v225
    v_mfma_f32_16x16x32_bf16 v[236:239], a[116:119], a[36:39], v[236:239]
    v_add_f32 v20, v20, v225
    v_cvt_pk_bf16_f32 v218, v224, v225
    v_mfma_f32_16x16x32_bf16 v[236:239], a[120:123], a[40:43], v[236:239]
    v_exp_f32 v226, v226
    v_mfma_f32_16x16x32_bf16 v[236:239], a[124:127], a[44:47], v[236:239]
    s_add_u32 m0, m0, 65536
    v_add_f32 v20, v20, v226
    v_mfma_f32_16x16x32_bf16 v[240:243], a[128:131], a[32:35], v[200:203]
    v_exp_f32 v227, v227
    v_mfma_f32_16x16x32_bf16 v[240:243], a[132:135], a[36:39], v[240:243]
    v_add_f32 v20, v20, v227
    v_cvt_pk_bf16_f32 v219, v226, v227
    v_mfma_f32_16x16x32_bf16 v[240:243], a[136:139], a[40:43], v[240:243]
    v_exp_f32 v228, v228
    v_mfma_f32_16x16x32_bf16 v[240:243], a[140:143], a[44:47], v[240:243]
    buffer_load_dwordx4 v17, s[16:19], s28 offen offset:0 nt lds
    v_add_f32 v21, v21, v228
    v_mfma_f32_16x16x32_bf16 v[64:67], a[144:147], v[212:215], v[64:67]
    v_exp_f32 v229, v229
    v_mfma_f32_16x16x32_bf16 v[64:67], a[176:179], v[216:219], v[64:67]
    v_add_f32 v21, v21, v229
    v_cvt_pk_bf16_f32 v228, v228, v229
    v_mfma_f32_16x16x32_bf16 v[68:71], a[148:151], v[212:215], v[68:71]
    v_exp_f32 v230, v230
    v_mfma_f32_16x16x32_bf16 v[68:71], a[180:183], v[216:219], v[68:71]
    buffer_load_dwordx4 v18, s[16:19], s28 offen offset:1024 nt lds
    v_add_f32 v21, v21, v230
    v_mfma_f32_16x16x32_bf16 v[72:75], a[152:155], v[212:215], v[72:75]
    v_exp_f32 v231, v231
    v_mfma_f32_16x16x32_bf16 v[72:75], a[184:187], v[216:219], v[72:75]
    v_add_f32 v21, v21, v231
    v_cvt_pk_bf16_f32 v229, v230, v231
    v_mfma_f32_16x16x32_bf16 v[76:79], a[156:159], v[212:215], v[76:79]
    v_exp_f32 v232, v232
    v_mfma_f32_16x16x32_bf16 v[76:79], a[188:191], v[216:219], v[76:79]
    buffer_load_dwordx4 v17, s[16:19], s28 offen offset:2048 nt lds
    v_add_f32 v21, v21, v232
    v_mfma_f32_16x16x32_bf16 v[80:83], a[160:163], v[212:215], v[80:83]
    v_exp_f32 v233, v233
    v_mfma_f32_16x16x32_bf16 v[80:83], a[192:195], v[216:219], v[80:83]
    v_add_f32 v21, v21, v233
    v_cvt_pk_bf16_f32 v230, v232, v233
    v_mfma_f32_16x16x32_bf16 v[84:87], a[164:167], v[212:215], v[84:87]
    v_exp_f32 v234, v234
    v_mfma_f32_16x16x32_bf16 v[84:87], a[196:199], v[216:219], v[84:87]
    buffer_load_dwordx4 v18, s[16:19], s28 offen offset:3072 nt lds
    v_add_f32 v21, v21, v234
    v_mfma_f32_16x16x32_bf16 v[88:91], a[168:171], v[212:215], v[88:91]
    v_exp_f32 v235, v235
    v_mfma_f32_16x16x32_bf16 v[88:91], a[200:203], v[216:219], v[88:91]
    v_add_f32 v21, v21, v235
    v_cvt_pk_bf16_f32 v231, v234, v235
    v_mfma_f32_16x16x32_bf16 v[92:95], a[172:175], v[212:215], v[92:95]
    v_exp_f32 v236, v236
    v_mfma_f32_16x16x32_bf16 v[92:95], a[204:207], v[216:219], v[92:95]
    s_add_u32 s28, s28, 16384
    v_add_f32 v21, v21, v236
    v_mfma_f32_16x16x32_bf16 v[212:215], a[80:83], a[48:51], v[204:207]
    v_exp_f32 v237, v237
    v_mfma_f32_16x16x32_bf16 v[212:215], a[84:87], a[52:55], v[212:215]
    v_add_f32 v21, v21, v237
    v_cvt_pk_bf16_f32 v232, v236, v237
    v_mfma_f32_16x16x32_bf16 v[212:215], a[88:91], a[56:59], v[212:215]
    v_exp_f32 v238, v238
    v_mfma_f32_16x16x32_bf16 v[212:215], a[92:95], a[60:63], v[212:215]
    s_sub_u32 s43, s30, 2
    v_add_f32 v21, v21, v238
    v_mfma_f32_16x16x32_bf16 v[216:219], a[96:99], a[48:51], v[204:207]
    v_exp_f32 v239, v239
    v_mfma_f32_16x16x32_bf16 v[216:219], a[100:103], a[52:55], v[216:219]
    v_add_f32 v21, v21, v239
    v_cvt_pk_bf16_f32 v233, v238, v239
    v_mfma_f32_16x16x32_bf16 v[216:219], a[104:107], a[56:59], v[216:219]
    v_exp_f32 v240, v240
    v_mfma_f32_16x16x32_bf16 v[216:219], a[108:111], a[60:63], v[216:219]
    s_cmp_le_u32 s43, 1
    v_add_f32 v21, v21, v240
    v_mfma_f32_16x16x32_bf16 v[220:223], a[112:115], a[48:51], v[204:207]
    v_exp_f32 v241, v241
    v_mfma_f32_16x16x32_bf16 v[220:223], a[116:119], a[52:55], v[220:223]
    v_add_f32 v21, v21, v241
    v_cvt_pk_bf16_f32 v234, v240, v241
    v_mfma_f32_16x16x32_bf16 v[220:223], a[120:123], a[56:59], v[220:223]
    v_exp_f32 v242, v242
    v_mfma_f32_16x16x32_bf16 v[220:223], a[124:127], a[60:63], v[220:223]
    v_add_f32 v21, v21, v242
    v_mfma_f32_16x16x32_bf16 v[224:227], a[128:131], a[48:51], v[204:207]
    v_exp_f32 v243, v243
    v_mfma_f32_16x16x32_bf16 v[224:227], a[132:135], a[52:55], v[224:227]
    v_add_f32 v21, v21, v243
    v_cvt_pk_bf16_f32 v235, v242, v243
    v_mfma_f32_16x16x32_bf16 v[224:227], a[136:139], a[56:59], v[224:227]
    v_exp_f32 v212, v212
    v_mfma_f32_16x16x32_bf16 v[224:227], a[140:143], a[60:63], v[224:227]
    v_add_f32 v22, v22, v212
    v_mfma_f32_16x16x32_bf16 v[96:99], a[144:147], v[228:231], v[96:99]
    v_exp_f32 v213, v213
    v_mfma_f32_16x16x32_bf16 v[96:99], a[176:179], v[232:235], v[96:99]
    v_add_f32 v22, v22, v213
    v_cvt_pk_bf16_f32 v212, v212, v213
    v_mfma_f32_16x16x32_bf16 v[100:103], a[148:151], v[228:231], v[100:103]
    v_exp_f32 v214, v214
    v_mfma_f32_16x16x32_bf16 v[100:103], a[180:183], v[232:235], v[100:103]
    v_add_f32 v22, v22, v214
    v_mfma_f32_16x16x32_bf16 v[104:107], a[152:155], v[228:231], v[104:107]
    v_exp_f32 v215, v215
    v_mfma_f32_16x16x32_bf16 v[104:107], a[184:187], v[232:235], v[104:107]
    v_add_f32 v22, v22, v215
    v_cvt_pk_bf16_f32 v213, v214, v215
    v_mfma_f32_16x16x32_bf16 v[108:111], a[156:159], v[228:231], v[108:111]
    v_exp_f32 v216, v216
    v_mfma_f32_16x16x32_bf16 v[108:111], a[188:191], v[232:235], v[108:111]
    v_add_f32 v22, v22, v216
    v_mfma_f32_16x16x32_bf16 v[112:115], a[160:163], v[228:231], v[112:115]
    v_exp_f32 v217, v217
    v_mfma_f32_16x16x32_bf16 v[112:115], a[192:195], v[232:235], v[112:115]
    v_add_f32 v22, v22, v217
    v_cvt_pk_bf16_f32 v214, v216, v217
    v_mfma_f32_16x16x32_bf16 v[116:119], a[164:167], v[228:231], v[116:119]
    v_exp_f32 v218, v218
    v_mfma_f32_16x16x32_bf16 v[116:119], a[196:199], v[232:235], v[116:119]
    v_add_f32 v22, v22, v218
    v_mfma_f32_16x16x32_bf16 v[120:123], a[168:171], v[228:231], v[120:123]
    v_exp_f32 v219, v219
    v_mfma_f32_16x16x32_bf16 v[120:123], a[200:203], v[232:235], v[120:123]
    v_add_f32 v22, v22, v219
    v_cvt_pk_bf16_f32 v215, v218, v219
    v_mfma_f32_16x16x32_bf16 v[124:127], a[172:175], v[228:231], v[124:127]
    v_exp_f32 v220, v220
    v_mfma_f32_16x16x32_bf16 v[124:127], a[204:207], v[232:235], v[124:127]
    v_add_f32 v22, v22, v220
    s_waitcnt vmcnt(8)
    s_barrier
    v_mfma_f32_16x16x32_bf16 v[228:231], a[80:83], a[64:67], v[208:211]
    v_exp_f32 v221, v221
    v_mfma_f32_16x16x32_bf16 v[228:231], a[84:87], a[68:71], v[228:231]
    ds_read_b128 a[80:83], v1 offset:32768
    v_add_f32 v22, v22, v221
    v_cvt_pk_bf16_f32 v216, v220, v221
    v_mfma_f32_16x16x32_bf16 v[228:231], a[88:91], a[72:75], v[228:231]
    v_exp_f32 v222, v222
    v_mfma_f32_16x16x32_bf16 v[228:231], a[92:95], a[76:79], v[228:231]
    ds_read_b128 a[84:87], v2 offset:32768
    v_add_f32 v22, v22, v222
    v_mfma_f32_16x16x32_bf16 v[232:235], a[96:99], a[64:67], v[208:211]
    v_exp_f32 v223, v223
    v_mfma_f32_16x16x32_bf16 v[232:235], a[100:103], a[68:71], v[232:235]
    ds_read_b128 a[88:91], v3 offset:32768
    v_add_f32 v22, v22, v223
    v_cvt_pk_bf16_f32 v217, v222, v223
    v_mfma_f32_16x16x32_bf16 v[232:235], a[104:107], a[72:75], v[232:235]
    v_exp_f32 v224, v224
    v_mfma_f32_16x16x32_bf16 v[232:235], a[108:111], a[76:79], v[232:235]
    ds_read_b128 a[92:95], v4 offset:32768
    v_add_f32 v22, v22, v224
    v_mfma_f32_16x16x32_bf16 v[236:239], a[112:115], a[64:67], v[208:211]
    v_exp_f32 v225, v225
    v_mfma_f32_16x16x32_bf16 v[236:239], a[116:119], a[68:71], v[236:239]
    ds_read_b128 a[96:99], v1 offset:36864
    v_add_f32 v22, v22, v225
    v_cvt_pk_bf16_f32 v218, v224, v225
    v_mfma_f32_16x16x32_bf16 v[236:239], a[120:123], a[72:75], v[236:239]
    v_exp_f32 v226, v226
    v_mfma_f32_16x16x32_bf16 v[236:239], a[124:127], a[76:79], v[236:239]
    ds_read_b128 a[100:103], v2 offset:36864
    v_add_f32 v22, v22, v226
    v_mfma_f32_16x16x32_bf16 v[240:243], a[128:131], a[64:67], v[208:211]
    v_exp_f32 v227, v227
    v_mfma_f32_16x16x32_bf16 v[240:243], a[132:135], a[68:71], v[240:243]
    ds_read_b128 a[104:107], v3 offset:36864
    v_add_f32 v22, v22, v227
    v_cvt_pk_bf16_f32 v219, v226, v227
    v_mfma_f32_16x16x32_bf16 v[240:243], a[136:139], a[72:75], v[240:243]
    v_exp_f32 v228, v228
    v_mfma_f32_16x16x32_bf16 v[240:243], a[140:143], a[76:79], v[240:243]
    ds_read_b128 a[108:111], v4 offset:36864
    v_add_f32 v23, v23, v228
    v_mfma_f32_16x16x32_bf16 v[128:131], a[144:147], v[212:215], v[128:131]
    v_exp_f32 v229, v229
    v_mfma_f32_16x16x32_bf16 v[128:131], a[176:179], v[216:219], v[128:131]
    ds_read_b128 a[112:115], v1 offset:40960
    v_add_f32 v23, v23, v229
    v_cvt_pk_bf16_f32 v228, v228, v229
    v_mfma_f32_16x16x32_bf16 v[132:135], a[148:151], v[212:215], v[132:135]
    v_exp_f32 v230, v230
    v_mfma_f32_16x16x32_bf16 v[132:135], a[180:183], v[216:219], v[132:135]
    ds_read_b128 a[116:119], v2 offset:40960
    v_add_f32 v23, v23, v230
    v_mfma_f32_16x16x32_bf16 v[136:139], a[152:155], v[212:215], v[136:139]
    v_exp_f32 v231, v231
    v_mfma_f32_16x16x32_bf16 v[136:139], a[184:187], v[216:219], v[136:139]
    ds_read_b128 a[120:123], v3 offset:40960
    v_add_f32 v23, v23, v231
    v_cvt_pk_bf16_f32 v229, v230, v231
    v_mfma_f32_16x16x32_bf16 v[140:143], a[156:159], v[212:215], v[140:143]
    v_exp_f32 v232, v232
    v_mfma_f32_16x16x32_bf16 v[140:143], a[188:191], v[216:219], v[140:143]
    ds_read_b128 a[124:127], v4 offset:40960
    v_add_f32 v23, v23, v232
    v_mfma_f32_16x16x32_bf16 v[144:147], a[160:163], v[212:215], v[144:147]
    v_exp_f32 v233, v233
    v_mfma_f32_16x16x32_bf16 v[144:147], a[192:195], v[216:219], v[144:147]
    ds_read_b128 a[128:131], v1 offset:45056
    v_add_f32 v23, v23, v233
    v_cvt_pk_bf16_f32 v230, v232, v233
    v_mfma_f32_16x16x32_bf16 v[148:151], a[164:167], v[212:215], v[148:151]
    v_exp_f32 v234, v234
    v_mfma_f32_16x16x32_bf16 v[148:151], a[196:199], v[216:219], v[148:151]
    ds_read_b128 a[132:135], v2 offset:45056
    v_add_f32 v23, v23, v234
    v_mfma_f32_16x16x32_bf16 v[152:155], a[168:171], v[212:215], v[152:155]
    v_exp_f32 v235, v235
    v_mfma_f32_16x16x32_bf16 v[152:155], a[200:203], v[216:219], v[152:155]
    ds_read_b128 a[136:139], v3 offset:45056
    v_add_f32 v23, v23, v235
    v_cvt_pk_bf16_f32 v231, v234, v235
    v_mfma_f32_16x16x32_bf16 v[156:159], a[172:175], v[212:215], v[156:159]
    v_exp_f32 v236, v236
    v_mfma_f32_16x16x32_bf16 v[156:159], a[204:207], v[216:219], v[156:159]
    ds_read_b128 a[140:143], v4 offset:45056
    v_add_f32 v23, v23, v236
    s_cbranch_vccz L_qlds
L_b2:
    s_waitcnt lgkmcnt(4)
    v_mfma_f32_16x16x32_bf16 v[212:215], a[80:83], a[0:3], v[192:195]
    v_exp_f32 v237, v237
    v_mfma_f32_16x16x32_bf16 v[212:215], a[84:87], a[4:7], v[212:215]
    v_add_f32 v23, v23, v237
    v_cvt_pk_bf16_f32 v232, v236, v237
    v_mfma_f32_16x16x32_bf16 v[212:215], a[88:91], a[8:11], v[212:215]
    v_exp_f32 v238, v238
    v_mfma_f32_16x16x32_bf16 v[212:215], a[92:95], a[12:15], v[212:215]
    v_add_f32 v23, v23, v238
    v_mfma_f32_16x16x32_bf16 v[216:219], a[96:99], a[0:3], v[192:195]
    v_exp_f32 v239, v239
    v_mfma_f32_16x16x32_bf16 v[216:219], a[100:103], a[4:7], v[216:219]
    v_add_f32 v23, v23, v239
    v_cvt_pk_bf16_f32 v233, v238, v239
    v_mfma_f32_16x16x32_bf16 v[216:219], a[104:107], a[8:11], v[216:219]
    v_exp_f32 v240, v240
    v_mfma_f32_16x16x32_bf16 v[216:219], a[108:111], a[12:15], v[216:219]
    v_add_f32 v23, v23, v240
    v_mfma_f32_16x16x32_bf16 v[220:223], a[112:115], a[0:3], v[192:195]
    v_exp_f32 v241, v241
    v_mfma_f32_16x16x32_bf16 v[220:223], a[116:119], a[4:7], v[220:223]
    v_add_f32 v23, v23, v241
    v_cvt_pk_bf16_f32 v234, v240, v241
    v_mfma_f32_16x16x32_bf16 v[220:223], a[120:123], a[8:11], v[220:223]
    v_exp_f32 v242, v242
    v_mfma_f32_16x16x32_bf16 v[220:223], a[124:127], a[12:15], v[220:223]
    v_add_f32 v23, v23, v242
    s_waitcnt lgkmcnt(0)
    v_mfma_f32_16x16x32_bf16 v[224:227], a[128:131], a[0:3], v[192:195]
    v_exp_f32 v243, v243
    v_mfma_f32_16x16x32_bf16 v[224:227], a[132:135], a[4:7], v[224:227]
    v_add_f32 v23, v23, v243
    v_cvt_pk_bf16_f32 v235, v242, v243
    v_mfma_f32_16x16x32_bf16 v[224:227], a[136:139], a[8:11], v[224:227]
    v_exp_f32 v212, v212
    v_mfma_f32_16x16x32_bf16 v[224:227], a[140:143], a[12:15], v[224:227]
    v_add_f32 v19, v19, v212
L_b2g1:
    v_mfma_f32_16x16x32_bf16 v[160:163], a[144:147], v[228:231], v[160:163]
    v_exp_f32 v213, v213
    v_mfma_f32_16x16x32_bf16 v[160:163], a[176:179], v[232:235], v[160:163]
    ds_read_b64_tr_b16 a[144:145], v5 offset:32768
    ds_read_b64_tr_b16 a[146:147], v5 offset:36864
    v_add_f32 v19, v19, v213
    v_cvt_pk_bf16_f32 v212, v212, v213
    v_mfma_f32_16x16x32_bf16 v[164:167], a[148:151], v[228:231], v[164:167]
    v_exp_f32 v214, v214
    v_mfma_f32_16x16x32_bf16 v[164:167], a[180:183], v[232:235], v[164:167]
    ds_read_b64_tr_b16 a[176:177], v5 offset:40960
    ds_read_b64_tr_b16 a[178:179], v5 offset:45056
    v_add_f32 v19, v19, v214
    v_mfma_f32_16x16x32_bf16 v[168:171], a[152:155], v[228:231], v[168:171]
    v_exp_f32 v215, v215
    v_mfma_f32_16x16x32_bf16 v[168:171], a[184:187], v[232:235], v[168:171]
    ds_read_b64_tr_b16 a[148:149], v6 offset:32768
    ds_read_b64_tr_b16 a[150:151], v6 offset:36864
    v_add_f32 v19, v19, v215
    v_cvt_pk_bf16_f32 v213, v214, v215
    v_mfma_f32_16x16x32_bf16 v[172:175], a[156:159], v[228:231], v[172:175]
    v_exp_f32 v216, v216
    v_mfma_f32_16x16x32_bf16 v[172:175], a[188:191], v[232:235], v[172:175]
    ds_read_b64_tr_b16 a[180:181], v6 offset:40960
    ds_read_b64_tr_b16 a[182:183], v6 offset:45056
    v_add_f32 v19, v19, v216
    v_mfma_f32_16x16x32_bf16 v[176:179], a[160:163], v[228:231], v[176:179]
    v_exp_f32 v217, v217
    v_mfma_f32_16x16x32_bf16 v[176:179], a[192:195], v[232:235], v[176:179]
    ds_read_b64_tr_b16 a[152:153], v7 offset:32768
    ds_read_b64_tr_b16 a[154:155], v7 offset:36864
    v_add_f32 v19, v19, v217
    v_cvt_pk_bf16_f32 v214, v216, v217
    v_mfma_f32_16x16x32_bf16 v[180:183], a[164:167], v[228:231], v[180:183]
    v_exp_f32 v218, v218
    v_mfma_f32_16x16x32_bf16 v[180:183], a[196:199], v[232:235], v[180:183]
    ds_read_b64_tr_b16 a[184:185], v7 offset:40960
    ds_read_b64_tr_b16 a[186:187], v7 offset:45056
    v_add_f32 v19, v19, v218
    v_mfma_f32_16x16x32_bf16 v[184:187], a[168:171], v[228:231], v[184:187]
    v_exp_f32 v219, v219
    v_mfma_f32_16x16x32_bf16 v[184:187], a[200:203], v[232:235], v[184:187]
    ds_read_b64_tr_b16 a[156:157], v8 offset:32768
    ds_read_b64_tr_b16 a[158:159], v8 offset:36864
    v_add_f32 v19, v19, v219
    v_cvt_pk_bf16_f32 v215, v218, v219
    v_mfma_f32_16x16x32_bf16 v[188:191], a[172:175], v[228:231], v[188:191]
    v_exp_f32 v220, v220
    v_mfma_f32_16x16x32_bf16 v[188:191], a[204:207], v[232:235], v[188:191]
    ds_read_b64_tr_b16 a[188:189], v8 offset:40960
    ds_read_b64_tr_b16 a[190:191], v8 offset:45056
    v_add_f32 v19, v19, v220
    v_mfma_f32_16x16x32_bf16 v[228:231], a[80:83], a[16:19], v[196:199]
    v_exp_f32 v221, v221
    v_mfma_f32_16x16x32_bf16 v[228:231], a[84:87], a[20:23], v[228:231]
    ds_read_b64_tr_b16 a[160:161], v9 offset:32768
    ds_read_b64_tr_b16 a[162:163], v9 offset:36864
    v_add_f32 v19, v19, v221
    v_cvt_pk_bf16_f32 v216, v220, v221
    v_mfma_f32_16x16x32_bf16 v[228:231], a[88:91], a[24:27], v[228:231]
    v_exp_f32 v222, v222
    v_mfma_f32_16x16x32_bf16 v[228:231], a[92:95], a[28:31], v[228:231]
    ds_read_b64_tr_b16 a[192:193], v9 offset:40960
    ds_read_b64_tr_b16 a[194:195], v9 offset:45056
    v_add_f32 v19, v19, v222
    v_mfma_f32_16x16x32_bf16 v[232:235], a[96:99], a[16:19], v[196:199]
    v_exp_f32 v223, v223
    v_mfma_f32_16x16x32_bf16 v[232:235], a[100:103], a[20:23], v[232:235]
    ds_read_b64_tr_b16 a[164:165], v10 offset:32768
    ds_read_b64_tr_b16 a[166:167], v10 offset:36864
    v_add_f32 v19, v19, v223
    v_cvt_pk_bf16_f32 v217, v222, v223
    v_mfma_f32_16x16x32_bf16 v[232:235], a[104:107], a[24:27], v[232:235]
    v_exp_f32 v224, v224
    v_mfma_f32_16x16x32_bf16 v[232:235], a[108:111], a[28:31], v[232:235]
    ds_read_b64_tr_b16 a[196:197], v10 offset:40960
    ds_read_b64_tr_b16 a[198:199], v10 offset:45056
    v_add_f32 v19, v19, v224
    v_mfma_f32_16x16x32_bf16 v[236:239], a[112:115], a[16:19], v[196:199]
    v_exp_f32 v225, v225
    v_mfma_f32_16x16x32_bf16 v[236:239], a[116:119], a[20:23], v[236:239]
    ds_read_b64_tr_b16 a[168:169], v11 offset:32768
    ds_read_b64_tr_b16 a[170:171], v11 offset:36864
    v_add_f32 v19, v19, v225
    v_cvt_pk_bf16_f32 v218, v224, v225
    v_mfma_f32_16x16x32_bf16 v[236:239], a[120:123], a[24:27], v[236:239]
    v_exp_f32 v226, v226
    v_mfma_f32_16x16x32_bf16 v[236:239], a[124:127], a[28:31], v[236:239]
    ds_read_b64_tr_b16 a[200:201], v11 offset:40960
    ds_read_b64_tr_b16 a[202:203], v11 offset:45056
    v_add_f32 v19, v19, v226
    v_mfma_f32_16x16x32_bf16 v[240:243], a[128:131], a[16:19], v[196:199]
    v_exp_f32 v227, v227
    v_mfma_f32_16x16x32_bf16 v[240:243], a[132:135], a[20:23], v[240:243]
    ds_read_b64_tr_b16 a[172:173], v12 offset:32768
    ds_read_b64_tr_b16 a[174:175], v12 offset:36864
    v_add_f32 v19, v19, v227
    v_cvt_pk_bf16_f32 v219, v226, v227
    v_mfma_f32_16x16x32_bf16 v[240:243], a[136:139], a[24:27], v[240:243]
    v_exp_f32 v228, v228
    v_mfma_f32_16x16x32_bf16 v[240:243], a[140:143], a[28:31], v[240:243]
    ds_read_b64_tr_b16 a[204:205], v12 offset:40960
    ds_read_b64_tr_b16 a[206:207], v12 offset:45056
    v_add_f32 v20, v20, v228
    s_waitcnt lgkmcnt(8)
    v_mfma_f32_16x16x32_bf16 v[32:35], a[144:147], v[212:215], v[32:35]
    v_exp_f32 v229, v229
    v_mfma_f32_16x16x32_bf16 v[32:35], a[176:179], v[216:219], v[32:35]
    v_add_f32 v20, v20, v229
    v_cvt_pk_bf16_f32 v228, v228, v229
    v_mfma_f32_16x16x32_bf16 v[36:39], a[148:151], v[212:215], v[36:39]
    v_exp_f32 v230, v230
    v_mfma_f32_16x16x32_bf16 v[36:39], a[180:183], v[216:219], v[36:39]
    s_and_b32 m0, s28, 0xffff
    v_add_f32 v20, v20, v230
    v_mfma_f32_16x16x32_bf16 v[40:43], a[152:155], v[212:215], v[40:43]
    v_exp_f32 v231, v231
    v_mfma_f32_16x16x32_bf16 v[40:43], a[184:187], v[216:219], v[40:43]
    v_add_f32 v20, v20, v231
    v_cvt_pk_bf16_f32 v229, v230, v231
    v_mfma_f32_16x16x32_bf16 v[44:47], a[156:159], v[212:215], v[44:47]
    v_exp_f32 v232, v232
    v_mfma_f32_16x16x32_bf16 v[44:47], a[188:191], v[216:219], v[44:47]
    buffer_load_dwordx4 v13, s[12:15], s28 offen offset:0 nt lds
    v_add_f32 v20, v20, v232
    v_mfma_f32_16x16x32_bf16 v[48:51], a[160:163], v[212:215], v[48:51]
    v_exp_f32 v233, v233
    v_mfma_f32_16x16x32_bf16 v[48:51], a[192:195], v[216:219], v[48:51]
    v_add_f32 v20, v20, v233
    v_cvt_pk_bf16_f32 v230, v232, v233
    v_mfma_f32_16x16x32_bf16 v[52:55], a[164:167], v[212:215], v[52:55]
    v_exp_f32 v234, v234
    v_mfma_f32_16x16x32_bf16 v[52:55], a[196:199], v[216:219], v[52:55]
    v_add_f32 v20, v20, v234
    s_waitcnt lgkmcnt(0)
    v_mfma_f32_16x16x32_bf16 v[56:59], a[168:171], v[212:215], v[56:59]
    v_exp_f32 v235, v235
    v_mfma_f32_16x16x32_bf16 v[56:59], a[200:203], v[216:219], v[56:59]
    v_add_f32 v20, v20, v235
    v_cvt_pk_bf16_f32 v231, v234, v235
    v_mfma_f32_16x16x32_bf16 v[60:63], a[172:175], v[212:215], v[60:63]
    v_exp_f32 v236, v236
    v_mfma_f32_16x16x32_bf16 v[60:63], a[204:207], v[216:219], v[60:63]
    buffer_load_dwordx4 v14, s[12:15], s28 offen offset:1024 nt lds
    v_add_f32 v20, v20, v236
    v_mfma_f32_16x16x32_bf16 v[212:215], a[80:83], a[32:35], v[200:203]
    v_exp_f32 v237, v237
    v_mfma_f32_16x16x32_bf16 v[212:215], a[84:87], a[36:39], v[212:215]
    v_add_f32 v20, v20, v237
    v_cvt_pk_bf16_f32 v232, v236, v237
    v_mfma_f32_16x16x32_bf16 v[212:215], a[88:91], a[40:43], v[212:215]
    v_exp_f32 v238, v238
    v_mfma_f32_16x16x32_bf16 v[212:215], a[92:95], a[44:47], v[212:215]
    buffer_load_dwordx4 v15, s[12:15], s28 offen offset:2048 nt lds
    v_add_f32 v20, v20, v238
    v_mfma_f32_16x16x32_bf16 v[216:219], a[96:99], a[32:35], v[200:203]
    v_exp_f32 v239, v239
    v_mfma_f32_16x16x32_bf16 v[216:219], a[100:103], a[36:39], v[216:219]
    v_add_f32 v20, v20, v239
    v_cvt_pk_bf16_f32 v233, v238, v239
    v_mfma_f32_16x16x32_bf16 v[216:219], a[104:107], a[40:43], v[216:219]
    v_exp_f32 v240, v240
    v_mfma_f32_16x16x32_bf16 v[216:219], a[108:111], a[44:47], v[216:219]
    buffer_load_dwordx4 v16, s[12:15], s28 offen offset:3072 nt lds
    v_add_f32 v20, v20, v240
    v_mfma_f32_16x16x32_bf16 v[220:223], a[112:115], a[32:35], v[200:203]
    v_exp_f32 v241, v241
    v_mfma_f32_16x16x32_bf16 v[220:223], a[116:119], a[36:39], v[220:223]
    v_add_f32 v20, v20, v241
    v_cvt_pk_bf16_f32 v234, v240, v241
    v_mfma_f32_16x16x32_bf16 v[220:223], a[120:123], a[40:43], v[220:223]
    v_exp_f32 v242, v242
    v_mfma_f32_16x16x32_bf16 v[220:223], a[124:127], a[44:47], v[220:223]
    s_add_u32 m0, m0, 65536
    v_add_f32 v20, v20, v242
    v_mfma_f32_16x16x32_bf16 v[224:227], a[128:131], a[32:35], v[200:203]
    v_exp_f32 v243, v243
    v_mfma_f32_16x16x32_bf16 v[224:227], a[132:135], a[36:39], v[224:227]
    v_add_f32 v20, v20, v243
    v_cvt_pk_bf16_f32 v235, v242, v243
    v_mfma_f32_16x16x32_bf16 v[224:227], a[136:139], a[40:43], v[224:227]
    v_exp_f32 v212, v212
    v_mfma_f32_16x16x32_bf16 v[224:227], a[140:143], a[44:47], v[224:227]
    buffer_load_dwordx4 v17, s[16:19], s28 offen offset:0 nt lds
    v_add_f32 v21, v21, v212
    v_mfma_f32_16x16x32_bf16 v[64:67], a[144:147], v[228:231], v[64:67]
    v_exp_f32 v213, v213
    v_mfma_f32_16x16x32_bf16 v[64:67], a[176:179], v[232:235], v[64:67]
    v_add_f32 v21, v21, v213
    v_cvt_pk_bf16_f32 v212, v212, v213
    v_mfma_f32_16x16x32_bf16 v[68:71], a[148:151], v[228:231], v[68:71]
    v_exp_f32 v214, v214
    v_mfma_f32_16x16x32_bf16 v[68:71], a[180:183], v[232:235], v[68:71]
    buffer_load_dwordx4 v18, s[16:19], s28 offen offset:1024 nt lds
    v_add_f32 v21, v21, v214
    v_mfma_f32_16x16x32_bf16 v[72:75], a[152:155], v[228:231], v[72:75]
    v_exp_f32 v215, v215
    v_mfma_f32_16x16x32_bf16 v[72:75], a[184:187], v[232:235], v[72:75]
    v_add_f32 v21, v21, v215
    v_cvt_pk_bf16_f32 v213, v214, v215
    v_mfma_f32_16x16x32_bf16 v[76:79], a[156:159], v[228:231], v[76:79]
    v_exp_f32 v216, v216
    v_mfma_f32_16x16x32_bf16 v[76:79], a[188:191], v[232:235], v[76:79]
    buffer_load_dwordx4 v17, s[16:19], s28 offen offset:2048 nt lds
    v_add_f32 v21, v21, v216
    v_mfma_f32_16x16x32_bf16 v[80:83], a[160:163], v[228:231], v[80:83]
    v_exp_f32 v217, v217
    v_mfma_f32_16x16x32_bf16 v[80:83], a[192:195], v[232:235], v[80:83]
    v_add_f32 v21, v21, v217
    v_cvt_pk_bf16_f32 v214, v216, v217
    v_mfma_f32_16x16x32_bf16 v[84:87], a[164:167], v[228:231], v[84:87]
    v_exp_f32 v218, v218
    v_mfma_f32_16x16x32_bf16 v[84:87], a[196:199], v[232:235], v[84:87]
    buffer_load_dwordx4 v18, s[16:19], s28 offen offset:3072 nt lds
    v_add_f32 v21, v21, v218
    v_mfma_f32_16x16x32_bf16 v[88:91], a[168:171], v[228:231], v[88:91]
    v_exp_f32 v219, v219
    v_mfma_f32_16x16x32_bf16 v[88:91], a[200:203], v[232:235], v[88:91]
    v_add_f32 v21, v21, v219
    v_cvt_pk_bf16_f32 v215, v218, v219
    v_mfma_f32_16x16x32_bf16 v[92:95], a[172:175], v[228:231], v[92:95]
    v_exp_f32 v220, v220
    v_mfma_f32_16x16x32_bf16 v[92:95], a[204:207], v[232:235], v[92:95]
    s_add_u32 s28, s28, 16384
    v_add_f32 v21, v21, v220
    v_mfma_f32_16x16x32_bf16 v[228:231], a[80:83], a[48:51], v[204:207]
    v_exp_f32 v221, v221
    v_mfma_f32_16x16x32_bf16 v[228:231], a[84:87], a[52:55], v[228:231]
    v_add_f32 v21, v21, v221
    v_cvt_pk_bf16_f32 v216, v220, v221
    v_mfma_f32_16x16x32_bf16 v[228:231], a[88:91], a[56:59], v[228:231]
    v_exp_f32 v222, v222
    v_mfma_f32_16x16x32_bf16 v[228:231], a[92:95], a[60:63], v[228:231]
    s_sub_u32 s30, s30, 1
    v_add_f32 v21, v21, v222
    v_mfma_f32_16x16x32_bf16 v[232:235], a[96:99], a[48:51], v[204:207]
    v_exp_f32 v223, v223
    v_mfma_f32_16x16x32_bf16 v[232:235], a[100:103], a[52:55], v[232:235]
    v_add_f32 v21, v21, v223
    v_cvt_pk_bf16_f32 v217, v222, v223
    v_mfma_f32_16x16x32_bf16 v[232:235], a[104:107], a[56:59], v[232:235]
    v_exp_f32 v224, v224
    v_mfma_f32_16x16x32_bf16 v[232:235], a[108:111], a[60:63], v[232:235]
    v_add_f32 v21, v21, v224
    v_mfma_f32_16x16x32_bf16 v[236:239], a[112:115], a[48:51], v[204:207]
    v_exp_f32 v225, v225
    v_mfma_f32_16x16x32_bf16 v[236:239], a[116:119], a[52:55], v[236:239]
    v_add_f32 v21, v21, v225
    v_cvt_pk_bf16_f32 v218, v224, v225
    v_mfma_f32_16x16x32_bf16 v[236:239], a[120:123], a[56:59], v[236:239]
    v_exp_f32 v226, v226
    v_mfma_f32_16x16x32_bf16 v[236:239], a[124:127], a[60:63], v[236:239]
    v_add_f32 v21, v21, v226
    v_mfma_f32_16x16x32_bf16 v[240:243], a[128:131], a[48:51], v[204:207]
    v_exp_f32 v227, v227
    v_mfma_f32_16x16x32_bf16 v[240:243], a[132:135], a[52:55], v[240:243]
    v_add_f32 v21, v21, v227
    v_cvt_pk_bf16_f32 v219, v226, v227
    v_mfma_f32_16x16x32_bf16 v[240:243], a[136:139], a[56:59], v[240:243]
    v_exp_f32 v228, v228
    v_mfma_f32_16x16x32_bf16 v[240:243], a[140:143], a[60:63], v[240:243]
    v_add_f32 v22, v22, v228
    v_mfma_f32_16x16x32_bf16 v[96:99], a[144:147], v[212:215], v[96:99]
    v_exp_f32 v229, v229
    v_mfma_f32_16x16x32_bf16 v[96:99], a[176:179], v[216:219], v[96:99]
    v_add_f32 v22, v22, v229
    v_cvt_pk_bf16_f32 v228, v228, v229
    v_mfma_f32_16x16x32_bf16 v[100:103], a[148:151], v[212:215], v[100:103]
    v_exp_f32 v230, v230
    v_mfma_f32_16x16x32_bf16 v[100:103], a[180:183], v[216:219], v[100:103]
    v_add_f32 v22, v22, v230
    v_mfma_f32_16x16x32_bf16 v[104:107], a[152:155], v[212:215], v[104:107]
    v_exp_f32 v231, v231
    v_mfma_f32_16x16x32_bf16 v[104:107], a[184:187], v[216:219], v[104:107]
    v_add_f32 v22, v22, v231
    v_cvt_pk_bf16_f32 v229, v230, v231
    v_mfma_f32_16x16x32_bf16 v[108:111], a[156:159], v[212:215], v[108:111]
    v_exp_f32 v232, v232
    v_mfma_f32_16x16x32_bf16 v[108:111], a[188:191], v[216:219], v[108:111]
    v_add_f32 v22, v22, v232
    v_mfma_f32_16x16x32_bf16 v[112:115], a[160:163], v[212:215], v[112:115]
    v_exp_f32 v233, v233
    v_mfma_f32_16x16x32_bf16 v[112:115], a[192:195], v[216:219], v[112:115]
    v_add_f32 v22, v22, v233
    v_cvt_pk_bf16_f32 v230, v232, v233
    v_mfma_f32_16x16x32_bf16 v[116:119], a[164:167], v[212:215], v[116:119]
    v_exp_f32 v234, v234
    v_mfma_f32_16x16x32_bf16 v[116:119], a[196:199], v[216:219], v[116:119]
    v_add_f32 v22, v22, v234
    v_mfma_f32_16x16x32_bf16 v[120:123], a[168:171], v[212:215], v[120:123]
    v_exp_f32 v235, v235
    v_mfma_f32_16x16x32_bf16 v[120:123], a[200:203], v[216:219], v[120:123]
    v_add_f32 v22, v22, v235
    v_cvt_pk_bf16_f32 v231, v234, v235
    v_mfma_f32_16x16x32_bf16 v[124:127], a[172:175], v[212:215], v[124:127]
    v_exp_f32 v236, v236
    v_mfma_f32_16x16x32_bf16 v[124:127], a[204:207], v[216:219], v[124:127]
    v_add_f32 v22, v22, v236
    s_waitcnt vmcnt(8)
    s_barrier
    v_mfma_f32_16x16x32_bf16 v[212:215], a[80:83], a[64:67], v[208:211]
    v_exp_f32 v237, v237
    v_mfma_f32_16x16x32_bf16 v[212:215], a[84:87], a[68:71], v[212:215]
    ds_read_b128 a[80:83], v1 offset:49152
    v_add_f32 v22, v22, v237
    v_cvt_pk_bf16_f32 v232, v236, v237
    v_mfma_f32_16x16x32_bf16 v[212:215], a[88:91], a[72:75], v[212:215]
    v_exp_f32 v238, v238
    v_mfma_f32_16x16x32_bf16 v[212:215], a[92:95], a[76:79], v[212:215]
    ds_read_b128 a[84:87], v2 offset:49152
    v_add_f32 v22, v22, v238
    v_mfma_f32_16x16x32_bf16 v[216:219], a[96:99], a[64:67], v[208:211]
    v_exp_f32 v239, v239
    v_mfma_f32_16x16x32_bf16 v[216:219], a[100:103], a[68:71], v[216:219]
    ds_read_b128 a[88:91], v3 offset:49152
    v_add_f32 v22, v22, v239
    v_cvt_pk_bf16_f32 v233, v238, v239
    v_mfma_f32_16x16x32_bf16 v[216:219], a[104:107], a[72:75], v[216:219]
    v_exp_f32 v240, v240
    v_mfma_f32_16x16x32_bf16 v[216:219], a[108:111], a[76:79], v[216:219]
    ds_read_b128 a[92:95], v4 offset:49152
    v_add_f32 v22, v22, v240
    v_mfma_f32_16x16x32_bf16 v[220:223], a[112:115], a[64:67], v[208:211]
    v_exp_f32 v241, v241
    v_mfma_f32_16x16x32_bf16 v[220:223], a[116:119], a[68:71], v[220:223]
    ds_read_b128 a[96:99], v1 offset:53248
    v_add_f32 v22, v22, v241
    v_cvt_pk_bf16_f32 v234, v240, v241
    v_mfma_f32_16x16x32_bf16 v[220:223], a[120:123], a[72:75], v[220:223]
    v_exp_f32 v242, v242
    v_mfma_f32_16x16x32_bf16 v[220:223], a[124:127], a[76:79], v[220:223]
    ds_read_b128 a[100:103], v2 offset:53248
    v_add_f32 v22, v22, v242
    v_mfma_f32_16x16x32_bf16 v[224:227], a[128:131], a[64:67], v[208:211]
    v_exp_f32 v243, v243
    v_mfma_f32_16x16x32_bf16 v[224:227], a[132:135], a[68:71], v[224:227]
    ds_read_b128 a[104:107], v3 offset:53248
    v_add_f32 v22, v22, v243
    v_cvt_pk_bf16_f32 v235, v242, v243
    v_mfma_f32_16x16x32_bf16 v[224:227], a[136:139], a[72:75], v[224:227]
    v_exp_f32 v212, v212
    v_mfma_f32_16x16x32_bf16 v[224:227], a[140:143], a[76:79], v[224:227]
    ds_read_b128 a[108:111], v4 offset:53248
    v_add_f32 v23, v23, v212
    v_mfma_f32_16x16x32_bf16 v[128:131], a[144:147], v[228:231], v[128:131]
    v_exp_f32 v213, v213
    v_mfma_f32_16x16x32_bf16 v[128:131], a[176:179], v[232:235], v[128:131]
    ds_read_b128 a[112:115], v1 offset:57344
    v_add_f32 v23, v23, v213
    v_cvt_pk_bf16_f32 v212, v212, v213
    v_mfma_f32_16x16x32_bf16 v[132:135], a[148:151], v[228:231], v[132:135]
    v_exp_f32 v214, v214
    v_mfma_f32_16x16x32_bf16 v[132:135], a[180:183], v[232:235], v[132:135]
    ds_read_b128 a[116:119], v2 offset:57344
    v_add_f32 v23, v23, v214
    v_mfma_f32_16x16x32_bf16 v[136:139], a[152:155], v[228:231], v[136:139]
    v_exp_f32 v215, v215
    v_mfma_f32_16x16x32_bf16 v[136:139], a[184:187], v[232:235], v[136:139]
    ds_read_b128 a[120:123], v3 offset:57344
    v_add_f32 v23, v23, v215
    v_cvt_pk_bf16_f32 v213, v214, v215
    v_mfma_f32_16x16x32_bf16 v[140:143], a[156:159], v[228:231], v[140:143]
    v_exp_f32 v216, v216
    v_mfma_f32_16x16x32_bf16 v[140:143], a[188:191], v[232:235], v[140:143]
    ds_read_b128 a[124:127], v4 offset:57344
    v_add_f32 v23, v23, v216
    v_mfma_f32_16x16x32_bf16 v[144:147], a[160:163], v[228:231], v[144:147]
    v_exp_f32 v217, v217
    v_mfma_f32_16x16x32_bf16 v[144:147], a[192:195], v[232:235], v[144:147]
    ds_read_b128 a[128:131], v1 offset:61440
    v_add_f32 v23, v23, v217
    v_cvt_pk_bf16_f32 v214, v216, v217
    v_mfma_f32_16x16x32_bf16 v[148:151], a[164:167], v[228:231], v[148:151]
    v_exp_f32 v218, v218
    v_mfma_f32_16x16x32_bf16 v[148:151], a[196:199], v[232:235], v[148:151]
    ds_read_b128 a[132:135], v2 offset:61440
    s_cmp_eq_u32 s30, s40
    v_add_f32 v23, v23, v218
    v_mfma_f32_16x16x32_bf16 v[152:155], a[168:171], v[228:231], v[152:155]
    v_exp_f32 v219, v219
    v_mfma_f32_16x16x32_bf16 v[152:155], a[200:203], v[232:235], v[152:155]
    ds_read_b128 a[136:139], v3 offset:61440
    v_add_f32 v23, v23, v219
    v_cvt_pk_bf16_f32 v215, v218, v219
    v_mfma_f32_16x16x32_bf16 v[156:159], a[172:175], v[228:231], v[156:159]
    v_exp_f32 v220, v220
    v_mfma_f32_16x16x32_bf16 v[156:159], a[204:207], v[232:235], v[156:159]
    ds_read_b128 a[140:143], v4 offset:61440
    v_add_f32 v23, v23, v220
    s_cbranch_scc1 L_exit
L_b3:
    s_waitcnt lgkmcnt(4)
    v_mfma_f32_16x16x32_bf16 v[228:231], a[80:83], a[0:3], v[192:195]
    v_exp_f32 v221, v221
    v_mfma_f32_16x16x32_bf16 v[228:231], a[84:87], a[4:7], v[228:231]
    v_add_f32 v23, v23, v221
    v_cvt_pk_bf16_f32 v216, v220, v221
    v_mfma_f32_16x16x32_bf16 v[228:231], a[88:91], a[8:11], v[228:231]
    v_exp_f32 v222, v222
    v_mfma_f32_16x16x32_bf16 v[228:231], a[92:95], a[12:15], v[228:231]
    v_add_f32 v23, v23, v222
    v_mfma_f32_16x16x32_bf16 v[232:235], a[96:99], a[0:3], v[192:195]
    v_exp_f32 v223, v223
    v_mfma_f32_16x16x32_bf16 v[232:235], a[100:103], a[4:7], v[232:235]
    v_add_f32 v23, v23, v223
    v_cvt_pk_bf16_f32 v217, v222, v223
    v_mfma_f32_16x16x32_bf16 v[232:235], a[104:107], a[8:11], v[232:235]
    v_exp_f32 v224, v224
    v_mfma_f32_16x16x32_bf16 v[232:235], a[108:111], a[12:15], v[232:235]
    v_add_f32 v23, v23, v224
    v_mfma_f32_16x16x32_bf16 v[236:239], a[112:115], a[0:3], v[192:195]
    v_exp_f32 v225, v225
    v_mfma_f32_16x16x32_bf16 v[236:239], a[116:119], a[4:7], v[236:239]
    v_add_f32 v23, v23, v225
    v_cvt_pk_bf16_f32 v218, v224, v225
    v_mfma_f32_16x16x32_bf16 v[236:239], a[120:123], a[8:11], v[236:239]
    v_exp_f32 v226, v226
    v_mfma_f32_16x16x32_bf16 v[236:239], a[124:127], a[12:15], v[236:239]
    v_add_f32 v23, v23, v226
    s_waitcnt lgkmcnt(0)
    v_mfma_f32_16x16x32_bf16 v[240:243], a[128:131], a[0:3], v[192:195]
    v_exp_f32 v227, v227
    v_mfma_f32_16x16x32_bf16 v[240:243], a[132:135], a[4:7], v[240:243]
    v_add_f32 v23, v23, v227
    v_cvt_pk_bf16_f32 v219, v226, v227
    v_mfma_f32_16x16x32_bf16 v[240:243], a[136:139], a[8:11], v[240:243]
    v_exp_f32 v228, v228
    v_mfma_f32_16x16x32_bf16 v[240:243], a[140:143], a[12:15], v[240:243]
    v_add_f32 v19, v19, v228
L_b3g1:
    v_mfma_f32_16x16x32_bf16 v[160:163], a[144:147], v[212:215], v[160:163]
    v_exp_f32 v229, v229
    v_mfma_f32_16x16x32_bf16 v[160:163], a[176:179], v[216:219], v[160:163]
    ds_read_b64_tr_b16 a[144:145], v5 offset:49152
    ds_read_b64_tr_b16 a[146:147], v5 offset:53248
    v_add_f32 v19, v19, v229
    v_cvt_pk_bf16_f32 v228, v228, v229
    v_mfma_f32_16x16x32_bf16 v[164:167], a[148:151], v[212:215], v[164:167]
    v_exp_f32 v230, v230
    v_mfma_f32_16x16x32_bf16 v[164:167], a[180:183], v[216:219], v[164:167]
    ds_read_b64_tr_b16 a[176:177], v5 offset:57344
    ds_read_b64_tr_b16 a[178:179], v5 offset:61440
    v_add_f32 v19, v19, v230
    v_mfma_f32_16x16x32_bf16 v[168:171], a[152:155], v[212:215], v[168:171]
    v_exp_f32 v231, v231
    v_mfma_f32_16x16x32_bf16 v[168:171], a[184:187], v[216:219], v[168:171]
    ds_read_b64_tr_b16 a[148:149], v6 offset:49152
    ds_read_b64_tr_b16 a[150:151], v6 offset:53248
    v_add_f32 v19, v19, v231
    v_cvt_pk_bf16_f32 v229, v230, v231
    v_mfma_f32_16x16x32_bf16 v[172:175], a[156:159], v[212:215], v[172:175]
    v_exp_f32 v232, v232
    v_mfma_f32_16x16x32_bf16 v[172:175], a[188:191], v[216:219], v[172:175]
    ds_read_b64_tr_b16 a[180:181], v6 offset:57344
    ds_read_b64_tr_b16 a[182:183], v6 offset:61440
    v_add_f32 v19, v19, v232
    v_mfma_f32_16x16x32_bf16 v[176:179], a[160:163], v[212:215], v[176:179]
    v_exp_f32 v233, v233
    v_mfma_f32_16x16x32_bf16 v[176:179], a[192:195], v[216:219], v[176:179]
    ds_read_b64_tr_b16 a[152:153], v7 offset:49152
    ds_read_b64_tr_b16 a[154:155], v7 offset:53248
    v_add_f32 v19, v19, v233
    v_cvt_pk_bf16_f32 v230, v232, v233
    v_mfma_f32_16x16x32_bf16 v[180:183], a[164:167], v[212:215], v[180:183]
    v_exp_f32 v234, v234
    v_mfma_f32_16x16x32_bf16 v[180:183], a[196:199], v[216:219], v[180:183]
    ds_read_b64_tr_b16 a[184:185], v7 offset:57344
    ds_read_b64_tr_b16 a[186:187], v7 offset:61440
    v_add_f32 v19, v19, v234
    v_mfma_f32_16x16x32_bf16 v[184:187], a[168:171], v[212:215], v[184:187]
    v_exp_f32 v235, v235
    v_mfma_f32_16x16x32_bf16 v[184:187], a[200:203], v[216:219], v[184:187]
    ds_read_b64_tr_b16 a[156:157], v8 offset:49152
    ds_read_b64_tr_b16 a[158:159], v8 offset:53248
    v_add_f32 v19, v19, v235
    v_cvt_pk_bf16_f32 v231, v234, v235
    v_mfma_f32_16x16x32_bf16 v[188:191], a[172:175], v[212:215], v[188:191]
    v_exp_f32 v236, v236
    v_mfma_f32_16x16x32_bf16 v[188:191], a[204:207], v[216:219], v[188:191]
    ds_read_b64_tr_b16 a[188:189], v8 offset:57344
    ds_read_b64_tr_b16 a[190:191], v8 offset:61440
    v_add_f32 v19, v19, v236
    v_mfma_f32_16x16x32_bf16 v[212:215], a[80:83], a[16:19], v[196:199]
    v_exp_f32 v237, v237
    v_mfma_f32_16x16x32_bf16 v[212:215], a[84:87], a[20:23], v[212:215]
    ds_read_b64_tr_b16 a[160:161], v9 offset:49152
    ds_read_b64_tr_b16 a[162:163], v9 offset:53248
    v_add_f32 v19, v19, v237
    v_cvt_pk_bf16_f32 v232, v236, v237
    v_mfma_f32_16x16x32_bf16 v[212:215], a[88:91], a[24:27], v[212:215]
    v_exp_f32 v238, v238
    v_mfma_f32_16x16x32_bf16 v[212:215], a[92:95], a[28:31], v[212:215]
    ds_read_b64_tr_b16 a[192:193], v9 offset:57344
    ds_read_b64_tr_b16 a[194:195], v9 offset:61440
    v_add_f32 v19, v19, v238
    v_mfma_f32_16x16x32_bf16 v[216:219], a[96:99], a[16:19], v[196:199]
    v_exp_f32 v239, v239
    v_mfma_f32_16x16x32_bf16 v[216:219], a[100:103], a[20:23], v[216:219]
    ds_read_b64_tr_b16 a[164:165], v10 offset:49152
    ds_read_b64_tr_b16 a[166:167], v10 offset:53248
    v_add_f32 v19, v19, v239
    v_cvt_pk_bf16_f32 v233, v238, v239
    v_mfma_f32_16x16x32_bf16 v[216:219], a[104:107], a[24:27], v[216:219]
    v_exp_f32 v240, v240
    v_mfma_f32_16x16x32_bf16 v[216:219], a[108:111], a[28:31], v[216:219]
    ds_read_b64_tr_b16 a[196:197], v10 offset:57344
    ds_read_b64_tr_b16 a[198:199], v10 offset:61440
    v_add_f32 v19, v19, v240
    v_mfma_f32_16x16x32_bf16 v[220:223], a[112:115], a[16:19], v[196:199]
    v_exp_f32 v241, v241
    v_mfma_f32_16x16x32_bf16 v[220:223], a[116:119], a[20:23], v[220:223]
    ds_read_b64_tr_b16 a[168:169], v11 offset:49152
    ds_read_b64_tr_b16 a[170:171], v11 offset:53248
    v_add_f32 v19, v19, v241
    v_cvt_pk_bf16_f32 v234, v240, v241
    v_mfma_f32_16x16x32_bf16 v[220:223], a[120:123], a[24:27], v[220:223]
    v_exp_f32 v242, v242
    v_mfma_f32_16x16x32_bf16 v[220:223], a[124:127], a[28:31], v[220:223]
    ds_read_b64_tr_b16 a[200:201], v11 offset:57344
    ds_read_b64_tr_b16 a[202:203], v11 offset:61440
    v_add_f32 v19, v19, v242
    v_mfma_f32_16x16x32_bf16 v[224:227], a[128:131], a[16:19], v[196:199]
    v_exp_f32 v243, v243
    v_mfma_f32_16x16x32_bf16 v[224:227], a[132:135], a[20:23], v[224:227]
    ds_read_b64_tr_b16 a[172:173], v12 offset:49152
    ds_read_b64_tr_b16 a[174:175], v12 offset:53248
    v_add_f32 v19, v19, v243
    v_cvt_pk_bf16_f32 v235, v242, v243
    v_mfma_f32_16x16x32_bf16 v[224:227], a[136:139], a[24:27], v[224:227]
    v_exp_f32 v212, v212
    v_mfma_f32_16x16x32_bf16 v[224:227], a[140:143], a[28:31], v[224:227]
    ds_read_b64_tr_b16 a[204:205], v12 offset:57344
    ds_read_b64_tr_b16 a[206:207], v12 offset:61440
    v_add_f32 v20, v20, v212
    s_waitcnt lgkmcnt(8)
    v_mfma_f32_16x16x32_bf16 v[32:35], a[144:147], v[228:231], v[32:35]
    v_exp_f32 v213, v213
    v_mfma_f32_16x16x32_bf16 v[32:35], a[176:179], v[232:235], v[32:35]
    v_add_f32 v20, v20, v213
    v_cvt_pk_bf16_f32 v212, v212, v213
    v_mfma_f32_16x16x32_bf16 v[36:39], a[148:151], v[228:231], v[36:39]
    v_exp_f32 v214, v214
    v_mfma_f32_16x16x32_bf16 v[36:39], a[180:183], v[232:235], v[36:39]
    s_and_b32 m0, s28, 0xffff
    v_add_f32 v20, v20, v214
    v_mfma_f32_16x16x32_bf16 v[40:43], a[152:155], v[228:231], v[40:43]
    v_exp_f32 v215, v215
    v_mfma_f32_16x16x32_bf16 v[40:43], a[184:187], v[232:235], v[40:43]
    v_add_f32 v20, v20, v215
    v_cvt_pk_bf16_f32 v213, v214, v215
    v_mfma_f32_16x16x32_bf16 v[44:47], a[156:159], v[228:231], v[44:47]
    v_exp_f32 v216, v216
    v_mfma_f32_16x16x32_bf16 v[44:47], a[188:191], v[232:235], v[44:47]
    buffer_load_dwordx4 v13, s[12:15], s28 offen offset:0 nt lds
    v_add_f32 v20, v20, v216
    v_mfma_f32_16x16x32_bf16 v[48:51], a[160:163], v[228:231], v[48:51]
    v_exp_f32 v217, v217
    v_mfma_f32_16x16x32_bf16 v[48:51], a[192:195], v[232:235], v[48:51]
    v_add_f32 v20, v20, v217
    v_cvt_pk_bf16_f32 v214, v216, v217
    v_mfma_f32_16x16x32_bf16 v[52:55], a[164:167], v[228:231], v[52:55]
    v_exp_f32 v218, v218
    v_mfma_f32_16x16x32_bf16 v[52:55], a[196:199], v[232:235], v[52:55]
    v_add_f32 v20, v20, v218
    s_waitcnt lgkmcnt(0)
    v_mfma_f32_16x16x32_bf16 v[56:59], a[168:171], v[228:231], v[56:59]
    v_exp_f32 v219, v219
    v_mfma_f32_16x16x32_bf16 v[56:59], a[200:203], v[232:235], v[56:59]
    v_add_f32 v20, v20, v219
    v_cvt_pk_bf16_f32 v215, v218, v219
    v_mfma_f32_16x16x32_bf16 v[60:63], a[172:175], v[228:231], v[60:63]
    v_exp_f32 v220, v220
    v_mfma_f32_16x16x32_bf16 v[60:63], a[204:207], v[232:235], v[60:63]
    buffer_load_dwordx4 v14, s[12:15], s28 offen offset:1024 nt lds
    v_add_f32 v20, v20, v220
    v_mfma_f32_16x16x32_bf16 v[228:231], a[80:83], a[32:35], v[200:203]
    v_exp_f32 v221, v221
    v_mfma_f32_16x16x32_bf16 v[228:231], a[84:87], a[36:39], v[228:231]
    v_add_f32 v20, v20, v221
    v_cvt_pk_bf16_f32 v216, v220, v221
    v_mfma_f32_16x16x32_bf16 v[228:231], a[88:91], a[40:43], v[228:231]
    v_exp_f32 v222, v222
    v_mfma_f32_16x16x32_bf16 v[228:231], a[92:95], a[44:47], v[228:231]
    buffer_load_dwordx4 v15, s[12:15], s28 offen offset:2048 nt lds
    v_add_f32 v20, v20, v222
    v_mfma_f32_16x16x32_bf16 v[232:235], a[96:99], a[32:35], v[200:203]
    v_exp_f32 v223, v223
    v_mfma_f32_16x16x32_bf16 v[232:235], a[100:103], a[36:39], v[232:235]
    v_add_f32 v20, v20, v223
    v_cvt_pk_bf16_f32 v217, v222, v223
    v_mfma_f32_16x16x32_bf16 v[232:235], a[104:107], a[40:43], v[232:235]
    v_exp_f32 v224, v224
    v_mfma_f32_16x16x32_bf16 v[232:235], a[108:111], a[44:47], v[232:235]
    buffer_load_dwordx4 v16, s[12:15], s28 offen offset:3072 nt lds
    v_add_f32 v20, v20, v224
    v_mfma_f32_16x16x32_bf16 v[236:239], a[112:115], a[32:35], v[200:203]
    v_exp_f32 v225, v225
    v_mfma_f32_16x16x32_bf16 v[236:239], a[116:119], a[36:39], v[236:239]
    v_add_f32 v20, v20, v225
    v_cvt_pk_bf16_f32 v218, v224, v225
    v_mfma_f32_16x16x32_bf16 v[236:239], a[120:123], a[40:43], v[236:239]
    v_exp_f32 v226, v226
    v_mfma_f32_16x16x32_bf16 v[236:239], a[124:127], a[44:47], v[236:239]
    s_add_u32 m0, m0, 65536
    v_add_f32 v20, v20, v226
    v_mfma_f32_16x16x32_bf16 v[240:243], a[128:131], a[32:35], v[200:203]
    v_exp_f32 v227, v227
    v_mfma_f32_16x16x32_bf16 v[240:243], a[132:135], a[36:39], v[240:243]
    v_add_f32 v20, v20, v227
    v_cvt_pk_bf16_f32 v219, v226, v227
    v_mfma_f32_16x16x32_bf16 v[240:243], a[136:139], a[40:43], v[240:243]
    v_exp_f32 v228, v228
    v_mfma_f32_16x16x32_bf16 v[240:243], a[140:143], a[44:47], v[240:243]
    buffer_load_dwordx4 v17, s[16:19], s28 offen offset:0 nt lds
    v_add_f32 v21, v21, v228
    v_mfma_f32_16x16x32_bf16 v[64:67], a[144:147], v[212:215], v[64:67]
    v_exp_f32 v229, v229
    v_mfma_f32_16x16x32_bf16 v[64:67], a[176:179], v[216:219], v[64:67]
    v_add_f32 v21, v21, v229
    v_cvt_pk_bf16_f32 v228, v228, v229
    v_mfma_f32_16x16x32_bf16 v[68:71], a[148:151], v[212:215], v[68:71]
    v_exp_f32 v230, v230
    v_mfma_f32_16x16x32_bf16 v[68:71], a[180:183], v[216:219], v[68:71]
    buffer_load_dwordx4 v18, s[16:19], s28 offen offset:1024 nt lds
    v_add_f32 v21, v21, v230
    v_mfma_f32_16x16x32_bf16 v[72:75], a[152:155], v[212:215], v[72:75]
    v_exp_f32 v231, v231
    v_mfma_f32_16x16x32_bf16 v[72:75], a[184:187], v[216:219], v[72:75]
    v_add_f32 v21, v21, v231
    v_cvt_pk_bf16_f32 v229, v230, v231
    v_mfma_f32_16x16x32_bf16 v[76:79], a[156:159], v[212:215], v[76:79]
    v_exp_f32 v232, v232
    v_mfma_f32_16x16x32_bf16 v[76:79], a[188:191], v[216:219], v[76:79]
    buffer_load_dwordx4 v17, s[16:19], s28 offen offset:2048 nt lds
    v_add_f32 v21, v21, v232
    v_mfma_f32_16x16x32_bf16 v[80:83], a[160:163], v[212:215], v[80:83]
    v_exp_f32 v233, v233
    v_mfma_f32_16x16x32_bf16 v[80:83], a[192:195], v[216:219], v[80:83]
    v_add_f32 v21, v21, v233
    v_cvt_pk_bf16_f32 v230, v232, v233
    v_mfma_f32_16x16x32_bf16 v[84:87], a[164:167], v[212:215], v[84:87]
    v_exp_f32 v234, v234
    v_mfma_f32_16x16x32_bf16 v[84:87], a[196:199], v[216:219], v[84:87]
    buffer_load_dwordx4 v18, s[16:19], s28 offen offset:3072 nt lds
    v_add_f32 v21, v21, v234
    v_mfma_f32_16x16x32_bf16 v[88:91], a[168:171], v[212:215], v[88:91]
    v_exp_f32 v235, v235
    v_mfma_f32_16x16x32_bf16 v[88:91], a[200:203], v[216:219], v[88:91]
    v_add_f32 v21, v21, v235
    v_cvt_pk_bf16_f32 v231, v234, v235
    v_mfma_f32_16x16x32_bf16 v[92:95], a[172:175], v[212:215], v[92:95]
    v_exp_f32 v236, v236
    v_mfma_f32_16x16x32_bf16 v[92:95], a[204:207], v[216:219], v[92:95]
    s_add_u32 s28, s28, 16384
    v_add_f32 v21, v21, v236
    v_mfma_f32_16x16x32_bf16 v[212:215], a[80:83], a[48:51], v[204:207]
    v_exp_f32 v237, v237
    v_mfma_f32_16x16x32_bf16 v[212:215], a[84:87], a[52:55], v[212:215]
    v_add_f32 v21, v21, v237
    v_cvt_pk_bf16_f32 v232, v236, v237
    v_mfma_f32_16x16x32_bf16 v[212:215], a[88:91], a[56:59], v[212:215]
    v_exp_f32 v238, v238
    v_mfma_f32_16x16x32_bf16 v[212:215], a[92:95], a[60:63], v[212:215]
    s_sub_u32 s43, s30, s40
    v_add_f32 v21, v21, v238
    v_mfma_f32_16x16x32_bf16 v[216:219], a[96:99], a[48:51], v[204:207]
    v_exp_f32 v239, v239
    v_mfma_f32_16x16x32_bf16 v[216:219], a[100:103], a[52:55], v[216:219]
    v_add_f32 v21, v21, v239
    v_cvt_pk_bf16_f32 v233, v238, v239
    v_mfma_f32_16x16x32_bf16 v[216:219], a[104:107], a[56:59], v[216:219]
    v_exp_f32 v240, v240
    v_mfma_f32_16x16x32_bf16 v[216:219], a[108:111], a[60:63], v[216:219]
    s_cmp_eq_u32 s43, 3
    v_add_f32 v21, v21, v240
    v_mfma_f32_16x16x32_bf16 v[220:223], a[112:115], a[48:51], v[204:207]
    v_exp_f32 v241, v241
    v_mfma_f32_16x16x32_bf16 v[220:223], a[116:119], a[52:55], v[220:223]
    v_add_f32 v21, v21, v241
    v_cvt_pk_bf16_f32 v234, v240, v241
    v_mfma_f32_16x16x32_bf16 v[220:223], a[120:123], a[56:59], v[220:223]
    v_exp_f32 v242, v242
    v_mfma_f32_16x16x32_bf16 v[220:223], a[124:127], a[60:63], v[220:223]
    v_add_f32 v21, v21, v242
    v_mfma_f32_16x16x32_bf16 v[224:227], a[128:131], a[48:51], v[204:207]
    v_exp_f32 v243, v243
    v_mfma_f32_16x16x32_bf16 v[224:227], a[132:135], a[52:55], v[224:227]
    v_add_f32 v21, v21, v243
    v_cvt_pk_bf16_f32 v235, v242, v243
    v_mfma_f32_16x16x32_bf16 v[224:227], a[136:139], a[56:59], v[224:227]
    v_exp_f32 v212, v212
    v_mfma_f32_16x16x32_bf16 v[224:227], a[140:143], a[60:63], v[224:227]
    v_add_f32 v22, v22, v212
    v_mfma_f32_16x16x32_bf16 v[96:99], a[144:147], v[228:231], v[96:99]
    v_exp_f32 v213, v213
    v_mfma_f32_16x16x32_bf16 v[96:99], a[176:179], v[232:235], v[96:99]
    v_add_f32 v22, v22, v213
    v_cvt_pk_bf16_f32 v212, v212, v213
    v_mfma_f32_16x16x32_bf16 v[100:103], a[148:151], v[228:231], v[100:103]
    v_exp_f32 v214, v214
    v_mfma_f32_16x16x32_bf16 v[100:103], a[180:183], v[232:235], v[100:103]
    v_add_f32 v22, v22, v214
    v_mfma_f32_16x16x32_bf16 v[104:107], a[152:155], v[228:231], v[104:107]
    v_exp_f32 v215, v215
    v_mfma_f32_16x16x32_bf16 v[104:107], a[184:187], v[232:235], v[104:107]
    v_add_f32 v22, v22, v215
    v_cvt_pk_bf16_f32 v213, v214, v215
    v_mfma_f32_16x16x32_bf16 v[108:111], a[156:159], v[228:231], v[108:111]
    v_exp_f32 v216, v216
    v_mfma_f32_16x16x32_bf16 v[108:111], a[188:191], v[232:235], v[108:111]
    v_add_f32 v22, v22, v216
    v_mfma_f32_16x16x32_bf16 v[112:115], a[160:163], v[228:231], v[112:115]
    v_exp_f32 v217, v217
    v_mfma_f32_16x16x32_bf16 v[112:115], a[192:195], v[232:235], v[112:115]
    v_add_f32 v22, v22, v217
    v_cvt_pk_bf16_f32 v214, v216, v217
    v_mfma_f32_16x16x32_bf16 v[116:119], a[164:167], v[228:231], v[116:119]
    v_exp_f32 v218, v218
    v_mfma_f32_16x16x32_bf16 v[116:119], a[196:199], v[232:235], v[116:119]
    v_add_f32 v22, v22, v218
    v_mfma_f32_16x16x32_bf16 v[120:123], a[168:171], v[228:231], v[120:123]
    v_exp_f32 v219, v219
    v_mfma_f32_16x16x32_bf16 v[120:123], a[200:203], v[232:235], v[120:123]
    v_add_f32 v22, v22, v219
    v_cvt_pk_bf16_f32 v215, v218, v219
    v_mfma_f32_16x16x32_bf16 v[124:127], a[172:175], v[228:231], v[124:127]
    v_exp_f32 v220, v220
    v_mfma_f32_16x16x32_bf16 v[124:127], a[204:207], v[232:235], v[124:127]
    v_add_f32 v22, v22, v220
    s_waitcnt vmcnt(8)
    s_barrier
    v_mfma_f32_16x16x32_bf16 v[228:231], a[80:83], a[64:67], v[208:211]
    v_exp_f32 v221, v221
    v_mfma_f32_16x16x32_bf16 v[228:231], a[84:87], a[68:71], v[228:231]
    ds_read_b128 a[80:83], v1 offset:0
    v_add_f32 v22, v22, v221
    v_cvt_pk_bf16_f32 v216, v220, v221
    v_mfma_f32_16x16x32_bf16 v[228:231], a[88:91], a[72:75], v[228:231]
    v_exp_f32 v222, v222
    v_mfma_f32_16x16x32_bf16 v[228:231], a[92:95], a[76:79], v[228:231]
    ds_read_b128 a[84:87], v2 offset:0
    v_add_f32 v22, v22, v222
    v_mfma_f32_16x16x32_bf16 v[232:235], a[96:99], a[64:67], v[208:211]
    v_exp_f32 v223, v223
    v_mfma_f32_16x16x32_bf16 v[232:235], a[100:103], a[68:71], v[232:235]
    ds_read_b128 a[88:91], v3 offset:0
    v_add_f32 v22, v22, v223
    v_cvt_pk_bf16_f32 v217, v222, v223
    v_mfma_f32_16x16x32_bf16 v[232:235], a[104:107], a[72:75], v[232:235]
    v_exp_f32 v224, v224
    v_mfma_f32_16x16x32_bf16 v[232:235], a[108:111], a[76:79], v[232:235]
    ds_read_b128 a[92:95], v4 offset:0
    v_add_f32 v22, v22, v224
    v_mfma_f32_16x16x32_bf16 v[236:239], a[112:115], a[64:67], v[208:211]
    v_exp_f32 v225, v225
    v_mfma_f32_16x16x32_bf16 v[236:239], a[116:119], a[68:71], v[236:239]
    ds_read_b128 a[96:99], v1 offset:4096
    v_add_f32 v22, v22, v225
    v_cvt_pk_bf16_f32 v218, v224, v225
    v_mfma_f32_16x16x32_bf16 v[236:239], a[120:123], a[72:75], v[236:239]
    v_exp_f32 v226, v226
    v_mfma_f32_16x16x32_bf16 v[236:239], a[124:127], a[76:79], v[236:239]
    ds_read_b128 a[100:103], v2 offset:4096
    v_add_f32 v22, v22, v226
    v_mfma_f32_16x16x32_bf16 v[240:243], a[128:131], a[64:67], v[208:211]
    v_exp_f32 v227, v227
    v_mfma_f32_16x16x32_bf16 v[240:243], a[132:135], a[68:71], v[240:243]
    ds_read_b128 a[104:107], v3 offset:4096
    v_add_f32 v22, v22, v227
    v_cvt_pk_bf16_f32 v219, v226, v227
    v_mfma_f32_16x16x32_bf16 v[240:243], a[136:139], a[72:75], v[240:243]
    v_exp_f32 v228, v228
    v_mfma_f32_16x16x32_bf16 v[240:243], a[140:143], a[76:79], v[240:243]
    ds_read_b128 a[108:111], v4 offset:4096
    v_add_f32 v23, v23, v228
    v_mfma_f32_16x16x32_bf16 v[128:131], a[144:147], v[212:215], v[128:131]
    v_exp_f32 v229, v229
    v_mfma_f32_16x16x32_bf16 v[128:131], a[176:179], v[216:219], v[128:131]
    ds_read_b128 a[112:115], v1 offset:8192
    v_add_f32 v23, v23, v229
    v_cvt_pk_bf16_f32 v228, v228, v229
    v_mfma_f32_16x16x32_bf16 v[132:135], a[148:151], v[212:215], v[132:135]
    v_exp_f32 v230, v230
    v_mfma_f32_16x16x32_bf16 v[132:135], a[180:183], v[216:219], v[132:135]
    ds_read_b128 a[116:119], v2 offset:8192
    v_add_f32 v23, v23, v230
    v_mfma_f32_16x16x32_bf16 v[136:139], a[152:155], v[212:215], v[136:139]
    v_exp_f32 v231, v231
    v_mfma_f32_16x16x32_bf16 v[136:139], a[184:187], v[216:219], v[136:139]
    ds_read_b128 a[120:123], v3 offset:8192
    v_add_f32 v23, v23, v231
    v_cvt_pk_bf16_f32 v229, v230, v231
    v_mfma_f32_16x16x32_bf16 v[140:143], a[156:159], v[212:215], v[140:143]
    v_exp_f32 v232, v232
    v_mfma_f32_16x16x32_bf16 v[140:143], a[188:191], v[216:219], v[140:143]
    ds_read_b128 a[124:127], v4 offset:8192
    v_add_f32 v23, v23, v232
    v_mfma_f32_16x16x32_bf16 v[144:147], a[160:163], v[212:215], v[144:147]
    v_exp_f32 v233, v233
    v_mfma_f32_16x16x32_bf16 v[144:147], a[192:195], v[216:219], v[144:147]
    ds_read_b128 a[128:131], v1 offset:12288
    v_add_f32 v23, v23, v233
    v_cvt_pk_bf16_f32 v230, v232, v233
    v_mfma_f32_16x16x32_bf16 v[148:151], a[164:167], v[212:215], v[148:151]
    v_exp_f32 v234, v234
    v_mfma_f32_16x16x32_bf16 v[148:151], a[196:199], v[216:219], v[148:151]
    ds_read_b128 a[132:135], v2 offset:12288
    v_add_f32 v23, v23, v234
    v_mfma_f32_16x16x32_bf16 v[152:155], a[168:171], v[212:215], v[152:155]
    v_exp_f32 v235, v235
    v_mfma_f32_16x16x32_bf16 v[152:155], a[200:203], v[216:219], v[152:155]
    ds_read_b128 a[136:139], v3 offset:12288
    v_add_f32 v23, v23, v235
    v_cvt_pk_bf16_f32 v231, v234, v235
    v_mfma_f32_16x16x32_bf16 v[156:159], a[172:175], v[212:215], v[156:159]
    v_exp_f32 v236, v236
    v_mfma_f32_16x16x32_bf16 v[156:159], a[204:207], v[216:219], v[156:159]
    ds_read_b128 a[140:143], v4 offset:12288
    v_add_f32 v23, v23, v236
    s_cbranch_vccnz L_backb
    s_cbranch_scc1 L_qa3
    s_cmp_eq_u32 s43, 2
    s_cbranch_scc1 L_qa2
    s_branch L_qa1
L_backb:
    s_cbranch_scc1 L_qb3
    s_cmp_eq_u32 s43, 2
    s_cbranch_scc1 L_qb2
    s_branch L_qb1
L_qlds:
    s_cbranch_scc0 L_qm41
    s_cmp_eq_u32 s30, 2
    s_cbranch_scc1 L_qm2
L_qm3:
    s_waitcnt lgkmcnt(4)
    v_mfma_f32_16x16x32_bf16 v[212:215], a[80:83], a[0:3], v[192:195]
    v_exp_f32 v237, v237
    v_add_u32 v244, s99, v1
    v_add_u32 v245, s99, v2
    v_mfma_f32_16x16x32_bf16 v[212:215], a[84:87], a[4:7], v[212:215]
    v_add_f32 v23, v23, v237
    v_cvt_pk_bf16_f32 v232, v236, v237
    v_add_u32 v246, s99, v3
    v_add_u32 v247, s99, v4
    v_mfma_f32_16x16x32_bf16 v[212:215], a[88:91], a[8:11], v[212:215]
    ds_read_b128 a[208:211], v244 offset:0
    ds_read_b128 a[212:215], v245 offset:0
    s_add_u32 m0, s99, 4096
    s_add_u32 s42, s100, 12288
    v_exp_f32 v238, v238
    v_mfma_f32_16x16x32_bf16 v[212:215], a[92:95], a[12:15], v[212:215]
    buffer_load_dwordx4 v15, s[20:23], s42 offen offset:2048 nt lds
    v_add_f32 v23, v23, v238
    v_mfma_f32_16x16x32_bf16 v[216:219], a[96:99], a[0:3], v[192:195]
    ds_read_b128 a[216:219], v246 offset:0
    v_exp_f32 v239, v239
    v_mfma_f32_16x16x32_bf16 v[216:219], a[100:103], a[4:7], v[216:219]
    ds_read_b128 a[220:223], v247 offset:0
    v_add_f32 v23, v23, v239
    v_cvt_pk_bf16_f32 v233, v238, v239
    v_mfma_f32_16x16x32_bf16 v[216:219], a[104:107], a[8:11], v[216:219]
    v_exp_f32 v240, v240
    v_mfma_f32_16x16x32_bf16 v[216:219], a[108:111], a[12:15], v[216:219]
    v_add_f32 v23, v23, v240
    v_mfma_f32_16x16x32_bf16 v[220:223], a[112:115], a[0:3], v[192:195]
    v_exp_f32 v241, v241
    v_mfma_f32_16x16x32_bf16 v[220:223], a[116:119], a[4:7], v[220:223]
    buffer_load_dwordx4 v16, s[20:23], s42 offen offset:3072 nt lds
    v_add_f32 v23, v23, v241
    v_cvt_pk_bf16_f32 v234, v240, v241
    v_mfma_f32_16x16x32_bf16 v[220:223], a[120:123], a[8:11], v[220:223]
    v_exp_f32 v242, v242
    v_mfma_f32_16x16x32_bf16 v[220:223], a[124:127], a[12:15], v[220:223]
    v_add_f32 v23, v23, v242
    s_waitcnt lgkmcnt(2)
    v_mfma_f32_16x16x32_bf16 v[224:227], a[128:131], a[0:3], v[192:195]
    v_exp_f32 v243, v243
    v_mfma_f32_16x16x32_bf16 v[224:227], a[132:135], a[4:7], v[224:227]
    v_add_f32 v23, v23, v243
    v_cvt_pk_bf16_f32 v235, v242, v243
    v_accvgpr_read_b32 v245, a208
    v_accvgpr_read_b32 v247, a209
    v_accvgpr_read_b32 v249, a210
    v_accvgpr_read_b32 v251, a211
    v_lshlrev_b32 v244, 16, v245
    v_lshlrev_b32 v246, 16, v247
    v_lshlrev_b32 v248, 16, v249
    v_lshlrev_b32 v250, 16, v251
    v_and_b32 v245, s37, v245
    v_and_b32 v247, s37, v247
    v_and_b32 v249, s37, v249
    v_and_b32 v251, s37, v251
    v_pk_mul_f32 v[244:245], v[244:245], s[34:35]
    v_pk_mul_f32 v[246:247], v[246:247], s[34:35]
    v_pk_mul_f32 v[248:249], v[248:249], s[34:35]
    v_pk_mul_f32 v[250:251], v[250:251], s[34:35]
    v_cvt_pk_bf16_f32 v244, v244, v245
    v_cvt_pk_bf16_f32 v246, v246, v247
    v_cvt_pk_bf16_f32 v248, v248, v249
    v_cvt_pk_bf16_f32 v250, v250, v251
    v_accvgpr_write_b32 a208, v244
    v_accvgpr_write_b32 a209, v246
    v_accvgpr_write_b32 a210, v248
    v_accvgpr_write_b32 a211, v250
    v_accvgpr_read_b32 v245, a212
    v_accvgpr_read_b32 v247, a213
    v_accvgpr_read_b32 v249, a214
    v_accvgpr_read_b32 v251, a215
    v_lshlrev_b32 v244, 16, v245
    v_lshlrev_b32 v246, 16, v247
    v_lshlrev_b32 v248, 16, v249
    v_lshlrev_b32 v250, 16, v251
    v_and_b32 v245, s37, v245
    v_and_b32 v247, s37, v247
    v_and_b32 v249, s37, v249
    v_and_b32 v251, s37, v251
    v_pk_mul_f32 v[244:245], v[244:245], s[34:35]
    v_pk_mul_f32 v[246:247], v[246:247], s[34:35]
    v_pk_mul_f32 v[248:249], v[248:249], s[34:35]
    v_pk_mul_f32 v[250:251], v[250:251], s[34:35]
    v_cvt_pk_bf16_f32 v244, v244, v245
    v_cvt_pk_bf16_f32 v246, v246, v247
    v_cvt_pk_bf16_f32 v248, v248, v249
    v_cvt_pk_bf16_f32 v250, v250, v251
    v_accvgpr_write_b32 a212, v244
    v_accvgpr_write_b32 a213, v246
    v_accvgpr_write_b32 a214, v248
    v_accvgpr_write_b32 a215, v250
    s_waitcnt lgkmcnt(0)
    v_accvgpr_read_b32 v245, a216
    v_accvgpr_read_b32 v247, a217
    v_accvgpr_read_b32 v249, a218
    v_accvgpr_read_b32 v251, a219
    v_lshlrev_b32 v244, 16, v245
    v_lshlrev_b32 v246, 16, v247
    v_lshlrev_b32 v248, 16, v249
    v_lshlrev_b32 v250, 16, v251
    v_and_b32 v245, s37, v245
    v_and_b32 v247, s37, v247
    v_and_b32 v249, s37, v249
    v_and_b32 v251, s37, v251
    v_pk_mul_f32 v[244:245], v[244:245], s[34:35]
    v_pk_mul_f32 v[246:247], v[246:247], s[34:35]
    v_pk_mul_f32 v[248:249], v[248:249], s[34:35]
    v_pk_mul_f32 v[250:251], v[250:251], s[34:35]
    v_cvt_pk_bf16_f32 v244, v244, v245
    v_cvt_pk_bf16_f32 v246, v246, v247
    v_cvt_pk_bf16_f32 v248, v248, v249
    v_cvt_pk_bf16_f32 v250, v250, v251
    v_accvgpr_write_b32 a216, v244
    v_accvgpr_write_b32 a217, v246
    v_accvgpr_write_b32 a218, v248
    v_accvgpr_write_b32 a219, v250
    v_accvgpr_read_b32 v245, a220
    v_accvgpr_read_b32 v247, a221
    v_accvgpr_read_b32 v249, a222
    v_accvgpr_read_b32 v251, a223
    v_lshlrev_b32 v244, 16, v245
    v_lshlrev_b32 v246, 16, v247
    v_lshlrev_b32 v248, 16, v249
    v_lshlrev_b32 v250, 16, v251
    v_and_b32 v245, s37, v245
    v_and_b32 v247, s37, v247
    v_and_b32 v249, s37, v249
    v_and_b32 v251, s37, v251
    v_pk_mul_f32 v[244:245], v[244:245], s[34:35]
    v_pk_mul_f32 v[246:247], v[246:247], s[34:35]
    v_pk_mul_f32 v[248:249], v[248:249], s[34:35]
    v_pk_mul_f32 v[250:251], v[250:251], s[34:35]
    v_cvt_pk_bf16_f32 v244, v244, v245
    v_cvt_pk_bf16_f32 v246, v246, v247
    v_cvt_pk_bf16_f32 v248, v248, v249
    v_cvt_pk_bf16_f32 v250, v250, v251
    v_accvgpr_write_b32 a220, v244
    v_accvgpr_write_b32 a221, v246
    v_accvgpr_write_b32 a222, v248
    v_accvgpr_write_b32 a223, v250
    v_mfma_f32_16x16x32_bf16 v[224:227], a[136:139], a[8:11], v[224:227]
    s_add_u32 m0, s99, 0
    s_add_u32 s42, s100, 16384
    v_exp_f32 v212, v212
    v_mfma_f32_16x16x32_bf16 v[224:227], a[140:143], a[12:15], v[224:227]
    buffer_load_dwordx4 v13, s[20:23], s42 offen offset:0 nt lds
    v_add_f32 v19, v19, v212
    s_branch L_b2g1
L_qm2:
    s_waitcnt lgkmcnt(4)
    v_mfma_f32_16x16x32_bf16 v[212:215], a[80:83], a[0:3], v[192:195]
    v_exp_f32 v237, v237
    v_add_u32 v244, s99, v1
    v_add_u32 v245, s99, v2
    v_mfma_f32_16x16x32_bf16 v[212:215], a[84:87], a[4:7], v[212:215]
    v_add_f32 v23, v23, v237
    v_cvt_pk_bf16_f32 v232, v236, v237
    v_add_u32 v246, s99, v3
    v_add_u32 v247, s99, v4
    v_mfma_f32_16x16x32_bf16 v[212:215], a[88:91], a[8:11], v[212:215]
    ds_read_b128 a[240:243], v244 offset:0
    ds_read_b128 a[244:247], v245 offset:0
    s_add_u32 m0, s99, 4096
    s_add_u32 s42, s100, 0
    v_exp_f32 v238, v238
    v_mfma_f32_16x16x32_bf16 v[212:215], a[92:95], a[12:15], v[212:215]
    buffer_load_dwordx4 v13, s[20:23], s42 offen offset:0 nt lds
    v_add_f32 v23, v23, v238
    v_mfma_f32_16x16x32_bf16 v[216:219], a[96:99], a[0:3], v[192:195]
    ds_read_b128 a[248:251], v246 offset:0
    v_exp_f32 v239, v239
    v_mfma_f32_16x16x32_bf16 v[216:219], a[100:103], a[4:7], v[216:219]
    ds_read_b128 a[252:255], v247 offset:0
    v_add_f32 v23, v23, v239
    v_cvt_pk_bf16_f32 v233, v238, v239
    v_mfma_f32_16x16x32_bf16 v[216:219], a[104:107], a[8:11], v[216:219]
    v_exp_f32 v240, v240
    v_mfma_f32_16x16x32_bf16 v[216:219], a[108:111], a[12:15], v[216:219]
    v_add_f32 v23, v23, v240
    v_mfma_f32_16x16x32_bf16 v[220:223], a[112:115], a[0:3], v[192:195]
    v_exp_f32 v241, v241
    v_mfma_f32_16x16x32_bf16 v[220:223], a[116:119], a[4:7], v[220:223]
    buffer_load_dwordx4 v14, s[20:23], s42 offen offset:1024 nt lds
    v_add_f32 v23, v23, v241
    v_cvt_pk_bf16_f32 v234, v240, v241
    v_mfma_f32_16x16x32_bf16 v[220:223], a[120:123], a[8:11], v[220:223]
    v_exp_f32 v242, v242
    v_mfma_f32_16x16x32_bf16 v[220:223], a[124:127], a[12:15], v[220:223]
    v_add_f32 v23, v23, v242
    s_waitcnt lgkmcnt(2)
    v_mfma_f32_16x16x32_bf16 v[224:227], a[128:131], a[0:3], v[192:195]
    v_exp_f32 v243, v243
    v_mfma_f32_16x16x32_bf16 v[224:227], a[132:135], a[4:7], v[224:227]
    v_add_f32 v23, v23, v243
    v_cvt_pk_bf16_f32 v235, v242, v243
    v_accvgpr_read_b32 v245, a240
    v_accvgpr_read_b32 v247, a241
    v_accvgpr_read_b32 v249, a242
    v_accvgpr_read_b32 v251, a243
    v_lshlrev_b32 v244, 16, v245
    v_lshlrev_b32 v246, 16, v247
    v_lshlrev_b32 v248, 16, v249
    v_lshlrev_b32 v250, 16, v251
    v_and_b32 v245, s37, v245
    v_and_b32 v247, s37, v247
    v_and_b32 v249, s37, v249
    v_and_b32 v251, s37, v251
    v_pk_mul_f32 v[244:245], v[244:245], s[34:35]
    v_pk_mul_f32 v[246:247], v[246:247], s[34:35]
    v_pk_mul_f32 v[248:249], v[248:249], s[34:35]
    v_pk_mul_f32 v[250:251], v[250:251], s[34:35]
    v_cvt_pk_bf16_f32 v244, v244, v245
    v_cvt_pk_bf16_f32 v246, v246, v247
    v_cvt_pk_bf16_f32 v248, v248, v249
    v_cvt_pk_bf16_f32 v250, v250, v251
    v_accvgpr_write_b32 a240, v244
    v_accvgpr_write_b32 a241, v246
    v_accvgpr_write_b32 a242, v248
    v_accvgpr_write_b32 a243, v250
    v_accvgpr_read_b32 v245, a244
    v_accvgpr_read_b32 v247, a245
    v_accvgpr_read_b32 v249, a246
    v_accvgpr_read_b32 v251, a247
    v_lshlrev_b32 v244, 16, v245
    v_lshlrev_b32 v246, 16, v247
    v_lshlrev_b32 v248, 16, v249
    v_lshlrev_b32 v250, 16, v251
    v_and_b32 v245, s37, v245
    v_and_b32 v247, s37, v247
    v_and_b32 v249, s37, v249
    v_and_b32 v251, s37, v251
    v_pk_mul_f32 v[244:245], v[244:245], s[34:35]
    v_pk_mul_f32 v[246:247], v[246:247], s[34:35]
    v_pk_mul_f32 v[248:249], v[248:249], s[34:35]
    v_pk_mul_f32 v[250:251], v[250:251], s[34:35]
    v_cvt_pk_bf16_f32 v244, v244, v245
    v_cvt_pk_bf16_f32 v246, v246, v247
    v_cvt_pk_bf16_f32 v248, v248, v249
    v_cvt_pk_bf16_f32 v250, v250, v251
    v_accvgpr_write_b32 a244, v244
    v_accvgpr_write_b32 a245, v246
    v_accvgpr_write_b32 a246, v248
    v_accvgpr_write_b32 a247, v250
    s_waitcnt lgkmcnt(0)
    v_accvgpr_read_b32 v245, a248
    v_accvgpr_read_b32 v247, a249
    v_accvgpr_read_b32 v249, a250
    v_accvgpr_read_b32 v251, a251
    v_lshlrev_b32 v244, 16, v245
    v_lshlrev_b32 v246, 16, v247
    v_lshlrev_b32 v248, 16, v249
    v_lshlrev_b32 v250, 16, v251
    v_and_b32 v245, s37, v245
    v_and_b32 v247, s37, v247
    v_and_b32 v249, s37, v249
    v_and_b32 v251, s37, v251
    v_pk_mul_f32 v[244:245], v[244:245], s[34:35]
    v_pk_mul_f32 v[246:247], v[246:247], s[34:35]
    v_pk_mul_f32 v[248:249], v[248:249], s[34:35]
    v_pk_mul_f32 v[250:251], v[250:251], s[34:35]
    v_cvt_pk_bf16_f32 v244, v244, v245
    v_cvt_pk_bf16_f32 v246, v246, v247
    v_cvt_pk_bf16_f32 v248, v248, v249
    v_cvt_pk_bf16_f32 v250, v250, v251
    v_accvgpr_write_b32 a248, v244
    v_accvgpr_write_b32 a249, v246
    v_accvgpr_write_b32 a250, v248
    v_accvgpr_write_b32 a251, v250
    v_accvgpr_read_b32 v245, a252
    v_accvgpr_read_b32 v247, a253
    v_accvgpr_read_b32 v249, a254
    v_accvgpr_read_b32 v251, a255
    v_lshlrev_b32 v244, 16, v245
    v_lshlrev_b32 v246, 16, v247
    v_lshlrev_b32 v248, 16, v249
    v_lshlrev_b32 v250, 16, v251
    v_and_b32 v245, s37, v245
    v_and_b32 v247, s37, v247
    v_and_b32 v249, s37, v249
    v_and_b32 v251, s37, v251
    v_pk_mul_f32 v[244:245], v[244:245], s[34:35]
    v_pk_mul_f32 v[246:247], v[246:247], s[34:35]
    v_pk_mul_f32 v[248:249], v[248:249], s[34:35]
    v_pk_mul_f32 v[250:251], v[250:251], s[34:35]
    v_cvt_pk_bf16_f32 v244, v244, v245
    v_cvt_pk_bf16_f32 v246, v246, v247
    v_cvt_pk_bf16_f32 v248, v248, v249
    v_cvt_pk_bf16_f32 v250, v250, v251
    v_accvgpr_write_b32 a252, v244
    v_accvgpr_write_b32 a253, v246
    v_accvgpr_write_b32 a254, v248
    v_accvgpr_write_b32 a255, v250
    v_mfma_f32_16x16x32_bf16 v[224:227], a[136:139], a[8:11], v[224:227]
    v_exp_f32 v212, v212
    v_mfma_f32_16x16x32_bf16 v[224:227], a[140:143], a[12:15], v[224:227]
    buffer_load_dwordx4 v15, s[20:23], s42 offen offset:2048 nt lds
    v_add_f32 v19, v19, v212
    s_branch L_b2g1
L_qm41:
    s_cmp_eq_u32 s30, 1
    s_cbranch_scc1 L_qm1
L_qm4:
    s_waitcnt lgkmcnt(4)
    v_mfma_f32_16x16x32_bf16 v[212:215], a[80:83], a[0:3], v[192:195]
    v_exp_f32 v237, v237
    v_mfma_f32_16x16x32_bf16 v[212:215], a[84:87], a[4:7], v[212:215]
    v_add_f32 v23, v23, v237
    v_cvt_pk_bf16_f32 v232, v236, v237
    v_mfma_f32_16x16x32_bf16 v[212:215], a[88:91], a[8:11], v[212:215]
    s_add_u32 m0, s99, 0
    s_add_u32 s42, s100, 8192
    v_exp_f32 v238, v238
    v_mfma_f32_16x16x32_bf16 v[212:215], a[92:95], a[12:15], v[212:215]
    buffer_load_dwordx4 v13, s[20:23], s42 offen offset:0 nt lds
    v_add_f32 v23, v23, v238
    v_mfma_f32_16x16x32_bf16 v[216:219], a[96:99], a[0:3], v[192:195]
    v_exp_f32 v239, v239
    v_mfma_f32_16x16x32_bf16 v[216:219], a[100:103], a[4:7], v[216:219]
    v_add_f32 v23, v23, v239
    v_cvt_pk_bf16_f32 v233, v238, v239
    v_mfma_f32_16x16x32_bf16 v[216:219], a[104:107], a[8:11], v[216:219]
    v_exp_f32 v240, v240
    v_mfma_f32_16x16x32_bf16 v[216:219], a[108:111], a[12:15], v[216:219]
    v_add_f32 v23, v23, v240
    v_mfma_f32_16x16x32_bf16 v[220:223], a[112:115], a[0:3], v[192:195]
    v_exp_f32 v241, v241
    v_mfma_f32_16x16x32_bf16 v[220:223], a[116:119], a[4:7], v[220:223]
    buffer_load_dwordx4 v14, s[20:23], s42 offen offset:1024 nt lds
    v_add_f32 v23, v23, v241
    v_cvt_pk_bf16_f32 v234, v240, v241
    v_mfma_f32_16x16x32_bf16 v[220:223], a[120:123], a[8:11], v[220:223]
    v_exp_f32 v242, v242
    v_mfma_f32_16x16x32_bf16 v[220:223], a[124:127], a[12:15], v[220:223]
    v_add_f32 v23, v23, v242
    s_waitcnt lgkmcnt(0)
    v_mfma_f32_16x16x32_bf16 v[224:227], a[128:131], a[0:3], v[192:195]
    v_exp_f32 v243, v243
    v_mfma_f32_16x16x32_bf16 v[224:227], a[132:135], a[4:7], v[224:227]
    v_add_f32 v23, v23, v243
    v_cvt_pk_bf16_f32 v235, v242, v243
    v_mfma_f32_16x16x32_bf16 v[224:227], a[136:139], a[8:11], v[224:227]
    v_exp_f32 v212, v212
    v_mfma_f32_16x16x32_bf16 v[224:227], a[140:143], a[12:15], v[224:227]
    buffer_load_dwordx4 v15, s[20:23], s42 offen offset:2048 nt lds
    v_add_f32 v19, v19, v212
    s_branch L_b2g1
L_qm1:
    s_waitcnt lgkmcnt(4)
    v_mfma_f32_16x16x32_bf16 v[212:215], a[80:83], a[0:3], v[192:195]
    v_exp_f32 v237, v237
    v_mfma_f32_16x16x32_bf16 v[212:215], a[84:87], a[4:7], v[212:215]
    v_add_f32 v23, v23, v237
    v_cvt_pk_bf16_f32 v232, v236, v237
    v_mfma_f32_16x16x32_bf16 v[212:215], a[88:91], a[8:11], v[212:215]
    s_add_u32 m0, s99, 0
    s_add_u32 s42, s100, 4096
    v_exp_f32 v238, v238
    v_mfma_f32_16x16x32_bf16 v[212:215], a[92:95], a[12:15], v[212:215]
    buffer_load_dwordx4 v15, s[20:23], s42 offen offset:2048 nt lds
    v_add_f32 v23, v23, v238
    v_mfma_f32_16x16x32_bf16 v[216:219], a[96:99], a[0:3], v[192:195]
    v_exp_f32 v239, v239
    v_mfma_f32_16x16x32_bf16 v[216:219], a[100:103], a[4:7], v[216:219]
    v_add_f32 v23, v23, v239
    v_cvt_pk_bf16_f32 v233, v238, v239
    v_mfma_f32_16x16x32_bf16 v[216:219], a[104:107], a[8:11], v[216:219]
    v_exp_f32 v240, v240
    v_mfma_f32_16x16x32_bf16 v[216:219], a[108:111], a[12:15], v[216:219]
    v_add_f32 v23, v23, v240
    v_mfma_f32_16x16x32_bf16 v[220:223], a[112:115], a[0:3], v[192:195]
    v_exp_f32 v241, v241
    v_mfma_f32_16x16x32_bf16 v[220:223], a[116:119], a[4:7], v[220:223]
    buffer_load_dwordx4 v16, s[20:23], s42 offen offset:3072 nt lds
    v_add_f32 v23, v23, v241
    v_cvt_pk_bf16_f32 v234, v240, v241
    v_mfma_f32_16x16x32_bf16 v[220:223], a[120:123], a[8:11], v[220:223]
    v_exp_f32 v242, v242
    v_mfma_f32_16x16x32_bf16 v[220:223], a[124:127], a[12:15], v[220:223]
    v_add_f32 v23, v23, v242
    s_waitcnt lgkmcnt(0)
    v_mfma_f32_16x16x32_bf16 v[224:227], a[128:131], a[0:3], v[192:195]
    v_exp_f32 v243, v243
    v_mfma_f32_16x16x32_bf16 v[224:227], a[132:135], a[4:7], v[224:227]
    v_add_f32 v23, v23, v243
    v_cvt_pk_bf16_f32 v235, v242, v243
    v_mfma_f32_16x16x32_bf16 v[224:227], a[136:139], a[8:11], v[224:227]
    v_exp_f32 v212, v212
    v_mfma_f32_16x16x32_bf16 v[224:227], a[140:143], a[12:15], v[224:227]
    v_add_f32 v19, v19, v212
    s_branch L_b2g1
L_exit:
    s_cbranch_vccnz L_lastb
    s_waitcnt lgkmcnt(4)
    v_mfma_f32_16x16x32_bf16 v[228:231], a[80:83], a[0:3], v[192:195]
    v_exp_f32 v221, v221
    v_mfma_f32_16x16x32_bf16 v[228:231], a[84:87], a[4:7], v[228:231]
    s_and_b32 m0, s28, 0xffff
    v_add_f32 v23, v23, v221
    v_cvt_pk_bf16_f32 v216, v220, v221
    v_mfma_f32_16x16x32_bf16 v[228:231], a[88:91], a[8:11], v[228:231]
    v_exp_f32 v222, v222
    v_mfma_f32_16x16x32_bf16 v[228:231], a[92:95], a[12:15], v[228:231]
    v_add_f32 v23, v23, v222
    v_add_u32 v252, s99, v1
    v_mfma_f32_16x16x32_bf16 v[232:235], a[96:99], a[0:3], v[192:195]
    v_exp_f32 v223, v223
    v_mfma_f32_16x16x32_bf16 v[232:235], a[100:103], a[4:7], v[232:235]
    buffer_load_dwordx4 v13, s[12:15], s28 offen offset:0 nt lds
    v_add_f32 v23, v23, v223
    v_cvt_pk_bf16_f32 v217, v222, v223
    v_mfma_f32_16x16x32_bf16 v[232:235], a[104:107], a[8:11], v[232:235]
    v_exp_f32 v224, v224
    v_mfma_f32_16x16x32_bf16 v[232:235], a[108:111], a[12:15], v[232:235]
    v_add_f32 v23, v23, v224
    v_add_u32 v253, s99, v2
    v_mfma_f32_16x16x32_bf16 v[236:239], a[112:115], a[0:3], v[192:195]
    v_exp_f32 v225, v225
    v_mfma_f32_16x16x32_bf16 v[236:239], a[116:119], a[4:7], v[236:239]
    v_add_f32 v23, v23, v225
    v_cvt_pk_bf16_f32 v218, v224, v225
    v_mfma_f32_16x16x32_bf16 v[236:239], a[120:123], a[8:11], v[236:239]
    v_exp_f32 v226, v226
    v_mfma_f32_16x16x32_bf16 v[236:239], a[124:127], a[12:15], v[236:239]
    v_add_f32 v23, v23, v226
    v_add_u32 v254, s99, v3
    s_waitcnt lgkmcnt(0)
    v_mfma_f32_16x16x32_bf16 v[240:243], a[128:131], a[0:3], v[192:195]
    v_exp_f32 v227, v227
    v_mfma_f32_16x16x32_bf16 v[240:243], a[132:135], a[4:7], v[240:243]
    v_add_f32 v23, v23, v227
    v_cvt_pk_bf16_f32 v219, v226, v227
    v_mfma_f32_16x16x32_bf16 v[240:243], a[136:139], a[8:11], v[240:243]
    v_exp_f32 v228, v228
    v_mfma_f32_16x16x32_bf16 v[240:243], a[140:143], a[12:15], v[240:243]
    v_add_f32 v19, v19, v228
    v_add_u32 v255, s99, v4
    v_mfma_f32_16x16x32_bf16 v[160:163], a[144:147], v[212:215], v[160:163]
    ds_read_b128 a[0:3], v252 offset:4096
    ds_read_b128 a[4:7], v253 offset:4096
    ds_read_b128 a[8:11], v254 offset:4096
    ds_read_b128 a[12:15], v255 offset:4096
    v_exp_f32 v229, v229
    v_mfma_f32_16x16x32_bf16 v[160:163], a[176:179], v[216:219], v[160:163]
    ds_read_b64_tr_b16 a[144:145], v5 offset:49152
    ds_read_b64_tr_b16 a[146:147], v5 offset:53248
    v_add_f32 v19, v19, v229
    v_cvt_pk_bf16_f32 v228, v228, v229
    v_mfma_f32_16x16x32_bf16 v[164:167], a[148:151], v[212:215], v[164:167]
    v_exp_f32 v230, v230
    v_mfma_f32_16x16x32_bf16 v[164:167], a[180:183], v[216:219], v[164:167]
    ds_read_b64_tr_b16 a[176:177], v5 offset:57344
    ds_read_b64_tr_b16 a[178:179], v5 offset:61440
    buffer_load_dwordx4 v14, s[12:15], s28 offen offset:1024 nt lds
    v_add_f32 v19, v19, v230
    v_mfma_f32_16x16x32_bf16 v[168:171], a[152:155], v[212:215], v[168:171]
    v_exp_f32 v231, v231
    v_mfma_f32_16x16x32_bf16 v[168:171], a[184:187], v[216:219], v[168:171]
    ds_read_b64_tr_b16 a[148:149], v6 offset:49152
    ds_read_b64_tr_b16 a[150:151], v6 offset:53248
    v_add_f32 v19, v19, v231
    v_cvt_pk_bf16_f32 v229, v230, v231
    v_mfma_f32_16x16x32_bf16 v[172:175], a[156:159], v[212:215], v[172:175]
    v_exp_f32 v232, v232
    v_mfma_f32_16x16x32_bf16 v[172:175], a[188:191], v[216:219], v[172:175]
    ds_read_b64_tr_b16 a[180:181], v6 offset:57344
    ds_read_b64_tr_b16 a[182:183], v6 offset:61440
    v_add_f32 v19, v19, v232
    v_mfma_f32_16x16x32_bf16 v[176:179], a[160:163], v[212:215], v[176:179]
    v_exp_f32 v233, v233
    v_mfma_f32_16x16x32_bf16 v[176:179], a[192:195], v[216:219], v[176:179]
    ds_read_b64_tr_b16 a[152:153], v7 offset:49152
    ds_read_b64_tr_b16 a[154:155], v7 offset:53248
    v_add_f32 v19, v19, v233
    v_cvt_pk_bf16_f32 v230, v232, v233
    v_mfma_f32_16x16x32_bf16 v[180:183], a[164:167], v[212:215], v[180:183]
    v_exp_f32 v234, v234
    v_mfma_f32_16x16x32_bf16 v[180:183], a[196:199], v[216:219], v[180:183]
    ds_read_b64_tr_b16 a[184:185], v7 offset:57344
    ds_read_b64_tr_b16 a[186:187], v7 offset:61440
    v_add_f32 v19, v19, v234
    v_mfma_f32_16x16x32_bf16 v[184:187], a[168:171], v[212:215], v[184:187]
    buffer_load_dwordx4 v15, s[12:15], s28 offen offset:2048 nt lds
    v_exp_f32 v235, v235
    v_mfma_f32_16x16x32_bf16 v[184:187], a[200:203], v[216:219], v[184:187]
    ds_read_b64_tr_b16 a[156:157], v8 offset:49152
    ds_read_b64_tr_b16 a[158:159], v8 offset:53248
    v_add_f32 v19, v19, v235
    v_cvt_pk_bf16_f32 v231, v234, v235
    s_waitcnt lgkmcnt(8)
    v_accvgpr_read_b32 v245, a0
    v_accvgpr_read_b32 v247, a1
    v_accvgpr_read_b32 v249, a2
    v_accvgpr_read_b32 v251, a3
    v_lshlrev_b32 v244, 16, v245
    v_lshlrev_b32 v246, 16, v247
    v_lshlrev_b32 v248, 16, v249
    v_lshlrev_b32 v250, 16, v251
    v_and_b32 v245, s37, v245
    v_and_b32 v247, s37, v247
    v_and_b32 v249, s37, v249
    v_and_b32 v251, s37, v251
    v_pk_mul_f32 v[244:245], v[244:245], s[34:35]
    v_pk_mul_f32 v[246:247], v[246:247], s[34:35]
    v_pk_mul_f32 v[248:249], v[248:249], s[34:35]
    v_pk_mul_f32 v[250:251], v[250:251], s[34:35]
    v_cvt_pk_bf16_f32 v244, v244, v245
    v_cvt_pk_bf16_f32 v246, v246, v247
    v_cvt_pk_bf16_f32 v248, v248, v249
    v_cvt_pk_bf16_f32 v250, v250, v251
    v_accvgpr_write_b32 a0, v244
    v_accvgpr_write_b32 a1, v246
    v_accvgpr_write_b32 a2, v248
    v_accvgpr_write_b32 a3, v250
    v_accvgpr_read_b32 v245, a4
    v_accvgpr_read_b32 v247, a5
    v_accvgpr_read_b32 v249, a6
    v_accvgpr_read_b32 v251, a7
    v_lshlrev_b32 v244, 16, v245
    v_lshlrev_b32 v246, 16, v247
    v_lshlrev_b32 v248, 16, v249
    v_lshlrev_b32 v250, 16, v251
    v_and_b32 v245, s37, v245
    v_and_b32 v247, s37, v247
    v_and_b32 v249, s37, v249
    v_and_b32 v251, s37, v251
    v_pk_mul_f32 v[244:245], v[244:245], s[34:35]
    v_pk_mul_f32 v[246:247], v[246:247], s[34:35]
    v_pk_mul_f32 v[248:249], v[248:249], s[34:35]
    v_pk_mul_f32 v[250:251], v[250:251], s[34:35]
    v_cvt_pk_bf16_f32 v244, v244, v245
    v_cvt_pk_bf16_f32 v246, v246, v247
    v_cvt_pk_bf16_f32 v248, v248, v249
    v_cvt_pk_bf16_f32 v250, v250, v251
    v_accvgpr_write_b32 a4, v244
    v_accvgpr_write_b32 a5, v246
    v_accvgpr_write_b32 a6, v248
    v_accvgpr_write_b32 a7, v250
    v_accvgpr_read_b32 v245, a8
    v_accvgpr_read_b32 v247, a9
    v_accvgpr_read_b32 v249, a10
    v_accvgpr_read_b32 v251, a11
    v_lshlrev_b32 v244, 16, v245
    v_lshlrev_b32 v246, 16, v247
    v_lshlrev_b32 v248, 16, v249
    v_lshlrev_b32 v250, 16, v251
    v_and_b32 v245, s37, v245
    v_and_b32 v247, s37, v247
    v_and_b32 v249, s37, v249
    v_and_b32 v251, s37, v251
    v_pk_mul_f32 v[244:245], v[244:245], s[34:35]
    v_pk_mul_f32 v[246:247], v[246:247], s[34:35]
    v_pk_mul_f32 v[248:249], v[248:249], s[34:35]
    v_pk_mul_f32 v[250:251], v[250:251], s[34:35]
    v_cvt_pk_bf16_f32 v244, v244, v245
    v_cvt_pk_bf16_f32 v246, v246, v247
    v_cvt_pk_bf16_f32 v248, v248, v249
    v_cvt_pk_bf16_f32 v250, v250, v251
    v_accvgpr_write_b32 a8, v244
    v_accvgpr_write_b32 a9, v246
    v_accvgpr_write_b32 a10, v248
    v_accvgpr_write_b32 a11, v250
    v_accvgpr_read_b32 v245, a12
    v_accvgpr_read_b32 v247, a13
    v_accvgpr_read_b32 v249, a14
    v_accvgpr_read_b32 v251, a15
    v_lshlrev_b32 v244, 16, v245
    v_lshlrev_b32 v246, 16, v247
    v_lshlrev_b32 v248, 16, v249
    v_lshlrev_b32 v250, 16, v251
    v_and_b32 v245, s37, v245
    v_and_b32 v247, s37, v247
    v_and_b32 v249, s37, v249
    v_and_b32 v251, s37, v251
    v_pk_mul_f32 v[244:245], v[244:245], s[34:35]
    v_pk_mul_f32 v[246:247], v[246:247], s[34:35]
    v_pk_mul_f32 v[248:249], v[248:249], s[34:35]
    v_pk_mul_f32 v[250:251], v[250:251], s[34:35]
    v_cvt_pk_bf16_f32 v244, v244, v245
    v_cvt_pk_bf16_f32 v246, v246, v247
    v_cvt_pk_bf16_f32 v248, v248, v249
    v_cvt_pk_bf16_f32 v250, v250, v251
    v_accvgpr_write_b32 a12, v244
    v_accvgpr_write_b32 a13, v246
    v_accvgpr_write_b32 a14, v248
    v_accvgpr_write_b32 a15, v250
    v_mfma_f32_16x16x32_bf16 v[188:191], a[172:175], v[212:215], v[188:191]
    v_exp_f32 v236, v236
    v_mfma_f32_16x16x32_bf16 v[188:191], a[204:207], v[216:219], v[188:191]
    ds_read_b64_tr_b16 a[188:189], v8 offset:57344
    ds_read_b64_tr_b16 a[190:191], v8 offset:61440
    v_add_f32 v19, v19, v236
    v_mfma_f32_16x16x32_bf16 v[212:215], a[80:83], a[16:19], v[196:199]
    v_exp_f32 v237, v237
    v_mfma_f32_16x16x32_bf16 v[212:215], a[84:87], a[20:23], v[212:215]
    ds_read_b64_tr_b16 a[160:161], v9 offset:49152
    ds_read_b64_tr_b16 a[162:163], v9 offset:53248
    v_add_f32 v19, v19, v237
    v_cvt_pk_bf16_f32 v232, v236, v237
    v_mfma_f32_16x16x32_bf16 v[212:215], a[88:91], a[24:27], v[212:215]
    v_exp_f32 v238, v238
    v_mfma_f32_16x16x32_bf16 v[212:215], a[92:95], a[28:31], v[212:215]
    ds_read_b64_tr_b16 a[192:193], v9 offset:57344
    ds_read_b64_tr_b16 a[194:195], v9 offset:61440
    v_add_f32 v19, v19, v238
    v_mfma_f32_16x16x32_bf16 v[216:219], a[96:99], a[16:19], v[196:199]
    v_exp_f32 v239, v239
    v_mfma_f32_16x16x32_bf16 v[216:219], a[100:103], a[20:23], v[216:219]
    ds_read_b64_tr_b16 a[164:165], v10 offset:49152
    ds_read_b64_tr_b16 a[166:167], v10 offset:53248
    v_add_f32 v19, v19, v239
    v_cvt_pk_bf16_f32 v233, v238, v239
    v_mfma_f32_16x16x32_bf16 v[216:219], a[104:107], a[24:27], v[216:219]
    v_exp_f32 v240, v240
    v_mfma_f32_16x16x32_bf16 v[216:219], a[108:111], a[28:31], v[216:219]
    ds_read_b64_tr_b16 a[196:197], v10 offset:57344
    ds_read_b64_tr_b16 a[198:199], v10 offset:61440
    v_add_f32 v19, v19, v240
    v_mfma_f32_16x16x32_bf16 v[220:223], a[112:115], a[16:19], v[196:199]
    v_exp_f32 v241, v241
    v_mfma_f32_16x16x32_bf16 v[220:223], a[116:119], a[20:23], v[220:223]
    ds_read_b64_tr_b16 a[168:169], v11 offset:49152
    ds_read_b64_tr_b16 a[170:171], v11 offset:53248
    v_add_f32 v19, v19, v241
    v_cvt_pk_bf16_f32 v234, v240, v241
    v_mfma_f32_16x16x32_bf16 v[220:223], a[120:123], a[24:27], v[220:223]
    v_exp_f32 v242, v242
    v_mfma_f32_16x16x32_bf16 v[220:223], a[124:127], a[28:31], v[220:223]
    ds_read_b64_tr_b16 a[200:201], v11 offset:57344
    ds_read_b64_tr_b16 a[202:203], v11 offset:61440
    buffer_load_dwordx4 v16, s[12:15], s28 offen offset:3072 nt lds
    v_add_f32 v19, v19, v242
    v_mfma_f32_16x16x32_bf16 v[224:227], a[128:131], a[16:19], v[196:199]
    v_exp_f32 v243, v243
    v_mfma_f32_16x16x32_bf16 v[224:227], a[132:135], a[20:23], v[224:227]
    ds_read_b64_tr_b16 a[172:173], v12 offset:49152
    ds_read_b64_tr_b16 a[174:175], v12 offset:53248
    s_add_u32 m0, m0, 65536
    v_add_f32 v19, v19, v243
    v_cvt_pk_bf16_f32 v235, v242, v243
    v_mfma_f32_16x16x32_bf16 v[224:227], a[136:139], a[24:27], v[224:227]
    v_exp_f32 v212, v212
    v_mov_b32 v30, v19
    v_mfma_f32_16x16x32_bf16 v[224:227], a[140:143], a[28:31], v[224:227]
    ds_read_b64_tr_b16 a[204:205], v12 offset:57344
    ds_read_b64_tr_b16 a[206:207], v12 offset:61440
    v_add_f32 v20, v20, v212
    s_waitcnt vmcnt(12)
    v_mfma_f32_16x16x32_bf16 v[32:35], a[144:147], v[228:231], v[32:35]
    ds_read_b128 a[16:19], v252 offset:0
    ds_read_b128 a[20:23], v253 offset:0
    ds_read_b128 a[24:27], v254 offset:0
    ds_read_b128 a[28:31], v255 offset:0
    v_exp_f32 v213, v213
    v_permlane16_swap_b32 v19, v30
    v_mfma_f32_16x16x32_bf16 v[32:35], a[176:179], v[232:235], v[32:35]
    v_add_f32 v20, v20, v213
    v_cvt_pk_bf16_f32 v212, v212, v213
    v_mfma_f32_16x16x32_bf16 v[36:39], a[148:151], v[228:231], v[36:39]
    v_exp_f32 v214, v214
    s_waitcnt lgkmcnt(10)
    v_mfma_f32_16x16x32_bf16 v[36:39], a[180:183], v[232:235], v[36:39]
    v_add_f32 v20, v20, v214
    v_add_f32 v19, v19, v30
    v_mfma_f32_16x16x32_bf16 v[40:43], a[152:155], v[228:231], v[40:43]
    v_exp_f32 v215, v215
    v_mfma_f32_16x16x32_bf16 v[40:43], a[184:187], v[232:235], v[40:43]
    v_add_f32 v20, v20, v215
    v_cvt_pk_bf16_f32 v213, v214, v215
    v_mov_b32 v30, v19
    v_mfma_f32_16x16x32_bf16 v[44:47], a[156:159], v[228:231], v[44:47]
    v_exp_f32 v216, v216
    v_mfma_f32_16x16x32_bf16 v[44:47], a[188:191], v[232:235], v[44:47]
    buffer_load_dwordx4 v17, s[16:19], s28 offen offset:0 nt lds
    v_add_f32 v20, v20, v216
    v_permlane32_swap_b32 v19, v30
    v_mfma_f32_16x16x32_bf16 v[48:51], a[160:163], v[228:231], v[48:51]
    v_exp_f32 v217, v217
    v_mfma_f32_16x16x32_bf16 v[48:51], a[192:195], v[232:235], v[48:51]
    v_add_f32 v20, v20, v217
    v_cvt_pk_bf16_f32 v214, v216, v217
    v_add_f32 v19, v19, v30
    v_mfma_f32_16x16x32_bf16 v[52:55], a[164:167], v[228:231], v[52:55]
    v_exp_f32 v218, v218
    v_mfma_f32_16x16x32_bf16 v[52:55], a[196:199], v[232:235], v[52:55]
    v_add_f32 v20, v20, v218
    v_rcp_f32 v28, v19
    v_mfma_f32_16x16x32_bf16 v[56:59], a[168:171], v[228:231], v[56:59]
    v_exp_f32 v219, v219
    s_waitcnt lgkmcnt(0)
    v_mfma_f32_16x16x32_bf16 v[56:59], a[200:203], v[232:235], v[56:59]
    v_add_f32 v20, v20, v219
    v_cvt_pk_bf16_f32 v215, v218, v219
    v_cmp_nge_f32 s[96:97], s36, v19
    v_accvgpr_read_b32 v245, a16
    v_accvgpr_read_b32 v247, a17
    v_accvgpr_read_b32 v249, a18
    v_accvgpr_read_b32 v251, a19
    v_lshlrev_b32 v244, 16, v245
    v_lshlrev_b32 v246, 16, v247
    v_lshlrev_b32 v248, 16, v249
    v_lshlrev_b32 v250, 16, v251
    v_and_b32 v245, s37, v245
    v_and_b32 v247, s37, v247
    v_and_b32 v249, s37, v249
    v_and_b32 v251, s37, v251
    v_pk_mul_f32 v[244:245], v[244:245], s[34:35]
    v_pk_mul_f32 v[246:247], v[246:247], s[34:35]
    v_pk_mul_f32 v[248:249], v[248:249], s[34:35]
    v_pk_mul_f32 v[250:251], v[250:251], s[34:35]
    v_cvt_pk_bf16_f32 v244, v244, v245
    v_cvt_pk_bf16_f32 v246, v246, v247
    v_cvt_pk_bf16_f32 v248, v248, v249
    v_cvt_pk_bf16_f32 v250, v250, v251
    v_accvgpr_write_b32 a16, v244
    v_accvgpr_write_b32 a17, v246
    v_accvgpr_write_b32 a18, v248
    v_accvgpr_write_b32 a19, v250
    v_accvgpr_read_b32 v245, a20
    v_accvgpr_read_b32 v247, a21
    v_accvgpr_read_b32 v249, a22
    v_accvgpr_read_b32 v251, a23
    v_lshlrev_b32 v244, 16, v245
    v_lshlrev_b32 v246, 16, v247
    v_lshlrev_b32 v248, 16, v249
    v_lshlrev_b32 v250, 16, v251
    v_and_b32 v245, s37, v245
    v_and_b32 v247, s37, v247
    v_and_b32 v249, s37, v249
    v_and_b32 v251, s37, v251
    v_pk_mul_f32 v[244:245], v[244:245], s[34:35]
    v_pk_mul_f32 v[246:247], v[246:247], s[34:35]
    v_pk_mul_f32 v[248:249], v[248:249], s[34:35]
    v_pk_mul_f32 v[250:251], v[250:251], s[34:35]
    v_cvt_pk_bf16_f32 v244, v244, v245
    v_cvt_pk_bf16_f32 v246, v246, v247
    v_cvt_pk_bf16_f32 v248, v248, v249
    v_cvt_pk_bf16_f32 v250, v250, v251
    v_accvgpr_write_b32 a20, v244
    v_accvgpr_write_b32 a21, v246
    v_accvgpr_write_b32 a22, v248
    v_accvgpr_write_b32 a23, v250
    v_accvgpr_read_b32 v245, a24
    v_accvgpr_read_b32 v247, a25
    v_accvgpr_read_b32 v249, a26
    v_accvgpr_read_b32 v251, a27
    v_lshlrev_b32 v244, 16, v245
    v_lshlrev_b32 v246, 16, v247
    v_lshlrev_b32 v248, 16, v249
    v_lshlrev_b32 v250, 16, v251
    v_and_b32 v245, s37, v245
    v_and_b32 v247, s37, v247
    v_and_b32 v249, s37, v249
    v_and_b32 v251, s37, v251
    v_pk_mul_f32 v[244:245], v[244:245], s[34:35]
    v_pk_mul_f32 v[246:247], v[246:247], s[34:35]
    v_pk_mul_f32 v[248:249], v[248:249], s[34:35]
    v_pk_mul_f32 v[250:251], v[250:251], s[34:35]
    v_cvt_pk_bf16_f32 v244, v244, v245
    v_cvt_pk_bf16_f32 v246, v246, v247
    v_cvt_pk_bf16_f32 v248, v248, v249
    v_cvt_pk_bf16_f32 v250, v250, v251
    v_accvgpr_write_b32 a24, v244
    v_accvgpr_write_b32 a25, v246
    v_accvgpr_write_b32 a26, v248
    v_accvgpr_write_b32 a27, v250
    v_accvgpr_read_b32 v245, a28
    v_accvgpr_read_b32 v247, a29
    v_accvgpr_read_b32 v249, a30
    v_accvgpr_read_b32 v251, a31
    v_lshlrev_b32 v244, 16, v245
    v_lshlrev_b32 v246, 16, v247
    v_lshlrev_b32 v248, 16, v249
    v_lshlrev_b32 v250, 16, v251
    v_and_b32 v245, s37, v245
    v_and_b32 v247, s37, v247
    v_and_b32 v249, s37, v249
    v_and_b32 v251, s37, v251
    v_pk_mul_f32 v[244:245], v[244:245], s[34:35]
    v_pk_mul_f32 v[246:247], v[246:247], s[34:35]
    v_pk_mul_f32 v[248:249], v[248:249], s[34:35]
    v_pk_mul_f32 v[250:251], v[250:251], s[34:35]
    v_cvt_pk_bf16_f32 v244, v244, v245
    v_cvt_pk_bf16_f32 v246, v246, v247
    v_cvt_pk_bf16_f32 v248, v248, v249
    v_cvt_pk_bf16_f32 v250, v250, v251
    v_accvgpr_write_b32 a28, v244
    v_accvgpr_write_b32 a29, v246
    v_accvgpr_write_b32 a30, v248
    v_accvgpr_write_b32 a31, v250
    v_mfma_f32_16x16x32_bf16 v[60:63], a[172:175], v[228:231], v[60:63]
    v_exp_f32 v220, v220
    v_mfma_f32_16x16x32_bf16 v[60:63], a[204:207], v[232:235], v[60:63]
    buffer_load_dwordx4 v18, s[16:19], s28 offen offset:1024 nt lds
    v_add_f32 v20, v20, v220
    s_or_b64 s[38:39], s[38:39], s[96:97]
    v_mfma_f32_16x16x32_bf16 v[228:231], a[80:83], a[32:35], v[200:203]
    v_exp_f32 v221, v221
    v_mfma_f32_16x16x32_bf16 v[228:231], a[84:87], a[36:39], v[228:231]
    v_add_f32 v20, v20, v221
    v_cvt_pk_bf16_f32 v216, v220, v221
    v_pk_mul_f32 v[32:33], v[32:33], v[28:29] op_sel_hi:[1,0]
    v_pk_mul_f32 v[34:35], v[34:35], v[28:29] op_sel_hi:[1,0]
    v_pk_mul_f32 v[36:37], v[36:37], v[28:29] op_sel_hi:[1,0]
    v_pk_mul_f32 v[38:39], v[38:39], v[28:29] op_sel_hi:[1,0]
    v_pk_mul_f32 v[40:41], v[40:41], v[28:29] op_sel_hi:[1,0]
    v_pk_mul_f32 v[42:43], v[42:43], v[28:29] op_sel_hi:[1,0]
    v_pk_mul_f32 v[44:45], v[44:45], v[28:29] op_sel_hi:[1,0]
    v_pk_mul_f32 v[46:47], v[46:47], v[28:29] op_sel_hi:[1,0]
    v_cvt_pk_bf16_f32 v32, v32, v33
    v_cvt_pk_bf16_f32 v33, v34, v35
    v_cvt_pk_bf16_f32 v36, v36, v37
    v_cvt_pk_bf16_f32 v37, v38, v39
    v_cvt_pk_bf16_f32 v40, v40, v41
    v_cvt_pk_bf16_f32 v41, v42, v43
    v_cvt_pk_bf16_f32 v44, v44, v45
    v_cvt_pk_bf16_f32 v45, v46, v47
    v_pk_mul_f32 v[48:49], v[48:49], v[28:29] op_sel_hi:[1,0]
    v_pk_mul_f32 v[50:51], v[50:51], v[28:29] op_sel_hi:[1,0]
    v_pk_mul_f32 v[52:53], v[52:53], v[28:29] op_sel_hi:[1,0]
    v_pk_mul_f32 v[54:55], v[54:55], v[28:29] op_sel_hi:[1,0]
    v_pk_mul_f32 v[56:57], v[56:57], v[28:29] op_sel_hi:[1,0]
    v_pk_mul_f32 v[58:59], v[58:59], v[28:29] op_sel_hi:[1,0]
    v_pk_mul_f32 v[60:61], v[60:61], v[28:29] op_sel_hi:[1,0]
    v_pk_mul_f32 v[62:63], v[62:63], v[28:29] op_sel_hi:[1,0]
    v_cvt_pk_bf16_f32 v48, v48, v49
    v_cvt_pk_bf16_f32 v49, v50, v51
    v_cvt_pk_bf16_f32 v52, v52, v53
    v_cvt_pk_bf16_f32 v53, v54, v55
    v_cvt_pk_bf16_f32 v56, v56, v57
    v_cvt_pk_bf16_f32 v57, v58, v59
    v_cvt_pk_bf16_f32 v60, v60, v61
    v_cvt_pk_bf16_f32 v61, v62, v63
    v_mfma_f32_16x16x32_bf16 v[228:231], a[88:91], a[40:43], v[228:231]
    v_exp_f32 v222, v222
    v_mfma_f32_16x16x32_bf16 v[228:231], a[92:95], a[44:47], v[228:231]
    ds_write_b64 v24, v[32:33] offset:0
    v_add_f32 v20, v20, v222
    v_mfma_f32_16x16x32_bf16 v[232:235], a[96:99], a[32:35], v[200:203]
    v_exp_f32 v223, v223
    v_mfma_f32_16x16x32_bf16 v[232:235], a[100:103], a[36:39], v[232:235]
    v_add_f32 v20, v20, v223
    v_cvt_pk_bf16_f32 v217, v222, v223
    v_mfma_f32_16x16x32_bf16 v[232:235], a[104:107], a[40:43], v[232:235]
    v_exp_f32 v224, v224
    v_mfma_f32_16x16x32_bf16 v[232:235], a[108:111], a[44:47], v[232:235]
    ds_write_b64 v24, v[36:37] offset:32
    v_add_f32 v20, v20, v224
    v_mfma_f32_16x16x32_bf16 v[236:239], a[112:115], a[32:35], v[200:203]
    v_exp_f32 v225, v225
    v_mfma_f32_16x16x32_bf16 v[236:239], a[116:119], a[36:39], v[236:239]
    ds_write_b64 v24, v[40:41] offset:64
    v_add_f32 v20, v20, v225
    v_cvt_pk_bf16_f32 v218, v224, v225
    v_mfma_f32_16x16x32_bf16 v[236:239], a[120:123], a[40:43], v[236:239]
    v_exp_f32 v226, v226
    v_mfma_f32_16x16x32_bf16 v[236:239], a[124:127], a[44:47], v[236:239]
    buffer_load_dwordx4 v17, s[16:19], s28 offen offset:2048 nt lds
    ds_write_b64 v24, v[44:45] offset:96
    v_add_f32 v20, v20, v226
    v_mfma_f32_16x16x32_bf16 v[240:243], a[128:131], a[32:35], v[200:203]
    v_exp_f32 v227, v227
    v_mfma_f32_16x16x32_bf16 v[240:243], a[132:135], a[36:39], v[240:243]
    v_add_f32 v20, v20, v227
    v_cvt_pk_bf16_f32 v219, v226, v227
    v_mfma_f32_16x16x32_bf16 v[240:243], a[136:139], a[40:43], v[240:243]
    v_exp_f32 v228, v228
    v_mov_b32 v30, v20
    v_mfma_f32_16x16x32_bf16 v[240:243], a[140:143], a[44:47], v[240:243]
    ds_write_b64 v24, v[48:49] offset:128
    v_add_f32 v21, v21, v228
    v_mfma_f32_16x16x32_bf16 v[64:67], a[144:147], v[212:215], v[64:67]
    v_exp_f32 v229, v229
    v_permlane16_swap_b32 v20, v30
    v_mfma_f32_16x16x32_bf16 v[64:67], a[176:179], v[216:219], v[64:67]
    ds_write_b64 v24, v[52:53] offset:160
    v_add_f32 v21, v21, v229
    v_cvt_pk_bf16_f32 v228, v228, v229
    v_accvgpr_mov_b32 a32, a208
    v_accvgpr_mov_b32 a33, a209
    v_accvgpr_mov_b32 a34, a210
    v_accvgpr_mov_b32 a35, a211
    v_accvgpr_mov_b32 a36, a212
    v_accvgpr_mov_b32 a37, a213
    v_accvgpr_mov_b32 a38, a214
    v_accvgpr_mov_b32 a39, a215
    v_accvgpr_mov_b32 a40, a216
    v_accvgpr_mov_b32 a41, a217
    v_accvgpr_mov_b32 a42, a218
    v_accvgpr_mov_b32 a43, a219
    v_accvgpr_mov_b32 a44, a220
    v_accvgpr_mov_b32 a45, a221
    v_accvgpr_mov_b32 a46, a222
    v_accvgpr_mov_b32 a47, a223
    v_mfma_f32_16x16x32_bf16 v[68:71], a[148:151], v[212:215], v[68:71]
    v_exp_f32 v230, v230
    v_add_f32 v20, v20, v30
    v_mfma_f32_16x16x32_bf16 v[68:71], a[180:183], v[216:219], v[68:71]
    buffer_load_dwordx4 v18, s[16:19], s28 offen offset:3072 nt lds
    ds_write_b64 v24, v[56:57] offset:192
    v_add_f32 v21, v21, v230
    v_mfma_f32_16x16x32_bf16 v[72:75], a[152:155], v[212:215], v[72:75]
    v_exp_f32 v231, v231
    v_mov_b32 v30, v20
    v_mfma_f32_16x16x32_bf16 v[72:75], a[184:187], v[216:219], v[72:75]
    ds_write_b64 v24, v[60:61] offset:224
    s_add_u32 s28, s28, 16384
    v_add_f32 v21, v21, v231
    v_cvt_pk_bf16_f32 v229, v230, v231
    v_mfma_f32_16x16x32_bf16 v[76:79], a[156:159], v[212:215], v[76:79]
    v_exp_f32 v232, v232
    v_permlane32_swap_b32 v20, v30
    v_mfma_f32_16x16x32_bf16 v[76:79], a[188:191], v[216:219], v[76:79]
    ds_read_b128 v[32:35], v25 offset:0
    v_add_f32 v21, v21, v232
    v_mfma_f32_16x16x32_bf16 v[80:83], a[160:163], v[212:215], v[80:83]
    v_exp_f32 v233, v233
    v_add_f32 v20, v20, v30
    v_mfma_f32_16x16x32_bf16 v[80:83], a[192:195], v[216:219], v[80:83]
    v_add_f32 v21, v21, v233
    v_cvt_pk_bf16_f32 v230, v232, v233
    v_mfma_f32_16x16x32_bf16 v[84:87], a[164:167], v[212:215], v[84:87]
    v_exp_f32 v234, v234
    v_rcp_f32 v28, v20
    v_mfma_f32_16x16x32_bf16 v[84:87], a[196:199], v[216:219], v[84:87]
    ds_read_b128 v[36:39], v25 offset:1088
    v_add_f32 v21, v21, v234
    v_mfma_f32_16x16x32_bf16 v[88:91], a[168:171], v[212:215], v[88:91]
    ds_read_b128 v[40:43], v25 offset:2176
    v_exp_f32 v235, v235
    v_cmp_nge_f32 s[96:97], s36, v20
    v_mfma_f32_16x16x32_bf16 v[88:91], a[200:203], v[216:219], v[88:91]
    v_add_f32 v21, v21, v235
    v_cvt_pk_bf16_f32 v231, v234, v235
    v_mfma_f32_16x16x32_bf16 v[92:95], a[172:175], v[212:215], v[92:95]
    v_exp_f32 v236, v236
    s_or_b64 s[38:39], s[38:39], s[96:97]
    v_mfma_f32_16x16x32_bf16 v[92:95], a[204:207], v[216:219], v[92:95]
    ds_read_b128 v[44:47], v25 offset:3264
    v_add_f32 v21, v21, v236
    v_mfma_f32_16x16x32_bf16 v[212:215], a[80:83], a[48:51], v[204:207]
    v_exp_f32 v237, v237
    v_mfma_f32_16x16x32_bf16 v[212:215], a[84:87], a[52:55], v[212:215]
    v_add_f32 v21, v21, v237
    v_cvt_pk_bf16_f32 v232, v236, v237
    v_pk_mul_f32 v[64:65], v[64:65], v[28:29] op_sel_hi:[1,0]
    v_pk_mul_f32 v[66:67], v[66:67], v[28:29] op_sel_hi:[1,0]
    v_pk_mul_f32 v[68:69], v[68:69], v[28:29] op_sel_hi:[1,0]
    v_pk_mul_f32 v[70:71], v[70:71], v[28:29] op_sel_hi:[1,0]
    v_pk_mul_f32 v[72:73], v[72:73], v[28:29] op_sel_hi:[1,0]
    v_pk_mul_f32 v[74:75], v[74:75], v[28:29] op_sel_hi:[1,0]
    v_pk_mul_f32 v[76:77], v[76:77], v[28:29] op_sel_hi:[1,0]
    v_pk_mul_f32 v[78:79], v[78:79], v[28:29] op_sel_hi:[1,0]
    v_cvt_pk_bf16_f32 v64, v64, v65
    v_cvt_pk_bf16_f32 v65, v66, v67
    v_cvt_pk_bf16_f32 v68, v68, v69
    v_cvt_pk_bf16_f32 v69, v70, v71
    v_cvt_pk_bf16_f32 v72, v72, v73
    v_cvt_pk_bf16_f32 v73, v74, v75
    v_cvt_pk_bf16_f32 v76, v76, v77
    v_cvt_pk_bf16_f32 v77, v78, v79
    v_pk_mul_f32 v[80:81], v[80:81], v[28:29] op_sel_hi:[1,0]
    v_pk_mul_f32 v[82:83], v[82:83], v[28:29] op_sel_hi:[1,0]
    v_pk_mul_f32 v[84:85], v[84:85], v[28:29] op_sel_hi:[1,0]
    v_pk_mul_f32 v[86:87], v[86:87], v[28:29] op_sel_hi:[1,0]
    v_pk_mul_f32 v[88:89], v[88:89], v[28:29] op_sel_hi:[1,0]
    v_pk_mul_f32 v[90:91], v[90:91], v[28:29] op_sel_hi:[1,0]
    v_pk_mul_f32 v[92:93], v[92:93], v[28:29] op_sel_hi:[1,0]
    v_pk_mul_f32 v[94:95], v[94:95], v[28:29] op_sel_hi:[1,0]
    v_cvt_pk_bf16_f32 v80, v80, v81
    v_cvt_pk_bf16_f32 v81, v82, v83
    v_cvt_pk_bf16_f32 v84, v84, v85
    v_cvt_pk_bf16_f32 v85, v86, v87
    v_cvt_pk_bf16_f32 v88, v88, v89
    v_cvt_pk_bf16_f32 v89, v90, v91
    v_cvt_pk_bf16_f32 v92, v92, v93
    v_cvt_pk_bf16_f32 v93, v94, v95
    v_mfma_f32_16x16x32_bf16 v[212:215], a[88:91], a[56:59], v[212:215]
    v_exp_f32 v238, v238
    v_mfma_f32_16x16x32_bf16 v[212:215], a[92:95], a[60:63], v[212:215]
    ds_write_b64 v24, v[64:65] offset:0
    v_add_f32 v21, v21, v238
    v_mfma_f32_16x16x32_bf16 v[216:219], a[96:99], a[48:51], v[204:207]
    v_exp_f32 v239, v239
    v_mfma_f32_16x16x32_bf16 v[216:219], a[100:103], a[52:55], v[216:219]
    ds_write_b64 v24, v[68:69] offset:32
    v_add_f32 v21, v21, v239
    v_cvt_pk_bf16_f32 v233, v238, v239
    v_mfma_f32_16x16x32_bf16 v[216:219], a[104:107], a[56:59], v[216:219]
    v_exp_f32 v240, v240
    v_mfma_f32_16x16x32_bf16 v[216:219], a[108:111], a[60:63], v[216:219]
    ds_write_b64 v24, v[72:73] offset:64
    s_add_u32 s101, s100, 0
    v_add_f32 v21, v21, v240
    v_mfma_f32_16x16x32_bf16 v[220:223], a[112:115], a[48:51], v[204:207]
    v_exp_f32 v241, v241
    v_mfma_f32_16x16x32_bf16 v[220:223], a[116:119], a[52:55], v[220:223]
    ds_write_b64 v24, v[76:77] offset:96
    v_add_f32 v21, v21, v241
    v_cvt_pk_bf16_f32 v234, v240, v241
    v_mfma_f32_16x16x32_bf16 v[220:223], a[120:123], a[56:59], v[220:223]
    v_exp_f32 v242, v242
    v_mfma_f32_16x16x32_bf16 v[220:223], a[124:127], a[60:63], v[220:223]
    s_waitcnt lgkmcnt(3)
    buffer_store_dwordx4 v[32:35], v26, s[24:27], s101 offen offset:0 sc1
    ds_write_b64 v24, v[80:81] offset:128
    v_add_f32 v21, v21, v242
    v_mfma_f32_16x16x32_bf16 v[224:227], a[128:131], a[48:51], v[204:207]
    v_exp_f32 v243, v243
    v_mfma_f32_16x16x32_bf16 v[224:227], a[132:135], a[52:55], v[224:227]
    ds_write_b64 v24, v[84:85] offset:160
    v_add_f32 v21, v21, v243
    v_cvt_pk_bf16_f32 v235, v242, v243
    v_mfma_f32_16x16x32_bf16 v[224:227], a[136:139], a[56:59], v[224:227]
    v_exp_f32 v212, v212
    v_mov_b32 v30, v21
    v_mfma_f32_16x16x32_bf16 v[224:227], a[140:143], a[60:63], v[224:227]
    buffer_store_dwordx4 v[36:39], v26, s[24:27], s101 offen offset:1024 sc1
    ds_write_b64 v24, v[88:89] offset:192
    v_add_f32 v22, v22, v212
    v_mfma_f32_16x16x32_bf16 v[96:99], a[144:147], v[228:231], v[96:99]
    v_exp_f32 v213, v213
    v_permlane16_swap_b32 v21, v30
    v_mfma_f32_16x16x32_bf16 v[96:99], a[176:179], v[232:235], v[96:99]
    ds_write_b64 v24, v[92:93] offset:224
    v_add_f32 v22, v22, v213
    v_cvt_pk_bf16_f32 v212, v212, v213
    v_accvgpr_mov_b32 a48, a224
    v_accvgpr_mov_b32 a49, a225
    v_accvgpr_mov_b32 a50, a226
    v_accvgpr_mov_b32 a51, a227
    v_accvgpr_mov_b32 a52, a228
    v_accvgpr_mov_b32 a53, a229
    v_accvgpr_mov_b32 a54, a230
    v_accvgpr_mov_b32 a55, a231
    v_accvgpr_mov_b32 a56, a232
    v_accvgpr_mov_b32 a57, a233
    v_accvgpr_mov_b32 a58, a234
    v_accvgpr_mov_b32 a59, a235
    v_accvgpr_mov_b32 a60, a236
    v_accvgpr_mov_b32 a61, a237
    v_accvgpr_mov_b32 a62, a238
    v_accvgpr_mov_b32 a63, a239
    v_mfma_f32_16x16x32_bf16 v[100:103], a[148:151], v[228:231], v[100:103]
    v_exp_f32 v214, v214
    v_add_f32 v21, v21, v30
    v_mfma_f32_16x16x32_bf16 v[100:103], a[180:183], v[232:235], v[100:103]
    buffer_store_dwordx4 v[40:43], v26, s[24:27], s101 offen offset:2048 sc1
    v_add_f32 v22, v22, v214
    v_mfma_f32_16x16x32_bf16 v[104:107], a[152:155], v[228:231], v[104:107]
    v_exp_f32 v215, v215
    v_mov_b32 v30, v21
    v_mfma_f32_16x16x32_bf16 v[104:107], a[184:187], v[232:235], v[104:107]
    buffer_store_dwordx4 v[44:47], v26, s[24:27], s101 offen offset:3072 sc1
    v_add_f32 v22, v22, v215
    v_cvt_pk_bf16_f32 v213, v214, v215
    v_mfma_f32_16x16x32_bf16 v[108:111], a[156:159], v[228:231], v[108:111]
    v_exp_f32 v216, v216
    v_permlane32_swap_b32 v21, v30
    v_mfma_f32_16x16x32_bf16 v[108:111], a[188:191], v[232:235], v[108:111]
    ds_read_b128 v[64:67], v25 offset:0
    v_add_f32 v22, v22, v216
    v_mfma_f32_16x16x32_bf16 v[112:115], a[160:163], v[228:231], v[112:115]
    v_exp_f32 v217, v217
    v_add_f32 v21, v21, v30
    v_mfma_f32_16x16x32_bf16 v[112:115], a[192:195], v[232:235], v[112:115]
    v_add_f32 v22, v22, v217
    v_cvt_pk_bf16_f32 v214, v216, v217
    v_mfma_f32_16x16x32_bf16 v[116:119], a[164:167], v[228:231], v[116:119]
    v_exp_f32 v218, v218
    v_rcp_f32 v28, v21
    v_mfma_f32_16x16x32_bf16 v[116:119], a[196:199], v[232:235], v[116:119]
    ds_read_b128 v[68:71], v25 offset:1088
    v_add_f32 v22, v22, v218
    v_mfma_f32_16x16x32_bf16 v[120:123], a[168:171], v[228:231], v[120:123]
    ds_read_b128 v[72:75], v25 offset:2176
    v_exp_f32 v219, v219
    v_cmp_nge_f32 s[96:97], s36, v21
    v_mfma_f32_16x16x32_bf16 v[120:123], a[200:203], v[232:235], v[120:123]
    v_add_f32 v22, v22, v219
    v_cvt_pk_bf16_f32 v215, v218, v219
    v_mfma_f32_16x16x32_bf16 v[124:127], a[172:175], v[228:231], v[124:127]
    v_exp_f32 v220, v220
    s_or_b64 s[38:39], s[38:39], s[96:97]
    v_mfma_f32_16x16x32_bf16 v[124:127], a[204:207], v[232:235], v[124:127]
    ds_read_b128 v[76:79], v25 offset:3264
    v_add_f32 v22, v22, v220
    s_waitcnt vmcnt(8)
    s_barrier
    v_mfma_f32_16x16x32_bf16 v[228:231], a[80:83], a[64:67], v[208:211]
    v_exp_f32 v221, v221
    v_mfma_f32_16x16x32_bf16 v[228:231], a[84:87], a[68:71], v[228:231]
    ds_read_b128 a[80:83], v1 offset:0
    v_add_f32 v22, v22, v221
    v_cvt_pk_bf16_f32 v216, v220, v221
    v_pk_mul_f32 v[96:97], v[96:97], v[28:29] op_sel_hi:[1,0]
    v_pk_mul_f32 v[98:99], v[98:99], v[28:29] op_sel_hi:[1,0]
    v_pk_mul_f32 v[100:101], v[100:101], v[28:29] op_sel_hi:[1,0]
    v_pk_mul_f32 v[102:103], v[102:103], v[28:29] op_sel_hi:[1,0]
    v_pk_mul_f32 v[104:105], v[104:105], v[28:29] op_sel_hi:[1,0]
    v_pk_mul_f32 v[106:107], v[106:107], v[28:29] op_sel_hi:[1,0]
    v_pk_mul_f32 v[108:109], v[108:109], v[28:29] op_sel_hi:[1,0]
    v_pk_mul_f32 v[110:111], v[110:111], v[28:29] op_sel_hi:[1,0]
    v_cvt_pk_bf16_f32 v96, v96, v97
    v_cvt_pk_bf16_f32 v97, v98, v99
    v_cvt_pk_bf16_f32 v100, v100, v101
    v_cvt_pk_bf16_f32 v101, v102, v103
    v_cvt_pk_bf16_f32 v104, v104, v105
    v_cvt_pk_bf16_f32 v105, v106, v107
    v_cvt_pk_bf16_f32 v108, v108, v109
    v_cvt_pk_bf16_f32 v109, v110, v111
    v_pk_mul_f32 v[112:113], v[112:113], v[28:29] op_sel_hi:[1,0]
    v_pk_mul_f32 v[114:115], v[114:115], v[28:29] op_sel_hi:[1,0]
    v_pk_mul_f32 v[116:117], v[116:117], v[28:29] op_sel_hi:[1,0]
    v_pk_mul_f32 v[118:119], v[118:119], v[28:29] op_sel_hi:[1,0]
    v_pk_mul_f32 v[120:121], v[120:121], v[28:29] op_sel_hi:[1,0]
    v_pk_mul_f32 v[122:123], v[122:123], v[28:29] op_sel_hi:[1,0]
    v_pk_mul_f32 v[124:125], v[124:125], v[28:29] op_sel_hi:[1,0]
    v_pk_mul_f32 v[126:127], v[126:127], v[28:29] op_sel_hi:[1,0]
    v_cvt_pk_bf16_f32 v112, v112, v113
    v_cvt_pk_bf16_f32 v113, v114, v115
    v_cvt_pk_bf16_f32 v116, v116, v117
    v_cvt_pk_bf16_f32 v117, v118, v119
    v_cvt_pk_bf16_f32 v120, v120, v121
    v_cvt_pk_bf16_f32 v121, v122, v123
    v_cvt_pk_bf16_f32 v124, v124, v125
    v_cvt_pk_bf16_f32 v125, v126, v127
    v_mfma_f32_16x16x32_bf16 v[228:231], a[88:91], a[72:75], v[228:231]
    ds_write_b64 v24, v[96:97] offset:0
    v_exp_f32 v222, v222
    v_mfma_f32_16x16x32_bf16 v[228:231], a[92:95], a[76:79], v[228:231]
    ds_read_b128 a[84:87], v2 offset:0
    v_add_f32 v22, v22, v222
    v_mfma_f32_16x16x32_bf16 v[232:235], a[96:99], a[64:67], v[208:211]
    ds_write_b64 v24, v[100:101] offset:32
    s_add_u32 s101, s100, 4096
    v_exp_f32 v223, v223
    v_mfma_f32_16x16x32_bf16 v[232:235], a[100:103], a[68:71], v[232:235]
    ds_read_b128 a[88:91], v3 offset:0
    v_add_f32 v22, v22, v223
    v_cvt_pk_bf16_f32 v217, v222, v223
    v_mfma_f32_16x16x32_bf16 v[232:235], a[104:107], a[72:75], v[232:235]
    s_waitcnt lgkmcnt(6)
    buffer_store_dwordx4 v[64:67], v26, s[24:27], s101 offen offset:0 sc1
    ds_write_b64 v24, v[104:105] offset:64
    v_exp_f32 v224, v224
    v_mfma_f32_16x16x32_bf16 v[232:235], a[108:111], a[76:79], v[232:235]
    ds_read_b128 a[92:95], v4 offset:0
    v_add_f32 v22, v22, v224
    v_mfma_f32_16x16x32_bf16 v[236:239], a[112:115], a[64:67], v[208:211]
    buffer_store_dwordx4 v[68:71], v26, s[24:27], s101 offen offset:1024 sc1
    ds_write_b64 v24, v[108:109] offset:96
    v_exp_f32 v225, v225
    v_mfma_f32_16x16x32_bf16 v[236:239], a[116:119], a[68:71], v[236:239]
    ds_read_b128 a[96:99], v1 offset:4096
    v_add_f32 v22, v22, v225
    v_cvt_pk_bf16_f32 v218, v224, v225
    v_mfma_f32_16x16x32_bf16 v[236:239], a[120:123], a[72:75], v[236:239]
    buffer_store_dwordx4 v[72:75], v26, s[24:27], s101 offen offset:2048 sc1
    ds_write_b64 v24, v[112:113] offset:128
    v_exp_f32 v226, v226
    v_mfma_f32_16x16x32_bf16 v[236:239], a[124:127], a[76:79], v[236:239]
    ds_read_b128 a[100:103], v2 offset:4096
    v_add_f32 v22, v22, v226
    v_mfma_f32_16x16x32_bf16 v[240:243], a[128:131], a[64:67], v[208:211]
    s_waitcnt lgkmcnt(7)
    buffer_store_dwordx4 v[76:79], v26, s[24:27], s101 offen offset:3072 sc1
    ds_write_b64 v24, v[116:117] offset:160
    v_exp_f32 v227, v227
    v_mfma_f32_16x16x32_bf16 v[240:243], a[132:135], a[68:71], v[240:243]
    ds_read_b128 a[104:107], v3 offset:4096
    v_add_f32 v22, v22, v227
    v_cvt_pk_bf16_f32 v219, v226, v227
    v_mfma_f32_16x16x32_bf16 v[240:243], a[136:139], a[72:75], v[240:243]
    ds_write_b64 v24, v[120:121] offset:192
    v_exp_f32 v228, v228
    v_mov_b32 v30, v22
    v_mfma_f32_16x16x32_bf16 v[240:243], a[140:143], a[76:79], v[240:243]
    ds_read_b128 a[108:111], v4 offset:4096
    v_add_f32 v23, v23, v228
    v_mfma_f32_16x16x32_bf16 v[128:131], a[144:147], v[212:215], v[128:131]
    ds_write_b64 v24, v[124:125] offset:224
    v_exp_f32 v229, v229
    v_permlane16_swap_b32 v22, v30
    v_mfma_f32_16x16x32_bf16 v[128:131], a[176:179], v[216:219], v[128:131]
    ds_read_b128 a[112:115], v1 offset:8192
    v_add_f32 v23, v23, v229
    v_cvt_pk_bf16_f32 v228, v228, v229
    v_accvgpr_mov_b32 a64, a240
    v_accvgpr_mov_b32 a65, a241
    v_accvgpr_mov_b32 a66, a242
    v_accvgpr_mov_b32 a67, a243
    v_accvgpr_mov_b32 a68, a244
    v_accvgpr_mov_b32 a69, a245
    v_accvgpr_mov_b32 a70, a246
    v_accvgpr_mov_b32 a71, a247
    v_accvgpr_mov_b32 a72, a248
    v_accvgpr_mov_b32 a73, a249
    v_accvgpr_mov_b32 a74, a250
    v_accvgpr_mov_b32 a75, a251
    v_accvgpr_mov_b32 a76, a252
    v_accvgpr_mov_b32 a77, a253
    v_accvgpr_mov_b32 a78, a254
    v_accvgpr_mov_b32 a79, a255
    v_mfma_f32_16x16x32_bf16 v[132:135], a[148:151], v[212:215], v[132:135]
    ds_read_b128 v[96:99], v25 offset:0
    v_exp_f32 v230, v230
    v_add_f32 v22, v22, v30
    v_mfma_f32_16x16x32_bf16 v[132:135], a[180:183], v[216:219], v[132:135]
    ds_read_b128 a[116:119], v2 offset:8192
    ds_read_b128 v[100:103], v25 offset:1088
    v_add_f32 v23, v23, v230
    v_mfma_f32_16x16x32_bf16 v[136:139], a[152:155], v[212:215], v[136:139]
    ds_read_b128 v[104:107], v25 offset:2176
    v_exp_f32 v231, v231
    v_mov_b32 v30, v22
    v_mfma_f32_16x16x32_bf16 v[136:139], a[184:187], v[216:219], v[136:139]
    ds_read_b128 a[120:123], v3 offset:8192
    ds_read_b128 v[108:111], v25 offset:3264
    v_add_f32 v23, v23, v231
    v_cvt_pk_bf16_f32 v229, v230, v231
    v_mfma_f32_16x16x32_bf16 v[140:143], a[156:159], v[212:215], v[140:143]
    v_exp_f32 v232, v232
    v_permlane32_swap_b32 v22, v30
    v_mfma_f32_16x16x32_bf16 v[140:143], a[188:191], v[216:219], v[140:143]
    ds_read_b128 a[124:127], v4 offset:8192
    v_add_f32 v23, v23, v232
    v_mfma_f32_16x16x32_bf16 v[144:147], a[160:163], v[212:215], v[144:147]
    v_exp_f32 v233, v233
    v_add_f32 v22, v22, v30
    v_mfma_f32_16x16x32_bf16 v[144:147], a[192:195], v[216:219], v[144:147]
    ds_read_b128 a[128:131], v1 offset:12288
    s_add_u32 s101, s100, 8192
    v_add_f32 v23, v23, v233
    v_cvt_pk_bf16_f32 v230, v232, v233
    v_mfma_f32_16x16x32_bf16 v[148:151], a[164:167], v[212:215], v[148:151]
    s_waitcnt lgkmcnt(7)
    buffer_store_dwordx4 v[96:99], v26, s[24:27], s101 offen offset:0 sc1
    v_exp_f32 v234, v234
    v_rcp_f32 v28, v22
    v_mfma_f32_16x16x32_bf16 v[148:151], a[196:199], v[216:219], v[148:151]
    ds_read_b128 a[132:135], v2 offset:12288
    s_waitcnt lgkmcnt(6)
    buffer_store_dwordx4 v[100:103], v26, s[24:27], s101 offen offset:1024 sc1
    v_add_f32 v23, v23, v234
    v_mfma_f32_16x16x32_bf16 v[152:155], a[168:171], v[212:215], v[152:155]
    s_waitcnt lgkmcnt(5)
    buffer_store_dwordx4 v[104:107], v26, s[24:27], s101 offen offset:2048 sc1
    v_exp_f32 v235, v235
    v_cmp_nge_f32 s[96:97], s36, v22
    v_mfma_f32_16x16x32_bf16 v[152:155], a[200:203], v[216:219], v[152:155]
    ds_read_b128 a[136:139], v3 offset:12288
    s_waitcnt lgkmcnt(4)
    buffer_store_dwordx4 v[108:111], v26, s[24:27], s101 offen offset:3072 sc1
    v_add_f32 v23, v23, v235
    v_cvt_pk_bf16_f32 v231, v234, v235
    v_mfma_f32_16x16x32_bf16 v[156:159], a[172:175], v[212:215], v[156:159]
    v_exp_f32 v236, v236
    s_or_b64 s[38:39], s[38:39], s[96:97]
    v_mfma_f32_16x16x32_bf16 v[156:159], a[204:207], v[216:219], v[156:159]
    ds_read_b128 a[140:143], v4 offset:12288
    v_add_f32 v23, v23, v236
    s_mov_b32 s30, 14
    s_mov_b32 s40, 10
    s_mov_b64 vcc, -1
    v_mfma_f32_16x16x32_bf16 v[192:195], a[80:83], a[0:3], 0
    v_mul_f32 v128, v28, v128
    v_mul_f32 v129, v28, v129
    v_mfma_f32_16x16x32_bf16 v[192:195], a[84:87], a[4:7], v[192:195]
    v_mul_f32 v130, v28, v130
    v_mul_f32 v131, v28, v131
    v_mfma_f32_16x16x32_bf16 v[192:195], a[88:91], a[8:11], v[192:195]
    v_mul_f32 v132, v28, v132
    v_mul_f32 v133, v28, v133
    v_mfma_f32_16x16x32_bf16 v[192:195], a[92:95], a[12:15], v[192:195]
    v_mul_f32 v134, v28, v134
    v_mul_f32 v135, v28, v135
    v_mfma_f32_16x16x32_bf16 v[196:199], a[80:83], a[16:19], 0
    v_mul_f32 v136, v28, v136
    v_mul_f32 v137, v28, v137
    v_mfma_f32_16x16x32_bf16 v[196:199], a[84:87], a[20:23], v[196:199]
    v_mul_f32 v138, v28, v138
    v_mul_f32 v139, v28, v139
    v_mfma_f32_16x16x32_bf16 v[196:199], a[88:91], a[24:27], v[196:199]
    v_max3_f32 v244, v192, v193, v194
    v_max_f32 v244, v244, v195
    v_mfma_f32_16x16x32_bf16 v[196:199], a[92:95], a[28:31], v[196:199]
    v_mov_b32 v245, v244
    v_mul_f32 v140, v28, v140
    v_mfma_f32_16x16x32_bf16 v[200:203], a[80:83], a[32:35], 0
    v_mul_f32 v141, v28, v141
    v_permlane16_swap_b32 v244, v245
    v_mfma_f32_16x16x32_bf16 v[200:203], a[84:87], a[36:39], v[200:203]
    v_max_f32 v244, v244, v245
    v_mov_b32 v245, v244
    v_mfma_f32_16x16x32_bf16 v[200:203], a[88:91], a[40:43], v[200:203]
    v_mul_f32 v142, v28, v142
    v_mul_f32 v143, v28, v143
    v_mfma_f32_16x16x32_bf16 v[200:203], a[92:95], a[44:47], v[200:203]
    v_permlane32_swap_b32 v244, v245
    v_min_f32 v192, -v244, -v245
    v_mfma_f32_16x16x32_bf16 v[204:207], a[80:83], a[48:51], 0
    v_min_f32 v193, -v244, -v245
    v_min_f32 v194, -v244, -v245
    v_mfma_f32_16x16x32_bf16 v[204:207], a[84:87], a[52:55], v[204:207]
    v_min_f32 v195, -v244, -v245
    v_max3_f32 v246, v196, v197, v198
    v_mfma_f32_16x16x32_bf16 v[204:207], a[88:91], a[56:59], v[204:207]
    v_max_f32 v246, v246, v199
    v_mov_b32 v247, v246
    v_mfma_f32_16x16x32_bf16 v[204:207], a[92:95], a[60:63], v[204:207]
    v_cvt_pk_bf16_f32 v128, v128, v129
    v_cvt_pk_bf16_f32 v129, v130, v131
    v_mfma_f32_16x16x32_bf16 v[208:211], a[80:83], a[64:67], 0
    v_permlane16_swap_b32 v246, v247
    v_max_f32 v246, v246, v247
    v_mfma_f32_16x16x32_bf16 v[208:211], a[84:87], a[68:71], v[208:211]
    v_mov_b32 v247, v246
    v_cvt_pk_bf16_f32 v132, v132, v133
    v_mfma_f32_16x16x32_bf16 v[208:211], a[88:91], a[72:75], v[208:211]
    v_cvt_pk_bf16_f32 v133, v134, v135
    v_permlane32_swap_b32 v246, v247
    v_mfma_f32_16x16x32_bf16 v[208:211], a[92:95], a[76:79], v[208:211]
    v_min_f32 v196, -v246, -v247
    v_min_f32 v197, -v246, -v247
    v_min_f32 v198, -v246, -v247
    v_min_f32 v199, -v246, -v247
    v_max3_f32 v248, v200, v201, v202
    v_max_f32 v248, v248, v203
    v_mov_b32 v249, v248
    v_cvt_pk_bf16_f32 v136, v136, v137
    v_cvt_pk_bf16_f32 v137, v138, v139
    v_permlane16_swap_b32 v248, v249
    v_max_f32 v248, v248, v249
    v_mov_b32 v249, v248
    v_cvt_pk_bf16_f32 v140, v140, v141
    v_cvt_pk_bf16_f32 v141, v142, v143
    v_permlane32_swap_b32 v248, v249
    v_min_f32 v200, -v248, -v249
    v_min_f32 v201, -v248, -v249
    v_min_f32 v202, -v248, -v249
    v_min_f32 v203, -v248, -v249
    v_max3_f32 v250, v204, v205, v206
    v_max_f32 v250, v250, v207
    v_mov_b32 v251, v250
    v_mul_f32 v144, v28, v144
    v_mul_f32 v145, v28, v145
    v_permlane16_swap_b32 v250, v251
    v_max_f32 v250, v250, v251
    v_mov_b32 v251, v250
    v_mul_f32 v146, v28, v146
    v_mul_f32 v147, v28, v147
    v_permlane32_swap_b32 v250, v251
    v_min_f32 v204, -v250, -v251
    v_min_f32 v205, -v250, -v251
    v_min_f32 v206, -v250, -v251
    v_min_f32 v207, -v250, -v251
    v_max3_f32 v252, v208, v209, v210
    v_max_f32 v252, v252, v211
    v_mov_b32 v253, v252
    v_mul_f32 v148, v28, v148
    v_mul_f32 v149, v28, v149
    v_permlane16_swap_b32 v252, v253
    v_max_f32 v252, v252, v253
    v_mov_b32 v253, v252
    v_mul_f32 v150, v28, v150
    v_mul_f32 v151, v28, v151
    v_permlane32_swap_b32 v252, v253
    v_min_f32 v208, -v252, -v253
    v_min_f32 v209, -v252, -v253
    v_min_f32 v210, -v252, -v253
    v_min_f32 v211, -v252, -v253
    v_pk_mul_f32 v[152:153], v[152:153], v[28:29] op_sel_hi:[1,0]
    v_pk_mul_f32 v[154:155], v[154:155], v[28:29] op_sel_hi:[1,0]
    v_pk_mul_f32 v[156:157], v[156:157], v[28:29] op_sel_hi:[1,0]
    v_pk_mul_f32 v[158:159], v[158:159], v[28:29] op_sel_hi:[1,0]
    v_cvt_pk_bf16_f32 v144, v144, v145
    v_cvt_pk_bf16_f32 v145, v146, v147
    v_cvt_pk_bf16_f32 v148, v148, v149
    v_cvt_pk_bf16_f32 v149, v150, v151
    v_cvt_pk_bf16_f32 v152, v152, v153
    v_cvt_pk_bf16_f32 v153, v154, v155
    v_cvt_pk_bf16_f32 v156, v156, v157
    v_cvt_pk_bf16_f32 v157, v158, v159
    s_cmp_lg_u32 s32, 3
    s_cbranch_scc1 L_ndb
    v_mov_b32 v208, 0xf149f2ca
    v_mov_b32 v209, 0xf149f2ca
    v_mov_b32 v210, 0xf149f2ca
    v_mov_b32 v211, 0xf149f2ca
L_ndb:
    s_nop 1
    v_mfma_f32_16x16x32_bf16 v[212:215], a[80:83], a[0:3], v[192:195]
    v_exp_f32 v237, v237
    v_mfma_f32_16x16x32_bf16 v[212:215], a[84:87], a[4:7], v[212:215]
    v_add_f32 v23, v23, v237
    v_cvt_pk_bf16_f32 v232, v236, v237
    v_mfma_f32_16x16x32_bf16 v[212:215], a[88:91], a[8:11], v[212:215]
    v_exp_f32 v238, v238
    v_mfma_f32_16x16x32_bf16 v[212:215], a[92:95], a[12:15], v[212:215]
    ds_write_b64 v24, v[128:129] offset:0
    v_add_f32 v23, v23, v238
    v_mfma_f32_16x16x32_bf16 v[216:219], a[96:99], a[0:3], v[192:195]
    v_exp_f32 v239, v239
    v_mfma_f32_16x16x32_bf16 v[216:219], a[100:103], a[4:7], v[216:219]
    v_add_f32 v23, v23, v239
    v_cvt_pk_bf16_f32 v233, v238, v239
    v_mfma_f32_16x16x32_bf16 v[216:219], a[104:107], a[8:11], v[216:219]
    v_exp_f32 v240, v240
    v_mfma_f32_16x16x32_bf16 v[216:219], a[108:111], a[12:15], v[216:219]
    ds_write_b64 v24, v[132:133] offset:32
    v_add_f32 v23, v23, v240
    v_mfma_f32_16x16x32_bf16 v[220:223], a[112:115], a[0:3], v[192:195]
    v_exp_f32 v241, v241
    v_mfma_f32_16x16x32_bf16 v[220:223], a[116:119], a[4:7], v[220:223]
    ds_write_b64 v24, v[136:137] offset:64
    v_add_f32 v23, v23, v241
    v_cvt_pk_bf16_f32 v234, v240, v241
    v_mfma_f32_16x16x32_bf16 v[220:223], a[120:123], a[8:11], v[220:223]
    v_exp_f32 v242, v242
    s_waitcnt lgkmcnt(3)
    v_mfma_f32_16x16x32_bf16 v[220:223], a[124:127], a[12:15], v[220:223]
    ds_write_b64 v24, v[140:141] offset:96
    v_add_f32 v23, v23, v242
    v_mfma_f32_16x16x32_bf16 v[224:227], a[128:131], a[0:3], v[192:195]
    v_exp_f32 v243, v243
    v_mfma_f32_16x16x32_bf16 v[224:227], a[132:135], a[4:7], v[224:227]
    ds_write_b64 v24, v[144:145] offset:128
    v_add_f32 v23, v23, v243
    v_cvt_pk_bf16_f32 v235, v242, v243
    v_mfma_f32_16x16x32_bf16 v[224:227], a[136:139], a[8:11], v[224:227]
    v_exp_f32 v212, v212
    v_mfma_f32_16x16x32_bf16 v[224:227], a[140:143], a[12:15], v[224:227]
    ds_write_b64 v24, v[148:149] offset:160
    v_mov_b32 v19, v212
    v_mfma_f32_16x16x32_bf16 v[160:163], a[144:147], v[228:231], v[160:163]
    v_exp_f32 v213, v213
    v_mfma_f32_16x16x32_bf16 v[160:163], a[176:179], v[232:235], v[160:163]
    ds_read_b64_tr_b16 a[144:145], v5 offset:0
    ds_read_b64_tr_b16 a[146:147], v5 offset:4096
    ds_write_b64 v24, v[152:153] offset:192
    v_add_f32 v19, v19, v213
    v_cvt_pk_bf16_f32 v212, v212, v213
    v_mfma_f32_16x16x32_bf16 v[164:167], a[148:151], v[228:231], v[164:167]
    v_exp_f32 v214, v214
    v_mfma_f32_16x16x32_bf16 v[164:167], a[180:183], v[232:235], v[164:167]
    ds_read_b64_tr_b16 a[176:177], v5 offset:8192
    ds_read_b64_tr_b16 a[178:179], v5 offset:12288
    ds_write_b64 v24, v[156:157] offset:224
    v_add_f32 v19, v19, v214
    v_mfma_f32_16x16x32_bf16 v[168:171], a[152:155], v[228:231], v[168:171]
    v_exp_f32 v215, v215
    v_mfma_f32_16x16x32_bf16 v[168:171], a[184:187], v[232:235], v[168:171]
    ds_read_b64_tr_b16 a[148:149], v6 offset:0
    ds_read_b64_tr_b16 a[150:151], v6 offset:4096
    ds_read_b128 a[224:227], v25 offset:0
    v_add_f32 v19, v19, v215
    v_cvt_pk_bf16_f32 v213, v214, v215
    v_mfma_f32_16x16x32_bf16 v[172:175], a[156:159], v[228:231], v[172:175]
    ds_read_b128 a[228:231], v25 offset:1088
    v_exp_f32 v216, v216
    v_mov_b32 v30, v23
    v_mfma_f32_16x16x32_bf16 v[172:175], a[188:191], v[232:235], v[172:175]
    ds_read_b64_tr_b16 a[180:181], v6 offset:8192
    ds_read_b64_tr_b16 a[182:183], v6 offset:12288
    ds_read_b128 a[232:235], v25 offset:2176
    v_add_f32 v19, v19, v216
    v_mfma_f32_16x16x32_bf16 v[176:179], a[160:163], v[228:231], v[176:179]
    ds_read_b128 a[236:239], v25 offset:3264
    v_exp_f32 v217, v217
    v_permlane16_swap_b32 v23, v30
    v_mfma_f32_16x16x32_bf16 v[176:179], a[192:195], v[232:235], v[176:179]
    ds_read_b64_tr_b16 a[152:153], v7 offset:0
    ds_read_b64_tr_b16 a[154:155], v7 offset:4096
    v_add_f32 v19, v19, v217
    v_cvt_pk_bf16_f32 v214, v216, v217
    v_mfma_f32_16x16x32_bf16 v[180:183], a[164:167], v[228:231], v[180:183]
    v_exp_f32 v218, v218
    v_add_f32 v23, v23, v30
    v_mfma_f32_16x16x32_bf16 v[180:183], a[196:199], v[232:235], v[180:183]
    ds_read_b64_tr_b16 a[184:185], v7 offset:8192
    ds_read_b64_tr_b16 a[186:187], v7 offset:12288
    v_add_f32 v19, v19, v218
    v_mfma_f32_16x16x32_bf16 v[184:187], a[168:171], v[228:231], v[184:187]
    v_exp_f32 v219, v219
    v_mov_b32 v30, v23
    v_mfma_f32_16x16x32_bf16 v[184:187], a[200:203], v[232:235], v[184:187]
    ds_read_b64_tr_b16 a[156:157], v8 offset:0
    ds_read_b64_tr_b16 a[158:159], v8 offset:4096
    v_add_f32 v19, v19, v219
    v_cvt_pk_bf16_f32 v215, v218, v219
    v_mfma_f32_16x16x32_bf16 v[188:191], a[172:175], v[228:231], v[188:191]
    v_exp_f32 v220, v220
    v_permlane32_swap_b32 v23, v30
    v_mfma_f32_16x16x32_bf16 v[188:191], a[204:207], v[232:235], v[188:191]
    ds_read_b64_tr_b16 a[188:189], v8 offset:8192
    ds_read_b64_tr_b16 a[190:191], v8 offset:12288
    v_add_f32 v19, v19, v220
    v_mfma_f32_16x16x32_bf16 v[228:231], a[80:83], a[16:19], v[196:199]
    v_exp_f32 v221, v221
    v_add_f32 v23, v23, v30
    v_mfma_f32_16x16x32_bf16 v[228:231], a[84:87], a[20:23], v[228:231]
    ds_read_b64_tr_b16 a[160:161], v9 offset:0
    ds_read_b64_tr_b16 a[162:163], v9 offset:4096
    v_add_f32 v19, v19, v221
    v_cvt_pk_bf16_f32 v216, v220, v221
    v_mfma_f32_16x16x32_bf16 v[228:231], a[88:91], a[24:27], v[228:231]
    v_exp_f32 v222, v222
    v_rcp_f32 v28, v23
    v_mfma_f32_16x16x32_bf16 v[228:231], a[92:95], a[28:31], v[228:231]
    ds_read_b64_tr_b16 a[192:193], v9 offset:8192
    ds_read_b64_tr_b16 a[194:195], v9 offset:12288
    v_add_f32 v19, v19, v222
    v_mfma_f32_16x16x32_bf16 v[232:235], a[96:99], a[16:19], v[196:199]
    v_exp_f32 v223, v223
    v_cmp_nge_f32 s[96:97], s36, v23
    v_mfma_f32_16x16x32_bf16 v[232:235], a[100:103], a[20:23], v[232:235]
    ds_read_b64_tr_b16 a[164:165], v10 offset:0
    ds_read_b64_tr_b16 a[166:167], v10 offset:4096
    v_add_f32 v19, v19, v223
    v_cvt_pk_bf16_f32 v217, v222, v223
    v_mfma_f32_16x16x32_bf16 v[232:235], a[104:107], a[24:27], v[232:235]
    v_exp_f32 v224, v224
    s_or_b64 s[38:39], s[38:39], s[96:97]
    v_mfma_f32_16x16x32_bf16 v[232:235], a[108:111], a[28:31], v[232:235]
    ds_read_b64_tr_b16 a[196:197], v10 offset:8192
    ds_read_b64_tr_b16 a[198:199], v10 offset:12288
    v_add_f32 v19, v19, v224
    v_mfma_f32_16x16x32_bf16 v[236:239], a[112:115], a[16:19], v[196:199]
    v_exp_f32 v225, v225
    v_mfma_f32_16x16x32_bf16 v[236:239], a[116:119], a[20:23], v[236:239]
    ds_read_b64_tr_b16 a[168:169], v11 offset:0
    ds_read_b64_tr_b16 a[170:171], v11 offset:4096
    v_add_f32 v19, v19, v225
    v_cvt_pk_bf16_f32 v218, v224, v225
    v_mfma_f32_16x16x32_bf16 v[236:239], a[120:123], a[24:27], v[236:239]
    v_exp_f32 v226, v226
    v_mfma_f32_16x16x32_bf16 v[236:239], a[124:127], a[28:31], v[236:239]
    ds_read_b64_tr_b16 a[200:201], v11 offset:8192
    ds_read_b64_tr_b16 a[202:203], v11 offset:12288
    v_add_f32 v19, v19, v226
    v_mfma_f32_16x16x32_bf16 v[240:243], a[128:131], a[16:19], v[196:199]
    v_exp_f32 v227, v227
    v_mfma_f32_16x16x32_bf16 v[240:243], a[132:135], a[20:23], v[240:243]
    ds_read_b64_tr_b16 a[172:173], v12 offset:0
    ds_read_b64_tr_b16 a[174:175], v12 offset:4096
    v_add_f32 v19, v19, v227
    v_cvt_pk_bf16_f32 v219, v226, v227
    v_mfma_f32_16x16x32_bf16 v[240:243], a[136:139], a[24:27], v[240:243]
    v_exp_f32 v228, v228
    v_mfma_f32_16x16x32_bf16 v[240:243], a[140:143], a[28:31], v[240:243]
    ds_read_b64_tr_b16 a[204:205], v12 offset:8192
    ds_read_b64_tr_b16 a[206:207], v12 offset:12288
    v_mov_b32 v20, v228
    v_pk_mul_f32 v[160:161], v[160:161], v[28:29] op_sel_hi:[1,0]
    v_pk_mul_f32 v[162:163], v[162:163], v[28:29] op_sel_hi:[1,0]
    v_pk_mul_f32 v[164:165], v[164:165], v[28:29] op_sel_hi:[1,0]
    v_pk_mul_f32 v[166:167], v[166:167], v[28:29] op_sel_hi:[1,0]
    v_pk_mul_f32 v[168:169], v[168:169], v[28:29] op_sel_hi:[1,0]
    v_pk_mul_f32 v[170:171], v[170:171], v[28:29] op_sel_hi:[1,0]
    v_pk_mul_f32 v[172:173], v[172:173], v[28:29] op_sel_hi:[1,0]
    v_pk_mul_f32 v[174:175], v[174:175], v[28:29] op_sel_hi:[1,0]
    v_cvt_pk_bf16_f32 v160, v160, v161
    v_cvt_pk_bf16_f32 v161, v162, v163
    v_cvt_pk_bf16_f32 v164, v164, v165
    v_cvt_pk_bf16_f32 v165, v166, v167
    v_cvt_pk_bf16_f32 v168, v168, v169
    v_cvt_pk_bf16_f32 v169, v170, v171
    v_cvt_pk_bf16_f32 v172, v172, v173
    v_cvt_pk_bf16_f32 v173, v174, v175
    v_pk_mul_f32 v[176:177], v[176:177], v[28:29] op_sel_hi:[1,0]
    v_pk_mul_f32 v[178:179], v[178:179], v[28:29] op_sel_hi:[1,0]
    v_pk_mul_f32 v[180:181], v[180:181], v[28:29] op_sel_hi:[1,0]
    v_pk_mul_f32 v[182:183], v[182:183], v[28:29] op_sel_hi:[1,0]
    v_pk_mul_f32 v[184:185], v[184:185], v[28:29] op_sel_hi:[1,0]
    v_pk_mul_f32 v[186:187], v[186:187], v[28:29] op_sel_hi:[1,0]
    v_pk_mul_f32 v[188:189], v[188:189], v[28:29] op_sel_hi:[1,0]
    v_pk_mul_f32 v[190:191], v[190:191], v[28:29] op_sel_hi:[1,0]
    v_cvt_pk_bf16_f32 v176, v176, v177
    v_cvt_pk_bf16_f32 v177, v178, v179
    v_cvt_pk_bf16_f32 v180, v180, v181
    v_cvt_pk_bf16_f32 v181, v182, v183
    v_cvt_pk_bf16_f32 v184, v184, v185
    v_cvt_pk_bf16_f32 v185, v186, v187
    v_cvt_pk_bf16_f32 v188, v188, v189
    v_cvt_pk_bf16_f32 v189, v190, v191
    s_waitcnt lgkmcnt(8)
    v_mfma_f32_16x16x32_bf16 v[32:35], a[144:147], v[212:215], 0
    ds_write_b64 v24, v[160:161] offset:0
    v_exp_f32 v229, v229
    v_mfma_f32_16x16x32_bf16 v[32:35], a[176:179], v[216:219], v[32:35]
    v_add_f32 v20, v20, v229
    v_cvt_pk_bf16_f32 v228, v228, v229
    v_mfma_f32_16x16x32_bf16 v[36:39], a[148:151], v[212:215], 0
    ds_write_b64 v24, v[164:165] offset:32
    v_exp_f32 v230, v230
    v_mfma_f32_16x16x32_bf16 v[36:39], a[180:183], v[216:219], v[36:39]
    s_and_b32 m0, s28, 0xffff
    v_add_f32 v20, v20, v230
    v_mfma_f32_16x16x32_bf16 v[40:43], a[152:155], v[212:215], 0
    ds_write_b64 v24, v[168:169] offset:64
    v_exp_f32 v231, v231
    v_mfma_f32_16x16x32_bf16 v[40:43], a[184:187], v[216:219], v[40:43]
    v_add_f32 v20, v20, v231
    v_cvt_pk_bf16_f32 v229, v230, v231
    v_mfma_f32_16x16x32_bf16 v[44:47], a[156:159], v[212:215], 0
    v_exp_f32 v232, v232
    v_mfma_f32_16x16x32_bf16 v[44:47], a[188:191], v[216:219], v[44:47]
    buffer_load_dwordx4 v13, s[12:15], s28 offen offset:0 nt lds
    v_add_f32 v20, v20, v232
    v_mfma_f32_16x16x32_bf16 v[48:51], a[160:163], v[212:215], 0
    v_exp_f32 v233, v233
    v_mfma_f32_16x16x32_bf16 v[48:51], a[192:195], v[216:219], v[48:51]
    v_add_f32 v20, v20, v233
    v_cvt_pk_bf16_f32 v230, v232, v233
    v_mfma_f32_16x16x32_bf16 v[52:55], a[164:167], v[212:215], 0
    v_exp_f32 v234, v234
    v_mfma_f32_16x16x32_bf16 v[52:55], a[196:199], v[216:219], v[52:55]
    ds_write_b64 v24, v[172:173] offset:96
    v_add_f32 v20, v20, v234
    s_waitcnt lgkmcnt(2)
    v_mfma_f32_16x16x32_bf16 v[56:59], a[168:171], v[212:215], 0
    v_exp_f32 v235, v235
    v_mfma_f32_16x16x32_bf16 v[56:59], a[200:203], v[216:219], v[56:59]
    ds_write_b64 v24, v[176:177] offset:128
    v_add_f32 v20, v20, v235
    v_cvt_pk_bf16_f32 v231, v234, v235
    v_mfma_f32_16x16x32_bf16 v[60:63], a[172:175], v[212:215], 0
    v_exp_f32 v236, v236
    v_mfma_f32_16x16x32_bf16 v[60:63], a[204:207], v[216:219], v[60:63]
    buffer_load_dwordx4 v14, s[12:15], s28 offen offset:1024 nt lds
    ds_write_b64 v24, v[180:181] offset:160
    v_add_f32 v20, v20, v236
    v_mfma_f32_16x16x32_bf16 v[212:215], a[80:83], a[32:35], v[200:203]
    v_exp_f32 v237, v237
    v_mfma_f32_16x16x32_bf16 v[212:215], a[84:87], a[36:39], v[212:215]
    ds_write_b64 v24, v[184:185] offset:192
    v_add_f32 v20, v20, v237
    v_cvt_pk_bf16_f32 v232, v236, v237
    v_mfma_f32_16x16x32_bf16 v[212:215], a[88:91], a[40:43], v[212:215]
    v_exp_f32 v238, v238
    v_mfma_f32_16x16x32_bf16 v[212:215], a[92:95], a[44:47], v[212:215]
    buffer_load_dwordx4 v15, s[12:15], s28 offen offset:2048 nt lds
    ds_write_b64 v24, v[188:189] offset:224
    v_add_f32 v20, v20, v238
    v_mfma_f32_16x16x32_bf16 v[216:219], a[96:99], a[32:35], v[200:203]
    v_exp_f32 v239, v239
    v_mfma_f32_16x16x32_bf16 v[216:219], a[100:103], a[36:39], v[216:219]
    ds_read_b128 a[240:243], v25 offset:0
    v_add_f32 v20, v20, v239
    v_cvt_pk_bf16_f32 v233, v238, v239
    v_mfma_f32_16x16x32_bf16 v[216:219], a[104:107], a[40:43], v[216:219]
    ds_read_b128 a[244:247], v25 offset:1088
    v_exp_f32 v240, v240
    v_mfma_f32_16x16x32_bf16 v[216:219], a[108:111], a[44:47], v[216:219]
    buffer_load_dwordx4 v16, s[12:15], s28 offen offset:3072 nt lds
    ds_read_b128 a[248:251], v25 offset:2176
    v_add_f32 v20, v20, v240
    v_mfma_f32_16x16x32_bf16 v[220:223], a[112:115], a[32:35], v[200:203]
    ds_read_b128 a[252:255], v25 offset:3264
    v_exp_f32 v241, v241
    v_mfma_f32_16x16x32_bf16 v[220:223], a[116:119], a[36:39], v[220:223]
    v_add_f32 v20, v20, v241
    v_cvt_pk_bf16_f32 v234, v240, v241
    v_mfma_f32_16x16x32_bf16 v[220:223], a[120:123], a[40:43], v[220:223]
    v_exp_f32 v242, v242
    v_mfma_f32_16x16x32_bf16 v[220:223], a[124:127], a[44:47], v[220:223]
    s_add_u32 m0, m0, 65536
    v_add_f32 v20, v20, v242
    v_mfma_f32_16x16x32_bf16 v[224:227], a[128:131], a[32:35], v[200:203]
    v_exp_f32 v243, v243
    v_mfma_f32_16x16x32_bf16 v[224:227], a[132:135], a[36:39], v[224:227]
    v_add_f32 v20, v20, v243
    v_cvt_pk_bf16_f32 v235, v242, v243
    v_mfma_f32_16x16x32_bf16 v[224:227], a[136:139], a[40:43], v[224:227]
    v_exp_f32 v212, v212
    v_mfma_f32_16x16x32_bf16 v[224:227], a[140:143], a[44:47], v[224:227]
    buffer_load_dwordx4 v17, s[16:19], s28 offen offset:0 nt lds
    v_mov_b32 v21, v212
    v_mfma_f32_16x16x32_bf16 v[64:67], a[144:147], v[228:231], 0
    v_exp_f32 v213, v213
    v_mfma_f32_16x16x32_bf16 v[64:67], a[176:179], v[232:235], v[64:67]
    v_add_f32 v21, v21, v213
    v_cvt_pk_bf16_f32 v212, v212, v213
    v_mfma_f32_16x16x32_bf16 v[68:71], a[148:151], v[228:231], 0
    v_exp_f32 v214, v214
    v_mfma_f32_16x16x32_bf16 v[68:71], a[180:183], v[232:235], v[68:71]
    buffer_load_dwordx4 v18, s[16:19], s28 offen offset:1024 nt lds
    v_add_f32 v21, v21, v214
    v_mfma_f32_16x16x32_bf16 v[72:75], a[152:155], v[228:231], 0
    v_exp_f32 v215, v215
    v_mfma_f32_16x16x32_bf16 v[72:75], a[184:187], v[232:235], v[72:75]
    v_add_f32 v21, v21, v215
    v_cvt_pk_bf16_f32 v213, v214, v215
    v_mfma_f32_16x16x32_bf16 v[76:79], a[156:159], v[228:231], 0
    v_exp_f32 v216, v216
    v_mfma_f32_16x16x32_bf16 v[76:79], a[188:191], v[232:235], v[76:79]
    buffer_load_dwordx4 v17, s[16:19], s28 offen offset:2048 nt lds
    v_add_f32 v21, v21, v216
    v_mfma_f32_16x16x32_bf16 v[80:83], a[160:163], v[228:231], 0
    v_exp_f32 v217, v217
    v_mfma_f32_16x16x32_bf16 v[80:83], a[192:195], v[232:235], v[80:83]
    v_add_f32 v21, v21, v217
    v_cvt_pk_bf16_f32 v214, v216, v217
    v_mfma_f32_16x16x32_bf16 v[84:87], a[164:167], v[228:231], 0
    v_exp_f32 v218, v218
    v_mfma_f32_16x16x32_bf16 v[84:87], a[196:199], v[232:235], v[84:87]
    buffer_load_dwordx4 v18, s[16:19], s28 offen offset:3072 nt lds
    v_add_f32 v21, v21, v218
    v_mfma_f32_16x16x32_bf16 v[88:91], a[168:171], v[228:231], 0
    v_exp_f32 v219, v219
    v_mfma_f32_16x16x32_bf16 v[88:91], a[200:203], v[232:235], v[88:91]
    v_add_f32 v21, v21, v219
    v_cvt_pk_bf16_f32 v215, v218, v219
    v_mfma_f32_16x16x32_bf16 v[92:95], a[172:175], v[228:231], 0
    v_exp_f32 v220, v220
    v_mfma_f32_16x16x32_bf16 v[92:95], a[204:207], v[232:235], v[92:95]
    s_add_u32 s28, s28, 16384
    v_add_f32 v21, v21, v220
    v_mfma_f32_16x16x32_bf16 v[228:231], a[80:83], a[48:51], v[204:207]
    v_exp_f32 v221, v221
    v_mfma_f32_16x16x32_bf16 v[228:231], a[84:87], a[52:55], v[228:231]
    v_add_f32 v21, v21, v221
    v_cvt_pk_bf16_f32 v216, v220, v221
    v_mfma_f32_16x16x32_bf16 v[228:231], a[88:91], a[56:59], v[228:231]
    v_exp_f32 v222, v222
    v_mfma_f32_16x16x32_bf16 v[228:231], a[92:95], a[60:63], v[228:231]
    v_add_f32 v21, v21, v222
    v_mfma_f32_16x16x32_bf16 v[232:235], a[96:99], a[48:51], v[204:207]
    v_exp_f32 v223, v223
    v_mfma_f32_16x16x32_bf16 v[232:235], a[100:103], a[52:55], v[232:235]
    v_add_f32 v21, v21, v223
    v_cvt_pk_bf16_f32 v217, v222, v223
    v_mfma_f32_16x16x32_bf16 v[232:235], a[104:107], a[56:59], v[232:235]
    v_exp_f32 v224, v224
    v_mfma_f32_16x16x32_bf16 v[232:235], a[108:111], a[60:63], v[232:235]
    v_add_f32 v21, v21, v224
    v_mfma_f32_16x16x32_bf16 v[236:239], a[112:115], a[48:51], v[204:207]
    v_exp_f32 v225, v225
    v_mfma_f32_16x16x32_bf16 v[236:239], a[116:119], a[52:55], v[236:239]
    v_add_f32 v21, v21, v225
    v_cvt_pk_bf16_f32 v218, v224, v225
    v_mfma_f32_16x16x32_bf16 v[236:239], a[120:123], a[56:59], v[236:239]
    v_exp_f32 v226, v226
    v_mfma_f32_16x16x32_bf16 v[236:239], a[124:127], a[60:63], v[236:239]
    v_add_f32 v21, v21, v226
    v_mfma_f32_16x16x32_bf16 v[240:243], a[128:131], a[48:51], v[204:207]
    v_exp_f32 v227, v227
    v_mfma_f32_16x16x32_bf16 v[240:243], a[132:135], a[52:55], v[240:243]
    v_add_f32 v21, v21, v227
    v_cvt_pk_bf16_f32 v219, v226, v227
    v_mfma_f32_16x16x32_bf16 v[240:243], a[136:139], a[56:59], v[240:243]
    v_exp_f32 v228, v228
    v_mfma_f32_16x16x32_bf16 v[240:243], a[140:143], a[60:63], v[240:243]
    v_mov_b32 v22, v228
    v_mfma_f32_16x16x32_bf16 v[96:99], a[144:147], v[212:215], 0
    v_exp_f32 v229, v229
    v_mfma_f32_16x16x32_bf16 v[96:99], a[176:179], v[216:219], v[96:99]
    v_add_f32 v22, v22, v229
    v_cvt_pk_bf16_f32 v228, v228, v229
    v_mfma_f32_16x16x32_bf16 v[100:103], a[148:151], v[212:215], 0
    v_exp_f32 v230, v230
    v_mfma_f32_16x16x32_bf16 v[100:103], a[180:183], v[216:219], v[100:103]
    v_add_f32 v22, v22, v230
    v_mov_b64 v[160:161], 0
    v_mov_b64 v[162:163], 0
    v_mov_b64 v[164:165], 0
    v_mov_b64 v[166:167], 0
    v_mov_b64 v[168:169], 0
    v_mov_b64 v[170:171], 0
    v_mov_b64 v[172:173], 0
    v_mov_b64 v[174:175], 0
    v_mov_b64 v[176:177], 0
    v_mov_b64 v[178:179], 0
    v_mov_b64 v[180:181], 0
    v_mov_b64 v[182:183], 0
    v_mov_b64 v[184:185], 0
    v_mov_b64 v[186:187], 0
    v_mov_b64 v[188:189], 0
    v_mov_b64 v[190:191], 0
    v_mfma_f32_16x16x32_bf16 v[104:107], a[152:155], v[212:215], 0
    v_exp_f32 v231, v231
    v_mfma_f32_16x16x32_bf16 v[104:107], a[184:187], v[216:219], v[104:107]
    v_add_f32 v22, v22, v231
    v_cvt_pk_bf16_f32 v229, v230, v231
    v_mfma_f32_16x16x32_bf16 v[108:111], a[156:159], v[212:215], 0
    v_exp_f32 v232, v232
    v_mfma_f32_16x16x32_bf16 v[108:111], a[188:191], v[216:219], v[108:111]
    v_add_f32 v22, v22, v232
    v_mfma_f32_16x16x32_bf16 v[112:115], a[160:163], v[212:215], 0
    v_exp_f32 v233, v233
    v_mfma_f32_16x16x32_bf16 v[112:115], a[192:195], v[216:219], v[112:115]
    v_add_f32 v22, v22, v233
    v_cvt_pk_bf16_f32 v230, v232, v233
    v_mfma_f32_16x16x32_bf16 v[116:119], a[164:167], v[212:215], 0
    v_exp_f32 v234, v234
    v_mfma_f32_16x16x32_bf16 v[116:119], a[196:199], v[216:219], v[116:119]
    v_add_f32 v22, v22, v234
    v_mfma_f32_16x16x32_bf16 v[120:123], a[168:171], v[212:215], 0
    v_exp_f32 v235, v235
    v_mfma_f32_16x16x32_bf16 v[120:123], a[200:203], v[216:219], v[120:123]
    v_add_f32 v22, v22, v235
    v_cvt_pk_bf16_f32 v231, v234, v235
    v_mfma_f32_16x16x32_bf16 v[124:127], a[172:175], v[212:215], 0
    v_exp_f32 v236, v236
    v_mfma_f32_16x16x32_bf16 v[124:127], a[204:207], v[216:219], v[124:127]
    v_add_f32 v22, v22, v236
    s_waitcnt vmcnt(8)
    s_barrier
    v_mfma_f32_16x16x32_bf16 v[212:215], a[80:83], a[64:67], v[208:211]
    v_exp_f32 v237, v237
    v_mfma_f32_16x16x32_bf16 v[212:215], a[84:87], a[68:71], v[212:215]
    ds_read_b128 a[80:83], v1 offset:16384
    v_add_f32 v22, v22, v237
    v_cvt_pk_bf16_f32 v232, v236, v237
    v_mfma_f32_16x16x32_bf16 v[212:215], a[88:91], a[72:75], v[212:215]
    v_exp_f32 v238, v238
    v_mfma_f32_16x16x32_bf16 v[212:215], a[92:95], a[76:79], v[212:215]
    ds_read_b128 a[84:87], v2 offset:16384
    v_add_f32 v22, v22, v238
    v_mfma_f32_16x16x32_bf16 v[216:219], a[96:99], a[64:67], v[208:211]
    v_exp_f32 v239, v239
    v_mfma_f32_16x16x32_bf16 v[216:219], a[100:103], a[68:71], v[216:219]
    ds_read_b128 a[88:91], v3 offset:16384
    v_add_f32 v22, v22, v239
    v_cvt_pk_bf16_f32 v233, v238, v239
    v_mfma_f32_16x16x32_bf16 v[216:219], a[104:107], a[72:75], v[216:219]
    v_exp_f32 v240, v240
    v_mfma_f32_16x16x32_bf16 v[216:219], a[108:111], a[76:79], v[216:219]
    ds_read_b128 a[92:95], v4 offset:16384
    v_add_f32 v22, v22, v240
    v_mfma_f32_16x16x32_bf16 v[220:223], a[112:115], a[64:67], v[208:211]
    v_exp_f32 v241, v241
    v_mfma_f32_16x16x32_bf16 v[220:223], a[116:119], a[68:71], v[220:223]
    ds_read_b128 a[96:99], v1 offset:20480
    v_add_f32 v22, v22, v241
    v_cvt_pk_bf16_f32 v234, v240, v241
    v_mfma_f32_16x16x32_bf16 v[220:223], a[120:123], a[72:75], v[220:223]
    v_exp_f32 v242, v242
    v_mfma_f32_16x16x32_bf16 v[220:223], a[124:127], a[76:79], v[220:223]
    ds_read_b128 a[100:103], v2 offset:20480
    v_add_f32 v22, v22, v242
    v_mfma_f32_16x16x32_bf16 v[224:227], a[128:131], a[64:67], v[208:211]
    v_exp_f32 v243, v243
    v_mfma_f32_16x16x32_bf16 v[224:227], a[132:135], a[68:71], v[224:227]
    ds_read_b128 a[104:107], v3 offset:20480
    v_add_f32 v22, v22, v243
    v_cvt_pk_bf16_f32 v235, v242, v243
    v_mfma_f32_16x16x32_bf16 v[224:227], a[136:139], a[72:75], v[224:227]
    v_exp_f32 v212, v212
    v_mfma_f32_16x16x32_bf16 v[224:227], a[140:143], a[76:79], v[224:227]
    ds_read_b128 a[108:111], v4 offset:20480
    v_mov_b32 v23, v212
    v_mfma_f32_16x16x32_bf16 v[128:131], a[144:147], v[228:231], 0
    v_exp_f32 v213, v213
    v_mfma_f32_16x16x32_bf16 v[128:131], a[176:179], v[232:235], v[128:131]
    ds_read_b128 a[112:115], v1 offset:24576
    v_add_f32 v23, v23, v213
    v_cvt_pk_bf16_f32 v212, v212, v213
    v_mfma_f32_16x16x32_bf16 v[132:135], a[148:151], v[228:231], 0
    v_exp_f32 v214, v214
    v_mfma_f32_16x16x32_bf16 v[132:135], a[180:183], v[232:235], v[132:135]
    ds_read_b128 a[116:119], v2 offset:24576
    v_add_f32 v23, v23, v214
    v_mfma_f32_16x16x32_bf16 v[136:139], a[152:155], v[228:231], 0
    v_exp_f32 v215, v215
    v_mfma_f32_16x16x32_bf16 v[136:139], a[184:187], v[232:235], v[136:139]
    ds_read_b128 a[120:123], v3 offset:24576
    v_add_f32 v23, v23, v215
    v_cvt_pk_bf16_f32 v213, v214, v215
    v_mfma_f32_16x16x32_bf16 v[140:143], a[156:159], v[228:231], 0
    v_exp_f32 v216, v216
    v_mfma_f32_16x16x32_bf16 v[140:143], a[188:191], v[232:235], v[140:143]
    ds_read_b128 a[124:127], v4 offset:24576
    v_add_f32 v23, v23, v216
    v_mfma_f32_16x16x32_bf16 v[144:147], a[160:163], v[228:231], 0
    v_exp_f32 v217, v217
    v_mfma_f32_16x16x32_bf16 v[144:147], a[192:195], v[232:235], v[144:147]
    ds_read_b128 a[128:131], v1 offset:28672
    v_add_f32 v23, v23, v217
    v_cvt_pk_bf16_f32 v214, v216, v217
    v_mfma_f32_16x16x32_bf16 v[148:151], a[164:167], v[228:231], 0
    v_exp_f32 v218, v218
    v_mfma_f32_16x16x32_bf16 v[148:151], a[196:199], v[232:235], v[148:151]
    ds_read_b128 a[132:135], v2 offset:28672
    v_add_f32 v23, v23, v218
    v_mfma_f32_16x16x32_bf16 v[152:155], a[168:171], v[228:231], 0
    v_exp_f32 v219, v219
    v_mfma_f32_16x16x32_bf16 v[152:155], a[200:203], v[232:235], v[152:155]
    ds_read_b128 a[136:139], v3 offset:28672
    v_add_f32 v23, v23, v219
    v_cvt_pk_bf16_f32 v215, v218, v219
    v_mfma_f32_16x16x32_bf16 v[156:159], a[172:175], v[228:231], 0
    v_exp_f32 v220, v220
    v_mfma_f32_16x16x32_bf16 v[156:159], a[204:207], v[232:235], v[156:159]
    ds_read_b128 a[140:143], v4 offset:28672
    v_add_f32 v23, v23, v220
    s_branch L_b1
L_lastb:
    s_waitcnt lgkmcnt(4)
    v_mfma_f32_16x16x32_bf16 v[228:231], a[80:83], a[0:3], v[192:195]
    v_exp_f32 v221, v221
    v_mfma_f32_16x16x32_bf16 v[228:231], a[84:87], a[4:7], v[228:231]
    v_add_f32 v23, v23, v221
    v_cvt_pk_bf16_f32 v216, v220, v221
    v_mfma_f32_16x16x32_bf16 v[228:231], a[88:91], a[8:11], v[228:231]
    v_exp_f32 v222, v222
    v_mfma_f32_16x16x32_bf16 v[228:231], a[92:95], a[12:15], v[228:231]
    s_waitcnt vmcnt(0)
    v_add_f32 v23, v23, v222
    v_mfma_f32_16x16x32_bf16 v[232:235], a[96:99], a[0:3], v[192:195]
    v_exp_f32 v223, v223
    v_mfma_f32_16x16x32_bf16 v[232:235], a[100:103], a[4:7], v[232:235]
    v_add_f32 v23, v23, v223
    v_cvt_pk_bf16_f32 v217, v222, v223
    v_mfma_f32_16x16x32_bf16 v[232:235], a[104:107], a[8:11], v[232:235]
    v_exp_f32 v224, v224
    v_mfma_f32_16x16x32_bf16 v[232:235], a[108:111], a[12:15], v[232:235]
    v_add_f32 v23, v23, v224
    v_mfma_f32_16x16x32_bf16 v[236:239], a[112:115], a[0:3], v[192:195]
    v_exp_f32 v225, v225
    v_mfma_f32_16x16x32_bf16 v[236:239], a[116:119], a[4:7], v[236:239]
    v_add_f32 v23, v23, v225
    v_cvt_pk_bf16_f32 v218, v224, v225
    v_mfma_f32_16x16x32_bf16 v[236:239], a[120:123], a[8:11], v[236:239]
    v_exp_f32 v226, v226
    v_mfma_f32_16x16x32_bf16 v[236:239], a[124:127], a[12:15], v[236:239]
    v_add_f32 v23, v23, v226
    s_waitcnt lgkmcnt(0)
    v_mfma_f32_16x16x32_bf16 v[240:243], a[128:131], a[0:3], v[192:195]
    v_exp_f32 v227, v227
    v_mfma_f32_16x16x32_bf16 v[240:243], a[132:135], a[4:7], v[240:243]
    v_add_f32 v23, v23, v227
    v_cvt_pk_bf16_f32 v219, v226, v227
    v_mfma_f32_16x16x32_bf16 v[240:243], a[136:139], a[8:11], v[240:243]
    v_exp_f32 v228, v228
    v_mfma_f32_16x16x32_bf16 v[240:243], a[140:143], a[12:15], v[240:243]
    v_add_f32 v19, v19, v228
    v_mfma_f32_16x16x32_bf16 v[160:163], a[144:147], v[212:215], v[160:163]
    v_exp_f32 v229, v229
    v_mfma_f32_16x16x32_bf16 v[160:163], a[176:179], v[216:219], v[160:163]
    ds_read_b64_tr_b16 a[144:145], v5 offset:49152
    ds_read_b64_tr_b16 a[146:147], v5 offset:53248
    v_add_f32 v19, v19, v229
    v_cvt_pk_bf16_f32 v228, v228, v229
    v_mfma_f32_16x16x32_bf16 v[164:167], a[148:151], v[212:215], v[164:167]
    v_exp_f32 v230, v230
    v_mfma_f32_16x16x32_bf16 v[164:167], a[180:183], v[216:219], v[164:167]
    ds_read_b64_tr_b16 a[176:177], v5 offset:57344
    ds_read_b64_tr_b16 a[178:179], v5 offset:61440
    v_add_f32 v19, v19, v230
    v_mfma_f32_16x16x32_bf16 v[168:171], a[152:155], v[212:215], v[168:171]
    v_exp_f32 v231, v231
    v_mfma_f32_16x16x32_bf16 v[168:171], a[184:187], v[216:219], v[168:171]
    ds_read_b64_tr_b16 a[148:149], v6 offset:49152
    ds_read_b64_tr_b16 a[150:151], v6 offset:53248
    v_add_f32 v19, v19, v231
    v_cvt_pk_bf16_f32 v229, v230, v231
    v_mfma_f32_16x16x32_bf16 v[172:175], a[156:159], v[212:215], v[172:175]
    v_exp_f32 v232, v232
    v_mfma_f32_16x16x32_bf16 v[172:175], a[188:191], v[216:219], v[172:175]
    ds_read_b64_tr_b16 a[180:181], v6 offset:57344
    ds_read_b64_tr_b16 a[182:183], v6 offset:61440
    v_add_f32 v19, v19, v232
    v_mfma_f32_16x16x32_bf16 v[176:179], a[160:163], v[212:215], v[176:179]
    v_exp_f32 v233, v233
    v_mfma_f32_16x16x32_bf16 v[176:179], a[192:195], v[216:219], v[176:179]
    ds_read_b64_tr_b16 a[152:153], v7 offset:49152
    ds_read_b64_tr_b16 a[154:155], v7 offset:53248
    v_add_f32 v19, v19, v233
    v_cvt_pk_bf16_f32 v230, v232, v233
    v_mfma_f32_16x16x32_bf16 v[180:183], a[164:167], v[212:215], v[180:183]
    v_exp_f32 v234, v234
    v_mfma_f32_16x16x32_bf16 v[180:183], a[196:199], v[216:219], v[180:183]
    ds_read_b64_tr_b16 a[184:185], v7 offset:57344
    ds_read_b64_tr_b16 a[186:187], v7 offset:61440
    v_add_f32 v19, v19, v234
    v_mfma_f32_16x16x32_bf16 v[184:187], a[168:171], v[212:215], v[184:187]
    v_exp_f32 v235, v235
    v_mfma_f32_16x16x32_bf16 v[184:187], a[200:203], v[216:219], v[184:187]
    ds_read_b64_tr_b16 a[156:157], v8 offset:49152
    ds_read_b64_tr_b16 a[158:159], v8 offset:53248
    v_add_f32 v19, v19, v235
    v_cvt_pk_bf16_f32 v231, v234, v235
    v_mfma_f32_16x16x32_bf16 v[188:191], a[172:175], v[212:215], v[188:191]
    v_exp_f32 v236, v236
    v_mfma_f32_16x16x32_bf16 v[188:191], a[204:207], v[216:219], v[188:191]
    ds_read_b64_tr_b16 a[188:189], v8 offset:57344
    ds_read_b64_tr_b16 a[190:191], v8 offset:61440
    v_add_f32 v19, v19, v236
    v_mfma_f32_16x16x32_bf16 v[212:215], a[80:83], a[16:19], v[196:199]
    v_exp_f32 v237, v237
    v_mfma_f32_16x16x32_bf16 v[212:215], a[84:87], a[20:23], v[212:215]
    ds_read_b64_tr_b16 a[160:161], v9 offset:49152
    ds_read_b64_tr_b16 a[162:163], v9 offset:53248
    v_add_f32 v19, v19, v237
    v_cvt_pk_bf16_f32 v232, v236, v237
    v_mfma_f32_16x16x32_bf16 v[212:215], a[88:91], a[24:27], v[212:215]
    v_exp_f32 v238, v238
    v_mfma_f32_16x16x32_bf16 v[212:215], a[92:95], a[28:31], v[212:215]
    ds_read_b64_tr_b16 a[192:193], v9 offset:57344
    ds_read_b64_tr_b16 a[194:195], v9 offset:61440
    v_add_f32 v19, v19, v238
    v_mfma_f32_16x16x32_bf16 v[216:219], a[96:99], a[16:19], v[196:199]
    v_exp_f32 v239, v239
    v_mfma_f32_16x16x32_bf16 v[216:219], a[100:103], a[20:23], v[216:219]
    ds_read_b64_tr_b16 a[164:165], v10 offset:49152
    ds_read_b64_tr_b16 a[166:167], v10 offset:53248
    v_add_f32 v19, v19, v239
    v_cvt_pk_bf16_f32 v233, v238, v239
    v_mfma_f32_16x16x32_bf16 v[216:219], a[104:107], a[24:27], v[216:219]
    v_exp_f32 v240, v240
    v_mfma_f32_16x16x32_bf16 v[216:219], a[108:111], a[28:31], v[216:219]
    ds_read_b64_tr_b16 a[196:197], v10 offset:57344
    ds_read_b64_tr_b16 a[198:199], v10 offset:61440
    v_add_f32 v19, v19, v240
    v_mfma_f32_16x16x32_bf16 v[220:223], a[112:115], a[16:19], v[196:199]
    v_exp_f32 v241, v241
    v_mfma_f32_16x16x32_bf16 v[220:223], a[116:119], a[20:23], v[220:223]
    ds_read_b64_tr_b16 a[168:169], v11 offset:49152
    ds_read_b64_tr_b16 a[170:171], v11 offset:53248
    v_add_f32 v19, v19, v241
    v_cvt_pk_bf16_f32 v234, v240, v241
    v_mfma_f32_16x16x32_bf16 v[220:223], a[120:123], a[24:27], v[220:223]
    v_exp_f32 v242, v242
    v_mfma_f32_16x16x32_bf16 v[220:223], a[124:127], a[28:31], v[220:223]
    ds_read_b64_tr_b16 a[200:201], v11 offset:57344
    ds_read_b64_tr_b16 a[202:203], v11 offset:61440
    v_add_f32 v19, v19, v242
    v_mfma_f32_16x16x32_bf16 v[224:227], a[128:131], a[16:19], v[196:199]
    v_exp_f32 v243, v243
    v_mfma_f32_16x16x32_bf16 v[224:227], a[132:135], a[20:23], v[224:227]
    ds_read_b64_tr_b16 a[172:173], v12 offset:49152
    ds_read_b64_tr_b16 a[174:175], v12 offset:53248
    v_add_f32 v19, v19, v243
    v_cvt_pk_bf16_f32 v235, v242, v243
    v_mfma_f32_16x16x32_bf16 v[224:227], a[136:139], a[24:27], v[224:227]
    v_exp_f32 v212, v212
    v_mov_b32 v30, v19
    v_mfma_f32_16x16x32_bf16 v[224:227], a[140:143], a[28:31], v[224:227]
    ds_read_b64_tr_b16 a[204:205], v12 offset:57344
    ds_read_b64_tr_b16 a[206:207], v12 offset:61440
    v_add_f32 v20, v20, v212
    s_waitcnt lgkmcnt(8)
    v_mfma_f32_16x16x32_bf16 v[32:35], a[144:147], v[228:231], v[32:35]
    v_exp_f32 v213, v213
    v_permlane16_swap_b32 v19, v30
    v_mfma_f32_16x16x32_bf16 v[32:35], a[176:179], v[232:235], v[32:35]
    v_add_f32 v20, v20, v213
    v_cvt_pk_bf16_f32 v212, v212, v213
    v_mfma_f32_16x16x32_bf16 v[36:39], a[148:151], v[228:231], v[36:39]
    v_exp_f32 v214, v214
    v_mfma_f32_16x16x32_bf16 v[36:39], a[180:183], v[232:235], v[36:39]
    v_add_f32 v20, v20, v214
    v_add_f32 v19, v19, v30
    v_mfma_f32_16x16x32_bf16 v[40:43], a[152:155], v[228:231], v[40:43]
    v_exp_f32 v215, v215
    v_mfma_f32_16x16x32_bf16 v[40:43], a[184:187], v[232:235], v[40:43]
    v_add_f32 v20, v20, v215
    v_cvt_pk_bf16_f32 v213, v214, v215
    v_mov_b32 v30, v19
    v_mfma_f32_16x16x32_bf16 v[44:47], a[156:159], v[228:231], v[44:47]
    v_exp_f32 v216, v216
    v_mfma_f32_16x16x32_bf16 v[44:47], a[188:191], v[232:235], v[44:47]
    v_add_f32 v20, v20, v216
    v_permlane32_swap_b32 v19, v30
    v_mfma_f32_16x16x32_bf16 v[48:51], a[160:163], v[228:231], v[48:51]
    v_exp_f32 v217, v217
    v_mfma_f32_16x16x32_bf16 v[48:51], a[192:195], v[232:235], v[48:51]
    v_add_f32 v20, v20, v217
    v_cvt_pk_bf16_f32 v214, v216, v217
    v_add_f32 v19, v19, v30
    v_mfma_f32_16x16x32_bf16 v[52:55], a[164:167], v[228:231], v[52:55]
    v_exp_f32 v218, v218
    v_mfma_f32_16x16x32_bf16 v[52:55], a[196:199], v[232:235], v[52:55]
    v_add_f32 v20, v20, v218
    v_rcp_f32 v28, v19
    s_waitcnt lgkmcnt(0)
    v_mfma_f32_16x16x32_bf16 v[56:59], a[168:171], v[228:231], v[56:59]
    v_exp_f32 v219, v219
    v_mfma_f32_16x16x32_bf16 v[56:59], a[200:203], v[232:235], v[56:59]
    v_add_f32 v20, v20, v219
    v_cvt_pk_bf16_f32 v215, v218, v219
    v_cmp_nge_f32 s[96:97], s36, v19
    v_mfma_f32_16x16x32_bf16 v[60:63], a[172:175], v[228:231], v[60:63]
    v_exp_f32 v220, v220
    v_mfma_f32_16x16x32_bf16 v[60:63], a[204:207], v[232:235], v[60:63]
    v_add_f32 v20, v20, v220
    s_or_b64 s[90:91], s[90:91], s[96:97]
    v_mfma_f32_16x16x32_bf16 v[228:231], a[80:83], a[32:35], v[200:203]
    v_exp_f32 v221, v221
    v_mfma_f32_16x16x32_bf16 v[228:231], a[84:87], a[36:39], v[228:231]
    v_add_f32 v20, v20, v221
    v_cvt_pk_bf16_f32 v216, v220, v221
    v_pk_mul_f32 v[32:33], v[32:33], v[28:29] op_sel_hi:[1,0]
    v_pk_mul_f32 v[34:35], v[34:35], v[28:29] op_sel_hi:[1,0]
    v_pk_mul_f32 v[36:37], v[36:37], v[28:29] op_sel_hi:[1,0]
    v_pk_mul_f32 v[38:39], v[38:39], v[28:29] op_sel_hi:[1,0]
    v_pk_mul_f32 v[40:41], v[40:41], v[28:29] op_sel_hi:[1,0]
    v_pk_mul_f32 v[42:43], v[42:43], v[28:29] op_sel_hi:[1,0]
    v_pk_mul_f32 v[44:45], v[44:45], v[28:29] op_sel_hi:[1,0]
    v_pk_mul_f32 v[46:47], v[46:47], v[28:29] op_sel_hi:[1,0]
    v_cvt_pk_bf16_f32 v32, v32, v33
    v_cvt_pk_bf16_f32 v33, v34, v35
    v_cvt_pk_bf16_f32 v36, v36, v37
    v_cvt_pk_bf16_f32 v37, v38, v39
    v_cvt_pk_bf16_f32 v40, v40, v41
    v_cvt_pk_bf16_f32 v41, v42, v43
    v_cvt_pk_bf16_f32 v44, v44, v45
    v_cvt_pk_bf16_f32 v45, v46, v47
    v_pk_mul_f32 v[48:49], v[48:49], v[28:29] op_sel_hi:[1,0]
    v_pk_mul_f32 v[50:51], v[50:51], v[28:29] op_sel_hi:[1,0]
    v_pk_mul_f32 v[52:53], v[52:53], v[28:29] op_sel_hi:[1,0]
    v_pk_mul_f32 v[54:55], v[54:55], v[28:29] op_sel_hi:[1,0]
    v_pk_mul_f32 v[56:57], v[56:57], v[28:29] op_sel_hi:[1,0]
    v_pk_mul_f32 v[58:59], v[58:59], v[28:29] op_sel_hi:[1,0]
    v_pk_mul_f32 v[60:61], v[60:61], v[28:29] op_sel_hi:[1,0]
    v_pk_mul_f32 v[62:63], v[62:63], v[28:29] op_sel_hi:[1,0]
    v_cvt_pk_bf16_f32 v48, v48, v49
    v_cvt_pk_bf16_f32 v49, v50, v51
    v_cvt_pk_bf16_f32 v52, v52, v53
    v_cvt_pk_bf16_f32 v53, v54, v55
    v_cvt_pk_bf16_f32 v56, v56, v57
    v_cvt_pk_bf16_f32 v57, v58, v59
    v_cvt_pk_bf16_f32 v60, v60, v61
    v_cvt_pk_bf16_f32 v61, v62, v63
    v_mfma_f32_16x16x32_bf16 v[228:231], a[88:91], a[40:43], v[228:231]
    v_exp_f32 v222, v222
    v_mfma_f32_16x16x32_bf16 v[228:231], a[92:95], a[44:47], v[228:231]
    ds_write_b64 v24, v[32:33] offset:0
    v_add_f32 v20, v20, v222
    v_mfma_f32_16x16x32_bf16 v[232:235], a[96:99], a[32:35], v[200:203]
    v_exp_f32 v223, v223
    v_mfma_f32_16x16x32_bf16 v[232:235], a[100:103], a[36:39], v[232:235]
    v_add_f32 v20, v20, v223
    v_cvt_pk_bf16_f32 v217, v222, v223
    v_mfma_f32_16x16x32_bf16 v[232:235], a[104:107], a[40:43], v[232:235]
    v_exp_f32 v224, v224
    v_mfma_f32_16x16x32_bf16 v[232:235], a[108:111], a[44:47], v[232:235]
    ds_write_b64 v24, v[36:37] offset:32
    v_add_f32 v20, v20, v224
    v_mfma_f32_16x16x32_bf16 v[236:239], a[112:115], a[32:35], v[200:203]
    v_exp_f32 v225, v225
    v_mfma_f32_16x16x32_bf16 v[236:239], a[116:119], a[36:39], v[236:239]
    v_add_f32 v20, v20, v225
    v_cvt_pk_bf16_f32 v218, v224, v225
    v_mfma_f32_16x16x32_bf16 v[236:239], a[120:123], a[40:43], v[236:239]
    v_exp_f32 v226, v226
    v_mfma_f32_16x16x32_bf16 v[236:239], a[124:127], a[44:47], v[236:239]
    ds_write_b64 v24, v[40:41] offset:64
    v_add_f32 v20, v20, v226
    v_mfma_f32_16x16x32_bf16 v[240:243], a[128:131], a[32:35], v[200:203]
    v_exp_f32 v227, v227
    v_mfma_f32_16x16x32_bf16 v[240:243], a[132:135], a[36:39], v[240:243]
    ds_write_b64 v24, v[44:45] offset:96
    v_add_f32 v20, v20, v227
    v_cvt_pk_bf16_f32 v219, v226, v227
    v_mfma_f32_16x16x32_bf16 v[240:243], a[136:139], a[40:43], v[240:243]
    v_exp_f32 v228, v228
    v_mov_b32 v30, v20
    v_mfma_f32_16x16x32_bf16 v[240:243], a[140:143], a[44:47], v[240:243]
    ds_write_b64 v24, v[48:49] offset:128
    v_add_f32 v21, v21, v228
    v_mfma_f32_16x16x32_bf16 v[64:67], a[144:147], v[212:215], v[64:67]
    v_exp_f32 v229, v229
    v_permlane16_swap_b32 v20, v30
    v_mfma_f32_16x16x32_bf16 v[64:67], a[176:179], v[216:219], v[64:67]
    ds_write_b64 v24, v[52:53] offset:160
    v_add_f32 v21, v21, v229
    v_cvt_pk_bf16_f32 v228, v228, v229
    v_mfma_f32_16x16x32_bf16 v[68:71], a[148:151], v[212:215], v[68:71]
    v_exp_f32 v230, v230
    v_add_f32 v20, v20, v30
    v_mfma_f32_16x16x32_bf16 v[68:71], a[180:183], v[216:219], v[68:71]
    ds_write_b64 v24, v[56:57] offset:192
    v_add_f32 v21, v21, v230
    v_mfma_f32_16x16x32_bf16 v[72:75], a[152:155], v[212:215], v[72:75]
    v_exp_f32 v231, v231
    v_mov_b32 v30, v20
    v_mfma_f32_16x16x32_bf16 v[72:75], a[184:187], v[216:219], v[72:75]
    ds_write_b64 v24, v[60:61] offset:224
    v_add_f32 v21, v21, v231
    v_cvt_pk_bf16_f32 v229, v230, v231
    v_mfma_f32_16x16x32_bf16 v[76:79], a[156:159], v[212:215], v[76:79]
    v_exp_f32 v232, v232
    v_permlane32_swap_b32 v20, v30
    v_mfma_f32_16x16x32_bf16 v[76:79], a[188:191], v[216:219], v[76:79]
    ds_read_b128 v[32:35], v25 offset:0
    v_add_f32 v21, v21, v232
    v_mfma_f32_16x16x32_bf16 v[80:83], a[160:163], v[212:215], v[80:83]
    v_exp_f32 v233, v233
    v_add_f32 v20, v20, v30
    v_mfma_f32_16x16x32_bf16 v[80:83], a[192:195], v[216:219], v[80:83]
    v_add_f32 v21, v21, v233
    v_cvt_pk_bf16_f32 v230, v232, v233
    v_mfma_f32_16x16x32_bf16 v[84:87], a[164:167], v[212:215], v[84:87]
    v_exp_f32 v234, v234
    v_rcp_f32 v28, v20
    v_mfma_f32_16x16x32_bf16 v[84:87], a[196:199], v[216:219], v[84:87]
    ds_read_b128 v[36:39], v25 offset:1088
    v_add_f32 v21, v21, v234
    v_mfma_f32_16x16x32_bf16 v[88:91], a[168:171], v[212:215], v[88:91]
    ds_read_b128 v[40:43], v25 offset:2176
    v_exp_f32 v235, v235
    v_cmp_nge_f32 s[96:97], s36, v20
    v_mfma_f32_16x16x32_bf16 v[88:91], a[200:203], v[216:219], v[88:91]
    v_add_f32 v21, v21, v235
    v_cvt_pk_bf16_f32 v231, v234, v235
    v_mfma_f32_16x16x32_bf16 v[92:95], a[172:175], v[212:215], v[92:95]
    v_exp_f32 v236, v236
    s_or_b64 s[90:91], s[90:91], s[96:97]
    v_mfma_f32_16x16x32_bf16 v[92:95], a[204:207], v[216:219], v[92:95]
    ds_read_b128 v[44:47], v25 offset:3264
    v_add_f32 v21, v21, v236
    v_mfma_f32_16x16x32_bf16 v[212:215], a[80:83], a[48:51], v[204:207]
    v_exp_f32 v237, v237
    v_mfma_f32_16x16x32_bf16 v[212:215], a[84:87], a[52:55], v[212:215]
    v_add_f32 v21, v21, v237
    v_cvt_pk_bf16_f32 v232, v236, v237
    v_pk_mul_f32 v[64:65], v[64:65], v[28:29] op_sel_hi:[1,0]
    v_pk_mul_f32 v[66:67], v[66:67], v[28:29] op_sel_hi:[1,0]
    v_pk_mul_f32 v[68:69], v[68:69], v[28:29] op_sel_hi:[1,0]
    v_pk_mul_f32 v[70:71], v[70:71], v[28:29] op_sel_hi:[1,0]
    v_pk_mul_f32 v[72:73], v[72:73], v[28:29] op_sel_hi:[1,0]
    v_pk_mul_f32 v[74:75], v[74:75], v[28:29] op_sel_hi:[1,0]
    v_pk_mul_f32 v[76:77], v[76:77], v[28:29] op_sel_hi:[1,0]
    v_pk_mul_f32 v[78:79], v[78:79], v[28:29] op_sel_hi:[1,0]
    v_cvt_pk_bf16_f32 v64, v64, v65
    v_cvt_pk_bf16_f32 v65, v66, v67
    v_cvt_pk_bf16_f32 v68, v68, v69
    v_cvt_pk_bf16_f32 v69, v70, v71
    v_cvt_pk_bf16_f32 v72, v72, v73
    v_cvt_pk_bf16_f32 v73, v74, v75
    v_cvt_pk_bf16_f32 v76, v76, v77
    v_cvt_pk_bf16_f32 v77, v78, v79
    v_pk_mul_f32 v[80:81], v[80:81], v[28:29] op_sel_hi:[1,0]
    v_pk_mul_f32 v[82:83], v[82:83], v[28:29] op_sel_hi:[1,0]
    v_pk_mul_f32 v[84:85], v[84:85], v[28:29] op_sel_hi:[1,0]
    v_pk_mul_f32 v[86:87], v[86:87], v[28:29] op_sel_hi:[1,0]
    v_pk_mul_f32 v[88:89], v[88:89], v[28:29] op_sel_hi:[1,0]
    v_pk_mul_f32 v[90:91], v[90:91], v[28:29] op_sel_hi:[1,0]
    v_pk_mul_f32 v[92:93], v[92:93], v[28:29] op_sel_hi:[1,0]
    v_pk_mul_f32 v[94:95], v[94:95], v[28:29] op_sel_hi:[1,0]
    v_cvt_pk_bf16_f32 v80, v80, v81
    v_cvt_pk_bf16_f32 v81, v82, v83
    v_cvt_pk_bf16_f32 v84, v84, v85
    v_cvt_pk_bf16_f32 v85, v86, v87
    v_cvt_pk_bf16_f32 v88, v88, v89
    v_cvt_pk_bf16_f32 v89, v90, v91
    v_cvt_pk_bf16_f32 v92, v92, v93
    v_cvt_pk_bf16_f32 v93, v94, v95
    v_mfma_f32_16x16x32_bf16 v[212:215], a[88:91], a[56:59], v[212:215]
    v_exp_f32 v238, v238
    v_mfma_f32_16x16x32_bf16 v[212:215], a[92:95], a[60:63], v[212:215]
    ds_write_b64 v24, v[64:65] offset:0
    v_add_f32 v21, v21, v238
    v_mfma_f32_16x16x32_bf16 v[216:219], a[96:99], a[48:51], v[204:207]
    v_exp_f32 v239, v239
    v_mfma_f32_16x16x32_bf16 v[216:219], a[100:103], a[52:55], v[216:219]
    ds_write_b64 v24, v[68:69] offset:32
    v_add_f32 v21, v21, v239
    v_cvt_pk_bf16_f32 v233, v238, v239
    v_mfma_f32_16x16x32_bf16 v[216:219], a[104:107], a[56:59], v[216:219]
    v_exp_f32 v240, v240
    v_mfma_f32_16x16x32_bf16 v[216:219], a[108:111], a[60:63], v[216:219]
    ds_write_b64 v24, v[72:73] offset:64
    s_add_u32 s101, s100, 0
    v_add_f32 v21, v21, v240
    v_mfma_f32_16x16x32_bf16 v[220:223], a[112:115], a[48:51], v[204:207]
    v_exp_f32 v241, v241
    v_mfma_f32_16x16x32_bf16 v[220:223], a[116:119], a[52:55], v[220:223]
    ds_write_b64 v24, v[76:77] offset:96
    v_add_f32 v21, v21, v241
    v_cvt_pk_bf16_f32 v234, v240, v241
    v_mfma_f32_16x16x32_bf16 v[220:223], a[120:123], a[56:59], v[220:223]
    v_exp_f32 v242, v242
    v_mfma_f32_16x16x32_bf16 v[220:223], a[124:127], a[60:63], v[220:223]
    s_waitcnt lgkmcnt(3)
    buffer_store_dwordx4 v[32:35], v26, s[92:95], s101 offen offset:0 sc1
    ds_write_b64 v24, v[80:81] offset:128
    v_add_f32 v21, v21, v242
    v_mfma_f32_16x16x32_bf16 v[224:227], a[128:131], a[48:51], v[204:207]
    v_exp_f32 v243, v243
    v_mfma_f32_16x16x32_bf16 v[224:227], a[132:135], a[52:55], v[224:227]
    ds_write_b64 v24, v[84:85] offset:160
    v_add_f32 v21, v21, v243
    v_cvt_pk_bf16_f32 v235, v242, v243
    v_mfma_f32_16x16x32_bf16 v[224:227], a[136:139], a[56:59], v[224:227]
    v_exp_f32 v212, v212
    v_mov_b32 v30, v21
    v_mfma_f32_16x16x32_bf16 v[224:227], a[140:143], a[60:63], v[224:227]
    buffer_store_dwordx4 v[36:39], v26, s[92:95], s101 offen offset:1024 sc1
    ds_write_b64 v24, v[88:89] offset:192
    v_add_f32 v22, v22, v212
    v_mfma_f32_16x16x32_bf16 v[96:99], a[144:147], v[228:231], v[96:99]
    v_exp_f32 v213, v213
    v_permlane16_swap_b32 v21, v30
    v_mfma_f32_16x16x32_bf16 v[96:99], a[176:179], v[232:235], v[96:99]
    ds_write_b64 v24, v[92:93] offset:224
    v_add_f32 v22, v22, v213
    v_cvt_pk_bf16_f32 v212, v212, v213
    v_mfma_f32_16x16x32_bf16 v[100:103], a[148:151], v[228:231], v[100:103]
    v_exp_f32 v214, v214
    v_add_f32 v21, v21, v30
    v_mfma_f32_16x16x32_bf16 v[100:103], a[180:183], v[232:235], v[100:103]
    buffer_store_dwordx4 v[40:43], v26, s[92:95], s101 offen offset:2048 sc1
    v_add_f32 v22, v22, v214
    v_mfma_f32_16x16x32_bf16 v[104:107], a[152:155], v[228:231], v[104:107]
    v_exp_f32 v215, v215
    v_mov_b32 v30, v21
    v_mfma_f32_16x16x32_bf16 v[104:107], a[184:187], v[232:235], v[104:107]
    buffer_store_dwordx4 v[44:47], v26, s[92:95], s101 offen offset:3072 sc1
    v_add_f32 v22, v22, v215
    v_cvt_pk_bf16_f32 v213, v214, v215
    v_mfma_f32_16x16x32_bf16 v[108:111], a[156:159], v[228:231], v[108:111]
    v_exp_f32 v216, v216
    v_permlane32_swap_b32 v21, v30
    v_mfma_f32_16x16x32_bf16 v[108:111], a[188:191], v[232:235], v[108:111]
    ds_read_b128 v[64:67], v25 offset:0
    v_add_f32 v22, v22, v216
    v_mfma_f32_16x16x32_bf16 v[112:115], a[160:163], v[228:231], v[112:115]
    v_exp_f32 v217, v217
    v_add_f32 v21, v21, v30
    v_mfma_f32_16x16x32_bf16 v[112:115], a[192:195], v[232:235], v[112:115]
    v_add_f32 v22, v22, v217
    v_cvt_pk_bf16_f32 v214, v216, v217
    v_mfma_f32_16x16x32_bf16 v[116:119], a[164:167], v[228:231], v[116:119]
    v_exp_f32 v218, v218
    v_rcp_f32 v28, v21
    v_mfma_f32_16x16x32_bf16 v[116:119], a[196:199], v[232:235], v[116:119]
    ds_read_b128 v[68:71], v25 offset:1088
    v_add_f32 v22, v22, v218
    v_mfma_f32_16x16x32_bf16 v[120:123], a[168:171], v[228:231], v[120:123]
    ds_read_b128 v[72:75], v25 offset:2176
    v_exp_f32 v219, v219
    v_cmp_nge_f32 s[96:97], s36, v21
    v_mfma_f32_16x16x32_bf16 v[120:123], a[200:203], v[232:235], v[120:123]
    v_add_f32 v22, v22, v219
    v_cvt_pk_bf16_f32 v215, v218, v219
    v_mfma_f32_16x16x32_bf16 v[124:127], a[172:175], v[228:231], v[124:127]
    v_exp_f32 v220, v220
    s_or_b64 s[90:91], s[90:91], s[96:97]
    v_mfma_f32_16x16x32_bf16 v[124:127], a[204:207], v[232:235], v[124:127]
    ds_read_b128 v[76:79], v25 offset:3264
    v_add_f32 v22, v22, v220
    s_barrier
    v_mfma_f32_16x16x32_bf16 v[228:231], a[80:83], a[64:67], v[208:211]
    v_exp_f32 v221, v221
    v_mfma_f32_16x16x32_bf16 v[228:231], a[84:87], a[68:71], v[228:231]
    v_add_f32 v22, v22, v221
    v_cvt_pk_bf16_f32 v216, v220, v221
    v_pk_mul_f32 v[96:97], v[96:97], v[28:29] op_sel_hi:[1,0]
    v_pk_mul_f32 v[98:99], v[98:99], v[28:29] op_sel_hi:[1,0]
    v_pk_mul_f32 v[100:101], v[100:101], v[28:29] op_sel_hi:[1,0]
    v_pk_mul_f32 v[102:103], v[102:103], v[28:29] op_sel_hi:[1,0]
    v_pk_mul_f32 v[104:105], v[104:105], v[28:29] op_sel_hi:[1,0]
    v_pk_mul_f32 v[106:107], v[106:107], v[28:29] op_sel_hi:[1,0]
    v_pk_mul_f32 v[108:109], v[108:109], v[28:29] op_sel_hi:[1,0]
    v_pk_mul_f32 v[110:111], v[110:111], v[28:29] op_sel_hi:[1,0]
    v_cvt_pk_bf16_f32 v96, v96, v97
    v_cvt_pk_bf16_f32 v97, v98, v99
    v_cvt_pk_bf16_f32 v100, v100, v101
    v_cvt_pk_bf16_f32 v101, v102, v103
    v_cvt_pk_bf16_f32 v104, v104, v105
    v_cvt_pk_bf16_f32 v105, v106, v107
    v_cvt_pk_bf16_f32 v108, v108, v109
    v_cvt_pk_bf16_f32 v109, v110, v111
    v_pk_mul_f32 v[112:113], v[112:113], v[28:29] op_sel_hi:[1,0]
    v_pk_mul_f32 v[114:115], v[114:115], v[28:29] op_sel_hi:[1,0]
    v_pk_mul_f32 v[116:117], v[116:117], v[28:29] op_sel_hi:[1,0]
    v_pk_mul_f32 v[118:119], v[118:119], v[28:29] op_sel_hi:[1,0]
    v_pk_mul_f32 v[120:121], v[120:121], v[28:29] op_sel_hi:[1,0]
    v_pk_mul_f32 v[122:123], v[122:123], v[28:29] op_sel_hi:[1,0]
    v_pk_mul_f32 v[124:125], v[124:125], v[28:29] op_sel_hi:[1,0]
    v_pk_mul_f32 v[126:127], v[126:127], v[28:29] op_sel_hi:[1,0]
    v_cvt_pk_bf16_f32 v112, v112, v113
    v_cvt_pk_bf16_f32 v113, v114, v115
    v_cvt_pk_bf16_f32 v116, v116, v117
    v_cvt_pk_bf16_f32 v117, v118, v119
    v_cvt_pk_bf16_f32 v120, v120, v121
    v_cvt_pk_bf16_f32 v121, v122, v123
    v_cvt_pk_bf16_f32 v124, v124, v125
    v_cvt_pk_bf16_f32 v125, v126, v127
    v_mfma_f32_16x16x32_bf16 v[228:231], a[88:91], a[72:75], v[228:231]
    v_exp_f32 v222, v222
    v_mfma_f32_16x16x32_bf16 v[228:231], a[92:95], a[76:79], v[228:231]
    ds_write_b64 v24, v[96:97] offset:0
    v_add_f32 v22, v22, v222
    v_mfma_f32_16x16x32_bf16 v[232:235], a[96:99], a[64:67], v[208:211]
    v_exp_f32 v223, v223
    v_mfma_f32_16x16x32_bf16 v[232:235], a[100:103], a[68:71], v[232:235]
    ds_write_b64 v24, v[100:101] offset:32
    v_add_f32 v22, v22, v223
    v_cvt_pk_bf16_f32 v217, v222, v223
    v_mfma_f32_16x16x32_bf16 v[232:235], a[104:107], a[72:75], v[232:235]
    v_exp_f32 v224, v224
    v_mfma_f32_16x16x32_bf16 v[232:235], a[108:111], a[76:79], v[232:235]
    ds_write_b64 v24, v[104:105] offset:64
    s_add_u32 s101, s100, 4096
    v_add_f32 v22, v22, v224
    v_mfma_f32_16x16x32_bf16 v[236:239], a[112:115], a[64:67], v[208:211]
    v_exp_f32 v225, v225
    v_mfma_f32_16x16x32_bf16 v[236:239], a[116:119], a[68:71], v[236:239]
    ds_write_b64 v24, v[108:109] offset:96
    v_add_f32 v22, v22, v225
    v_cvt_pk_bf16_f32 v218, v224, v225
    v_mfma_f32_16x16x32_bf16 v[236:239], a[120:123], a[72:75], v[236:239]
    v_exp_f32 v226, v226
    v_mfma_f32_16x16x32_bf16 v[236:239], a[124:127], a[76:79], v[236:239]
    s_waitcnt lgkmcnt(3)
    buffer_store_dwordx4 v[64:67], v26, s[92:95], s101 offen offset:0 sc1
    ds_write_b64 v24, v[112:113] offset:128
    v_add_f32 v22, v22, v226
    v_mfma_f32_16x16x32_bf16 v[240:243], a[128:131], a[64:67], v[208:211]
    v_exp_f32 v227, v227
    v_mfma_f32_16x16x32_bf16 v[240:243], a[132:135], a[68:71], v[240:243]
    ds_write_b64 v24, v[116:117] offset:160
    v_add_f32 v22, v22, v227
    v_cvt_pk_bf16_f32 v219, v226, v227
    v_mfma_f32_16x16x32_bf16 v[240:243], a[136:139], a[72:75], v[240:243]
    v_exp_f32 v228, v228
    v_mov_b32 v30, v22
    v_mfma_f32_16x16x32_bf16 v[240:243], a[140:143], a[76:79], v[240:243]
    buffer_store_dwordx4 v[68:71], v26, s[92:95], s101 offen offset:1024 sc1
    ds_write_b64 v24, v[120:121] offset:192
    v_add_f32 v23, v23, v228
    v_mfma_f32_16x16x32_bf16 v[128:131], a[144:147], v[212:215], v[128:131]
    v_exp_f32 v229, v229
    v_permlane16_swap_b32 v22, v30
    v_mfma_f32_16x16x32_bf16 v[128:131], a[176:179], v[216:219], v[128:131]
    ds_write_b64 v24, v[124:125] offset:224
    v_add_f32 v23, v23, v229
    v_cvt_pk_bf16_f32 v228, v228, v229
    v_mfma_f32_16x16x32_bf16 v[132:135], a[148:151], v[212:215], v[132:135]
    v_exp_f32 v230, v230
    v_add_f32 v22, v22, v30
    v_mfma_f32_16x16x32_bf16 v[132:135], a[180:183], v[216:219], v[132:135]
    buffer_store_dwordx4 v[72:75], v26, s[92:95], s101 offen offset:2048 sc1
    ds_read_b128 v[96:99], v25 offset:0
    v_add_f32 v23, v23, v230
    v_mfma_f32_16x16x32_bf16 v[136:139], a[152:155], v[212:215], v[136:139]
    ds_read_b128 v[100:103], v25 offset:1088
    v_exp_f32 v231, v231
    v_mov_b32 v30, v22
    v_mfma_f32_16x16x32_bf16 v[136:139], a[184:187], v[216:219], v[136:139]
    buffer_store_dwordx4 v[76:79], v26, s[92:95], s101 offen offset:3072 sc1
    ds_read_b128 v[104:107], v25 offset:2176
    v_add_f32 v23, v23, v231
    v_cvt_pk_bf16_f32 v229, v230, v231
    v_mfma_f32_16x16x32_bf16 v[140:143], a[156:159], v[212:215], v[140:143]
    ds_read_b128 v[108:111], v25 offset:3264
    v_exp_f32 v232, v232
    v_mfma_f32_16x16x32_bf16 v[140:143], a[188:191], v[216:219], v[140:143]
    v_add_f32 v23, v23, v232
    v_permlane32_swap_b32 v22, v30
    v_mfma_f32_16x16x32_bf16 v[144:147], a[160:163], v[212:215], v[144:147]
    v_exp_f32 v233, v233
    v_mfma_f32_16x16x32_bf16 v[144:147], a[192:195], v[216:219], v[144:147]
    v_add_f32 v23, v23, v233
    v_cvt_pk_bf16_f32 v230, v232, v233
    v_add_f32 v22, v22, v30
    v_mfma_f32_16x16x32_bf16 v[148:151], a[164:167], v[212:215], v[148:151]
    v_exp_f32 v234, v234
    v_mfma_f32_16x16x32_bf16 v[148:151], a[196:199], v[216:219], v[148:151]
    s_add_u32 s101, s100, 8192
    v_add_f32 v23, v23, v234
    v_rcp_f32 v28, v22
    v_mfma_f32_16x16x32_bf16 v[152:155], a[168:171], v[212:215], v[152:155]
    s_waitcnt lgkmcnt(2)
    buffer_store_dwordx4 v[96:99], v26, s[92:95], s101 offen offset:0 sc1
    v_exp_f32 v235, v235
    v_mfma_f32_16x16x32_bf16 v[152:155], a[200:203], v[216:219], v[152:155]
    buffer_store_dwordx4 v[100:103], v26, s[92:95], s101 offen offset:1024 sc1
    v_add_f32 v23, v23, v235
    v_cvt_pk_bf16_f32 v231, v234, v235
    v_cmp_nge_f32 s[96:97], s36, v22
    v_mfma_f32_16x16x32_bf16 v[156:159], a[172:175], v[212:215], v[156:159]
    s_waitcnt lgkmcnt(0)
    buffer_store_dwordx4 v[104:107], v26, s[92:95], s101 offen offset:2048 sc1
    v_exp_f32 v236, v236
    v_mfma_f32_16x16x32_bf16 v[156:159], a[204:207], v[216:219], v[156:159]
    buffer_store_dwordx4 v[108:111], v26, s[92:95], s101 offen offset:3072 sc1
    v_add_f32 v23, v23, v236
    s_or_b64 s[90:91], s[90:91], s[96:97]
    v_exp_f32 v237, v237
    v_pk_mul_f32 v[128:129], v[128:129], v[28:29] op_sel_hi:[1,0]
    v_add_f32 v23, v23, v237
    v_cvt_pk_bf16_f32 v232, v236, v237
    v_exp_f32 v238, v238
    v_pk_mul_f32 v[130:131], v[130:131], v[28:29] op_sel_hi:[1,0]
    v_add_f32 v23, v23, v238
    v_exp_f32 v239, v239
    v_pk_mul_f32 v[132:133], v[132:133], v[28:29] op_sel_hi:[1,0]
    v_add_f32 v23, v23, v239
    v_cvt_pk_bf16_f32 v233, v238, v239
    v_exp_f32 v240, v240
    v_pk_mul_f32 v[134:135], v[134:135], v[28:29] op_sel_hi:[1,0]
    v_add_f32 v23, v23, v240
    v_exp_f32 v241, v241
    v_pk_mul_f32 v[136:137], v[136:137], v[28:29] op_sel_hi:[1,0]
    v_add_f32 v23, v23, v241
    v_cvt_pk_bf16_f32 v234, v240, v241
    v_exp_f32 v242, v242
    v_pk_mul_f32 v[138:139], v[138:139], v[28:29] op_sel_hi:[1,0]
    v_add_f32 v23, v23, v242
    v_exp_f32 v243, v243
    v_pk_mul_f32 v[140:141], v[140:141], v[28:29] op_sel_hi:[1,0]
    v_add_f32 v23, v23, v243
    v_cvt_pk_bf16_f32 v235, v242, v243
    v_pk_mul_f32 v[142:143], v[142:143], v[28:29] op_sel_hi:[1,0]
    v_cvt_pk_bf16_f32 v128, v128, v129
    v_cvt_pk_bf16_f32 v129, v130, v131
    v_cvt_pk_bf16_f32 v132, v132, v133
    v_cvt_pk_bf16_f32 v133, v134, v135
    v_cvt_pk_bf16_f32 v136, v136, v137
    v_cvt_pk_bf16_f32 v137, v138, v139
    v_cvt_pk_bf16_f32 v140, v140, v141
    v_cvt_pk_bf16_f32 v141, v142, v143
    v_pk_mul_f32 v[144:145], v[144:145], v[28:29] op_sel_hi:[1,0]
    v_pk_mul_f32 v[146:147], v[146:147], v[28:29] op_sel_hi:[1,0]
    v_pk_mul_f32 v[148:149], v[148:149], v[28:29] op_sel_hi:[1,0]
    v_pk_mul_f32 v[150:151], v[150:151], v[28:29] op_sel_hi:[1,0]
    v_pk_mul_f32 v[152:153], v[152:153], v[28:29] op_sel_hi:[1,0]
    v_pk_mul_f32 v[154:155], v[154:155], v[28:29] op_sel_hi:[1,0]
    v_pk_mul_f32 v[156:157], v[156:157], v[28:29] op_sel_hi:[1,0]
    v_pk_mul_f32 v[158:159], v[158:159], v[28:29] op_sel_hi:[1,0]
    v_cvt_pk_bf16_f32 v144, v144, v145
    v_cvt_pk_bf16_f32 v145, v146, v147
    v_cvt_pk_bf16_f32 v148, v148, v149
    v_cvt_pk_bf16_f32 v149, v150, v151
    v_cvt_pk_bf16_f32 v152, v152, v153
    v_cvt_pk_bf16_f32 v153, v154, v155
    v_cvt_pk_bf16_f32 v156, v156, v157
    v_cvt_pk_bf16_f32 v157, v158, v159
    v_mfma_f32_16x16x32_bf16 v[160:163], a[144:147], v[228:231], v[160:163]
    ds_write_b64 v24, v[128:129] offset:0
    v_mov_b32 v30, v23
    v_mfma_f32_16x16x32_bf16 v[160:163], a[176:179], v[232:235], v[160:163]
    ds_write_b64 v24, v[132:133] offset:32
    v_permlane16_swap_b32 v23, v30
    v_mfma_f32_16x16x32_bf16 v[164:167], a[148:151], v[228:231], v[164:167]
    ds_write_b64 v24, v[136:137] offset:64
    v_add_f32 v23, v23, v30
    v_mfma_f32_16x16x32_bf16 v[164:167], a[180:183], v[232:235], v[164:167]
    ds_write_b64 v24, v[140:141] offset:96
    v_mov_b32 v30, v23
    v_mfma_f32_16x16x32_bf16 v[168:171], a[152:155], v[228:231], v[168:171]
    ds_write_b64 v24, v[144:145] offset:128
    v_permlane32_swap_b32 v23, v30
    v_mfma_f32_16x16x32_bf16 v[168:171], a[184:187], v[232:235], v[168:171]
    ds_write_b64 v24, v[148:149] offset:160
    v_add_f32 v23, v23, v30
    v_mfma_f32_16x16x32_bf16 v[172:175], a[156:159], v[228:231], v[172:175]
    ds_write_b64 v24, v[152:153] offset:192
    v_mfma_f32_16x16x32_bf16 v[172:175], a[188:191], v[232:235], v[172:175]
    v_rcp_f32 v28, v23
    v_mfma_f32_16x16x32_bf16 v[176:179], a[160:163], v[228:231], v[176:179]
    ds_write_b64 v24, v[156:157] offset:224
    v_cmp_nge_f32 s[96:97], s36, v23
    v_mfma_f32_16x16x32_bf16 v[176:179], a[192:195], v[232:235], v[176:179]
    s_or_b64 s[90:91], s[90:91], s[96:97]
    ds_read_b128 v[128:131], v25 offset:0
    v_mfma_f32_16x16x32_bf16 v[180:183], a[164:167], v[228:231], v[180:183]
    ds_read_b128 v[132:135], v25 offset:1088
    ds_read_b128 v[136:139], v25 offset:2176
    v_mfma_f32_16x16x32_bf16 v[180:183], a[196:199], v[232:235], v[180:183]
    ds_read_b128 v[140:143], v25 offset:3264
    v_mfma_f32_16x16x32_bf16 v[184:187], a[168:171], v[228:231], v[184:187]
    v_mfma_f32_16x16x32_bf16 v[184:187], a[200:203], v[232:235], v[184:187]
    v_mfma_f32_16x16x32_bf16 v[188:191], a[172:175], v[228:231], v[188:191]
    v_mfma_f32_16x16x32_bf16 v[188:191], a[204:207], v[232:235], v[188:191]
    s_add_u32 s101, s100, 12288
    s_waitcnt lgkmcnt(3)
    buffer_store_dwordx4 v[128:131], v26, s[92:95], s101 offen offset:0 sc1
    s_waitcnt lgkmcnt(2)
    buffer_store_dwordx4 v[132:135], v26, s[92:95], s101 offen offset:1024 sc1
    s_waitcnt lgkmcnt(1)
    buffer_store_dwordx4 v[136:139], v26, s[92:95], s101 offen offset:2048 sc1
    s_waitcnt lgkmcnt(0)
    buffer_store_dwordx4 v[140:143], v26, s[92:95], s101 offen offset:3072 sc1
    s_add_u32 s101, s100, 16384
    v_pk_mul_f32 v[160:161], v[160:161], v[28:29] op_sel_hi:[1,0]
    v_pk_mul_f32 v[162:163], v[162:163], v[28:29] op_sel_hi:[1,0]
    v_pk_mul_f32 v[164:165], v[164:165], v[28:29] op_sel_hi:[1,0]
    v_pk_mul_f32 v[166:167], v[166:167], v[28:29] op_sel_hi:[1,0]
    v_pk_mul_f32 v[168:169], v[168:169], v[28:29] op_sel_hi:[1,0]
    v_pk_mul_f32 v[170:171], v[170:171], v[28:29] op_sel_hi:[1,0]
    v_pk_mul_f32 v[172:173], v[172:173], v[28:29] op_sel_hi:[1,0]
    v_pk_mul_f32 v[174:175], v[174:175], v[28:29] op_sel_hi:[1,0]
    v_cvt_pk_bf16_f32 v160, v160, v161
    v_cvt_pk_bf16_f32 v161, v162, v163
    v_cvt_pk_bf16_f32 v162, v164, v165
    v_cvt_pk_bf16_f32 v163, v166, v167
    v_cvt_pk_bf16_f32 v168, v168, v169
    v_cvt_pk_bf16_f32 v169, v170, v171
    v_cvt_pk_bf16_f32 v170, v172, v173
    v_cvt_pk_bf16_f32 v171, v174, v175
    v_permlane16_swap_b32 v160, v162
    v_permlane16_swap_b32 v161, v163
    v_permlane16_swap_b32 v168, v170
    v_permlane16_swap_b32 v169, v171
    buffer_store_dwordx4 v[160:163], v27, s[92:95], s101 offen offset:0 sc1
    buffer_store_dwordx4 v[168:171], v27, s[92:95], s101 offen offset:64 sc1
    v_pk_mul_f32 v[176:177], v[176:177], v[28:29] op_sel_hi:[1,0]
    v_pk_mul_f32 v[178:179], v[178:179], v[28:29] op_sel_hi:[1,0]
    v_pk_mul_f32 v[180:181], v[180:181], v[28:29] op_sel_hi:[1,0]
    v_pk_mul_f32 v[182:183], v[182:183], v[28:29] op_sel_hi:[1,0]
    v_pk_mul_f32 v[184:185], v[184:185], v[28:29] op_sel_hi:[1,0]
    v_pk_mul_f32 v[186:187], v[186:187], v[28:29] op_sel_hi:[1,0]
    v_pk_mul_f32 v[188:189], v[188:189], v[28:29] op_sel_hi:[1,0]
    v_pk_mul_f32 v[190:191], v[190:191], v[28:29] op_sel_hi:[1,0]
    v_cvt_pk_bf16_f32 v176, v176, v177
    v_cvt_pk_bf16_f32 v177, v178, v179
    v_cvt_pk_bf16_f32 v178, v180, v181
    v_cvt_pk_bf16_f32 v179, v182, v183
    v_cvt_pk_bf16_f32 v184, v184, v185
    v_cvt_pk_bf16_f32 v185, v186, v187
    v_cvt_pk_bf16_f32 v186, v188, v189
    v_cvt_pk_bf16_f32 v187, v190, v191
    v_permlane16_swap_b32 v176, v178
    v_permlane16_swap_b32 v177, v179
    v_permlane16_swap_b32 v184, v186
    v_permlane16_swap_b32 v185, v187
    buffer_store_dwordx4 v[176:179], v27, s[92:95], s101 offen offset:128 sc1
    buffer_store_dwordx4 v[184:187], v27, s[92:95], s101 offen offset:192 sc1
    s_branch L_slow
L_wave3:
    s_cmp_lg_u32 s33, 0
    s_cbranch_scc1 L_y8_w3
    s_waitcnt vmcnt(0)
L_y8_w3:
    s_add_u32 m0, s29, 49152
    s_add_u32 s42, s100, 4096
    buffer_load_dwordx4 v13, s[20:23], s42 offen offset:0 nt lds
    buffer_load_dwordx4 v14, s[20:23], s42 offen offset:1024 nt lds
    buffer_load_dwordx4 v15, s[20:23], s42 offen offset:2048 nt lds
    buffer_load_dwordx4 v16, s[20:23], s42 offen offset:3072 nt lds
    v_add_u32 v252, s29, v1
    v_add_u32 v253, s29, v2
    v_add_u32 v254, s29, v3
    v_add_u32 v255, s29, v4
    s_waitcnt vmcnt(8)
    ds_read_b128 v[160:163], v252 offset:32768
    ds_read_b128 v[164:167], v253 offset:32768
    ds_read_b128 v[168:171], v254 offset:32768
    ds_read_b128 v[172:175], v255 offset:32768
    s_cmp_lg_u32 s33, 0
    s_cbranch_scc1 L_y9_w3
    s_waitcnt vmcnt(0)
L_y9_w3:
    s_add_u32 m0, s29, 65536
    s_nop 0
    buffer_load_dwordx4 v17, s[16:19], s28 offen offset:0 nt lds
    buffer_load_dwordx4 v18, s[16:19], s28 offen offset:1024 nt lds
    buffer_load_dwordx4 v17, s[16:19], s28 offen offset:2048 nt lds
    buffer_load_dwordx4 v18, s[16:19], s28 offen offset:3072 nt lds
    s_add_u32 s28, s28, 16384
    s_waitcnt lgkmcnt(3)
    v_lshlrev_b32 v244, 16, v160
    v_lshlrev_b32 v246, 16, v161
    v_lshlrev_b32 v248, 16, v162
    v_lshlrev_b32 v250, 16, v163
    v_and_b32 v245, s37, v160
    v_and_b32 v247, s37, v161
    v_and_b32 v249, s37, v162
    v_and_b32 v251, s37, v163
    v_pk_mul_f32 v[244:245], v[244:245], s[34:35]
    v_pk_mul_f32 v[246:247], v[246:247], s[34:35]
    v_pk_mul_f32 v[248:249], v[248:249], s[34:35]
    v_pk_mul_f32 v[250:251], v[250:251], s[34:35]
    v_cvt_pk_bf16_f32 v244, v244, v245
    v_cvt_pk_bf16_f32 v246, v246, v247
    v_cvt_pk_bf16_f32 v248, v248, v249
    v_cvt_pk_bf16_f32 v250, v250, v251
    v_accvgpr_write_b32 a0, v244
    v_accvgpr_write_b32 a1, v246
    v_accvgpr_write_b32 a2, v248
    v_accvgpr_write_b32 a3, v250
    s_waitcnt lgkmcnt(2)
    v_lshlrev_b32 v244, 16, v164
    v_lshlrev_b32 v246, 16, v165
    v_lshlrev_b32 v248, 16, v166
    v_lshlrev_b32 v250, 16, v167
    v_and_b32 v245, s37, v164
    v_and_b32 v247, s37, v165
    v_and_b32 v249, s37, v166
    v_and_b32 v251, s37, v167
    v_pk_mul_f32 v[244:245], v[244:245], s[34:35]
    v_pk_mul_f32 v[246:247], v[246:247], s[34:35]
    v_pk_mul_f32 v[248:249], v[248:249], s[34:35]
    v_pk_mul_f32 v[250:251], v[250:251], s[34:35]
    v_cvt_pk_bf16_f32 v244, v244, v245
    v_cvt_pk_bf16_f32 v246, v246, v247
    v_cvt_pk_bf16_f32 v248, v248, v249
    v_cvt_pk_bf16_f32 v250, v250, v251
    v_accvgpr_write_b32 a4, v244
    v_accvgpr_write_b32 a5, v246
    v_accvgpr_write_b32 a6, v248
    v_accvgpr_write_b32 a7, v250
    s_waitcnt lgkmcnt(1)
    v_lshlrev_b32 v244, 16, v168
    v_lshlrev_b32 v246, 16, v169
    v_lshlrev_b32 v248, 16, v170
    v_lshlrev_b32 v250, 16, v171
    v_and_b32 v245, s37, v168
    v_and_b32 v247, s37, v169
    v_and_b32 v249, s37, v170
    v_and_b32 v251, s37, v171
    v_pk_mul_f32 v[244:245], v[244:245], s[34:35]
    v_pk_mul_f32 v[246:247], v[246:247], s[34:35]
    v_pk_mul_f32 v[248:249], v[248:249], s[34:35]
    v_pk_mul_f32 v[250:251], v[250:251], s[34:35]
    v_cvt_pk_bf16_f32 v244, v244, v245
    v_cvt_pk_bf16_f32 v246, v246, v247
    v_cvt_pk_bf16_f32 v248, v248, v249
    v_cvt_pk_bf16_f32 v250, v250, v251
    v_accvgpr_write_b32 a8, v244
    v_accvgpr_write_b32 a9, v246
    v_accvgpr_write_b32 a10, v248
    v_accvgpr_write_b32 a11, v250
    s_waitcnt lgkmcnt(0)
    v_lshlrev_b32 v244, 16, v172
    v_lshlrev_b32 v246, 16, v173
    v_lshlrev_b32 v248, 16, v174
    v_lshlrev_b32 v250, 16, v175
    v_and_b32 v245, s37, v172
    v_and_b32 v247, s37, v173
    v_and_b32 v249, s37, v174
    v_and_b32 v251, s37, v175
    v_pk_mul_f32 v[244:245], v[244:245], s[34:35]
    v_pk_mul_f32 v[246:247], v[246:247], s[34:35]
    v_pk_mul_f32 v[248:249], v[248:249], s[34:35]
    v_pk_mul_f32 v[250:251], v[250:251], s[34:35]
    v_cvt_pk_bf16_f32 v244, v244, v245
    v_cvt_pk_bf16_f32 v246, v246, v247
    v_cvt_pk_bf16_f32 v248, v248, v249
    v_cvt_pk_bf16_f32 v250, v250, v251
    v_accvgpr_write_b32 a12, v244
    v_accvgpr_write_b32 a13, v246
    v_accvgpr_write_b32 a14, v248
    v_accvgpr_write_b32 a15, v250
    s_waitcnt vmcnt(8)
    s_barrier
    ds_read_b128 a[80:83], v1 offset:0
    ds_read_b128 a[84:87], v2 offset:0
    ds_read_b128 a[88:91], v3 offset:0
    ds_read_b128 a[92:95], v4 offset:0
    ds_read_b128 a[96:99], v1 offset:4096
    ds_read_b128 a[100:103], v2 offset:4096
    ds_read_b128 a[104:107], v3 offset:4096
    ds_read_b128 a[108:111], v4 offset:4096
    ds_read_b128 a[112:115], v1 offset:8192
    ds_read_b128 a[116:119], v2 offset:8192
    ds_read_b128 a[120:123], v3 offset:8192
    ds_read_b128 a[124:127], v4 offset:8192
    ds_read_b128 a[128:131], v1 offset:12288
    ds_read_b128 a[132:135], v2 offset:12288
    ds_read_b128 a[136:139], v3 offset:12288
    ds_read_b128 a[140:143], v4 offset:12288
    s_cmp_lg_u32 s33, 0
    s_cbranch_scc1 L_y10_w3
    s_waitcnt vmcnt(0)
L_y10_w3:
    s_add_u32 m0, s29, 98304
    s_add_u32 s42, s100, 8192
    buffer_load_dwordx4 v13, s[20:23], s42 offen offset:0 nt lds
    buffer_load_dwordx4 v14, s[20:23], s42 offen offset:1024 nt lds
    buffer_load_dwordx4 v15, s[20:23], s42 offen offset:2048 nt lds
    buffer_load_dwordx4 v16, s[20:23], s42 offen offset:3072 nt lds
    s_waitcnt lgkmcnt(15)
    v_mfma_f32_16x16x32_bf16 v[192:195], a[80:83], a[0:3], 0
    s_waitcnt lgkmcnt(14)
    v_mfma_f32_16x16x32_bf16 v[192:195], a[84:87], a[4:7], v[192:195]
    s_waitcnt lgkmcnt(13)
    v_mfma_f32_16x16x32_bf16 v[192:195], a[88:91], a[8:11], v[192:195]
    s_waitcnt lgkmcnt(12)
    v_mfma_f32_16x16x32_bf16 v[192:195], a[92:95], a[12:15], v[192:195]
    s_nop 7
    v_max3_f32 v244, v192, v193, v194
    v_max_f32 v244, v244, v195
    v_mov_b32 v245, v244
    s_nop 1
    v_permlane16_swap_b32 v244, v245
    v_max_f32 v244, v244, v245
    v_mov_b32 v245, v244
    s_nop 1
    v_permlane32_swap_b32 v244, v245
    v_min_f32 v192, -v244, -v245
    v_min_f32 v193, -v244, -v245
    v_min_f32 v194, -v244, -v245
    v_min_f32 v195, -v244, -v245
    s_nop 1
    v_mfma_f32_16x16x32_bf16 v[212:215], a[80:83], a[0:3], v[192:195]
    v_mfma_f32_16x16x32_bf16 v[212:215], a[84:87], a[4:7], v[212:215]
    v_mfma_f32_16x16x32_bf16 v[212:215], a[88:91], a[8:11], v[212:215]
    v_mfma_f32_16x16x32_bf16 v[212:215], a[92:95], a[12:15], v[212:215]
    s_waitcnt lgkmcnt(0)
    v_mfma_f32_16x16x32_bf16 v[216:219], a[96:99], a[0:3], v[192:195]
    v_mfma_f32_16x16x32_bf16 v[216:219], a[100:103], a[4:7], v[216:219]
    v_mfma_f32_16x16x32_bf16 v[216:219], a[104:107], a[8:11], v[216:219]
    v_mfma_f32_16x16x32_bf16 v[216:219], a[108:111], a[12:15], v[216:219]
    s_nop 2
    v_exp_f32 v212, v212
    v_mfma_f32_16x16x32_bf16 v[220:223], a[112:115], a[0:3], v[192:195]
    v_mov_b32 v19, v212
    v_mfma_f32_16x16x32_bf16 v[220:223], a[116:119], a[4:7], v[220:223]
    v_exp_f32 v213, v213
    v_mfma_f32_16x16x32_bf16 v[220:223], a[120:123], a[8:11], v[220:223]
    v_add_f32 v19, v19, v213
    v_cvt_pk_bf16_f32 v212, v212, v213
    v_mfma_f32_16x16x32_bf16 v[220:223], a[124:127], a[12:15], v[220:223]
    v_exp_f32 v214, v214
    v_mfma_f32_16x16x32_bf16 v[224:227], a[128:131], a[0:3], v[192:195]
    v_add_f32 v19, v19, v214
    v_mfma_f32_16x16x32_bf16 v[224:227], a[132:135], a[4:7], v[224:227]
    v_exp_f32 v215, v215
    v_mfma_f32_16x16x32_bf16 v[224:227], a[136:139], a[8:11], v[224:227]
    v_add_f32 v19, v19, v215
    v_cvt_pk_bf16_f32 v213, v214, v215
    v_mfma_f32_16x16x32_bf16 v[224:227], a[140:143], a[12:15], v[224:227]
    v_exp_f32 v216, v216
    s_nop 0
    v_add_f32 v19, v19, v216
    v_exp_f32 v217, v217
    s_nop 0
    v_add_f32 v19, v19, v217
    v_cvt_pk_bf16_f32 v214, v216, v217
    v_exp_f32 v218, v218
    s_nop 0
    v_add_f32 v19, v19, v218
    v_exp_f32 v219, v219
    s_nop 0
    v_add_f32 v19, v19, v219
    v_cvt_pk_bf16_f32 v215, v218, v219
    v_exp_f32 v220, v220
    s_nop 0
    v_add_f32 v19, v19, v220
    v_add_u32 v252, s29, v1
    v_add_u32 v253, s29, v2
    v_add_u32 v254, s29, v3
    v_add_u32 v255, s29, v4
    s_waitcnt vmcnt(8)
    ds_read_b128 v[160:163], v252 offset:49152
    ds_read_b128 v[164:167], v253 offset:49152
    ds_read_b128 v[168:171], v254 offset:49152
    ds_read_b128 v[172:175], v255 offset:49152
    s_cmp_lg_u32 s33, 0
    s_cbranch_scc1 L_y11_w3
    s_waitcnt vmcnt(0)
L_y11_w3:
    s_add_u32 m0, s29, 114688
    s_add_u32 s42, s100, 12288
    buffer_load_dwordx4 v13, s[20:23], s42 offen offset:0 nt lds
    buffer_load_dwordx4 v14, s[20:23], s42 offen offset:1024 nt lds
    buffer_load_dwordx4 v15, s[20:23], s42 offen offset:2048 nt lds
    buffer_load_dwordx4 v16, s[20:23], s42 offen offset:3072 nt lds
    s_waitcnt lgkmcnt(3)
    v_lshlrev_b32 v244, 16, v160
    v_lshlrev_b32 v246, 16, v161
    v_lshlrev_b32 v248, 16, v162
    v_lshlrev_b32 v250, 16, v163
    v_and_b32 v245, s37, v160
    v_and_b32 v247, s37, v161
    v_and_b32 v249, s37, v162
    v_and_b32 v251, s37, v163
    v_pk_mul_f32 v[244:245], v[244:245], s[34:35]
    v_pk_mul_f32 v[246:247], v[246:247], s[34:35]
    v_pk_mul_f32 v[248:249], v[248:249], s[34:35]
    v_pk_mul_f32 v[250:251], v[250:251], s[34:35]
    v_cvt_pk_bf16_f32 v244, v244, v245
    v_cvt_pk_bf16_f32 v246, v246, v247
    v_cvt_pk_bf16_f32 v248, v248, v249
    v_cvt_pk_bf16_f32 v250, v250, v251
    v_accvgpr_write_b32 a16, v244
    v_accvgpr_write_b32 a17, v246
    v_accvgpr_write_b32 a18, v248
    v_accvgpr_write_b32 a19, v250
    s_waitcnt lgkmcnt(2)
    v_lshlrev_b32 v244, 16, v164
    v_lshlrev_b32 v246, 16, v165
    v_lshlrev_b32 v248, 16, v166
    v_lshlrev_b32 v250, 16, v167
    v_and_b32 v245, s37, v164
    v_and_b32 v247, s37, v165
    v_and_b32 v249, s37, v166
    v_and_b32 v251, s37, v167
    v_pk_mul_f32 v[244:245], v[244:245], s[34:35]
    v_pk_mul_f32 v[246:247], v[246:247], s[34:35]
    v_pk_mul_f32 v[248:249], v[248:249], s[34:35]
    v_pk_mul_f32 v[250:251], v[250:251], s[34:35]
    v_cvt_pk_bf16_f32 v244, v244, v245
    v_cvt_pk_bf16_f32 v246, v246, v247
    v_cvt_pk_bf16_f32 v248, v248, v249
    v_cvt_pk_bf16_f32 v250, v250, v251
    v_accvgpr_write_b32 a20, v244
    v_accvgpr_write_b32 a21, v246
    v_accvgpr_write_b32 a22, v248
    v_accvgpr_write_b32 a23, v250
    s_waitcnt lgkmcnt(1)
    v_lshlrev_b32 v244, 16, v168
    v_lshlrev_b32 v246, 16, v169
    v_lshlrev_b32 v248, 16, v170
    v_lshlrev_b32 v250, 16, v171
    v_and_b32 v245, s37, v168
    v_and_b32 v247, s37, v169
    v_and_b32 v249, s37, v170
    v_and_b32 v251, s37, v171
    v_pk_mul_f32 v[244:245], v[244:245], s[34:35]
    v_pk_mul_f32 v[246:247], v[246:247], s[34:35]
    v_pk_mul_f32 v[248:249], v[248:249], s[34:35]
    v_pk_mul_f32 v[250:251], v[250:251], s[34:35]
    v_cvt_pk_bf16_f32 v244, v244, v245
    v_cvt_pk_bf16_f32 v246, v246, v247
    v_cvt_pk_bf16_f32 v248, v248, v249
    v_cvt_pk_bf16_f32 v250, v250, v251
    v_accvgpr_write_b32 a24, v244
    v_accvgpr_write_b32 a25, v246
    v_accvgpr_write_b32 a26, v248
    v_accvgpr_write_b32 a27, v250
    s_waitcnt lgkmcnt(0)
    v_lshlrev_b32 v244, 16, v172
    v_lshlrev_b32 v246, 16, v173
    v_lshlrev_b32 v248, 16, v174
    v_lshlrev_b32 v250, 16, v175
    v_and_b32 v245, s37, v172
    v_and_b32 v247, s37, v173
    v_and_b32 v249, s37, v174
    v_and_b32 v251, s37, v175
    v_pk_mul_f32 v[244:245], v[244:245], s[34:35]
    v_pk_mul_f32 v[246:247], v[246:247], s[34:35]
    v_pk_mul_f32 v[248:249], v[248:249], s[34:35]
    v_pk_mul_f32 v[250:251], v[250:251], s[34:35]
    v_cvt_pk_bf16_f32 v244, v244, v245
    v_cvt_pk_bf16_f32 v246, v246, v247
    v_cvt_pk_bf16_f32 v248, v248, v249
    v_cvt_pk_bf16_f32 v250, v250, v251
    v_accvgpr_write_b32 a28, v244
    v_accvgpr_write_b32 a29, v246
    v_accvgpr_write_b32 a30, v248
    v_accvgpr_write_b32 a31, v250
    v_mfma_f32_16x16x32_bf16 v[196:199], a[80:83], a[16:19], 0
    v_mfma_f32_16x16x32_bf16 v[196:199], a[84:87], a[20:23], v[196:199]
    v_mfma_f32_16x16x32_bf16 v[196:199], a[88:91], a[24:27], v[196:199]
    v_mfma_f32_16x16x32_bf16 v[196:199], a[92:95], a[28:31], v[196:199]
    s_nop 7
    v_max3_f32 v244, v196, v197, v198
    v_max_f32 v244, v244, v199
    v_mov_b32 v245, v244
    s_nop 1
    v_permlane16_swap_b32 v244, v245
    v_max_f32 v244, v244, v245
    v_mov_b32 v245, v244
    s_nop 1
    v_permlane32_swap_b32 v244, v245
    v_min_f32 v196, -v244, -v245
    v_min_f32 v197, -v244, -v245
    v_min_f32 v198, -v244, -v245
    v_min_f32 v199, -v244, -v245
    s_nop 1
    v_mfma_f32_16x16x32_bf16 v[228:231], a[80:83], a[16:19], v[196:199]
    v_exp_f32 v221, v221
    v_mfma_f32_16x16x32_bf16 v[228:231], a[84:87], a[20:23], v[228:231]
    v_add_f32 v19, v19, v221
    v_cvt_pk_bf16_f32 v216, v220, v221
    v_mfma_f32_16x16x32_bf16 v[228:231], a[88:91], a[24:27], v[228:231]
    v_exp_f32 v222, v222
    v_mfma_f32_16x16x32_bf16 v[228:231], a[92:95], a[28:31], v[228:231]
    v_add_f32 v19, v19, v222
    v_mfma_f32_16x16x32_bf16 v[232:235], a[96:99], a[16:19], v[196:199]
    v_exp_f32 v223, v223
    v_mfma_f32_16x16x32_bf16 v[232:235], a[100:103], a[20:23], v[232:235]
    v_add_f32 v19, v19, v223
    v_cvt_pk_bf16_f32 v217, v222, v223
    v_mfma_f32_16x16x32_bf16 v[232:235], a[104:107], a[24:27], v[232:235]
    v_exp_f32 v224, v224
    v_mfma_f32_16x16x32_bf16 v[232:235], a[108:111], a[28:31], v[232:235]
    v_add_f32 v19, v19, v224
    v_mfma_f32_16x16x32_bf16 v[236:239], a[112:115], a[16:19], v[196:199]
    v_exp_f32 v225, v225
    v_mfma_f32_16x16x32_bf16 v[236:239], a[116:119], a[20:23], v[236:239]
    v_add_f32 v19, v19, v225
    v_cvt_pk_bf16_f32 v218, v224, v225
    v_mfma_f32_16x16x32_bf16 v[236:239], a[120:123], a[24:27], v[236:239]
    v_exp_f32 v226, v226
    v_mfma_f32_16x16x32_bf16 v[236:239], a[124:127], a[28:31], v[236:239]
    v_add_f32 v19, v19, v226
    v_mfma_f32_16x16x32_bf16 v[240:243], a[128:131], a[16:19], v[196:199]
    v_exp_f32 v227, v227
    v_mfma_f32_16x16x32_bf16 v[240:243], a[132:135], a[20:23], v[240:243]
    v_add_f32 v19, v19, v227
    v_cvt_pk_bf16_f32 v219, v226, v227
    v_mfma_f32_16x16x32_bf16 v[240:243], a[136:139], a[24:27], v[240:243]
    v_exp_f32 v228, v228
    v_mfma_f32_16x16x32_bf16 v[240:243], a[140:143], a[28:31], v[240:243]
    v_mov_b32 v20, v228
    s_waitcnt vmcnt(8)
    s_barrier
    ds_read_b64_tr_b16 a[144:145], v5 offset:0
    ds_read_b64_tr_b16 a[146:147], v5 offset:4096
    ds_read_b64_tr_b16 a[176:177], v5 offset:8192
    ds_read_b64_tr_b16 a[178:179], v5 offset:12288
    ds_read_b64_tr_b16 a[148:149], v6 offset:0
    ds_read_b64_tr_b16 a[150:151], v6 offset:4096
    ds_read_b64_tr_b16 a[180:181], v6 offset:8192
    ds_read_b64_tr_b16 a[182:183], v6 offset:12288
    ds_read_b64_tr_b16 a[152:153], v7 offset:0
    ds_read_b64_tr_b16 a[154:155], v7 offset:4096
    ds_read_b64_tr_b16 a[184:185], v7 offset:8192
    ds_read_b64_tr_b16 a[186:187], v7 offset:12288
    ds_read_b64_tr_b16 a[156:157], v8 offset:0
    ds_read_b64_tr_b16 a[158:159], v8 offset:4096
    ds_read_b64_tr_b16 a[188:189], v8 offset:8192
    ds_read_b64_tr_b16 a[190:191], v8 offset:12288
    ds_read_b64_tr_b16 a[160:161], v9 offset:0
    ds_read_b64_tr_b16 a[162:163], v9 offset:4096
    ds_read_b64_tr_b16 a[192:193], v9 offset:8192
    ds_read_b64_tr_b16 a[194:195], v9 offset:12288
    ds_read_b64_tr_b16 a[164:165], v10 offset:0
    ds_read_b64_tr_b16 a[166:167], v10 offset:4096
    ds_read_b64_tr_b16 a[196:197], v10 offset:8192
    ds_read_b64_tr_b16 a[198:199], v10 offset:12288
    ds_read_b64_tr_b16 a[168:169], v11 offset:0
    ds_read_b64_tr_b16 a[170:171], v11 offset:4096
    ds_read_b64_tr_b16 a[200:201], v11 offset:8192
    ds_read_b64_tr_b16 a[202:203], v11 offset:12288
    ds_read_b64_tr_b16 a[172:173], v12 offset:0
    ds_read_b64_tr_b16 a[174:175], v12 offset:4096
    ds_read_b64_tr_b16 a[204:205], v12 offset:8192
    ds_read_b64_tr_b16 a[206:207], v12 offset:12288
    s_cmp_lg_u32 s33, 0
    s_cbranch_scc1 L_y12_w3
    s_waitcnt vmcnt(0)
L_y12_w3:
    s_add_u32 m0, s99, 0
    s_add_u32 s42, s100, 16384
    buffer_load_dwordx4 v13, s[20:23], s42 offen offset:0 nt lds
    buffer_load_dwordx4 v14, s[20:23], s42 offen offset:1024 nt lds
    buffer_load_dwordx4 v15, s[20:23], s42 offen offset:2048 nt lds
    buffer_load_dwordx4 v16, s[20:23], s42 offen offset:3072 nt lds
    s_waitcnt lgkmcnt(15)
    v_mfma_f32_16x16x32_bf16 v[32:35], a[144:147], v[212:215], 0
    v_exp_f32 v229, v229
    v_mfma_f32_16x16x32_bf16 v[32:35], a[176:179], v[216:219], v[32:35]
    v_add_f32 v20, v20, v229
    v_cvt_pk_bf16_f32 v228, v228, v229
    v_mfma_f32_16x16x32_bf16 v[36:39], a[148:151], v[212:215], 0
    v_exp_f32 v230, v230
    v_mfma_f32_16x16x32_bf16 v[36:39], a[180:183], v[216:219], v[36:39]
    v_add_f32 v20, v20, v230
    v_mfma_f32_16x16x32_bf16 v[40:43], a[152:155], v[212:215], 0
    v_exp_f32 v231, v231
    v_mfma_f32_16x16x32_bf16 v[40:43], a[184:187], v[216:219], v[40:43]
    v_add_f32 v20, v20, v231
    v_cvt_pk_bf16_f32 v229, v230, v231
    v_mfma_f32_16x16x32_bf16 v[44:47], a[156:159], v[212:215], 0
    v_exp_f32 v232, v232
    v_mfma_f32_16x16x32_bf16 v[44:47], a[188:191], v[216:219], v[44:47]
    v_add_f32 v20, v20, v232
    s_waitcnt lgkmcnt(0)
    v_mfma_f32_16x16x32_bf16 v[48:51], a[160:163], v[212:215], 0
    v_exp_f32 v233, v233
    v_mfma_f32_16x16x32_bf16 v[48:51], a[192:195], v[216:219], v[48:51]
    v_add_f32 v20, v20, v233
    v_cvt_pk_bf16_f32 v230, v232, v233
    v_mfma_f32_16x16x32_bf16 v[52:55], a[164:167], v[212:215], 0
    v_exp_f32 v234, v234
    v_mfma_f32_16x16x32_bf16 v[52:55], a[196:199], v[216:219], v[52:55]
    v_add_f32 v20, v20, v234
    v_mfma_f32_16x16x32_bf16 v[56:59], a[168:171], v[212:215], 0
    v_exp_f32 v235, v235
    v_mfma_f32_16x16x32_bf16 v[56:59], a[200:203], v[216:219], v[56:59]
    v_add_f32 v20, v20, v235
    v_cvt_pk_bf16_f32 v231, v234, v235
    v_mfma_f32_16x16x32_bf16 v[60:63], a[172:175], v[212:215], 0
    v_exp_f32 v236, v236
    v_mfma_f32_16x16x32_bf16 v[60:63], a[204:207], v[216:219], v[60:63]
    v_add_f32 v20, v20, v236
    v_add_u32 v252, s43, v1
    v_add_u32 v253, s43, v2
    v_add_u32 v254, s43, v3
    v_add_u32 v255, s43, v4
    s_waitcnt vmcnt(8)
    ds_read_b128 v[160:163], v252 offset:32768
    ds_read_b128 v[164:167], v253 offset:32768
    ds_read_b128 v[168:171], v254 offset:32768
    ds_read_b128 v[172:175], v255 offset:32768
    s_cmp_lg_u32 s33, 0
    s_cbranch_scc1 L_y13_w3
    s_waitcnt vmcnt(0)
L_y13_w3:
    s_and_b32 m0, s28, 0xffff
    s_nop 0
    buffer_load_dwordx4 v13, s[12:15], s28 offen offset:0 nt lds
    buffer_load_dwordx4 v14, s[12:15], s28 offen offset:1024 nt lds
    buffer_load_dwordx4 v15, s[12:15], s28 offen offset:2048 nt lds
    buffer_load_dwordx4 v16, s[12:15], s28 offen offset:3072 nt lds
    s_waitcnt lgkmcnt(3)
    v_lshlrev_b32 v244, 16, v160
    v_lshlrev_b32 v246, 16, v161
    v_lshlrev_b32 v248, 16, v162
    v_lshlrev_b32 v250, 16, v163
    v_and_b32 v245, s37, v160
    v_and_b32 v247, s37, v161
    v_and_b32 v249, s37, v162
    v_and_b32 v251, s37, v163
    v_pk_mul_f32 v[244:245], v[244:245], s[34:35]
    v_pk_mul_f32 v[246:247], v[246:247], s[34:35]
    v_pk_mul_f32 v[248:249], v[248:249], s[34:35]
    v_pk_mul_f32 v[250:251], v[250:251], s[34:35]
    v_cvt_pk_bf16_f32 v244, v244, v245
    v_cvt_pk_bf16_f32 v246, v246, v247
    v_cvt_pk_bf16_f32 v248, v248, v249
    v_cvt_pk_bf16_f32 v250, v250, v251
    v_accvgpr_write_b32 a32, v244
    v_accvgpr_write_b32 a33, v246
    v_accvgpr_write_b32 a34, v248
    v_accvgpr_write_b32 a35, v250
    s_waitcnt lgkmcnt(2)
    v_lshlrev_b32 v244, 16, v164
    v_lshlrev_b32 v246, 16, v165
    v_lshlrev_b32 v248, 16, v166
    v_lshlrev_b32 v250, 16, v167
    v_and_b32 v245, s37, v164
    v_and_b32 v247, s37, v165
    v_and_b32 v249, s37, v166
    v_and_b32 v251, s37, v167
    v_pk_mul_f32 v[244:245], v[244:245], s[34:35]
    v_pk_mul_f32 v[246:247], v[246:247], s[34:35]
    v_pk_mul_f32 v[248:249], v[248:249], s[34:35]
    v_pk_mul_f32 v[250:251], v[250:251], s[34:35]
    v_cvt_pk_bf16_f32 v244, v244, v245
    v_cvt_pk_bf16_f32 v246, v246, v247
    v_cvt_pk_bf16_f32 v248, v248, v249
    v_cvt_pk_bf16_f32 v250, v250, v251
    v_accvgpr_write_b32 a36, v244
    v_accvgpr_write_b32 a37, v246
    v_accvgpr_write_b32 a38, v248
    v_accvgpr_write_b32 a39, v250
    s_waitcnt lgkmcnt(1)
    v_lshlrev_b32 v244, 16, v168
    v_lshlrev_b32 v246, 16, v169
    v_lshlrev_b32 v248, 16, v170
    v_lshlrev_b32 v250, 16, v171
    v_and_b32 v245, s37, v168
    v_and_b32 v247, s37, v169
    v_and_b32 v249, s37, v170
    v_and_b32 v251, s37, v171
    v_pk_mul_f32 v[244:245], v[244:245], s[34:35]
    v_pk_mul_f32 v[246:247], v[246:247], s[34:35]
    v_pk_mul_f32 v[248:249], v[248:249], s[34:35]
    v_pk_mul_f32 v[250:251], v[250:251], s[34:35]
    v_cvt_pk_bf16_f32 v244, v244, v245
    v_cvt_pk_bf16_f32 v246, v246, v247
    v_cvt_pk_bf16_f32 v248, v248, v249
    v_cvt_pk_bf16_f32 v250, v250, v251
    v_accvgpr_write_b32 a40, v244
    v_accvgpr_write_b32 a41, v246
    v_accvgpr_write_b32 a42, v248
    v_accvgpr_write_b32 a43, v250
    s_waitcnt lgkmcnt(0)
    v_lshlrev_b32 v244, 16, v172
    v_lshlrev_b32 v246, 16, v173
    v_lshlrev_b32 v248, 16, v174
    v_lshlrev_b32 v250, 16, v175
    v_and_b32 v245, s37, v172
    v_and_b32 v247, s37, v173
    v_and_b32 v249, s37, v174
    v_and_b32 v251, s37, v175
    v_pk_mul_f32 v[244:245], v[244:245], s[34:35]
    v_pk_mul_f32 v[246:247], v[246:247], s[34:35]
    v_pk_mul_f32 v[248:249], v[248:249], s[34:35]
    v_pk_mul_f32 v[250:251], v[250:251], s[34:35]
    v_cvt_pk_bf16_f32 v244, v244, v245
    v_cvt_pk_bf16_f32 v246, v246, v247
    v_cvt_pk_bf16_f32 v248, v248, v249
    v_cvt_pk_bf16_f32 v250, v250, v251
    v_accvgpr_write_b32 a44, v244
    v_accvgpr_write_b32 a45, v246
    v_accvgpr_write_b32 a46, v248
    v_accvgpr_write_b32 a47, v250
    v_mfma_f32_16x16x32_bf16 v[200:203], a[80:83], a[32:35], 0
    v_mfma_f32_16x16x32_bf16 v[200:203], a[84:87], a[36:39], v[200:203]
    v_mfma_f32_16x16x32_bf16 v[200:203], a[88:91], a[40:43], v[200:203]
    v_mfma_f32_16x16x32_bf16 v[200:203], a[92:95], a[44:47], v[200:203]
    s_nop 7
    v_max3_f32 v244, v200, v201, v202
    v_max_f32 v244, v244, v203
    v_mov_b32 v245, v244
    s_nop 1
    v_permlane16_swap_b32 v244, v245
    v_max_f32 v244, v244, v245
    v_mov_b32 v245, v244
    s_nop 1
    v_permlane32_swap_b32 v244, v245
    v_min_f32 v200, -v244, -v245
    v_min_f32 v201, -v244, -v245
    v_min_f32 v202, -v244, -v245
    v_min_f32 v203, -v244, -v245
    s_nop 1
    v_mfma_f32_16x16x32_bf16 v[212:215], a[80:83], a[32:35], v[200:203]
    v_exp_f32 v237, v237
    v_mfma_f32_16x16x32_bf16 v[212:215], a[84:87], a[36:39], v[212:215]
    v_add_f32 v20, v20, v237
    v_cvt_pk_bf16_f32 v232, v236, v237
    v_mfma_f32_16x16x32_bf16 v[212:215], a[88:91], a[40:43], v[212:215]
    v_exp_f32 v238, v238
    v_mfma_f32_16x16x32_bf16 v[212:215], a[92:95], a[44:47], v[212:215]
    v_add_f32 v20, v20, v238
    v_mfma_f32_16x16x32_bf16 v[216:219], a[96:99], a[32:35], v[200:203]
    v_exp_f32 v239, v239
    v_mfma_f32_16x16x32_bf16 v[216:219], a[100:103], a[36:39], v[216:219]
    v_add_f32 v20, v20, v239
    v_cvt_pk_bf16_f32 v233, v238, v239
    v_mfma_f32_16x16x32_bf16 v[216:219], a[104:107], a[40:43], v[216:219]
    v_exp_f32 v240, v240
    v_mfma_f32_16x16x32_bf16 v[216:219], a[108:111], a[44:47], v[216:219]
    v_add_f32 v20, v20, v240
    v_mfma_f32_16x16x32_bf16 v[220:223], a[112:115], a[32:35], v[200:203]
    v_exp_f32 v241, v241
    v_mfma_f32_16x16x32_bf16 v[220:223], a[116:119], a[36:39], v[220:223]
    v_add_f32 v20, v20, v241
    v_cvt_pk_bf16_f32 v234, v240, v241
    v_mfma_f32_16x16x32_bf16 v[220:223], a[120:123], a[40:43], v[220:223]
    v_exp_f32 v242, v242
    v_mfma_f32_16x16x32_bf16 v[220:223], a[124:127], a[44:47], v[220:223]
    v_add_f32 v20, v20, v242
    v_mfma_f32_16x16x32_bf16 v[224:227], a[128:131], a[32:35], v[200:203]
    v_exp_f32 v243, v243
    v_mfma_f32_16x16x32_bf16 v[224:227], a[132:135], a[36:39], v[224:227]
    v_add_f32 v20, v20, v243
    v_cvt_pk_bf16_f32 v235, v242, v243
    v_mfma_f32_16x16x32_bf16 v[224:227], a[136:139], a[40:43], v[224:227]
    v_exp_f32 v212, v212
    v_mfma_f32_16x16x32_bf16 v[224:227], a[140:143], a[44:47], v[224:227]
    v_mov_b32 v21, v212
    v_mfma_f32_16x16x32_bf16 v[64:67], a[144:147], v[228:231], 0
    v_exp_f32 v213, v213
    v_mfma_f32_16x16x32_bf16 v[64:67], a[176:179], v[232:235], v[64:67]
    v_add_f32 v21, v21, v213
    v_cvt_pk_bf16_f32 v212, v212, v213
    v_mfma_f32_16x16x32_bf16 v[68:71], a[148:151], v[228:231], 0
    v_exp_f32 v214, v214
    v_mfma_f32_16x16x32_bf16 v[68:71], a[180:183], v[232:235], v[68:71]
    v_add_f32 v21, v21, v214
    v_mfma_f32_16x16x32_bf16 v[72:75], a[152:155], v[228:231], 0
    v_exp_f32 v215, v215
    v_mfma_f32_16x16x32_bf16 v[72:75], a[184:187], v[232:235], v[72:75]
    v_add_f32 v21, v21, v215
    v_cvt_pk_bf16_f32 v213, v214, v215
    v_mfma_f32_16x16x32_bf16 v[76:79], a[156:159], v[228:231], 0
    v_exp_f32 v216, v216
    v_mfma_f32_16x16x32_bf16 v[76:79], a[188:191], v[232:235], v[76:79]
    v_add_f32 v21, v21, v216
    v_mfma_f32_16x16x32_bf16 v[80:83], a[160:163], v[228:231], 0
    v_exp_f32 v217, v217
    v_mfma_f32_16x16x32_bf16 v[80:83], a[192:195], v[232:235], v[80:83]
    v_add_f32 v21, v21, v217
    v_cvt_pk_bf16_f32 v214, v216, v217
    v_mfma_f32_16x16x32_bf16 v[84:87], a[164:167], v[228:231], 0
    v_exp_f32 v218, v218
    v_mfma_f32_16x16x32_bf16 v[84:87], a[196:199], v[232:235], v[84:87]
    v_add_f32 v21, v21, v218
    v_mfma_f32_16x16x32_bf16 v[88:91], a[168:171], v[228:231], 0
    v_exp_f32 v219, v219
    v_mfma_f32_16x16x32_bf16 v[88:91], a[200:203], v[232:235], v[88:91]
    v_add_f32 v21, v21, v219
    v_cvt_pk_bf16_f32 v215, v218, v219
    v_mfma_f32_16x16x32_bf16 v[92:95], a[172:175], v[228:231], 0
    v_exp_f32 v220, v220
    v_mfma_f32_16x16x32_bf16 v[92:95], a[204:207], v[232:235], v[92:95]
    v_add_f32 v21, v21, v220
    v_add_u32 v252, s43, v1
    v_add_u32 v253, s43, v2
    v_add_u32 v254, s43, v3
    v_add_u32 v255, s43, v4
    s_waitcnt vmcnt(8)
    ds_read_b128 v[160:163], v252 offset:49152
    ds_read_b128 v[164:167], v253 offset:49152
    ds_read_b128 v[168:171], v254 offset:49152
    ds_read_b128 v[172:175], v255 offset:49152
    s_add_u32 m0, s29, 81920
    s_nop 0
    buffer_load_dwordx4 v17, s[16:19], s28 offen offset:0 nt lds
    buffer_load_dwordx4 v18, s[16:19], s28 offen offset:1024 nt lds
    buffer_load_dwordx4 v17, s[16:19], s28 offen offset:2048 nt lds
    buffer_load_dwordx4 v18, s[16:19], s28 offen offset:3072 nt lds
    s_add_u32 s28, s28, 16384
    s_waitcnt lgkmcnt(3)
    v_lshlrev_b32 v244, 16, v160
    v_lshlrev_b32 v246, 16, v161
    v_lshlrev_b32 v248, 16, v162
    v_lshlrev_b32 v250, 16, v163
    v_and_b32 v245, s37, v160
    v_and_b32 v247, s37, v161
    v_and_b32 v249, s37, v162
    v_and_b32 v251, s37, v163
    v_pk_mul_f32 v[244:245], v[244:245], s[34:35]
    v_pk_mul_f32 v[246:247], v[246:247], s[34:35]
    v_pk_mul_f32 v[248:249], v[248:249], s[34:35]
    v_pk_mul_f32 v[250:251], v[250:251], s[34:35]
    v_cvt_pk_bf16_f32 v244, v244, v245
    v_cvt_pk_bf16_f32 v246, v246, v247
    v_cvt_pk_bf16_f32 v248, v248, v249
    v_cvt_pk_bf16_f32 v250, v250, v251
    v_accvgpr_write_b32 a48, v244
    v_accvgpr_write_b32 a49, v246
    v_accvgpr_write_b32 a50, v248
    v_accvgpr_write_b32 a51, v250
    s_waitcnt lgkmcnt(2)
    v_lshlrev_b32 v244, 16, v164
    v_lshlrev_b32 v246, 16, v165
    v_lshlrev_b32 v248, 16, v166
    v_lshlrev_b32 v250, 16, v167
    v_and_b32 v245, s37, v164
    v_and_b32 v247, s37, v165
    v_and_b32 v249, s37, v166
    v_and_b32 v251, s37, v167
    v_pk_mul_f32 v[244:245], v[244:245], s[34:35]
    v_pk_mul_f32 v[246:247], v[246:247], s[34:35]
    v_pk_mul_f32 v[248:249], v[248:249], s[34:35]
    v_pk_mul_f32 v[250:251], v[250:251], s[34:35]
    v_cvt_pk_bf16_f32 v244, v244, v245
    v_cvt_pk_bf16_f32 v246, v246, v247
    v_cvt_pk_bf16_f32 v248, v248, v249
    v_cvt_pk_bf16_f32 v250, v250, v251
    v_accvgpr_write_b32 a52, v244
    v_accvgpr_write_b32 a53, v246
    v_accvgpr_write_b32 a54, v248
    v_accvgpr_write_b32 a55, v250
    s_waitcnt lgkmcnt(1)
    v_lshlrev_b32 v244, 16, v168
    v_lshlrev_b32 v246, 16, v169
    v_lshlrev_b32 v248, 16, v170
    v_lshlrev_b32 v250, 16, v171
    v_and_b32 v245, s37, v168
    v_and_b32 v247, s37, v169
    v_and_b32 v249, s37, v170
    v_and_b32 v251, s37, v171
    v_pk_mul_f32 v[244:245], v[244:245], s[34:35]
    v_pk_mul_f32 v[246:247], v[246:247], s[34:35]
    v_pk_mul_f32 v[248:249], v[248:249], s[34:35]
    v_pk_mul_f32 v[250:251], v[250:251], s[34:35]
    v_cvt_pk_bf16_f32 v244, v244, v245
    v_cvt_pk_bf16_f32 v246, v246, v247
    v_cvt_pk_bf16_f32 v248, v248, v249
    v_cvt_pk_bf16_f32 v250, v250, v251
    v_accvgpr_write_b32 a56, v244
    v_accvgpr_write_b32 a57, v246
    v_accvgpr_write_b32 a58, v248
    v_accvgpr_write_b32 a59, v250
    s_waitcnt lgkmcnt(0)
    v_lshlrev_b32 v244, 16, v172
    v_lshlrev_b32 v246, 16, v173
    v_lshlrev_b32 v248, 16, v174
    v_lshlrev_b32 v250, 16, v175
    v_and_b32 v245, s37, v172
    v_and_b32 v247, s37, v173
    v_and_b32 v249, s37, v174
    v_and_b32 v251, s37, v175
    v_pk_mul_f32 v[244:245], v[244:245], s[34:35]
    v_pk_mul_f32 v[246:247], v[246:247], s[34:35]
    v_pk_mul_f32 v[248:249], v[248:249], s[34:35]
    v_pk_mul_f32 v[250:251], v[250:251], s[34:35]
    v_cvt_pk_bf16_f32 v244, v244, v245
    v_cvt_pk_bf16_f32 v246, v246, v247
    v_cvt_pk_bf16_f32 v248, v248, v249
    v_cvt_pk_bf16_f32 v250, v250, v251
    v_accvgpr_write_b32 a60, v244
    v_accvgpr_write_b32 a61, v246
    v_accvgpr_write_b32 a62, v248
    v_accvgpr_write_b32 a63, v250
    v_mfma_f32_16x16x32_bf16 v[204:207], a[80:83], a[48:51], 0
    v_mfma_f32_16x16x32_bf16 v[204:207], a[84:87], a[52:55], v[204:207]
    v_mfma_f32_16x16x32_bf16 v[204:207], a[88:91], a[56:59], v[204:207]
    v_mfma_f32_16x16x32_bf16 v[204:207], a[92:95], a[60:63], v[204:207]
    s_nop 7
    v_max3_f32 v244, v204, v205, v206
    v_max_f32 v244, v244, v207
    v_mov_b32 v245, v244
    s_nop 1
    v_permlane16_swap_b32 v244, v245
    v_max_f32 v244, v244, v245
    v_mov_b32 v245, v244
    s_nop 1
    v_permlane32_swap_b32 v244, v245
    v_min_f32 v204, -v244, -v245
    v_min_f32 v205, -v244, -v245
    v_min_f32 v206, -v244, -v245
    v_min_f32 v207, -v244, -v245
    s_nop 1
    v_mfma_f32_16x16x32_bf16 v[228:231], a[80:83], a[48:51], v[204:207]
    v_exp_f32 v221, v221
    v_mfma_f32_16x16x32_bf16 v[228:231], a[84:87], a[52:55], v[228:231]
    v_add_f32 v21, v21, v221
    v_cvt_pk_bf16_f32 v216, v220, v221
    v_mfma_f32_16x16x32_bf16 v[228:231], a[88:91], a[56:59], v[228:231]
    v_exp_f32 v222, v222
    v_mfma_f32_16x16x32_bf16 v[228:231], a[92:95], a[60:63], v[228:231]
    v_add_f32 v21, v21, v222
    v_mfma_f32_16x16x32_bf16 v[232:235], a[96:99], a[48:51], v[204:207]
    v_exp_f32 v223, v223
    v_mfma_f32_16x16x32_bf16 v[232:235], a[100:103], a[52:55], v[232:235]
    v_add_f32 v21, v21, v223
    v_cvt_pk_bf16_f32 v217, v222, v223
    v_mfma_f32_16x16x32_bf16 v[232:235], a[104:107], a[56:59], v[232:235]
    v_exp_f32 v224, v224
    v_mfma_f32_16x16x32_bf16 v[232:235], a[108:111], a[60:63], v[232:235]
    v_add_f32 v21, v21, v224
    v_mfma_f32_16x16x32_bf16 v[236:239], a[112:115], a[48:51], v[204:207]
    v_exp_f32 v225, v225
    v_mfma_f32_16x16x32_bf16 v[236:239], a[116:119], a[52:55], v[236:239]
    v_add_f32 v21, v21, v225
    v_cvt_pk_bf16_f32 v218, v224, v225
    v_mfma_f32_16x16x32_bf16 v[236:239], a[120:123], a[56:59], v[236:239]
    v_exp_f32 v226, v226
    v_mfma_f32_16x16x32_bf16 v[236:239], a[124:127], a[60:63], v[236:239]
    v_add_f32 v21, v21, v226
    v_mfma_f32_16x16x32_bf16 v[240:243], a[128:131], a[48:51], v[204:207]
    v_exp_f32 v227, v227
    v_mfma_f32_16x16x32_bf16 v[240:243], a[132:135], a[52:55], v[240:243]
    v_add_f32 v21, v21, v227
    v_cvt_pk_bf16_f32 v219, v226, v227
    v_mfma_f32_16x16x32_bf16 v[240:243], a[136:139], a[56:59], v[240:243]
    v_exp_f32 v228, v228
    v_mfma_f32_16x16x32_bf16 v[240:243], a[140:143], a[60:63], v[240:243]
    v_mov_b32 v22, v228
    v_mfma_f32_16x16x32_bf16 v[96:99], a[144:147], v[212:215], 0
    v_exp_f32 v229, v229
    v_mfma_f32_16x16x32_bf16 v[96:99], a[176:179], v[216:219], v[96:99]
    v_add_f32 v22, v22, v229
    v_cvt_pk_bf16_f32 v228, v228, v229
    v_mfma_f32_16x16x32_bf16 v[100:103], a[148:151], v[212:215], 0
    v_exp_f32 v230, v230
    v_mfma_f32_16x16x32_bf16 v[100:103], a[180:183], v[216:219], v[100:103]
    v_add_f32 v22, v22, v230
    v_mfma_f32_16x16x32_bf16 v[104:107], a[152:155], v[212:215], 0
    v_exp_f32 v231, v231
    v_mfma_f32_16x16x32_bf16 v[104:107], a[184:187], v[216:219], v[104:107]
    v_add_f32 v22, v22, v231
    v_cvt_pk_bf16_f32 v229, v230, v231
    v_mfma_f32_16x16x32_bf16 v[108:111], a[156:159], v[212:215], 0
    v_exp_f32 v232, v232
    v_mfma_f32_16x16x32_bf16 v[108:111], a[188:191], v[216:219], v[108:111]
    v_add_f32 v22, v22, v232
    v_mfma_f32_16x16x32_bf16 v[112:115], a[160:163], v[212:215], 0
    v_exp_f32 v233, v233
    v_mfma_f32_16x16x32_bf16 v[112:115], a[192:195], v[216:219], v[112:115]
    v_add_f32 v22, v22, v233
    v_cvt_pk_bf16_f32 v230, v232, v233
    v_mfma_f32_16x16x32_bf16 v[116:119], a[164:167], v[212:215], 0
    v_exp_f32 v234, v234
    v_mfma_f32_16x16x32_bf16 v[116:119], a[196:199], v[216:219], v[116:119]
    v_add_f32 v22, v22, v234
    v_mfma_f32_16x16x32_bf16 v[120:123], a[168:171], v[212:215], 0
    v_exp_f32 v235, v235
    v_mfma_f32_16x16x32_bf16 v[120:123], a[200:203], v[216:219], v[120:123]
    v_add_f32 v22, v22, v235
    v_cvt_pk_bf16_f32 v231, v234, v235
    v_mfma_f32_16x16x32_bf16 v[124:127], a[172:175], v[212:215], 0
    v_exp_f32 v236, v236
    v_mfma_f32_16x16x32_bf16 v[124:127], a[204:207], v[216:219], v[124:127]
    v_add_f32 v22, v22, v236
    v_add_u32 v252, s99, v1
    v_add_u32 v253, s99, v2
    v_add_u32 v254, s99, v3
    v_add_u32 v255, s99, v4
    s_waitcnt vmcnt(8)
    ds_read_b128 v[160:163], v252 offset:0
    ds_read_b128 v[164:167], v253 offset:0
    ds_read_b128 v[168:171], v254 offset:0
    ds_read_b128 v[172:175], v255 offset:0
    s_and_b32 m0, s28, 0xffff
    s_nop 0
    buffer_load_dwordx4 v13, s[12:15], s28 offen offset:0 nt lds
    buffer_load_dwordx4 v14, s[12:15], s28 offen offset:1024 nt lds
    buffer_load_dwordx4 v15, s[12:15], s28 offen offset:2048 nt lds
    buffer_load_dwordx4 v16, s[12:15], s28 offen offset:3072 nt lds
    v_mfma_f32_16x16x32_bf16 v[208:211], a[80:83], a[64:67], 0
    v_mfma_f32_16x16x32_bf16 v[208:211], a[84:87], a[68:71], v[208:211]
    v_mfma_f32_16x16x32_bf16 v[208:211], a[88:91], a[72:75], v[208:211]
    v_mfma_f32_16x16x32_bf16 v[208:211], a[92:95], a[76:79], v[208:211]
    s_nop 7
    v_max3_f32 v244, v208, v209, v210
    v_max_f32 v244, v244, v211
    v_mov_b32 v245, v244
    s_nop 1
    v_permlane16_swap_b32 v244, v245
    v_max_f32 v244, v244, v245
    v_mov_b32 v245, v244
    s_nop 1
    v_permlane32_swap_b32 v244, v245
    v_min_f32 v208, -v244, -v245
    v_min_f32 v209, -v244, -v245
    v_min_f32 v210, -v244, -v245
    v_min_f32 v211, -v244, -v245
    s_cmp_lg_u32 s32, 3
    s_cbranch_scc1 L_nda_w3
    v_mov_b32 v208, 0xf149f2ca
    v_mov_b32 v209, 0xf149f2ca
    v_mov_b32 v210, 0xf149f2ca
    v_mov_b32 v211, 0xf149f2ca
L_nda_w3:
    s_nop 1
    v_exp_f32 v237, v237
    s_nop 0
    v_add_f32 v22, v22, v237
    v_cvt_pk_bf16_f32 v232, v236, v237
    v_exp_f32 v238, v238
    s_nop 0
    v_add_f32 v22, v22, v238
    v_exp_f32 v239, v239
    s_nop 0
    v_add_f32 v22, v22, v239
    v_cvt_pk_bf16_f32 v233, v238, v239
    v_exp_f32 v240, v240
    s_nop 0
    v_add_f32 v22, v22, v240
    v_exp_f32 v241, v241
    s_nop 0
    v_add_f32 v22, v22, v241
    v_cvt_pk_bf16_f32 v234, v240, v241
    v_exp_f32 v242, v242
    s_nop 0
    v_add_f32 v22, v22, v242
    v_exp_f32 v243, v243
    s_nop 0
    v_add_f32 v22, v22, v243
    v_cvt_pk_bf16_f32 v235, v242, v243
    s_waitcnt vmcnt(8)
    s_barrier
    v_mfma_f32_16x16x32_bf16 v[128:131], a[144:147], v[228:231], 0
    ds_read_b128 a[80:83], v1 offset:16384
    s_add_u32 m0, s29, 98304
    v_mfma_f32_16x16x32_bf16 v[128:131], a[176:179], v[232:235], v[128:131]
    ds_read_b128 a[84:87], v2 offset:16384
    v_mfma_f32_16x16x32_bf16 v[132:135], a[148:151], v[228:231], 0
    ds_read_b128 a[88:91], v3 offset:16384
    buffer_load_dwordx4 v17, s[16:19], s28 offen offset:0 nt lds
    v_mfma_f32_16x16x32_bf16 v[132:135], a[180:183], v[232:235], v[132:135]
    ds_read_b128 a[92:95], v4 offset:16384
    v_mfma_f32_16x16x32_bf16 v[136:139], a[152:155], v[228:231], 0
    ds_read_b128 a[96:99], v1 offset:20480
    v_mfma_f32_16x16x32_bf16 v[136:139], a[184:187], v[232:235], v[136:139]
    ds_read_b128 a[100:103], v2 offset:20480
    v_mfma_f32_16x16x32_bf16 v[140:143], a[156:159], v[228:231], 0
    ds_read_b128 a[104:107], v3 offset:20480
    buffer_load_dwordx4 v18, s[16:19], s28 offen offset:1024 nt lds
    v_mfma_f32_16x16x32_bf16 v[140:143], a[188:191], v[232:235], v[140:143]
    ds_read_b128 a[108:111], v4 offset:20480
    v_mfma_f32_16x16x32_bf16 v[144:147], a[160:163], v[228:231], 0
    ds_read_b128 a[112:115], v1 offset:24576
    v_mfma_f32_16x16x32_bf16 v[144:147], a[192:195], v[232:235], v[144:147]
    ds_read_b128 a[116:119], v2 offset:24576
    v_mfma_f32_16x16x32_bf16 v[148:151], a[164:167], v[228:231], 0
    ds_read_b128 a[120:123], v3 offset:24576
    buffer_load_dwordx4 v17, s[16:19], s28 offen offset:2048 nt lds
    v_mfma_f32_16x16x32_bf16 v[148:151], a[196:199], v[232:235], v[148:151]
    ds_read_b128 a[124:127], v4 offset:24576
    v_mfma_f32_16x16x32_bf16 v[152:155], a[168:171], v[228:231], 0
    ds_read_b128 a[128:131], v1 offset:28672
    v_mfma_f32_16x16x32_bf16 v[152:155], a[200:203], v[232:235], v[152:155]
    ds_read_b128 a[132:135], v2 offset:28672
    v_mfma_f32_16x16x32_bf16 v[156:159], a[172:175], v[228:231], 0
    ds_read_b128 a[136:139], v3 offset:28672
    buffer_load_dwordx4 v18, s[16:19], s28 offen offset:3072 nt lds
    s_add_u32 s28, s28, 16384
    v_mfma_f32_16x16x32_bf16 v[156:159], a[204:207], v[232:235], v[156:159]
    ds_read_b128 a[140:143], v4 offset:28672
    s_add_u32 s20, s4, s41
    s_addc_u32 s21, s5, 0
    s_and_b32 s21, s21, 0xffff
    s_mov_b32 s22, 77824
    s_waitcnt vmcnt(8)
    s_barrier
    s_branch L_b1_w3
.p2align 6
L_qa3_w3:
    s_waitcnt lgkmcnt(4)
    v_mfma_f32_16x16x32_bf16 v[212:215], a[80:83], a[0:3], v[192:195]
    v_mfma_f32_16x16x32_bf16 v[212:215], a[84:87], a[4:7], v[212:215]
    v_mfma_f32_16x16x32_bf16 v[212:215], a[88:91], a[8:11], v[212:215]
    s_add_u32 m0, s99, 0
    s_add_u32 s42, s100, 8192
    v_mfma_f32_16x16x32_bf16 v[212:215], a[92:95], a[12:15], v[212:215]
    buffer_load_dwordx4 v16, s[20:23], s42 offen offset:3072 nt lds
    v_mfma_f32_16x16x32_bf16 v[216:219], a[96:99], a[0:3], v[192:195]
    v_mfma_f32_16x16x32_bf16 v[216:219], a[100:103], a[4:7], v[216:219]
    v_mfma_f32_16x16x32_bf16 v[216:219], a[104:107], a[8:11], v[216:219]
    v_mfma_f32_16x16x32_bf16 v[216:219], a[108:111], a[12:15], v[216:219]
    v_mfma_f32_16x16x32_bf16 v[220:223], a[112:115], a[0:3], v[192:195]
    s_add_u32 m0, s99, 4096
    s_add_u32 s42, s100, 12288
    v_mfma_f32_16x16x32_bf16 v[220:223], a[116:119], a[4:7], v[220:223]
    buffer_load_dwordx4 v13, s[20:23], s42 offen offset:0 nt lds
    v_mfma_f32_16x16x32_bf16 v[220:223], a[120:123], a[8:11], v[220:223]
    v_mfma_f32_16x16x32_bf16 v[220:223], a[124:127], a[12:15], v[220:223]
    s_waitcnt lgkmcnt(0)
    v_mfma_f32_16x16x32_bf16 v[224:227], a[128:131], a[0:3], v[192:195]
    v_mfma_f32_16x16x32_bf16 v[224:227], a[132:135], a[4:7], v[224:227]
    v_mfma_f32_16x16x32_bf16 v[224:227], a[136:139], a[8:11], v[224:227]
    v_exp_f32 v212, v212
    v_mfma_f32_16x16x32_bf16 v[224:227], a[140:143], a[12:15], v[224:227]
    buffer_load_dwordx4 v14, s[20:23], s42 offen offset:1024 nt lds
    v_add_f32 v19, v19, v212
    s_branch L_b0g1_w3
L_qa2_w3:
    s_waitcnt lgkmcnt(4)
    v_mfma_f32_16x16x32_bf16 v[212:215], a[80:83], a[0:3], v[192:195]
    v_add_u32 v244, s99, v1
    v_add_u32 v245, s99, v2
    v_mfma_f32_16x16x32_bf16 v[212:215], a[84:87], a[4:7], v[212:215]
    v_add_u32 v246, s99, v3
    v_add_u32 v247, s99, v4
    v_mfma_f32_16x16x32_bf16 v[212:215], a[88:91], a[8:11], v[212:215]
    ds_read_b128 a[224:227], v244 offset:4096
    ds_read_b128 a[228:231], v245 offset:4096
    s_add_u32 m0, s99, 0
    s_add_u32 s42, s100, 16384
    v_mfma_f32_16x16x32_bf16 v[212:215], a[92:95], a[12:15], v[212:215]
    buffer_load_dwordx4 v14, s[20:23], s42 offen offset:1024 nt lds
    v_mfma_f32_16x16x32_bf16 v[216:219], a[96:99], a[0:3], v[192:195]
    ds_read_b128 a[232:235], v246 offset:4096
    v_mfma_f32_16x16x32_bf16 v[216:219], a[100:103], a[4:7], v[216:219]
    ds_read_b128 a[236:239], v247 offset:4096
    v_mfma_f32_16x16x32_bf16 v[216:219], a[104:107], a[8:11], v[216:219]
    v_mfma_f32_16x16x32_bf16 v[216:219], a[108:111], a[12:15], v[216:219]
    v_mfma_f32_16x16x32_bf16 v[220:223], a[112:115], a[0:3], v[192:195]
    v_mfma_f32_16x16x32_bf16 v[220:223], a[116:119], a[4:7], v[220:223]
    buffer_load_dwordx4 v15, s[20:23], s42 offen offset:2048 nt lds
    v_mfma_f32_16x16x32_bf16 v[220:223], a[120:123], a[8:11], v[220:223]
    v_mfma_f32_16x16x32_bf16 v[220:223], a[124:127], a[12:15], v[220:223]
    s_waitcnt lgkmcnt(2)
    v_mfma_f32_16x16x32_bf16 v[224:227], a[128:131], a[0:3], v[192:195]
    v_mfma_f32_16x16x32_bf16 v[224:227], a[132:135], a[4:7], v[224:227]
    v_accvgpr_read_b32 v245, a224
    v_accvgpr_read_b32 v247, a225
    v_accvgpr_read_b32 v249, a226
    v_accvgpr_read_b32 v251, a227
    v_lshlrev_b32 v244, 16, v245
    v_lshlrev_b32 v246, 16, v247
    v_lshlrev_b32 v248, 16, v249
    v_lshlrev_b32 v250, 16, v251
    v_and_b32 v245, s37, v245
    v_and_b32 v247, s37, v247
    v_and_b32 v249, s37, v249
    v_and_b32 v251, s37, v251
    v_pk_mul_f32 v[244:245], v[244:245], s[34:35]
    v_pk_mul_f32 v[246:247], v[246:247], s[34:35]
    v_pk_mul_f32 v[248:249], v[248:249], s[34:35]
    v_pk_mul_f32 v[250:251], v[250:251], s[34:35]
    v_cvt_pk_bf16_f32 v244, v244, v245
    v_cvt_pk_bf16_f32 v246, v246, v247
    v_cvt_pk_bf16_f32 v248, v248, v249
    v_cvt_pk_bf16_f32 v250, v250, v251
    v_accvgpr_write_b32 a224, v244
    v_accvgpr_write_b32 a225, v246
    v_accvgpr_write_b32 a226, v248
    v_accvgpr_write_b32 a227, v250
    v_accvgpr_read_b32 v245, a228
    v_accvgpr_read_b32 v247, a229
    v_accvgpr_read_b32 v249, a230
    v_accvgpr_read_b32 v251, a231
    v_lshlrev_b32 v244, 16, v245
    v_lshlrev_b32 v246, 16, v247
    v_lshlrev_b32 v248, 16, v249
    v_lshlrev_b32 v250, 16, v251
    v_and_b32 v245, s37, v245
    v_and_b32 v247, s37, v247
    v_and_b32 v249, s37, v249
    v_and_b32 v251, s37, v251
    v_pk_mul_f32 v[244:245], v[244:245], s[34:35]
    v_pk_mul_f32 v[246:247], v[246:247], s[34:35]
    v_pk_mul_f32 v[248:249], v[248:249], s[34:35]
    v_pk_mul_f32 v[250:251], v[250:251], s[34:35]
    v_cvt_pk_bf16_f32 v244, v244, v245
    v_cvt_pk_bf16_f32 v246, v246, v247
    v_cvt_pk_bf16_f32 v248, v248, v249
    v_cvt_pk_bf16_f32 v250, v250, v251
    v_accvgpr_write_b32 a228, v244
    v_accvgpr_write_b32 a229, v246
    v_accvgpr_write_b32 a230, v248
    v_accvgpr_write_b32 a231, v250
    s_waitcnt lgkmcnt(0)
    v_accvgpr_read_b32 v245, a232
    v_accvgpr_read_b32 v247, a233
    v_accvgpr_read_b32 v249, a234
    v_accvgpr_read_b32 v251, a235
    v_lshlrev_b32 v244, 16, v245
    v_lshlrev_b32 v246, 16, v247
    v_lshlrev_b32 v248, 16, v249
    v_lshlrev_b32 v250, 16, v251
    v_and_b32 v245, s37, v245
    v_and_b32 v247, s37, v247
    v_and_b32 v249, s37, v249
    v_and_b32 v251, s37, v251
    v_pk_mul_f32 v[244:245], v[244:245], s[34:35]
    v_pk_mul_f32 v[246:247], v[246:247], s[34:35]
    v_pk_mul_f32 v[248:249], v[248:249], s[34:35]
    v_pk_mul_f32 v[250:251], v[250:251], s[34:35]
    v_cvt_pk_bf16_f32 v244, v244, v245
    v_cvt_pk_bf16_f32 v246, v246, v247
    v_cvt_pk_bf16_f32 v248, v248, v249
    v_cvt_pk_bf16_f32 v250, v250, v251
    v_accvgpr_write_b32 a232, v244
    v_accvgpr_write_b32 a233, v246
    v_accvgpr_write_b32 a234, v248
    v_accvgpr_write_b32 a235, v250
    v_accvgpr_read_b32 v245, a236
    v_accvgpr_read_b32 v247, a237
    v_accvgpr_read_b32 v249, a238
    v_accvgpr_read_b32 v251, a239
    v_lshlrev_b32 v244, 16, v245
    v_lshlrev_b32 v246, 16, v247
    v_lshlrev_b32 v248, 16, v249
    v_lshlrev_b32 v250, 16, v251
    v_and_b32 v245, s37, v245
    v_and_b32 v247, s37, v247
    v_and_b32 v249, s37, v249
    v_and_b32 v251, s37, v251
    v_pk_mul_f32 v[244:245], v[244:245], s[34:35]
    v_pk_mul_f32 v[246:247], v[246:247], s[34:35]
    v_pk_mul_f32 v[248:249], v[248:249], s[34:35]
    v_pk_mul_f32 v[250:251], v[250:251], s[34:35]
    v_cvt_pk_bf16_f32 v244, v244, v245
    v_cvt_pk_bf16_f32 v246, v246, v247
    v_cvt_pk_bf16_f32 v248, v248, v249
    v_cvt_pk_bf16_f32 v250, v250, v251
    v_accvgpr_write_b32 a236, v244
    v_accvgpr_write_b32 a237, v246
    v_accvgpr_write_b32 a238, v248
    v_accvgpr_write_b32 a239, v250
    v_mfma_f32_16x16x32_bf16 v[224:227], a[136:139], a[8:11], v[224:227]
    v_exp_f32 v212, v212
    v_mfma_f32_16x16x32_bf16 v[224:227], a[140:143], a[12:15], v[224:227]
    buffer_load_dwordx4 v16, s[20:23], s42 offen offset:3072 nt lds
    v_add_f32 v19, v19, v212
    s_branch L_b0g1_w3
L_qb3_w3:
    s_waitcnt lgkmcnt(4)
    v_mfma_f32_16x16x32_bf16 v[212:215], a[80:83], a[0:3], v[192:195]
    v_mfma_f32_16x16x32_bf16 v[212:215], a[84:87], a[4:7], v[212:215]
    v_mfma_f32_16x16x32_bf16 v[212:215], a[88:91], a[8:11], v[212:215]
    s_add_u32 s101, s100, 12288
    v_mfma_f32_16x16x32_bf16 v[212:215], a[92:95], a[12:15], v[212:215]
    buffer_store_dwordx4 a[224:227], v26, s[24:27], s101 offen offset:0 sc1
    v_mfma_f32_16x16x32_bf16 v[216:219], a[96:99], a[0:3], v[192:195]
    v_mfma_f32_16x16x32_bf16 v[216:219], a[100:103], a[4:7], v[216:219]
    v_mfma_f32_16x16x32_bf16 v[216:219], a[104:107], a[8:11], v[216:219]
    v_mfma_f32_16x16x32_bf16 v[216:219], a[108:111], a[12:15], v[216:219]
    v_mfma_f32_16x16x32_bf16 v[220:223], a[112:115], a[0:3], v[192:195]
    v_mfma_f32_16x16x32_bf16 v[220:223], a[116:119], a[4:7], v[220:223]
    buffer_store_dwordx4 a[228:231], v26, s[24:27], s101 offen offset:1024 sc1
    v_mfma_f32_16x16x32_bf16 v[220:223], a[120:123], a[8:11], v[220:223]
    v_mfma_f32_16x16x32_bf16 v[220:223], a[124:127], a[12:15], v[220:223]
    s_waitcnt lgkmcnt(0)
    v_mfma_f32_16x16x32_bf16 v[224:227], a[128:131], a[0:3], v[192:195]
    v_mfma_f32_16x16x32_bf16 v[224:227], a[132:135], a[4:7], v[224:227]
    v_mfma_f32_16x16x32_bf16 v[224:227], a[136:139], a[8:11], v[224:227]
    v_exp_f32 v212, v212
    v_mfma_f32_16x16x32_bf16 v[224:227], a[140:143], a[12:15], v[224:227]
    v_add_f32 v19, v19, v212
    s_branch L_b0g1_w3
L_qb2_w3:
    s_waitcnt lgkmcnt(4)
    v_mfma_f32_16x16x32_bf16 v[212:215], a[80:83], a[0:3], v[192:195]
    v_mfma_f32_16x16x32_bf16 v[212:215], a[84:87], a[4:7], v[212:215]
    v_mfma_f32_16x16x32_bf16 v[212:215], a[88:91], a[8:11], v[212:215]
    s_add_u32 s101, s100, 12288
    v_mfma_f32_16x16x32_bf16 v[212:215], a[92:95], a[12:15], v[212:215]
    buffer_store_dwordx4 a[232:235], v26, s[24:27], s101 offen offset:2048 sc1
    v_mfma_f32_16x16x32_bf16 v[216:219], a[96:99], a[0:3], v[192:195]
    v_mfma_f32_16x16x32_bf16 v[216:219], a[100:103], a[4:7], v[216:219]
    v_mfma_f32_16x16x32_bf16 v[216:219], a[104:107], a[8:11], v[216:219]
    v_mfma_f32_16x16x32_bf16 v[216:219], a[108:111], a[12:15], v[216:219]
    v_mfma_f32_16x16x32_bf16 v[220:223], a[112:115], a[0:3], v[192:195]
    v_mfma_f32_16x16x32_bf16 v[220:223], a[116:119], a[4:7], v[220:223]
    buffer_store_dwordx4 a[236:239], v26, s[24:27], s101 offen offset:3072 sc1
    v_mfma_f32_16x16x32_bf16 v[220:223], a[120:123], a[8:11], v[220:223]
    v_mfma_f32_16x16x32_bf16 v[220:223], a[124:127], a[12:15], v[220:223]
    s_waitcnt lgkmcnt(0)
    v_mfma_f32_16x16x32_bf16 v[224:227], a[128:131], a[0:3], v[192:195]
    v_mfma_f32_16x16x32_bf16 v[224:227], a[132:135], a[4:7], v[224:227]
    v_mfma_f32_16x16x32_bf16 v[224:227], a[136:139], a[8:11], v[224:227]
    s_add_u32 s101, s100, 16384
    v_exp_f32 v212, v212
    v_mfma_f32_16x16x32_bf16 v[224:227], a[140:143], a[12:15], v[224:227]
    buffer_store_dwordx4 a[240:243], v26, s[24:27], s101 offen offset:0 sc1
    v_add_f32 v19, v19, v212
    s_branch L_b0g1_w3
L_qb1_w3:
    s_waitcnt lgkmcnt(4)
    v_mfma_f32_16x16x32_bf16 v[212:215], a[80:83], a[0:3], v[192:195]
    v_mfma_f32_16x16x32_bf16 v[212:215], a[84:87], a[4:7], v[212:215]
    v_mfma_f32_16x16x32_bf16 v[212:215], a[88:91], a[8:11], v[212:215]
    s_add_u32 s101, s100, 16384
    v_mfma_f32_16x16x32_bf16 v[212:215], a[92:95], a[12:15], v[212:215]
    buffer_store_dwordx4 a[244:247], v26, s[24:27], s101 offen offset:1024 sc1
    v_mfma_f32_16x16x32_bf16 v[216:219], a[96:99], a[0:3], v[192:195]
    v_mfma_f32_16x16x32_bf16 v[216:219], a[100:103], a[4:7], v[216:219]
    v_mfma_f32_16x16x32_bf16 v[216:219], a[104:107], a[8:11], v[216:219]
    v_mfma_f32_16x16x32_bf16 v[216:219], a[108:111], a[12:15], v[216:219]
    v_mfma_f32_16x16x32_bf16 v[220:223], a[112:115], a[0:3], v[192:195]
    v_mfma_f32_16x16x32_bf16 v[220:223], a[116:119], a[4:7], v[220:223]
    buffer_store_dwordx4 a[248:251], v26, s[24:27], s101 offen offset:2048 sc1
    v_mfma_f32_16x16x32_bf16 v[220:223], a[120:123], a[8:11], v[220:223]
    v_mfma_f32_16x16x32_bf16 v[220:223], a[124:127], a[12:15], v[220:223]
    s_waitcnt lgkmcnt(0)
    v_mfma_f32_16x16x32_bf16 v[224:227], a[128:131], a[0:3], v[192:195]
    v_mfma_f32_16x16x32_bf16 v[224:227], a[132:135], a[4:7], v[224:227]
    v_mfma_f32_16x16x32_bf16 v[224:227], a[136:139], a[8:11], v[224:227]
    v_exp_f32 v212, v212
    v_mfma_f32_16x16x32_bf16 v[224:227], a[140:143], a[12:15], v[224:227]
    buffer_store_dwordx4 a[252:255], v26, s[24:27], s101 offen offset:3072 sc1
    v_add_f32 v19, v19, v212
    s_branch L_b0g1_w3
L_qa1_w3:
    s_waitcnt lgkmcnt(4)
    v_mfma_f32_16x16x32_bf16 v[212:215], a[80:83], a[0:3], v[192:195]
    v_mfma_f32_16x16x32_bf16 v[212:215], a[84:87], a[4:7], v[212:215]
    v_mfma_f32_16x16x32_bf16 v[212:215], a[88:91], a[8:11], v[212:215]
    s_add_u32 m0, s99, 4096
    s_add_u32 s42, s100, 0
    v_mfma_f32_16x16x32_bf16 v[212:215], a[92:95], a[12:15], v[212:215]
    buffer_load_dwordx4 v16, s[20:23], s42 offen offset:3072 nt lds
    v_mfma_f32_16x16x32_bf16 v[216:219], a[96:99], a[0:3], v[192:195]
    v_mfma_f32_16x16x32_bf16 v[216:219], a[100:103], a[4:7], v[216:219]
    v_mfma_f32_16x16x32_bf16 v[216:219], a[104:107], a[8:11], v[216:219]
    v_mfma_f32_16x16x32_bf16 v[216:219], a[108:111], a[12:15], v[216:219]
    v_mfma_f32_16x16x32_bf16 v[220:223], a[112:115], a[0:3], v[192:195]
    s_add_u32 m0, s99, 0
    s_add_u32 s42, s100, 4096
    v_mfma_f32_16x16x32_bf16 v[220:223], a[116:119], a[4:7], v[220:223]
    buffer_load_dwordx4 v13, s[20:23], s42 offen offset:0 nt lds
    v_mfma_f32_16x16x32_bf16 v[220:223], a[120:123], a[8:11], v[220:223]
    v_mfma_f32_16x16x32_bf16 v[220:223], a[124:127], a[12:15], v[220:223]
    s_waitcnt lgkmcnt(0)
    v_mfma_f32_16x16x32_bf16 v[224:227], a[128:131], a[0:3], v[192:195]
    v_mfma_f32_16x16x32_bf16 v[224:227], a[132:135], a[4:7], v[224:227]
    v_mfma_f32_16x16x32_bf16 v[224:227], a[136:139], a[8:11], v[224:227]
    v_exp_f32 v212, v212
    v_mfma_f32_16x16x32_bf16 v[224:227], a[140:143], a[12:15], v[224:227]
    buffer_load_dwordx4 v14, s[20:23], s42 offen offset:1024 nt lds
    v_add_f32 v19, v19, v212
L_b0g1_w3:
    v_exp_f32 v213, v213
    ds_read_b64_tr_b16 a[144:145], v5 offset:0
    ds_read_b64_tr_b16 a[146:147], v5 offset:4096
    v_add_f32 v19, v19, v213
    v_cvt_pk_bf16_f32 v212, v212, v213
    v_exp_f32 v214, v214
    ds_read_b64_tr_b16 a[176:177], v5 offset:8192
    ds_read_b64_tr_b16 a[178:179], v5 offset:12288
    v_add_f32 v19, v19, v214
    v_exp_f32 v215, v215
    ds_read_b64_tr_b16 a[148:149], v6 offset:0
    ds_read_b64_tr_b16 a[150:151], v6 offset:4096
    v_add_f32 v19, v19, v215
    v_cvt_pk_bf16_f32 v213, v214, v215
    v_exp_f32 v216, v216
    ds_read_b64_tr_b16 a[180:181], v6 offset:8192
    ds_read_b64_tr_b16 a[182:183], v6 offset:12288
    v_add_f32 v19, v19, v216
    v_exp_f32 v217, v217
    ds_read_b64_tr_b16 a[152:153], v7 offset:0
    ds_read_b64_tr_b16 a[154:155], v7 offset:4096
    v_add_f32 v19, v19, v217
    v_cvt_pk_bf16_f32 v214, v216, v217
    v_exp_f32 v218, v218
    ds_read_b64_tr_b16 a[184:185], v7 offset:8192
    ds_read_b64_tr_b16 a[186:187], v7 offset:12288
    v_add_f32 v19, v19, v218
    v_exp_f32 v219, v219
    ds_read_b64_tr_b16 a[156:157], v8 offset:0
    ds_read_b64_tr_b16 a[158:159], v8 offset:4096
    v_add_f32 v19, v19, v219
    v_cvt_pk_bf16_f32 v215, v218, v219
    v_exp_f32 v220, v220
    ds_read_b64_tr_b16 a[188:189], v8 offset:8192
    ds_read_b64_tr_b16 a[190:191], v8 offset:12288
    v_add_f32 v19, v19, v220
    v_mfma_f32_16x16x32_bf16 v[228:231], a[80:83], a[16:19], v[196:199]
    v_exp_f32 v221, v221
    v_mfma_f32_16x16x32_bf16 v[228:231], a[84:87], a[20:23], v[228:231]
    ds_read_b64_tr_b16 a[160:161], v9 offset:0
    ds_read_b64_tr_b16 a[162:163], v9 offset:4096
    v_add_f32 v19, v19, v221
    v_cvt_pk_bf16_f32 v216, v220, v221
    v_mfma_f32_16x16x32_bf16 v[228:231], a[88:91], a[24:27], v[228:231]
    v_exp_f32 v222, v222
    v_mfma_f32_16x16x32_bf16 v[228:231], a[92:95], a[28:31], v[228:231]
    ds_read_b64_tr_b16 a[192:193], v9 offset:8192
    ds_read_b64_tr_b16 a[194:195], v9 offset:12288
    v_add_f32 v19, v19, v222
    v_mfma_f32_16x16x32_bf16 v[232:235], a[96:99], a[16:19], v[196:199]
    v_exp_f32 v223, v223
    v_mfma_f32_16x16x32_bf16 v[232:235], a[100:103], a[20:23], v[232:235]
    ds_read_b64_tr_b16 a[164:165], v10 offset:0
    ds_read_b64_tr_b16 a[166:167], v10 offset:4096
    v_add_f32 v19, v19, v223
    v_cvt_pk_bf16_f32 v217, v222, v223
    v_mfma_f32_16x16x32_bf16 v[232:235], a[104:107], a[24:27], v[232:235]
    v_exp_f32 v224, v224
    v_mfma_f32_16x16x32_bf16 v[232:235], a[108:111], a[28:31], v[232:235]
    ds_read_b64_tr_b16 a[196:197], v10 offset:8192
    ds_read_b64_tr_b16 a[198:199], v10 offset:12288
    v_add_f32 v19, v19, v224
    v_mfma_f32_16x16x32_bf16 v[236:239], a[112:115], a[16:19], v[196:199]
    v_exp_f32 v225, v225
    v_mfma_f32_16x16x32_bf16 v[236:239], a[116:119], a[20:23], v[236:239]
    ds_read_b64_tr_b16 a[168:169], v11 offset:0
    ds_read_b64_tr_b16 a[170:171], v11 offset:4096
    v_add_f32 v19, v19, v225
    v_cvt_pk_bf16_f32 v218, v224, v225
    v_mfma_f32_16x16x32_bf16 v[236:239], a[120:123], a[24:27], v[236:239]
    v_exp_f32 v226, v226
    v_mfma_f32_16x16x32_bf16 v[236:239], a[124:127], a[28:31], v[236:239]
    ds_read_b64_tr_b16 a[200:201], v11 offset:8192
    ds_read_b64_tr_b16 a[202:203], v11 offset:12288
    v_add_f32 v19, v19, v226
    v_mfma_f32_16x16x32_bf16 v[240:243], a[128:131], a[16:19], v[196:199]
    v_exp_f32 v227, v227
    v_mfma_f32_16x16x32_bf16 v[240:243], a[132:135], a[20:23], v[240:243]
    ds_read_b64_tr_b16 a[172:173], v12 offset:0
    ds_read_b64_tr_b16 a[174:175], v12 offset:4096
    v_add_f32 v19, v19, v227
    v_cvt_pk_bf16_f32 v219, v226, v227
    v_mfma_f32_16x16x32_bf16 v[240:243], a[136:139], a[24:27], v[240:243]
    v_exp_f32 v228, v228
    v_mfma_f32_16x16x32_bf16 v[240:243], a[140:143], a[28:31], v[240:243]
    ds_read_b64_tr_b16 a[204:205], v12 offset:8192
    ds_read_b64_tr_b16 a[206:207], v12 offset:12288
    v_add_f32 v20, v20, v228
    s_waitcnt lgkmcnt(8)
    v_mfma_f32_16x16x32_bf16 v[32:35], a[144:147], v[212:215], v[32:35]
    v_exp_f32 v229, v229
    v_mfma_f32_16x16x32_bf16 v[32:35], a[176:179], v[216:219], v[32:35]
    v_add_f32 v20, v20, v229
    v_cvt_pk_bf16_f32 v228, v228, v229
    v_mfma_f32_16x16x32_bf16 v[36:39], a[148:151], v[212:215], v[36:39]
    v_exp_f32 v230, v230
    v_mfma_f32_16x16x32_bf16 v[36:39], a[180:183], v[216:219], v[36:39]
    s_and_b32 m0, s28, 0xffff
    v_add_f32 v20, v20, v230
    v_mfma_f32_16x16x32_bf16 v[40:43], a[152:155], v[212:215], v[40:43]
    v_exp_f32 v231, v231
    v_mfma_f32_16x16x32_bf16 v[40:43], a[184:187], v[216:219], v[40:43]
    v_add_f32 v20, v20, v231
    v_cvt_pk_bf16_f32 v229, v230, v231
    v_mfma_f32_16x16x32_bf16 v[44:47], a[156:159], v[212:215], v[44:47]
    v_exp_f32 v232, v232
    v_mfma_f32_16x16x32_bf16 v[44:47], a[188:191], v[216:219], v[44:47]
    buffer_load_dwordx4 v13, s[12:15], s28 offen offset:0 nt lds
    v_add_f32 v20, v20, v232
    v_mfma_f32_16x16x32_bf16 v[48:51], a[160:163], v[212:215], v[48:51]
    v_exp_f32 v233, v233
    v_mfma_f32_16x16x32_bf16 v[48:51], a[192:195], v[216:219], v[48:51]
    v_add_f32 v20, v20, v233
    v_cvt_pk_bf16_f32 v230, v232, v233
    v_mfma_f32_16x16x32_bf16 v[52:55], a[164:167], v[212:215], v[52:55]
    v_exp_f32 v234, v234
    v_mfma_f32_16x16x32_bf16 v[52:55], a[196:199], v[216:219], v[52:55]
    v_add_f32 v20, v20, v234
    s_waitcnt lgkmcnt(0)
    v_mfma_f32_16x16x32_bf16 v[56:59], a[168:171], v[212:215], v[56:59]
    v_exp_f32 v235, v235
    v_mfma_f32_16x16x32_bf16 v[56:59], a[200:203], v[216:219], v[56:59]
    v_add_f32 v20, v20, v235
    v_cvt_pk_bf16_f32 v231, v234, v235
    v_mfma_f32_16x16x32_bf16 v[60:63], a[172:175], v[212:215], v[60:63]
    v_exp_f32 v236, v236
    v_mfma_f32_16x16x32_bf16 v[60:63], a[204:207], v[216:219], v[60:63]
    buffer_load_dwordx4 v14, s[12:15], s28 offen offset:1024 nt lds
    v_add_f32 v20, v20, v236
    v_mfma_f32_16x16x32_bf16 v[212:215], a[80:83], a[32:35], v[200:203]
    v_exp_f32 v237, v237
    v_mfma_f32_16x16x32_bf16 v[212:215], a[84:87], a[36:39], v[212:215]
    v_add_f32 v20, v20, v237
    v_cvt_pk_bf16_f32 v232, v236, v237
    v_mfma_f32_16x16x32_bf16 v[212:215], a[88:91], a[40:43], v[212:215]
    v_exp_f32 v238, v238
    v_mfma_f32_16x16x32_bf16 v[212:215], a[92:95], a[44:47], v[212:215]
    buffer_load_dwordx4 v15, s[12:15], s28 offen offset:2048 nt lds
    v_add_f32 v20, v20, v238
    v_mfma_f32_16x16x32_bf16 v[216:219], a[96:99], a[32:35], v[200:203]
    v_exp_f32 v239, v239
    v_mfma_f32_16x16x32_bf16 v[216:219], a[100:103], a[36:39], v[216:219]
    v_add_f32 v20, v20, v239
    v_cvt_pk_bf16_f32 v233, v238, v239
    v_mfma_f32_16x16x32_bf16 v[216:219], a[104:107], a[40:43], v[216:219]
    v_exp_f32 v240, v240
    v_mfma_f32_16x16x32_bf16 v[216:219], a[108:111], a[44:47], v[216:219]
    buffer_load_dwordx4 v16, s[12:15], s28 offen offset:3072 nt lds
    v_add_f32 v20, v20, v240
    v_mfma_f32_16x16x32_bf16 v[220:223], a[112:115], a[32:35], v[200:203]
    v_exp_f32 v241, v241
    v_mfma_f32_16x16x32_bf16 v[220:223], a[116:119], a[36:39], v[220:223]
    v_add_f32 v20, v20, v241
    v_cvt_pk_bf16_f32 v234, v240, v241
    v_mfma_f32_16x16x32_bf16 v[220:223], a[120:123], a[40:43], v[220:223]
    v_exp_f32 v242, v242
    v_mfma_f32_16x16x32_bf16 v[220:223], a[124:127], a[44:47], v[220:223]
    s_add_u32 m0, m0, 65536
    v_add_f32 v20, v20, v242
    v_mfma_f32_16x16x32_bf16 v[224:227], a[128:131], a[32:35], v[200:203]
    v_exp_f32 v243, v243
    v_mfma_f32_16x16x32_bf16 v[224:227], a[132:135], a[36:39], v[224:227]
    v_add_f32 v20, v20, v243
    v_cvt_pk_bf16_f32 v235, v242, v243
    v_mfma_f32_16x16x32_bf16 v[224:227], a[136:139], a[40:43], v[224:227]
    v_exp_f32 v212, v212
    v_mfma_f32_16x16x32_bf16 v[224:227], a[140:143], a[44:47], v[224:227]
    buffer_load_dwordx4 v17, s[16:19], s28 offen offset:0 nt lds
    v_add_f32 v21, v21, v212
    v_mfma_f32_16x16x32_bf16 v[64:67], a[144:147], v[228:231], v[64:67]
    v_exp_f32 v213, v213
    v_mfma_f32_16x16x32_bf16 v[64:67], a[176:179], v[232:235], v[64:67]
    v_add_f32 v21, v21, v213
    v_cvt_pk_bf16_f32 v212, v212, v213
    v_mfma_f32_16x16x32_bf16 v[68:71], a[148:151], v[228:231], v[68:71]
    v_exp_f32 v214, v214
    v_mfma_f32_16x16x32_bf16 v[68:71], a[180:183], v[232:235], v[68:71]
    buffer_load_dwordx4 v18, s[16:19], s28 offen offset:1024 nt lds
    v_add_f32 v21, v21, v214
    v_mfma_f32_16x16x32_bf16 v[72:75], a[152:155], v[228:231], v[72:75]
    v_exp_f32 v215, v215
    v_mfma_f32_16x16x32_bf16 v[72:75], a[184:187], v[232:235], v[72:75]
    v_add_f32 v21, v21, v215
    v_cvt_pk_bf16_f32 v213, v214, v215
    v_mfma_f32_16x16x32_bf16 v[76:79], a[156:159], v[228:231], v[76:79]
    v_exp_f32 v216, v216
    v_mfma_f32_16x16x32_bf16 v[76:79], a[188:191], v[232:235], v[76:79]
    buffer_load_dwordx4 v17, s[16:19], s28 offen offset:2048 nt lds
    v_add_f32 v21, v21, v216
    v_mfma_f32_16x16x32_bf16 v[80:83], a[160:163], v[228:231], v[80:83]
    v_exp_f32 v217, v217
    v_mfma_f32_16x16x32_bf16 v[80:83], a[192:195], v[232:235], v[80:83]
    v_add_f32 v21, v21, v217
    v_cvt_pk_bf16_f32 v214, v216, v217
    v_mfma_f32_16x16x32_bf16 v[84:87], a[164:167], v[228:231], v[84:87]
    v_exp_f32 v218, v218
    v_mfma_f32_16x16x32_bf16 v[84:87], a[196:199], v[232:235], v[84:87]
    buffer_load_dwordx4 v18, s[16:19], s28 offen offset:3072 nt lds
    v_add_f32 v21, v21, v218
    v_mfma_f32_16x16x32_bf16 v[88:91], a[168:171], v[228:231], v[88:91]
    v_exp_f32 v219, v219
    v_mfma_f32_16x16x32_bf16 v[88:91], a[200:203], v[232:235], v[88:91]
    v_add_f32 v21, v21, v219
    v_cvt_pk_bf16_f32 v215, v218, v219
    v_mfma_f32_16x16x32_bf16 v[92:95], a[172:175], v[228:231], v[92:95]
    v_exp_f32 v220, v220
    v_mfma_f32_16x16x32_bf16 v[92:95], a[204:207], v[232:235], v[92:95]
    s_add_u32 s28, s28, 16384
    v_add_f32 v21, v21, v220
    v_mfma_f32_16x16x32_bf16 v[228:231], a[80:83], a[48:51], v[204:207]
    v_exp_f32 v221, v221
    v_mfma_f32_16x16x32_bf16 v[228:231], a[84:87], a[52:55], v[228:231]
    v_add_f32 v21, v21, v221
    v_cvt_pk_bf16_f32 v216, v220, v221
    v_mfma_f32_16x16x32_bf16 v[228:231], a[88:91], a[56:59], v[228:231]
    v_exp_f32 v222, v222
    v_mfma_f32_16x16x32_bf16 v[228:231], a[92:95], a[60:63], v[228:231]
    v_add_f32 v21, v21, v222
    v_mfma_f32_16x16x32_bf16 v[232:235], a[96:99], a[48:51], v[204:207]
    v_exp_f32 v223, v223
    v_mfma_f32_16x16x32_bf16 v[232:235], a[100:103], a[52:55], v[232:235]
    v_add_f32 v21, v21, v223
    v_cvt_pk_bf16_f32 v217, v222, v223
    v_mfma_f32_16x16x32_bf16 v[232:235], a[104:107], a[56:59], v[232:235]
    v_exp_f32 v224, v224
    v_mfma_f32_16x16x32_bf16 v[232:235], a[108:111], a[60:63], v[232:235]
    v_add_f32 v21, v21, v224
    v_mfma_f32_16x16x32_bf16 v[236:239], a[112:115], a[48:51], v[204:207]
    v_exp_f32 v225, v225
    v_mfma_f32_16x16x32_bf16 v[236:239], a[116:119], a[52:55], v[236:239]
    v_add_f32 v21, v21, v225
    v_cvt_pk_bf16_f32 v218, v224, v225
    v_mfma_f32_16x16x32_bf16 v[236:239], a[120:123], a[56:59], v[236:239]
    v_exp_f32 v226, v226
    v_mfma_f32_16x16x32_bf16 v[236:239], a[124:127], a[60:63], v[236:239]
    v_add_f32 v21, v21, v226
    v_mfma_f32_16x16x32_bf16 v[240:243], a[128:131], a[48:51], v[204:207]
    v_exp_f32 v227, v227
    v_mfma_f32_16x16x32_bf16 v[240:243], a[132:135], a[52:55], v[240:243]
    v_add_f32 v21, v21, v227
    v_cvt_pk_bf16_f32 v219, v226, v227
    v_mfma_f32_16x16x32_bf16 v[240:243], a[136:139], a[56:59], v[240:243]
    v_exp_f32 v228, v228
    v_mfma_f32_16x16x32_bf16 v[240:243], a[140:143], a[60:63], v[240:243]
    v_add_f32 v22, v22, v228
    v_mfma_f32_16x16x32_bf16 v[96:99], a[144:147], v[212:215], v[96:99]
    v_exp_f32 v229, v229
    v_mfma_f32_16x16x32_bf16 v[96:99], a[176:179], v[216:219], v[96:99]
    v_add_f32 v22, v22, v229
    v_cvt_pk_bf16_f32 v228, v228, v229
    v_mfma_f32_16x16x32_bf16 v[100:103], a[148:151], v[212:215], v[100:103]
    v_exp_f32 v230, v230
    v_mfma_f32_16x16x32_bf16 v[100:103], a[180:183], v[216:219], v[100:103]
    v_add_f32 v22, v22, v230
    v_mfma_f32_16x16x32_bf16 v[104:107], a[152:155], v[212:215], v[104:107]
    v_exp_f32 v231, v231
    v_mfma_f32_16x16x32_bf16 v[104:107], a[184:187], v[216:219], v[104:107]
    v_add_f32 v22, v22, v231
    v_cvt_pk_bf16_f32 v229, v230, v231
    v_mfma_f32_16x16x32_bf16 v[108:111], a[156:159], v[212:215], v[108:111]
    v_exp_f32 v232, v232
    v_mfma_f32_16x16x32_bf16 v[108:111], a[188:191], v[216:219], v[108:111]
    v_add_f32 v22, v22, v232
    v_mfma_f32_16x16x32_bf16 v[112:115], a[160:163], v[212:215], v[112:115]
    v_exp_f32 v233, v233
    v_mfma_f32_16x16x32_bf16 v[112:115], a[192:195], v[216:219], v[112:115]
    v_add_f32 v22, v22, v233
    v_cvt_pk_bf16_f32 v230, v232, v233
    v_mfma_f32_16x16x32_bf16 v[116:119], a[164:167], v[212:215], v[116:119]
    v_exp_f32 v234, v234
    v_mfma_f32_16x16x32_bf16 v[116:119], a[196:199], v[216:219], v[116:119]
    v_add_f32 v22, v22, v234
    v_mfma_f32_16x16x32_bf16 v[120:123], a[168:171], v[212:215], v[120:123]
    v_exp_f32 v235, v235
    v_mfma_f32_16x16x32_bf16 v[120:123], a[200:203], v[216:219], v[120:123]
    v_add_f32 v22, v22, v235
    v_cvt_pk_bf16_f32 v231, v234, v235
    v_mfma_f32_16x16x32_bf16 v[124:127], a[172:175], v[212:215], v[124:127]
    v_exp_f32 v236, v236
    v_mfma_f32_16x16x32_bf16 v[124:127], a[204:207], v[216:219], v[124:127]
    v_add_f32 v22, v22, v236
    s_waitcnt vmcnt(8)
    s_barrier
    v_exp_f32 v237, v237
    ds_read_b128 a[80:83], v1 offset:16384
    v_add_f32 v22, v22, v237
    v_cvt_pk_bf16_f32 v232, v236, v237
    v_exp_f32 v238, v238
    ds_read_b128 a[84:87], v2 offset:16384
    v_add_f32 v22, v22, v238
    v_exp_f32 v239, v239
    ds_read_b128 a[88:91], v3 offset:16384
    v_add_f32 v22, v22, v239
    v_cvt_pk_bf16_f32 v233, v238, v239
    v_exp_f32 v240, v240
    ds_read_b128 a[92:95], v4 offset:16384
    v_add_f32 v22, v22, v240
    v_exp_f32 v241, v241
    ds_read_b128 a[96:99], v1 offset:20480
    v_add_f32 v22, v22, v241
    v_cvt_pk_bf16_f32 v234, v240, v241
    v_exp_f32 v242, v242
    ds_read_b128 a[100:103], v2 offset:20480
    v_add_f32 v22, v22, v242
    v_exp_f32 v243, v243
    ds_read_b128 a[104:107], v3 offset:20480
    v_add_f32 v22, v22, v243
    v_cvt_pk_bf16_f32 v235, v242, v243
    ds_read_b128 a[108:111], v4 offset:20480
    v_mfma_f32_16x16x32_bf16 v[128:131], a[144:147], v[228:231], v[128:131]
    v_mfma_f32_16x16x32_bf16 v[128:131], a[176:179], v[232:235], v[128:131]
    ds_read_b128 a[112:115], v1 offset:24576
    v_mfma_f32_16x16x32_bf16 v[132:135], a[148:151], v[228:231], v[132:135]
    v_mfma_f32_16x16x32_bf16 v[132:135], a[180:183], v[232:235], v[132:135]
    ds_read_b128 a[116:119], v2 offset:24576
    v_mfma_f32_16x16x32_bf16 v[136:139], a[152:155], v[228:231], v[136:139]
    v_mfma_f32_16x16x32_bf16 v[136:139], a[184:187], v[232:235], v[136:139]
    ds_read_b128 a[120:123], v3 offset:24576
    v_mfma_f32_16x16x32_bf16 v[140:143], a[156:159], v[228:231], v[140:143]
    v_mfma_f32_16x16x32_bf16 v[140:143], a[188:191], v[232:235], v[140:143]
    ds_read_b128 a[124:127], v4 offset:24576
    v_mfma_f32_16x16x32_bf16 v[144:147], a[160:163], v[228:231], v[144:147]
    v_mfma_f32_16x16x32_bf16 v[144:147], a[192:195], v[232:235], v[144:147]
    ds_read_b128 a[128:131], v1 offset:28672
    v_mfma_f32_16x16x32_bf16 v[148:151], a[164:167], v[228:231], v[148:151]
    v_mfma_f32_16x16x32_bf16 v[148:151], a[196:199], v[232:235], v[148:151]
    ds_read_b128 a[132:135], v2 offset:28672
    v_mfma_f32_16x16x32_bf16 v[152:155], a[168:171], v[228:231], v[152:155]
    v_mfma_f32_16x16x32_bf16 v[152:155], a[200:203], v[232:235], v[152:155]
    ds_read_b128 a[136:139], v3 offset:28672
    v_mfma_f32_16x16x32_bf16 v[156:159], a[172:175], v[228:231], v[156:159]
    v_mfma_f32_16x16x32_bf16 v[156:159], a[204:207], v[232:235], v[156:159]
    ds_read_b128 a[140:143], v4 offset:28672
L_b1_w3:
    s_waitcnt lgkmcnt(4)
    v_mfma_f32_16x16x32_bf16 v[228:231], a[80:83], a[0:3], v[192:195]
    v_mfma_f32_16x16x32_bf16 v[228:231], a[84:87], a[4:7], v[228:231]
    v_mfma_f32_16x16x32_bf16 v[228:231], a[88:91], a[8:11], v[228:231]
    v_mfma_f32_16x16x32_bf16 v[228:231], a[92:95], a[12:15], v[228:231]
    v_mfma_f32_16x16x32_bf16 v[232:235], a[96:99], a[0:3], v[192:195]
    v_mfma_f32_16x16x32_bf16 v[232:235], a[100:103], a[4:7], v[232:235]
    v_mfma_f32_16x16x32_bf16 v[232:235], a[104:107], a[8:11], v[232:235]
    v_mfma_f32_16x16x32_bf16 v[232:235], a[108:111], a[12:15], v[232:235]
    v_mfma_f32_16x16x32_bf16 v[236:239], a[112:115], a[0:3], v[192:195]
    v_mfma_f32_16x16x32_bf16 v[236:239], a[116:119], a[4:7], v[236:239]
    v_mfma_f32_16x16x32_bf16 v[236:239], a[120:123], a[8:11], v[236:239]
    v_mfma_f32_16x16x32_bf16 v[236:239], a[124:127], a[12:15], v[236:239]
    s_waitcnt lgkmcnt(0)
    v_mfma_f32_16x16x32_bf16 v[240:243], a[128:131], a[0:3], v[192:195]
    v_mfma_f32_16x16x32_bf16 v[240:243], a[132:135], a[4:7], v[240:243]
    v_mfma_f32_16x16x32_bf16 v[240:243], a[136:139], a[8:11], v[240:243]
    v_exp_f32 v228, v228
    v_mfma_f32_16x16x32_bf16 v[240:243], a[140:143], a[12:15], v[240:243]
    v_add_f32 v19, v19, v228
L_b1g1_w3:
    v_exp_f32 v229, v229
    ds_read_b64_tr_b16 a[144:145], v5 offset:16384
    ds_read_b64_tr_b16 a[146:147], v5 offset:20480
    v_add_f32 v19, v19, v229
    v_cvt_pk_bf16_f32 v228, v228, v229
    v_exp_f32 v230, v230
    ds_read_b64_tr_b16 a[176:177], v5 offset:24576
    ds_read_b64_tr_b16 a[178:179], v5 offset:28672
    v_add_f32 v19, v19, v230
    v_exp_f32 v231, v231
    ds_read_b64_tr_b16 a[148:149], v6 offset:16384
    ds_read_b64_tr_b16 a[150:151], v6 offset:20480
    v_add_f32 v19, v19, v231
    v_cvt_pk_bf16_f32 v229, v230, v231
    v_exp_f32 v232, v232
    ds_read_b64_tr_b16 a[180:181], v6 offset:24576
    ds_read_b64_tr_b16 a[182:183], v6 offset:28672
    v_add_f32 v19, v19, v232
    v_exp_f32 v233, v233
    ds_read_b64_tr_b16 a[152:153], v7 offset:16384
    ds_read_b64_tr_b16 a[154:155], v7 offset:20480
    v_add_f32 v19, v19, v233
    v_cvt_pk_bf16_f32 v230, v232, v233
    v_exp_f32 v234, v234
    ds_read_b64_tr_b16 a[184:185], v7 offset:24576
    ds_read_b64_tr_b16 a[186:187], v7 offset:28672
    v_add_f32 v19, v19, v234
    v_exp_f32 v235, v235
    ds_read_b64_tr_b16 a[156:157], v8 offset:16384
    ds_read_b64_tr_b16 a[158:159], v8 offset:20480
    v_add_f32 v19, v19, v235
    v_cvt_pk_bf16_f32 v231, v234, v235
    v_exp_f32 v236, v236
    ds_read_b64_tr_b16 a[188:189], v8 offset:24576
    ds_read_b64_tr_b16 a[190:191], v8 offset:28672
    v_add_f32 v19, v19, v236
    v_mfma_f32_16x16x32_bf16 v[212:215], a[80:83], a[16:19], v[196:199]
    v_exp_f32 v237, v237
    v_mfma_f32_16x16x32_bf16 v[212:215], a[84:87], a[20:23], v[212:215]
    ds_read_b64_tr_b16 a[160:161], v9 offset:16384
    ds_read_b64_tr_b16 a[162:163], v9 offset:20480
    v_add_f32 v19, v19, v237
    v_cvt_pk_bf16_f32 v232, v236, v237
    v_mfma_f32_16x16x32_bf16 v[212:215], a[88:91], a[24:27], v[212:215]
    v_exp_f32 v238, v238
    v_mfma_f32_16x16x32_bf16 v[212:215], a[92:95], a[28:31], v[212:215]
    ds_read_b64_tr_b16 a[192:193], v9 offset:24576
    ds_read_b64_tr_b16 a[194:195], v9 offset:28672
    v_add_f32 v19, v19, v238
    v_mfma_f32_16x16x32_bf16 v[216:219], a[96:99], a[16:19], v[196:199]
    v_exp_f32 v239, v239
    v_mfma_f32_16x16x32_bf16 v[216:219], a[100:103], a[20:23], v[216:219]
    ds_read_b64_tr_b16 a[164:165], v10 offset:16384
    ds_read_b64_tr_b16 a[166:167], v10 offset:20480
    v_add_f32 v19, v19, v239
    v_cvt_pk_bf16_f32 v233, v238, v239
    v_mfma_f32_16x16x32_bf16 v[216:219], a[104:107], a[24:27], v[216:219]
    v_exp_f32 v240, v240
    v_mfma_f32_16x16x32_bf16 v[216:219], a[108:111], a[28:31], v[216:219]
    ds_read_b64_tr_b16 a[196:197], v10 offset:24576
    ds_read_b64_tr_b16 a[198:199], v10 offset:28672
    v_add_f32 v19, v19, v240
    v_mfma_f32_16x16x32_bf16 v[220:223], a[112:115], a[16:19], v[196:199]
    v_exp_f32 v241, v241
    v_mfma_f32_16x16x32_bf16 v[220:223], a[116:119], a[20:23], v[220:223]
    ds_read_b64_tr_b16 a[168:169], v11 offset:16384
    ds_read_b64_tr_b16 a[170:171], v11 offset:20480
    v_add_f32 v19, v19, v241
    v_cvt_pk_bf16_f32 v234, v240, v241
    v_mfma_f32_16x16x32_bf16 v[220:223], a[120:123], a[24:27], v[220:223]
    v_exp_f32 v242, v242
    v_mfma_f32_16x16x32_bf16 v[220:223], a[124:127], a[28:31], v[220:223]
    ds_read_b64_tr_b16 a[200:201], v11 offset:24576
    ds_read_b64_tr_b16 a[202:203], v11 offset:28672
    v_add_f32 v19, v19, v242
    v_mfma_f32_16x16x32_bf16 v[224:227], a[128:131], a[16:19], v[196:199]
    v_exp_f32 v243, v243
    v_mfma_f32_16x16x32_bf16 v[224:227], a[132:135], a[20:23], v[224:227]
    ds_read_b64_tr_b16 a[172:173], v12 offset:16384
    ds_read_b64_tr_b16 a[174:175], v12 offset:20480
    v_add_f32 v19, v19, v243
    v_cvt_pk_bf16_f32 v235, v242, v243
    v_mfma_f32_16x16x32_bf16 v[224:227], a[136:139], a[24:27], v[224:227]
    v_exp_f32 v212, v212
    v_mfma_f32_16x16x32_bf16 v[224:227], a[140:143], a[28:31], v[224:227]
    ds_read_b64_tr_b16 a[204:205], v12 offset:24576
    ds_read_b64_tr_b16 a[206:207], v12 offset:28672
    v_add_f32 v20, v20, v212
    s_waitcnt lgkmcnt(8)
    v_mfma_f32_16x16x32_bf16 v[32:35], a[144:147], v[228:231], v[32:35]
    v_exp_f32 v213, v213
    v_mfma_f32_16x16x32_bf16 v[32:35], a[176:179], v[232:235], v[32:35]
    v_add_f32 v20, v20, v213
    v_cvt_pk_bf16_f32 v212, v212, v213
    v_mfma_f32_16x16x32_bf16 v[36:39], a[148:151], v[228:231], v[36:39]
    v_exp_f32 v214, v214
    v_mfma_f32_16x16x32_bf16 v[36:39], a[180:183], v[232:235], v[36:39]
    s_and_b32 m0, s28, 0xffff
    v_add_f32 v20, v20, v214
    v_mfma_f32_16x16x32_bf16 v[40:43], a[152:155], v[228:231], v[40:43]
    v_exp_f32 v215, v215
    v_mfma_f32_16x16x32_bf16 v[40:43], a[184:187], v[232:235], v[40:43]
    v_add_f32 v20, v20, v215
    v_cvt_pk_bf16_f32 v213, v214, v215
    v_mfma_f32_16x16x32_bf16 v[44:47], a[156:159], v[228:231], v[44:47]
    v_exp_f32 v216, v216
    v_mfma_f32_16x16x32_bf16 v[44:47], a[188:191], v[232:235], v[44:47]
    buffer_load_dwordx4 v13, s[12:15], s28 offen offset:0 nt lds
    v_add_f32 v20, v20, v216
    v_mfma_f32_16x16x32_bf16 v[48:51], a[160:163], v[228:231], v[48:51]
    v_exp_f32 v217, v217
    v_mfma_f32_16x16x32_bf16 v[48:51], a[192:195], v[232:235], v[48:51]
    v_add_f32 v20, v20, v217
    v_cvt_pk_bf16_f32 v214, v216, v217
    v_mfma_f32_16x16x32_bf16 v[52:55], a[164:167], v[228:231], v[52:55]
    v_exp_f32 v218, v218
    v_mfma_f32_16x16x32_bf16 v[52:55], a[196:199], v[232:235], v[52:55]
    v_add_f32 v20, v20, v218
    s_waitcnt lgkmcnt(0)
    v_mfma_f32_16x16x32_bf16 v[56:59], a[168:171], v[228:231], v[56:59]
    v_exp_f32 v219, v219
    v_mfma_f32_16x16x32_bf16 v[56:59], a[200:203], v[232:235], v[56:59]
    v_add_f32 v20, v20, v219
    v_cvt_pk_bf16_f32 v215, v218, v219
    v_mfma_f32_16x16x32_bf16 v[60:63], a[172:175], v[228:231], v[60:63]
    v_exp_f32 v220, v220
    v_mfma_f32_16x16x32_bf16 v[60:63], a[204:207], v[232:235], v[60:63]
    buffer_load_dwordx4 v14, s[12:15], s28 offen offset:1024 nt lds
    v_add_f32 v20, v20, v220
    v_mfma_f32_16x16x32_bf16 v[228:231], a[80:83], a[32:35], v[200:203]
    v_exp_f32 v221, v221
    v_mfma_f32_16x16x32_bf16 v[228:231], a[84:87], a[36:39], v[228:231]
    v_add_f32 v20, v20, v221
    v_cvt_pk_bf16_f32 v216, v220, v221
    v_mfma_f32_16x16x32_bf16 v[228:231], a[88:91], a[40:43], v[228:231]
    v_exp_f32 v222, v222
    v_mfma_f32_16x16x32_bf16 v[228:231], a[92:95], a[44:47], v[228:231]
    buffer_load_dwordx4 v15, s[12:15], s28 offen offset:2048 nt lds
    v_add_f32 v20, v20, v222
    v_mfma_f32_16x16x32_bf16 v[232:235], a[96:99], a[32:35], v[200:203]
    v_exp_f32 v223, v223
    v_mfma_f32_16x16x32_bf16 v[232:235], a[100:103], a[36:39], v[232:235]
    v_add_f32 v20, v20, v223
    v_cvt_pk_bf16_f32 v217, v222, v223
    v_mfma_f32_16x16x32_bf16 v[232:235], a[104:107], a[40:43], v[232:235]
    v_exp_f32 v224, v224
    v_mfma_f32_16x16x32_bf16 v[232:235], a[108:111], a[44:47], v[232:235]
    buffer_load_dwordx4 v16, s[12:15], s28 offen offset:3072 nt lds
    v_add_f32 v20, v20, v224
    v_mfma_f32_16x16x32_bf16 v[236:239], a[112:115], a[32:35], v[200:203]
    v_exp_f32 v225, v225
    v_mfma_f32_16x16x32_bf16 v[236:239], a[116:119], a[36:39], v[236:239]
    v_add_f32 v20, v20, v225
    v_cvt_pk_bf16_f32 v218, v224, v225
    v_mfma_f32_16x16x32_bf16 v[236:239], a[120:123], a[40:43], v[236:239]
    v_exp_f32 v226, v226
    v_mfma_f32_16x16x32_bf16 v[236:239], a[124:127], a[44:47], v[236:239]
    s_add_u32 m0, m0, 65536
    v_add_f32 v20, v20, v226
    v_mfma_f32_16x16x32_bf16 v[240:243], a[128:131], a[32:35], v[200:203]
    v_exp_f32 v227, v227
    v_mfma_f32_16x16x32_bf16 v[240:243], a[132:135], a[36:39], v[240:243]
    v_add_f32 v20, v20, v227
    v_cvt_pk_bf16_f32 v219, v226, v227
    v_mfma_f32_16x16x32_bf16 v[240:243], a[136:139], a[40:43], v[240:243]
    v_exp_f32 v228, v228
    v_mfma_f32_16x16x32_bf16 v[240:243], a[140:143], a[44:47], v[240:243]
    buffer_load_dwordx4 v17, s[16:19], s28 offen offset:0 nt lds
    v_add_f32 v21, v21, v228
    v_mfma_f32_16x16x32_bf16 v[64:67], a[144:147], v[212:215], v[64:67]
    v_exp_f32 v229, v229
    v_mfma_f32_16x16x32_bf16 v[64:67], a[176:179], v[216:219], v[64:67]
    v_add_f32 v21, v21, v229
    v_cvt_pk_bf16_f32 v228, v228, v229
    v_mfma_f32_16x16x32_bf16 v[68:71], a[148:151], v[212:215], v[68:71]
    v_exp_f32 v230, v230
    v_mfma_f32_16x16x32_bf16 v[68:71], a[180:183], v[216:219], v[68:71]
    buffer_load_dwordx4 v18, s[16:19], s28 offen offset:1024 nt lds
    v_add_f32 v21, v21, v230
    v_mfma_f32_16x16x32_bf16 v[72:75], a[152:155], v[212:215], v[72:75]
    v_exp_f32 v231, v231
    v_mfma_f32_16x16x32_bf16 v[72:75], a[184:187], v[216:219], v[72:75]
    v_add_f32 v21, v21, v231
    v_cvt_pk_bf16_f32 v229, v230, v231
    v_mfma_f32_16x16x32_bf16 v[76:79], a[156:159], v[212:215], v[76:79]
    v_exp_f32 v232, v232
    v_mfma_f32_16x16x32_bf16 v[76:79], a[188:191], v[216:219], v[76:79]
    buffer_load_dwordx4 v17, s[16:19], s28 offen offset:2048 nt lds
    v_add_f32 v21, v21, v232
    v_mfma_f32_16x16x32_bf16 v[80:83], a[160:163], v[212:215], v[80:83]
    v_exp_f32 v233, v233
    v_mfma_f32_16x16x32_bf16 v[80:83], a[192:195], v[216:219], v[80:83]
    v_add_f32 v21, v21, v233
    v_cvt_pk_bf16_f32 v230, v232, v233
    v_mfma_f32_16x16x32_bf16 v[84:87], a[164:167], v[212:215], v[84:87]
    v_exp_f32 v234, v234
    v_mfma_f32_16x16x32_bf16 v[84:87], a[196:199], v[216:219], v[84:87]
    buffer_load_dwordx4 v18, s[16:19], s28 offen offset:3072 nt lds
    v_add_f32 v21, v21, v234
    v_mfma_f32_16x16x32_bf16 v[88:91], a[168:171], v[212:215], v[88:91]
    v_exp_f32 v235, v235
    v_mfma_f32_16x16x32_bf16 v[88:91], a[200:203], v[216:219], v[88:91]
    v_add_f32 v21, v21, v235
    v_cvt_pk_bf16_f32 v231, v234, v235
    v_mfma_f32_16x16x32_bf16 v[92:95], a[172:175], v[212:215], v[92:95]
    v_exp_f32 v236, v236
    v_mfma_f32_16x16x32_bf16 v[92:95], a[204:207], v[216:219], v[92:95]
    s_add_u32 s28, s28, 16384
    v_add_f32 v21, v21, v236
    v_mfma_f32_16x16x32_bf16 v[212:215], a[80:83], a[48:51], v[204:207]
    v_exp_f32 v237, v237
    v_mfma_f32_16x16x32_bf16 v[212:215], a[84:87], a[52:55], v[212:215]
    v_add_f32 v21, v21, v237
    v_cvt_pk_bf16_f32 v232, v236, v237
    v_mfma_f32_16x16x32_bf16 v[212:215], a[88:91], a[56:59], v[212:215]
    v_exp_f32 v238, v238
    v_mfma_f32_16x16x32_bf16 v[212:215], a[92:95], a[60:63], v[212:215]
    s_sub_u32 s43, s30, 2
    v_add_f32 v21, v21, v238
    v_mfma_f32_16x16x32_bf16 v[216:219], a[96:99], a[48:51], v[204:207]
    v_exp_f32 v239, v239
    v_mfma_f32_16x16x32_bf16 v[216:219], a[100:103], a[52:55], v[216:219]
    v_add_f32 v21, v21, v239
    v_cvt_pk_bf16_f32 v233, v238, v239
    v_mfma_f32_16x16x32_bf16 v[216:219], a[104:107], a[56:59], v[216:219]
    v_exp_f32 v240, v240
    v_mfma_f32_16x16x32_bf16 v[216:219], a[108:111], a[60:63], v[216:219]
    s_cmp_le_u32 s43, 1
    v_add_f32 v21, v21, v240
    v_mfma_f32_16x16x32_bf16 v[220:223], a[112:115], a[48:51], v[204:207]
    v_exp_f32 v241, v241
    v_mfma_f32_16x16x32_bf16 v[220:223], a[116:119], a[52:55], v[220:223]
    v_add_f32 v21, v21, v241
    v_cvt_pk_bf16_f32 v234, v240, v241
    v_mfma_f32_16x16x32_bf16 v[220:223], a[120:123], a[56:59], v[220:223]
    v_exp_f32 v242, v242
    v_mfma_f32_16x16x32_bf16 v[220:223], a[124:127], a[60:63], v[220:223]
    v_add_f32 v21, v21, v242
    v_mfma_f32_16x16x32_bf16 v[224:227], a[128:131], a[48:51], v[204:207]
    v_exp_f32 v243, v243
    v_mfma_f32_16x16x32_bf16 v[224:227], a[132:135], a[52:55], v[224:227]
    v_add_f32 v21, v21, v243
    v_cvt_pk_bf16_f32 v235, v242, v243
    v_mfma_f32_16x16x32_bf16 v[224:227], a[136:139], a[56:59], v[224:227]
    v_exp_f32 v212, v212
    v_mfma_f32_16x16x32_bf16 v[224:227], a[140:143], a[60:63], v[224:227]
    v_add_f32 v22, v22, v212
    v_mfma_f32_16x16x32_bf16 v[96:99], a[144:147], v[228:231], v[96:99]
    v_exp_f32 v213, v213
    v_mfma_f32_16x16x32_bf16 v[96:99], a[176:179], v[232:235], v[96:99]
    v_add_f32 v22, v22, v213
    v_cvt_pk_bf16_f32 v212, v212, v213
    v_mfma_f32_16x16x32_bf16 v[100:103], a[148:151], v[228:231], v[100:103]
    v_exp_f32 v214, v214
    v_mfma_f32_16x16x32_bf16 v[100:103], a[180:183], v[232:235], v[100:103]
    v_add_f32 v22, v22, v214
    v_mfma_f32_16x16x32_bf16 v[104:107], a[152:155], v[228:231], v[104:107]
    v_exp_f32 v215, v215
    v_mfma_f32_16x16x32_bf16 v[104:107], a[184:187], v[232:235], v[104:107]
    v_add_f32 v22, v22, v215
    v_cvt_pk_bf16_f32 v213, v214, v215
    v_mfma_f32_16x16x32_bf16 v[108:111], a[156:159], v[228:231], v[108:111]
    v_exp_f32 v216, v216
    v_mfma_f32_16x16x32_bf16 v[108:111], a[188:191], v[232:235], v[108:111]
    v_add_f32 v22, v22, v216
    v_mfma_f32_16x16x32_bf16 v[112:115], a[160:163], v[228:231], v[112:115]
    v_exp_f32 v217, v217
    v_mfma_f32_16x16x32_bf16 v[112:115], a[192:195], v[232:235], v[112:115]
    v_add_f32 v22, v22, v217
    v_cvt_pk_bf16_f32 v214, v216, v217
    v_mfma_f32_16x16x32_bf16 v[116:119], a[164:167], v[228:231], v[116:119]
    v_exp_f32 v218, v218
    v_mfma_f32_16x16x32_bf16 v[116:119], a[196:199], v[232:235], v[116:119]
    v_add_f32 v22, v22, v218
    v_mfma_f32_16x16x32_bf16 v[120:123], a[168:171], v[228:231], v[120:123]
    v_exp_f32 v219, v219
    v_mfma_f32_16x16x32_bf16 v[120:123], a[200:203], v[232:235], v[120:123]
    v_add_f32 v22, v22, v219
    v_cvt_pk_bf16_f32 v215, v218, v219
    v_mfma_f32_16x16x32_bf16 v[124:127], a[172:175], v[228:231], v[124:127]
    v_exp_f32 v220, v220
    v_mfma_f32_16x16x32_bf16 v[124:127], a[204:207], v[232:235], v[124:127]
    v_add_f32 v22, v22, v220
    s_waitcnt vmcnt(8)
    s_barrier
    v_exp_f32 v221, v221
    ds_read_b128 a[80:83], v1 offset:32768
    v_add_f32 v22, v22, v221
    v_cvt_pk_bf16_f32 v216, v220, v221
    v_exp_f32 v222, v222
    ds_read_b128 a[84:87], v2 offset:32768
    v_add_f32 v22, v22, v222
    v_exp_f32 v223, v223
    ds_read_b128 a[88:91], v3 offset:32768
    v_add_f32 v22, v22, v223
    v_cvt_pk_bf16_f32 v217, v222, v223
    v_exp_f32 v224, v224
    ds_read_b128 a[92:95], v4 offset:32768
    v_add_f32 v22, v22, v224
    v_exp_f32 v225, v225
    ds_read_b128 a[96:99], v1 offset:36864
    v_add_f32 v22, v22, v225
    v_cvt_pk_bf16_f32 v218, v224, v225
    v_exp_f32 v226, v226
    ds_read_b128 a[100:103], v2 offset:36864
    v_add_f32 v22, v22, v226
    v_exp_f32 v227, v227
    ds_read_b128 a[104:107], v3 offset:36864
    v_add_f32 v22, v22, v227
    v_cvt_pk_bf16_f32 v219, v226, v227
    ds_read_b128 a[108:111], v4 offset:36864
    v_mfma_f32_16x16x32_bf16 v[128:131], a[144:147], v[212:215], v[128:131]
    v_mfma_f32_16x16x32_bf16 v[128:131], a[176:179], v[216:219], v[128:131]
    ds_read_b128 a[112:115], v1 offset:40960
    v_mfma_f32_16x16x32_bf16 v[132:135], a[148:151], v[212:215], v[132:135]
    v_mfma_f32_16x16x32_bf16 v[132:135], a[180:183], v[216:219], v[132:135]
    ds_read_b128 a[116:119], v2 offset:40960
    v_mfma_f32_16x16x32_bf16 v[136:139], a[152:155], v[212:215], v[136:139]
    v_mfma_f32_16x16x32_bf16 v[136:139], a[184:187], v[216:219], v[136:139]
    ds_read_b128 a[120:123], v3 offset:40960
    v_mfma_f32_16x16x32_bf16 v[140:143], a[156:159], v[212:215], v[140:143]
    v_mfma_f32_16x16x32_bf16 v[140:143], a[188:191], v[216:219], v[140:143]
    ds_read_b128 a[124:127], v4 offset:40960
    v_mfma_f32_16x16x32_bf16 v[144:147], a[160:163], v[212:215], v[144:147]
    v_mfma_f32_16x16x32_bf16 v[144:147], a[192:195], v[216:219], v[144:147]
    ds_read_b128 a[128:131], v1 offset:45056
    v_mfma_f32_16x16x32_bf16 v[148:151], a[164:167], v[212:215], v[148:151]
    v_mfma_f32_16x16x32_bf16 v[148:151], a[196:199], v[216:219], v[148:151]
    ds_read_b128 a[132:135], v2 offset:45056
    v_mfma_f32_16x16x32_bf16 v[152:155], a[168:171], v[212:215], v[152:155]
    v_mfma_f32_16x16x32_bf16 v[152:155], a[200:203], v[216:219], v[152:155]
    ds_read_b128 a[136:139], v3 offset:45056
    v_mfma_f32_16x16x32_bf16 v[156:159], a[172:175], v[212:215], v[156:159]
    v_mfma_f32_16x16x32_bf16 v[156:159], a[204:207], v[216:219], v[156:159]
    ds_read_b128 a[140:143], v4 offset:45056
    s_cbranch_vccz L_qlds_w3
L_b2_w3:
    s_waitcnt lgkmcnt(4)
    v_mfma_f32_16x16x32_bf16 v[212:215], a[80:83], a[0:3], v[192:195]
    v_mfma_f32_16x16x32_bf16 v[212:215], a[84:87], a[4:7], v[212:215]
    v_mfma_f32_16x16x32_bf16 v[212:215], a[88:91], a[8:11], v[212:215]
    v_mfma_f32_16x16x32_bf16 v[212:215], a[92:95], a[12:15], v[212:215]
    v_mfma_f32_16x16x32_bf16 v[216:219], a[96:99], a[0:3], v[192:195]
    v_mfma_f32_16x16x32_bf16 v[216:219], a[100:103], a[4:7], v[216:219]
    v_mfma_f32_16x16x32_bf16 v[216:219], a[104:107], a[8:11], v[216:219]
    v_mfma_f32_16x16x32_bf16 v[216:219], a[108:111], a[12:15], v[216:219]
    v_mfma_f32_16x16x32_bf16 v[220:223], a[112:115], a[0:3], v[192:195]
    v_mfma_f32_16x16x32_bf16 v[220:223], a[116:119], a[4:7], v[220:223]
    v_mfma_f32_16x16x32_bf16 v[220:223], a[120:123], a[8:11], v[220:223]
    v_mfma_f32_16x16x32_bf16 v[220:223], a[124:127], a[12:15], v[220:223]
    s_waitcnt lgkmcnt(0)
    v_mfma_f32_16x16x32_bf16 v[224:227], a[128:131], a[0:3], v[192:195]
    v_mfma_f32_16x16x32_bf16 v[224:227], a[132:135], a[4:7], v[224:227]
    v_mfma_f32_16x16x32_bf16 v[224:227], a[136:139], a[8:11], v[224:227]
    v_exp_f32 v212, v212
    v_mfma_f32_16x16x32_bf16 v[224:227], a[140:143], a[12:15], v[224:227]
    v_add_f32 v19, v19, v212
L_b2g1_w3:
    v_exp_f32 v213, v213
    ds_read_b64_tr_b16 a[144:145], v5 offset:32768
    ds_read_b64_tr_b16 a[146:147], v5 offset:36864
    v_add_f32 v19, v19, v213
    v_cvt_pk_bf16_f32 v212, v212, v213
    v_exp_f32 v214, v214
    ds_read_b64_tr_b16 a[176:177], v5 offset:40960
    ds_read_b64_tr_b16 a[178:179], v5 offset:45056
    v_add_f32 v19, v19, v214
    v_exp_f32 v215, v215
    ds_read_b64_tr_b16 a[148:149], v6 offset:32768
    ds_read_b64_tr_b16 a[150:151], v6 offset:36864
    v_add_f32 v19, v19, v215
    v_cvt_pk_bf16_f32 v213, v214, v215
    v_exp_f32 v216, v216
    ds_read_b64_tr_b16 a[180:181], v6 offset:40960
    ds_read_b64_tr_b16 a[182:183], v6 offset:45056
    v_add_f32 v19, v19, v216
    v_exp_f32 v217, v217
    ds_read_b64_tr_b16 a[152:153], v7 offset:32768
    ds_read_b64_tr_b16 a[154:155], v7 offset:36864
    v_add_f32 v19, v19, v217
    v_cvt_pk_bf16_f32 v214, v216, v217
    v_exp_f32 v218, v218
    ds_read_b64_tr_b16 a[184:185], v7 offset:40960
    ds_read_b64_tr_b16 a[186:187], v7 offset:45056
    v_add_f32 v19, v19, v218
    v_exp_f32 v219, v219
    ds_read_b64_tr_b16 a[156:157], v8 offset:32768
    ds_read_b64_tr_b16 a[158:159], v8 offset:36864
    v_add_f32 v19, v19, v219
    v_cvt_pk_bf16_f32 v215, v218, v219
    v_exp_f32 v220, v220
    ds_read_b64_tr_b16 a[188:189], v8 offset:40960
    ds_read_b64_tr_b16 a[190:191], v8 offset:45056
    v_add_f32 v19, v19, v220
    v_mfma_f32_16x16x32_bf16 v[228:231], a[80:83], a[16:19], v[196:199]
    v_exp_f32 v221, v221
    v_mfma_f32_16x16x32_bf16 v[228:231], a[84:87], a[20:23], v[228:231]
    ds_read_b64_tr_b16 a[160:161], v9 offset:32768
    ds_read_b64_tr_b16 a[162:163], v9 offset:36864
    v_add_f32 v19, v19, v221
    v_cvt_pk_bf16_f32 v216, v220, v221
    v_mfma_f32_16x16x32_bf16 v[228:231], a[88:91], a[24:27], v[228:231]
    v_exp_f32 v222, v222
    v_mfma_f32_16x16x32_bf16 v[228:231], a[92:95], a[28:31], v[228:231]
    ds_read_b64_tr_b16 a[192:193], v9 offset:40960
    ds_read_b64_tr_b16 a[194:195], v9 offset:45056
    v_add_f32 v19, v19, v222
    v_mfma_f32_16x16x32_bf16 v[232:235], a[96:99], a[16:19], v[196:199]
    v_exp_f32 v223, v223
    v_mfma_f32_16x16x32_bf16 v[232:235], a[100:103], a[20:23], v[232:235]
    ds_read_b64_tr_b16 a[164:165], v10 offset:32768
    ds_read_b64_tr_b16 a[166:167], v10 offset:36864
    v_add_f32 v19, v19, v223
    v_cvt_pk_bf16_f32 v217, v222, v223
    v_mfma_f32_16x16x32_bf16 v[232:235], a[104:107], a[24:27], v[232:235]
    v_exp_f32 v224, v224
    v_mfma_f32_16x16x32_bf16 v[232:235], a[108:111], a[28:31], v[232:235]
    ds_read_b64_tr_b16 a[196:197], v10 offset:40960
    ds_read_b64_tr_b16 a[198:199], v10 offset:45056
    v_add_f32 v19, v19, v224
    v_mfma_f32_16x16x32_bf16 v[236:239], a[112:115], a[16:19], v[196:199]
    v_exp_f32 v225, v225
    v_mfma_f32_16x16x32_bf16 v[236:239], a[116:119], a[20:23], v[236:239]
    ds_read_b64_tr_b16 a[168:169], v11 offset:32768
    ds_read_b64_tr_b16 a[170:171], v11 offset:36864
    v_add_f32 v19, v19, v225
    v_cvt_pk_bf16_f32 v218, v224, v225
    v_mfma_f32_16x16x32_bf16 v[236:239], a[120:123], a[24:27], v[236:239]
    v_exp_f32 v226, v226
    v_mfma_f32_16x16x32_bf16 v[236:239], a[124:127], a[28:31], v[236:239]
    ds_read_b64_tr_b16 a[200:201], v11 offset:40960
    ds_read_b64_tr_b16 a[202:203], v11 offset:45056
    v_add_f32 v19, v19, v226
    v_mfma_f32_16x16x32_bf16 v[240:243], a[128:131], a[16:19], v[196:199]
    v_exp_f32 v227, v227
    v_mfma_f32_16x16x32_bf16 v[240:243], a[132:135], a[20:23], v[240:243]
    ds_read_b64_tr_b16 a[172:173], v12 offset:32768
    ds_read_b64_tr_b16 a[174:175], v12 offset:36864
    v_add_f32 v19, v19, v227
    v_cvt_pk_bf16_f32 v219, v226, v227
    v_mfma_f32_16x16x32_bf16 v[240:243], a[136:139], a[24:27], v[240:243]
    v_exp_f32 v228, v228
    v_mfma_f32_16x16x32_bf16 v[240:243], a[140:143], a[28:31], v[240:243]
    ds_read_b64_tr_b16 a[204:205], v12 offset:40960
    ds_read_b64_tr_b16 a[206:207], v12 offset:45056
    v_add_f32 v20, v20, v228
    s_waitcnt lgkmcnt(8)
    v_mfma_f32_16x16x32_bf16 v[32:35], a[144:147], v[212:215], v[32:35]
    v_exp_f32 v229, v229
    v_mfma_f32_16x16x32_bf16 v[32:35], a[176:179], v[216:219], v[32:35]
    v_add_f32 v20, v20, v229
    v_cvt_pk_bf16_f32 v228, v228, v229
    v_mfma_f32_16x16x32_bf16 v[36:39], a[148:151], v[212:215], v[36:39]
    v_exp_f32 v230, v230
    v_mfma_f32_16x16x32_bf16 v[36:39], a[180:183], v[216:219], v[36:39]
    s_and_b32 m0, s28, 0xffff
    v_add_f32 v20, v20, v230
    v_mfma_f32_16x16x32_bf16 v[40:43], a[152:155], v[212:215], v[40:43]
    v_exp_f32 v231, v231
    v_mfma_f32_16x16x32_bf16 v[40:43], a[184:187], v[216:219], v[40:43]
    v_add_f32 v20, v20, v231
    v_cvt_pk_bf16_f32 v229, v230, v231
    v_mfma_f32_16x16x32_bf16 v[44:47], a[156:159], v[212:215], v[44:47]
    v_exp_f32 v232, v232
    v_mfma_f32_16x16x32_bf16 v[44:47], a[188:191], v[216:219], v[44:47]
    buffer_load_dwordx4 v13, s[12:15], s28 offen offset:0 nt lds
    v_add_f32 v20, v20, v232
    v_mfma_f32_16x16x32_bf16 v[48:51], a[160:163], v[212:215], v[48:51]
    v_exp_f32 v233, v233
    v_mfma_f32_16x16x32_bf16 v[48:51], a[192:195], v[216:219], v[48:51]
    v_add_f32 v20, v20, v233
    v_cvt_pk_bf16_f32 v230, v232, v233
    v_mfma_f32_16x16x32_bf16 v[52:55], a[164:167], v[212:215], v[52:55]
    v_exp_f32 v234, v234
    v_mfma_f32_16x16x32_bf16 v[52:55], a[196:199], v[216:219], v[52:55]
    v_add_f32 v20, v20, v234
    s_waitcnt lgkmcnt(0)
    v_mfma_f32_16x16x32_bf16 v[56:59], a[168:171], v[212:215], v[56:59]
    v_exp_f32 v235, v235
    v_mfma_f32_16x16x32_bf16 v[56:59], a[200:203], v[216:219], v[56:59]
    v_add_f32 v20, v20, v235
    v_cvt_pk_bf16_f32 v231, v234, v235
    v_mfma_f32_16x16x32_bf16 v[60:63], a[172:175], v[212:215], v[60:63]
    v_exp_f32 v236, v236
    v_mfma_f32_16x16x32_bf16 v[60:63], a[204:207], v[216:219], v[60:63]
    buffer_load_dwordx4 v14, s[12:15], s28 offen offset:1024 nt lds
    v_add_f32 v20, v20, v236
    v_mfma_f32_16x16x32_bf16 v[212:215], a[80:83], a[32:35], v[200:203]
    v_exp_f32 v237, v237
    v_mfma_f32_16x16x32_bf16 v[212:215], a[84:87], a[36:39], v[212:215]
    v_add_f32 v20, v20, v237
    v_cvt_pk_bf16_f32 v232, v236, v237
    v_mfma_f32_16x16x32_bf16 v[212:215], a[88:91], a[40:43], v[212:215]
    v_exp_f32 v238, v238
    v_mfma_f32_16x16x32_bf16 v[212:215], a[92:95], a[44:47], v[212:215]
    buffer_load_dwordx4 v15, s[12:15], s28 offen offset:2048 nt lds
    v_add_f32 v20, v20, v238
    v_mfma_f32_16x16x32_bf16 v[216:219], a[96:99], a[32:35], v[200:203]
    v_exp_f32 v239, v239
    v_mfma_f32_16x16x32_bf16 v[216:219], a[100:103], a[36:39], v[216:219]
    v_add_f32 v20, v20, v239
    v_cvt_pk_bf16_f32 v233, v238, v239
    v_mfma_f32_16x16x32_bf16 v[216:219], a[104:107], a[40:43], v[216:219]
    v_exp_f32 v240, v240
    v_mfma_f32_16x16x32_bf16 v[216:219], a[108:111], a[44:47], v[216:219]
    buffer_load_dwordx4 v16, s[12:15], s28 offen offset:3072 nt lds
    v_add_f32 v20, v20, v240
    v_mfma_f32_16x16x32_bf16 v[220:223], a[112:115], a[32:35], v[200:203]
    v_exp_f32 v241, v241
    v_mfma_f32_16x16x32_bf16 v[220:223], a[116:119], a[36:39], v[220:223]
    v_add_f32 v20, v20, v241
    v_cvt_pk_bf16_f32 v234, v240, v241
    v_mfma_f32_16x16x32_bf16 v[220:223], a[120:123], a[40:43], v[220:223]
    v_exp_f32 v242, v242
    v_mfma_f32_16x16x32_bf16 v[220:223], a[124:127], a[44:47], v[220:223]
    s_add_u32 m0, m0, 65536
    v_add_f32 v20, v20, v242
    v_mfma_f32_16x16x32_bf16 v[224:227], a[128:131], a[32:35], v[200:203]
    v_exp_f32 v243, v243
    v_mfma_f32_16x16x32_bf16 v[224:227], a[132:135], a[36:39], v[224:227]
    v_add_f32 v20, v20, v243
    v_cvt_pk_bf16_f32 v235, v242, v243
    v_mfma_f32_16x16x32_bf16 v[224:227], a[136:139], a[40:43], v[224:227]
    v_exp_f32 v212, v212
    v_mfma_f32_16x16x32_bf16 v[224:227], a[140:143], a[44:47], v[224:227]
    buffer_load_dwordx4 v17, s[16:19], s28 offen offset:0 nt lds
    v_add_f32 v21, v21, v212
    v_mfma_f32_16x16x32_bf16 v[64:67], a[144:147], v[228:231], v[64:67]
    v_exp_f32 v213, v213
    v_mfma_f32_16x16x32_bf16 v[64:67], a[176:179], v[232:235], v[64:67]
    v_add_f32 v21, v21, v213
    v_cvt_pk_bf16_f32 v212, v212, v213
    v_mfma_f32_16x16x32_bf16 v[68:71], a[148:151], v[228:231], v[68:71]
    v_exp_f32 v214, v214
    v_mfma_f32_16x16x32_bf16 v[68:71], a[180:183], v[232:235], v[68:71]
    buffer_load_dwordx4 v18, s[16:19], s28 offen offset:1024 nt lds
    v_add_f32 v21, v21, v214
    v_mfma_f32_16x16x32_bf16 v[72:75], a[152:155], v[228:231], v[72:75]
    v_exp_f32 v215, v215
    v_mfma_f32_16x16x32_bf16 v[72:75], a[184:187], v[232:235], v[72:75]
    v_add_f32 v21, v21, v215
    v_cvt_pk_bf16_f32 v213, v214, v215
    v_mfma_f32_16x16x32_bf16 v[76:79], a[156:159], v[228:231], v[76:79]
    v_exp_f32 v216, v216
    v_mfma_f32_16x16x32_bf16 v[76:79], a[188:191], v[232:235], v[76:79]
    buffer_load_dwordx4 v17, s[16:19], s28 offen offset:2048 nt lds
    v_add_f32 v21, v21, v216
    v_mfma_f32_16x16x32_bf16 v[80:83], a[160:163], v[228:231], v[80:83]
    v_exp_f32 v217, v217
    v_mfma_f32_16x16x32_bf16 v[80:83], a[192:195], v[232:235], v[80:83]
    v_add_f32 v21, v21, v217
    v_cvt_pk_bf16_f32 v214, v216, v217
    v_mfma_f32_16x16x32_bf16 v[84:87], a[164:167], v[228:231], v[84:87]
    v_exp_f32 v218, v218
    v_mfma_f32_16x16x32_bf16 v[84:87], a[196:199], v[232:235], v[84:87]
    buffer_load_dwordx4 v18, s[16:19], s28 offen offset:3072 nt lds
    v_add_f32 v21, v21, v218
    v_mfma_f32_16x16x32_bf16 v[88:91], a[168:171], v[228:231], v[88:91]
    v_exp_f32 v219, v219
    v_mfma_f32_16x16x32_bf16 v[88:91], a[200:203], v[232:235], v[88:91]
    v_add_f32 v21, v21, v219
    v_cvt_pk_bf16_f32 v215, v218, v219
    v_mfma_f32_16x16x32_bf16 v[92:95], a[172:175], v[228:231], v[92:95]
    v_exp_f32 v220, v220
    v_mfma_f32_16x16x32_bf16 v[92:95], a[204:207], v[232:235], v[92:95]
    s_add_u32 s28, s28, 16384
    v_add_f32 v21, v21, v220
    v_mfma_f32_16x16x32_bf16 v[228:231], a[80:83], a[48:51], v[204:207]
    v_exp_f32 v221, v221
    v_mfma_f32_16x16x32_bf16 v[228:231], a[84:87], a[52:55], v[228:231]
    v_add_f32 v21, v21, v221
    v_cvt_pk_bf16_f32 v216, v220, v221
    v_mfma_f32_16x16x32_bf16 v[228:231], a[88:91], a[56:59], v[228:231]
    v_exp_f32 v222, v222
    v_mfma_f32_16x16x32_bf16 v[228:231], a[92:95], a[60:63], v[228:231]
    s_sub_u32 s30, s30, 1
    v_add_f32 v21, v21, v222
    v_mfma_f32_16x16x32_bf16 v[232:235], a[96:99], a[48:51], v[204:207]
    v_exp_f32 v223, v223
    v_mfma_f32_16x16x32_bf16 v[232:235], a[100:103], a[52:55], v[232:235]
    v_add_f32 v21, v21, v223
    v_cvt_pk_bf16_f32 v217, v222, v223
    v_mfma_f32_16x16x32_bf16 v[232:235], a[104:107], a[56:59], v[232:235]
    v_exp_f32 v224, v224
    v_mfma_f32_16x16x32_bf16 v[232:235], a[108:111], a[60:63], v[232:235]
    v_add_f32 v21, v21, v224
    v_mfma_f32_16x16x32_bf16 v[236:239], a[112:115], a[48:51], v[204:207]
    v_exp_f32 v225, v225
    v_mfma_f32_16x16x32_bf16 v[236:239], a[116:119], a[52:55], v[236:239]
    v_add_f32 v21, v21, v225
    v_cvt_pk_bf16_f32 v218, v224, v225
    v_mfma_f32_16x16x32_bf16 v[236:239], a[120:123], a[56:59], v[236:239]
    v_exp_f32 v226, v226
    v_mfma_f32_16x16x32_bf16 v[236:239], a[124:127], a[60:63], v[236:239]
    v_add_f32 v21, v21, v226
    v_mfma_f32_16x16x32_bf16 v[240:243], a[128:131], a[48:51], v[204:207]
    v_exp_f32 v227, v227
    v_mfma_f32_16x16x32_bf16 v[240:243], a[132:135], a[52:55], v[240:243]
    v_add_f32 v21, v21, v227
    v_cvt_pk_bf16_f32 v219, v226, v227
    v_mfma_f32_16x16x32_bf16 v[240:243], a[136:139], a[56:59], v[240:243]
    v_exp_f32 v228, v228
    v_mfma_f32_16x16x32_bf16 v[240:243], a[140:143], a[60:63], v[240:243]
    v_add_f32 v22, v22, v228
    v_mfma_f32_16x16x32_bf16 v[96:99], a[144:147], v[212:215], v[96:99]
    v_exp_f32 v229, v229
    v_mfma_f32_16x16x32_bf16 v[96:99], a[176:179], v[216:219], v[96:99]
    v_add_f32 v22, v22, v229
    v_cvt_pk_bf16_f32 v228, v228, v229
    v_mfma_f32_16x16x32_bf16 v[100:103], a[148:151], v[212:215], v[100:103]
    v_exp_f32 v230, v230
    v_mfma_f32_16x16x32_bf16 v[100:103], a[180:183], v[216:219], v[100:103]
    v_add_f32 v22, v22, v230
    v_mfma_f32_16x16x32_bf16 v[104:107], a[152:155], v[212:215], v[104:107]
    v_exp_f32 v231, v231
    v_mfma_f32_16x16x32_bf16 v[104:107], a[184:187], v[216:219], v[104:107]
    v_add_f32 v22, v22, v231
    v_cvt_pk_bf16_f32 v229, v230, v231
    v_mfma_f32_16x16x32_bf16 v[108:111], a[156:159], v[212:215], v[108:111]
    v_exp_f32 v232, v232
    v_mfma_f32_16x16x32_bf16 v[108:111], a[188:191], v[216:219], v[108:111]
    v_add_f32 v22, v22, v232
    v_mfma_f32_16x16x32_bf16 v[112:115], a[160:163], v[212:215], v[112:115]
    v_exp_f32 v233, v233
    v_mfma_f32_16x16x32_bf16 v[112:115], a[192:195], v[216:219], v[112:115]
    v_add_f32 v22, v22, v233
    v_cvt_pk_bf16_f32 v230, v232, v233
    v_mfma_f32_16x16x32_bf16 v[116:119], a[164:167], v[212:215], v[116:119]
    v_exp_f32 v234, v234
    v_mfma_f32_16x16x32_bf16 v[116:119], a[196:199], v[216:219], v[116:119]
    v_add_f32 v22, v22, v234
    v_mfma_f32_16x16x32_bf16 v[120:123], a[168:171], v[212:215], v[120:123]
    v_exp_f32 v235, v235
    v_mfma_f32_16x16x32_bf16 v[120:123], a[200:203], v[216:219], v[120:123]
    v_add_f32 v22, v22, v235
    v_cvt_pk_bf16_f32 v231, v234, v235
    v_mfma_f32_16x16x32_bf16 v[124:127], a[172:175], v[212:215], v[124:127]
    v_exp_f32 v236, v236
    v_mfma_f32_16x16x32_bf16 v[124:127], a[204:207], v[216:219], v[124:127]
    v_add_f32 v22, v22, v236
    s_waitcnt vmcnt(8)
    s_barrier
    v_exp_f32 v237, v237
    ds_read_b128 a[80:83], v1 offset:49152
    v_add_f32 v22, v22, v237
    v_cvt_pk_bf16_f32 v232, v236, v237
    v_exp_f32 v238, v238
    ds_read_b128 a[84:87], v2 offset:49152
    v_add_f32 v22, v22, v238
    v_exp_f32 v239, v239
    ds_read_b128 a[88:91], v3 offset:49152
    v_add_f32 v22, v22, v239
    v_cvt_pk_bf16_f32 v233, v238, v239
    v_exp_f32 v240, v240
    ds_read_b128 a[92:95], v4 offset:49152
    v_add_f32 v22, v22, v240
    v_exp_f32 v241, v241
    ds_read_b128 a[96:99], v1 offset:53248
    v_add_f32 v22, v22, v241
    v_cvt_pk_bf16_f32 v234, v240, v241
    v_exp_f32 v242, v242
    ds_read_b128 a[100:103], v2 offset:53248
    v_add_f32 v22, v22, v242
    v_exp_f32 v243, v243
    ds_read_b128 a[104:107], v3 offset:53248
    v_add_f32 v22, v22, v243
    v_cvt_pk_bf16_f32 v235, v242, v243
    ds_read_b128 a[108:111], v4 offset:53248
    v_mfma_f32_16x16x32_bf16 v[128:131], a[144:147], v[228:231], v[128:131]
    v_mfma_f32_16x16x32_bf16 v[128:131], a[176:179], v[232:235], v[128:131]
    ds_read_b128 a[112:115], v1 offset:57344
    v_mfma_f32_16x16x32_bf16 v[132:135], a[148:151], v[228:231], v[132:135]
    v_mfma_f32_16x16x32_bf16 v[132:135], a[180:183], v[232:235], v[132:135]
    ds_read_b128 a[116:119], v2 offset:57344
    v_mfma_f32_16x16x32_bf16 v[136:139], a[152:155], v[228:231], v[136:139]
    v_mfma_f32_16x16x32_bf16 v[136:139], a[184:187], v[232:235], v[136:139]
    ds_read_b128 a[120:123], v3 offset:57344
    v_mfma_f32_16x16x32_bf16 v[140:143], a[156:159], v[228:231], v[140:143]
    v_mfma_f32_16x16x32_bf16 v[140:143], a[188:191], v[232:235], v[140:143]
    ds_read_b128 a[124:127], v4 offset:57344
    v_mfma_f32_16x16x32_bf16 v[144:147], a[160:163], v[228:231], v[144:147]
    v_mfma_f32_16x16x32_bf16 v[144:147], a[192:195], v[232:235], v[144:147]
    ds_read_b128 a[128:131], v1 offset:61440
    v_mfma_f32_16x16x32_bf16 v[148:151], a[164:167], v[228:231], v[148:151]
    v_mfma_f32_16x16x32_bf16 v[148:151], a[196:199], v[232:235], v[148:151]
    ds_read_b128 a[132:135], v2 offset:61440
    s_cmp_eq_u32 s30, s40
    v_mfma_f32_16x16x32_bf16 v[152:155], a[168:171], v[228:231], v[152:155]
    v_mfma_f32_16x16x32_bf16 v[152:155], a[200:203], v[232:235], v[152:155]
    ds_read_b128 a[136:139], v3 offset:61440
    v_mfma_f32_16x16x32_bf16 v[156:159], a[172:175], v[228:231], v[156:159]
    v_mfma_f32_16x16x32_bf16 v[156:159], a[204:207], v[232:235], v[156:159]
    ds_read_b128 a[140:143], v4 offset:61440
    s_cbranch_scc1 L_exit_w3
L_b3_w3:
    s_waitcnt lgkmcnt(4)
    v_mfma_f32_16x16x32_bf16 v[228:231], a[80:83], a[0:3], v[192:195]
    v_mfma_f32_16x16x32_bf16 v[228:231], a[84:87], a[4:7], v[228:231]
    v_mfma_f32_16x16x32_bf16 v[228:231], a[88:91], a[8:11], v[228:231]
    v_mfma_f32_16x16x32_bf16 v[228:231], a[92:95], a[12:15], v[228:231]
    v_mfma_f32_16x16x32_bf16 v[232:235], a[96:99], a[0:3], v[192:195]
    v_mfma_f32_16x16x32_bf16 v[232:235], a[100:103], a[4:7], v[232:235]
    v_mfma_f32_16x16x32_bf16 v[232:235], a[104:107], a[8:11], v[232:235]
    v_mfma_f32_16x16x32_bf16 v[232:235], a[108:111], a[12:15], v[232:235]
    v_mfma_f32_16x16x32_bf16 v[236:239], a[112:115], a[0:3], v[192:195]
    v_mfma_f32_16x16x32_bf16 v[236:239], a[116:119], a[4:7], v[236:239]
    v_mfma_f32_16x16x32_bf16 v[236:239], a[120:123], a[8:11], v[236:239]
    v_mfma_f32_16x16x32_bf16 v[236:239], a[124:127], a[12:15], v[236:239]
    s_waitcnt lgkmcnt(0)
    v_mfma_f32_16x16x32_bf16 v[240:243], a[128:131], a[0:3], v[192:195]
    v_mfma_f32_16x16x32_bf16 v[240:243], a[132:135], a[4:7], v[240:243]
    v_mfma_f32_16x16x32_bf16 v[240:243], a[136:139], a[8:11], v[240:243]
    v_exp_f32 v228, v228
    v_mfma_f32_16x16x32_bf16 v[240:243], a[140:143], a[12:15], v[240:243]
    v_add_f32 v19, v19, v228
L_b3g1_w3:
    v_exp_f32 v229, v229
    ds_read_b64_tr_b16 a[144:145], v5 offset:49152
    ds_read_b64_tr_b16 a[146:147], v5 offset:53248
    v_add_f32 v19, v19, v229
    v_cvt_pk_bf16_f32 v228, v228, v229
    v_exp_f32 v230, v230
    ds_read_b64_tr_b16 a[176:177], v5 offset:57344
    ds_read_b64_tr_b16 a[178:179], v5 offset:61440
    v_add_f32 v19, v19, v230
    v_exp_f32 v231, v231
    ds_read_b64_tr_b16 a[148:149], v6 offset:49152
    ds_read_b64_tr_b16 a[150:151], v6 offset:53248
    v_add_f32 v19, v19, v231
    v_cvt_pk_bf16_f32 v229, v230, v231
    v_exp_f32 v232, v232
    ds_read_b64_tr_b16 a[180:181], v6 offset:57344
    ds_read_b64_tr_b16 a[182:183], v6 offset:61440
    v_add_f32 v19, v19, v232
    v_exp_f32 v233, v233
    ds_read_b64_tr_b16 a[152:153], v7 offset:49152
    ds_read_b64_tr_b16 a[154:155], v7 offset:53248
    v_add_f32 v19, v19, v233
    v_cvt_pk_bf16_f32 v230, v232, v233
    v_exp_f32 v234, v234
    ds_read_b64_tr_b16 a[184:185], v7 offset:57344
    ds_read_b64_tr_b16 a[186:187], v7 offset:61440
    v_add_f32 v19, v19, v234
    v_exp_f32 v235, v235
    ds_read_b64_tr_b16 a[156:157], v8 offset:49152
    ds_read_b64_tr_b16 a[158:159], v8 offset:53248
    v_add_f32 v19, v19, v235
    v_cvt_pk_bf16_f32 v231, v234, v235
    v_exp_f32 v236, v236
    ds_read_b64_tr_b16 a[188:189], v8 offset:57344
    ds_read_b64_tr_b16 a[190:191], v8 offset:61440
    v_add_f32 v19, v19, v236
    v_mfma_f32_16x16x32_bf16 v[212:215], a[80:83], a[16:19], v[196:199]
    v_exp_f32 v237, v237
    v_mfma_f32_16x16x32_bf16 v[212:215], a[84:87], a[20:23], v[212:215]
    ds_read_b64_tr_b16 a[160:161], v9 offset:49152
    ds_read_b64_tr_b16 a[162:163], v9 offset:53248
    v_add_f32 v19, v19, v237
    v_cvt_pk_bf16_f32 v232, v236, v237
    v_mfma_f32_16x16x32_bf16 v[212:215], a[88:91], a[24:27], v[212:215]
    v_exp_f32 v238, v238
    v_mfma_f32_16x16x32_bf16 v[212:215], a[92:95], a[28:31], v[212:215]
    ds_read_b64_tr_b16 a[192:193], v9 offset:57344
    ds_read_b64_tr_b16 a[194:195], v9 offset:61440
    v_add_f32 v19, v19, v238
    v_mfma_f32_16x16x32_bf16 v[216:219], a[96:99], a[16:19], v[196:199]
    v_exp_f32 v239, v239
    v_mfma_f32_16x16x32_bf16 v[216:219], a[100:103], a[20:23], v[216:219]
    ds_read_b64_tr_b16 a[164:165], v10 offset:49152
    ds_read_b64_tr_b16 a[166:167], v10 offset:53248
    v_add_f32 v19, v19, v239
    v_cvt_pk_bf16_f32 v233, v238, v239
    v_mfma_f32_16x16x32_bf16 v[216:219], a[104:107], a[24:27], v[216:219]
    v_exp_f32 v240, v240
    v_mfma_f32_16x16x32_bf16 v[216:219], a[108:111], a[28:31], v[216:219]
    ds_read_b64_tr_b16 a[196:197], v10 offset:57344
    ds_read_b64_tr_b16 a[198:199], v10 offset:61440
    v_add_f32 v19, v19, v240
    v_mfma_f32_16x16x32_bf16 v[220:223], a[112:115], a[16:19], v[196:199]
    v_exp_f32 v241, v241
    v_mfma_f32_16x16x32_bf16 v[220:223], a[116:119], a[20:23], v[220:223]
    ds_read_b64_tr_b16 a[168:169], v11 offset:49152
    ds_read_b64_tr_b16 a[170:171], v11 offset:53248
    v_add_f32 v19, v19, v241
    v_cvt_pk_bf16_f32 v234, v240, v241
    v_mfma_f32_16x16x32_bf16 v[220:223], a[120:123], a[24:27], v[220:223]
    v_exp_f32 v242, v242
    v_mfma_f32_16x16x32_bf16 v[220:223], a[124:127], a[28:31], v[220:223]
    ds_read_b64_tr_b16 a[200:201], v11 offset:57344
    ds_read_b64_tr_b16 a[202:203], v11 offset:61440
    v_add_f32 v19, v19, v242
    v_mfma_f32_16x16x32_bf16 v[224:227], a[128:131], a[16:19], v[196:199]
    v_exp_f32 v243, v243
    v_mfma_f32_16x16x32_bf16 v[224:227], a[132:135], a[20:23], v[224:227]
    ds_read_b64_tr_b16 a[172:173], v12 offset:49152
    ds_read_b64_tr_b16 a[174:175], v12 offset:53248
    v_add_f32 v19, v19, v243
    v_cvt_pk_bf16_f32 v235, v242, v243
    v_mfma_f32_16x16x32_bf16 v[224:227], a[136:139], a[24:27], v[224:227]
    v_exp_f32 v212, v212
    v_mfma_f32_16x16x32_bf16 v[224:227], a[140:143], a[28:31], v[224:227]
    ds_read_b64_tr_b16 a[204:205], v12 offset:57344
    ds_read_b64_tr_b16 a[206:207], v12 offset:61440
    v_add_f32 v20, v20, v212
    s_waitcnt lgkmcnt(8)
    v_mfma_f32_16x16x32_bf16 v[32:35], a[144:147], v[228:231], v[32:35]
    v_exp_f32 v213, v213
    v_mfma_f32_16x16x32_bf16 v[32:35], a[176:179], v[232:235], v[32:35]
    v_add_f32 v20, v20, v213
    v_cvt_pk_bf16_f32 v212, v212, v213
    v_mfma_f32_16x16x32_bf16 v[36:39], a[148:151], v[228:231], v[36:39]
    v_exp_f32 v214, v214
    v_mfma_f32_16x16x32_bf16 v[36:39], a[180:183], v[232:235], v[36:39]
    s_and_b32 m0, s28, 0xffff
    v_add_f32 v20, v20, v214
    v_mfma_f32_16x16x32_bf16 v[40:43], a[152:155], v[228:231], v[40:43]
    v_exp_f32 v215, v215
    v_mfma_f32_16x16x32_bf16 v[40:43], a[184:187], v[232:235], v[40:43]
    v_add_f32 v20, v20, v215
    v_cvt_pk_bf16_f32 v213, v214, v215
    v_mfma_f32_16x16x32_bf16 v[44:47], a[156:159], v[228:231], v[44:47]
    v_exp_f32 v216, v216
    v_mfma_f32_16x16x32_bf16 v[44:47], a[188:191], v[232:235], v[44:47]
    buffer_load_dwordx4 v13, s[12:15], s28 offen offset:0 nt lds
    v_add_f32 v20, v20, v216
    v_mfma_f32_16x16x32_bf16 v[48:51], a[160:163], v[228:231], v[48:51]
    v_exp_f32 v217, v217
    v_mfma_f32_16x16x32_bf16 v[48:51], a[192:195], v[232:235], v[48:51]
    v_add_f32 v20, v20, v217
    v_cvt_pk_bf16_f32 v214, v216, v217
    v_mfma_f32_16x16x32_bf16 v[52:55], a[164:167], v[228:231], v[52:55]
    v_exp_f32 v218, v218
    v_mfma_f32_16x16x32_bf16 v[52:55], a[196:199], v[232:235], v[52:55]
    v_add_f32 v20, v20, v218
    s_waitcnt lgkmcnt(0)
    v_mfma_f32_16x16x32_bf16 v[56:59], a[168:171], v[228:231], v[56:59]
    v_exp_f32 v219, v219
    v_mfma_f32_16x16x32_bf16 v[56:59], a[200:203], v[232:235], v[56:59]
    v_add_f32 v20, v20, v219
    v_cvt_pk_bf16_f32 v215, v218, v219
    v_mfma_f32_16x16x32_bf16 v[60:63], a[172:175], v[228:231], v[60:63]
    v_exp_f32 v220, v220
    v_mfma_f32_16x16x32_bf16 v[60:63], a[204:207], v[232:235], v[60:63]
    buffer_load_dwordx4 v14, s[12:15], s28 offen offset:1024 nt lds
    v_add_f32 v20, v20, v220
    v_mfma_f32_16x16x32_bf16 v[228:231], a[80:83], a[32:35], v[200:203]
    v_exp_f32 v221, v221
    v_mfma_f32_16x16x32_bf16 v[228:231], a[84:87], a[36:39], v[228:231]
    v_add_f32 v20, v20, v221
    v_cvt_pk_bf16_f32 v216, v220, v221
    v_mfma_f32_16x16x32_bf16 v[228:231], a[88:91], a[40:43], v[228:231]
    v_exp_f32 v222, v222
    v_mfma_f32_16x16x32_bf16 v[228:231], a[92:95], a[44:47], v[228:231]
    buffer_load_dwordx4 v15, s[12:15], s28 offen offset:2048 nt lds
    v_add_f32 v20, v20, v222
    v_mfma_f32_16x16x32_bf16 v[232:235], a[96:99], a[32:35], v[200:203]
    v_exp_f32 v223, v223
    v_mfma_f32_16x16x32_bf16 v[232:235], a[100:103], a[36:39], v[232:235]
    v_add_f32 v20, v20, v223
    v_cvt_pk_bf16_f32 v217, v222, v223
    v_mfma_f32_16x16x32_bf16 v[232:235], a[104:107], a[40:43], v[232:235]
    v_exp_f32 v224, v224
    v_mfma_f32_16x16x32_bf16 v[232:235], a[108:111], a[44:47], v[232:235]
    buffer_load_dwordx4 v16, s[12:15], s28 offen offset:3072 nt lds
    v_add_f32 v20, v20, v224
    v_mfma_f32_16x16x32_bf16 v[236:239], a[112:115], a[32:35], v[200:203]
    v_exp_f32 v225, v225
    v_mfma_f32_16x16x32_bf16 v[236:239], a[116:119], a[36:39], v[236:239]
    v_add_f32 v20, v20, v225
    v_cvt_pk_bf16_f32 v218, v224, v225
    v_mfma_f32_16x16x32_bf16 v[236:239], a[120:123], a[40:43], v[236:239]
    v_exp_f32 v226, v226
    v_mfma_f32_16x16x32_bf16 v[236:239], a[124:127], a[44:47], v[236:239]
    s_add_u32 m0, m0, 65536
    v_add_f32 v20, v20, v226
    v_mfma_f32_16x16x32_bf16 v[240:243], a[128:131], a[32:35], v[200:203]
    v_exp_f32 v227, v227
    v_mfma_f32_16x16x32_bf16 v[240:243], a[132:135], a[36:39], v[240:243]
    v_add_f32 v20, v20, v227
    v_cvt_pk_bf16_f32 v219, v226, v227
    v_mfma_f32_16x16x32_bf16 v[240:243], a[136:139], a[40:43], v[240:243]
    v_exp_f32 v228, v228
    v_mfma_f32_16x16x32_bf16 v[240:243], a[140:143], a[44:47], v[240:243]
    buffer_load_dwordx4 v17, s[16:19], s28 offen offset:0 nt lds
    v_add_f32 v21, v21, v228
    v_mfma_f32_16x16x32_bf16 v[64:67], a[144:147], v[212:215], v[64:67]
    v_exp_f32 v229, v229
    v_mfma_f32_16x16x32_bf16 v[64:67], a[176:179], v[216:219], v[64:67]
    v_add_f32 v21, v21, v229
    v_cvt_pk_bf16_f32 v228, v228, v229
    v_mfma_f32_16x16x32_bf16 v[68:71], a[148:151], v[212:215], v[68:71]
    v_exp_f32 v230, v230
    v_mfma_f32_16x16x32_bf16 v[68:71], a[180:183], v[216:219], v[68:71]
    buffer_load_dwordx4 v18, s[16:19], s28 offen offset:1024 nt lds
    v_add_f32 v21, v21, v230
    v_mfma_f32_16x16x32_bf16 v[72:75], a[152:155], v[212:215], v[72:75]
    v_exp_f32 v231, v231
    v_mfma_f32_16x16x32_bf16 v[72:75], a[184:187], v[216:219], v[72:75]
    v_add_f32 v21, v21, v231
    v_cvt_pk_bf16_f32 v229, v230, v231
    v_mfma_f32_16x16x32_bf16 v[76:79], a[156:159], v[212:215], v[76:79]
    v_exp_f32 v232, v232
    v_mfma_f32_16x16x32_bf16 v[76:79], a[188:191], v[216:219], v[76:79]
    buffer_load_dwordx4 v17, s[16:19], s28 offen offset:2048 nt lds
    v_add_f32 v21, v21, v232
    v_mfma_f32_16x16x32_bf16 v[80:83], a[160:163], v[212:215], v[80:83]
    v_exp_f32 v233, v233
    v_mfma_f32_16x16x32_bf16 v[80:83], a[192:195], v[216:219], v[80:83]
    v_add_f32 v21, v21, v233
    v_cvt_pk_bf16_f32 v230, v232, v233
    v_mfma_f32_16x16x32_bf16 v[84:87], a[164:167], v[212:215], v[84:87]
    v_exp_f32 v234, v234
    v_mfma_f32_16x16x32_bf16 v[84:87], a[196:199], v[216:219], v[84:87]
    buffer_load_dwordx4 v18, s[16:19], s28 offen offset:3072 nt lds
    v_add_f32 v21, v21, v234
    v_mfma_f32_16x16x32_bf16 v[88:91], a[168:171], v[212:215], v[88:91]
    v_exp_f32 v235, v235
    v_mfma_f32_16x16x32_bf16 v[88:91], a[200:203], v[216:219], v[88:91]
    v_add_f32 v21, v21, v235
    v_cvt_pk_bf16_f32 v231, v234, v235
    v_mfma_f32_16x16x32_bf16 v[92:95], a[172:175], v[212:215], v[92:95]
    v_exp_f32 v236, v236
    v_mfma_f32_16x16x32_bf16 v[92:95], a[204:207], v[216:219], v[92:95]
    s_add_u32 s28, s28, 16384
    v_add_f32 v21, v21, v236
    v_mfma_f32_16x16x32_bf16 v[212:215], a[80:83], a[48:51], v[204:207]
    v_exp_f32 v237, v237
    v_mfma_f32_16x16x32_bf16 v[212:215], a[84:87], a[52:55], v[212:215]
    v_add_f32 v21, v21, v237
    v_cvt_pk_bf16_f32 v232, v236, v237
    v_mfma_f32_16x16x32_bf16 v[212:215], a[88:91], a[56:59], v[212:215]
    v_exp_f32 v238, v238
    v_mfma_f32_16x16x32_bf16 v[212:215], a[92:95], a[60:63], v[212:215]
    s_sub_u32 s43, s30, s40
    v_add_f32 v21, v21, v238
    v_mfma_f32_16x16x32_bf16 v[216:219], a[96:99], a[48:51], v[204:207]
    v_exp_f32 v239, v239
    v_mfma_f32_16x16x32_bf16 v[216:219], a[100:103], a[52:55], v[216:219]
    v_add_f32 v21, v21, v239
    v_cvt_pk_bf16_f32 v233, v238, v239
    v_mfma_f32_16x16x32_bf16 v[216:219], a[104:107], a[56:59], v[216:219]
    v_exp_f32 v240, v240
    v_mfma_f32_16x16x32_bf16 v[216:219], a[108:111], a[60:63], v[216:219]
    s_cmp_eq_u32 s43, 3
    v_add_f32 v21, v21, v240
    v_mfma_f32_16x16x32_bf16 v[220:223], a[112:115], a[48:51], v[204:207]
    v_exp_f32 v241, v241
    v_mfma_f32_16x16x32_bf16 v[220:223], a[116:119], a[52:55], v[220:223]
    v_add_f32 v21, v21, v241
    v_cvt_pk_bf16_f32 v234, v240, v241
    v_mfma_f32_16x16x32_bf16 v[220:223], a[120:123], a[56:59], v[220:223]
    v_exp_f32 v242, v242
    v_mfma_f32_16x16x32_bf16 v[220:223], a[124:127], a[60:63], v[220:223]
    v_add_f32 v21, v21, v242
    v_mfma_f32_16x16x32_bf16 v[224:227], a[128:131], a[48:51], v[204:207]
    v_exp_f32 v243, v243
    v_mfma_f32_16x16x32_bf16 v[224:227], a[132:135], a[52:55], v[224:227]
    v_add_f32 v21, v21, v243
    v_cvt_pk_bf16_f32 v235, v242, v243
    v_mfma_f32_16x16x32_bf16 v[224:227], a[136:139], a[56:59], v[224:227]
    v_exp_f32 v212, v212
    v_mfma_f32_16x16x32_bf16 v[224:227], a[140:143], a[60:63], v[224:227]
    v_add_f32 v22, v22, v212
    v_mfma_f32_16x16x32_bf16 v[96:99], a[144:147], v[228:231], v[96:99]
    v_exp_f32 v213, v213
    v_mfma_f32_16x16x32_bf16 v[96:99], a[176:179], v[232:235], v[96:99]
    v_add_f32 v22, v22, v213
    v_cvt_pk_bf16_f32 v212, v212, v213
    v_mfma_f32_16x16x32_bf16 v[100:103], a[148:151], v[228:231], v[100:103]
    v_exp_f32 v214, v214
    v_mfma_f32_16x16x32_bf16 v[100:103], a[180:183], v[232:235], v[100:103]
    v_add_f32 v22, v22, v214
    v_mfma_f32_16x16x32_bf16 v[104:107], a[152:155], v[228:231], v[104:107]
    v_exp_f32 v215, v215
    v_mfma_f32_16x16x32_bf16 v[104:107], a[184:187], v[232:235], v[104:107]
    v_add_f32 v22, v22, v215
    v_cvt_pk_bf16_f32 v213, v214, v215
    v_mfma_f32_16x16x32_bf16 v[108:111], a[156:159], v[228:231], v[108:111]
    v_exp_f32 v216, v216
    v_mfma_f32_16x16x32_bf16 v[108:111], a[188:191], v[232:235], v[108:111]
    v_add_f32 v22, v22, v216
    v_mfma_f32_16x16x32_bf16 v[112:115], a[160:163], v[228:231], v[112:115]
    v_exp_f32 v217, v217
    v_mfma_f32_16x16x32_bf16 v[112:115], a[192:195], v[232:235], v[112:115]
    v_add_f32 v22, v22, v217
    v_cvt_pk_bf16_f32 v214, v216, v217
    v_mfma_f32_16x16x32_bf16 v[116:119], a[164:167], v[228:231], v[116:119]
    v_exp_f32 v218, v218
    v_mfma_f32_16x16x32_bf16 v[116:119], a[196:199], v[232:235], v[116:119]
    v_add_f32 v22, v22, v218
    v_mfma_f32_16x16x32_bf16 v[120:123], a[168:171], v[228:231], v[120:123]
    v_exp_f32 v219, v219
    v_mfma_f32_16x16x32_bf16 v[120:123], a[200:203], v[232:235], v[120:123]
    v_add_f32 v22, v22, v219
    v_cvt_pk_bf16_f32 v215, v218, v219
    v_mfma_f32_16x16x32_bf16 v[124:127], a[172:175], v[228:231], v[124:127]
    v_exp_f32 v220, v220
    v_mfma_f32_16x16x32_bf16 v[124:127], a[204:207], v[232:235], v[124:127]
    v_add_f32 v22, v22, v220
    s_waitcnt vmcnt(8)
    s_barrier
    v_exp_f32 v221, v221
    ds_read_b128 a[80:83], v1 offset:0
    v_add_f32 v22, v22, v221
    v_cvt_pk_bf16_f32 v216, v220, v221
    v_exp_f32 v222, v222
    ds_read_b128 a[84:87], v2 offset:0
    v_add_f32 v22, v22, v222
    v_exp_f32 v223, v223
    ds_read_b128 a[88:91], v3 offset:0
    v_add_f32 v22, v22, v223
    v_cvt_pk_bf16_f32 v217, v222, v223
    v_exp_f32 v224, v224
    ds_read_b128 a[92:95], v4 offset:0
    v_add_f32 v22, v22, v224
    v_exp_f32 v225, v225
    ds_read_b128 a[96:99], v1 offset:4096
    v_add_f32 v22, v22, v225
    v_cvt_pk_bf16_f32 v218, v224, v225
    v_exp_f32 v226, v226
    ds_read_b128 a[100:103], v2 offset:4096
    v_add_f32 v22, v22, v226
    v_exp_f32 v227, v227
    ds_read_b128 a[104:107], v3 offset:4096
    v_add_f32 v22, v22, v227
    v_cvt_pk_bf16_f32 v219, v226, v227
    ds_read_b128 a[108:111], v4 offset:4096
    v_mfma_f32_16x16x32_bf16 v[128:131], a[144:147], v[212:215], v[128:131]
    v_mfma_f32_16x16x32_bf16 v[128:131], a[176:179], v[216:219], v[128:131]
    ds_read_b128 a[112:115], v1 offset:8192
    v_mfma_f32_16x16x32_bf16 v[132:135], a[148:151], v[212:215], v[132:135]
    v_mfma_f32_16x16x32_bf16 v[132:135], a[180:183], v[216:219], v[132:135]
    ds_read_b128 a[116:119], v2 offset:8192
    v_mfma_f32_16x16x32_bf16 v[136:139], a[152:155], v[212:215], v[136:139]
    v_mfma_f32_16x16x32_bf16 v[136:139], a[184:187], v[216:219], v[136:139]
    ds_read_b128 a[120:123], v3 offset:8192
    v_mfma_f32_16x16x32_bf16 v[140:143], a[156:159], v[212:215], v[140:143]
    v_mfma_f32_16x16x32_bf16 v[140:143], a[188:191], v[216:219], v[140:143]
    ds_read_b128 a[124:127], v4 offset:8192
    v_mfma_f32_16x16x32_bf16 v[144:147], a[160:163], v[212:215], v[144:147]
    v_mfma_f32_16x16x32_bf16 v[144:147], a[192:195], v[216:219], v[144:147]
    ds_read_b128 a[128:131], v1 offset:12288
    v_mfma_f32_16x16x32_bf16 v[148:151], a[164:167], v[212:215], v[148:151]
    v_mfma_f32_16x16x32_bf16 v[148:151], a[196:199], v[216:219], v[148:151]
    ds_read_b128 a[132:135], v2 offset:12288
    v_mfma_f32_16x16x32_bf16 v[152:155], a[168:171], v[212:215], v[152:155]
    v_mfma_f32_16x16x32_bf16 v[152:155], a[200:203], v[216:219], v[152:155]
    ds_read_b128 a[136:139], v3 offset:12288
    v_mfma_f32_16x16x32_bf16 v[156:159], a[172:175], v[212:215], v[156:159]
    v_mfma_f32_16x16x32_bf16 v[156:159], a[204:207], v[216:219], v[156:159]
    ds_read_b128 a[140:143], v4 offset:12288
    s_cbranch_vccnz L_backb_w3
    s_cbranch_scc1 L_qa3_w3
    s_cmp_eq_u32 s43, 2
    s_cbranch_scc1 L_qa2_w3
    s_branch L_qa1_w3
L_backb_w3:
    s_cbranch_scc1 L_qb3_w3
    s_cmp_eq_u32 s43, 2
    s_cbranch_scc1 L_qb2_w3
    s_branch L_qb1_w3
L_qlds_w3:
    s_cbranch_scc0 L_qm41_w3
    s_cmp_eq_u32 s30, 2
    s_cbranch_scc1 L_qm2_w3
L_qm3_w3:
    s_waitcnt lgkmcnt(4)
    v_mfma_f32_16x16x32_bf16 v[212:215], a[80:83], a[0:3], v[192:195]
    v_add_u32 v244, s99, v1
    v_add_u32 v245, s99, v2
    v_mfma_f32_16x16x32_bf16 v[212:215], a[84:87], a[4:7], v[212:215]
    v_add_u32 v246, s99, v3
    v_add_u32 v247, s99, v4
    v_mfma_f32_16x16x32_bf16 v[212:215], a[88:91], a[8:11], v[212:215]
    ds_read_b128 a[208:211], v244 offset:0
    ds_read_b128 a[212:215], v245 offset:0
    s_add_u32 m0, s99, 4096
    s_add_u32 s42, s100, 12288
    v_mfma_f32_16x16x32_bf16 v[212:215], a[92:95], a[12:15], v[212:215]
    buffer_load_dwordx4 v15, s[20:23], s42 offen offset:2048 nt lds
    v_mfma_f32_16x16x32_bf16 v[216:219], a[96:99], a[0:3], v[192:195]
    ds_read_b128 a[216:219], v246 offset:0
    v_mfma_f32_16x16x32_bf16 v[216:219], a[100:103], a[4:7], v[216:219]
    ds_read_b128 a[220:223], v247 offset:0
    v_mfma_f32_16x16x32_bf16 v[216:219], a[104:107], a[8:11], v[216:219]
    v_mfma_f32_16x16x32_bf16 v[216:219], a[108:111], a[12:15], v[216:219]
    v_mfma_f32_16x16x32_bf16 v[220:223], a[112:115], a[0:3], v[192:195]
    v_mfma_f32_16x16x32_bf16 v[220:223], a[116:119], a[4:7], v[220:223]
    buffer_load_dwordx4 v16, s[20:23], s42 offen offset:3072 nt lds
    v_mfma_f32_16x16x32_bf16 v[220:223], a[120:123], a[8:11], v[220:223]
    v_mfma_f32_16x16x32_bf16 v[220:223], a[124:127], a[12:15], v[220:223]
    s_waitcnt lgkmcnt(2)
    v_mfma_f32_16x16x32_bf16 v[224:227], a[128:131], a[0:3], v[192:195]
    v_mfma_f32_16x16x32_bf16 v[224:227], a[132:135], a[4:7], v[224:227]
    v_accvgpr_read_b32 v245, a208
    v_accvgpr_read_b32 v247, a209
    v_accvgpr_read_b32 v249, a210
    v_accvgpr_read_b32 v251, a211
    v_lshlrev_b32 v244, 16, v245
    v_lshlrev_b32 v246, 16, v247
    v_lshlrev_b32 v248, 16, v249
    v_lshlrev_b32 v250, 16, v251
    v_and_b32 v245, s37, v245
    v_and_b32 v247, s37, v247
    v_and_b32 v249, s37, v249
    v_and_b32 v251, s37, v251
    v_pk_mul_f32 v[244:245], v[244:245], s[34:35]
    v_pk_mul_f32 v[246:247], v[246:247], s[34:35]
    v_pk_mul_f32 v[248:249], v[248:249], s[34:35]
    v_pk_mul_f32 v[250:251], v[250:251], s[34:35]
    v_cvt_pk_bf16_f32 v244, v244, v245
    v_cvt_pk_bf16_f32 v246, v246, v247
    v_cvt_pk_bf16_f32 v248, v248, v249
    v_cvt_pk_bf16_f32 v250, v250, v251
    v_accvgpr_write_b32 a208, v244
    v_accvgpr_write_b32 a209, v246
    v_accvgpr_write_b32 a210, v248
    v_accvgpr_write_b32 a211, v250
    v_accvgpr_read_b32 v245, a212
    v_accvgpr_read_b32 v247, a213
    v_accvgpr_read_b32 v249, a214
    v_accvgpr_read_b32 v251, a215
    v_lshlrev_b32 v244, 16, v245
    v_lshlrev_b32 v246, 16, v247
    v_lshlrev_b32 v248, 16, v249
    v_lshlrev_b32 v250, 16, v251
    v_and_b32 v245, s37, v245
    v_and_b32 v247, s37, v247
    v_and_b32 v249, s37, v249
    v_and_b32 v251, s37, v251
    v_pk_mul_f32 v[244:245], v[244:245], s[34:35]
    v_pk_mul_f32 v[246:247], v[246:247], s[34:35]
    v_pk_mul_f32 v[248:249], v[248:249], s[34:35]
    v_pk_mul_f32 v[250:251], v[250:251], s[34:35]
    v_cvt_pk_bf16_f32 v244, v244, v245
    v_cvt_pk_bf16_f32 v246, v246, v247
    v_cvt_pk_bf16_f32 v248, v248, v249
    v_cvt_pk_bf16_f32 v250, v250, v251
    v_accvgpr_write_b32 a212, v244
    v_accvgpr_write_b32 a213, v246
    v_accvgpr_write_b32 a214, v248
    v_accvgpr_write_b32 a215, v250
    s_waitcnt lgkmcnt(0)
    v_accvgpr_read_b32 v245, a216
    v_accvgpr_read_b32 v247, a217
    v_accvgpr_read_b32 v249, a218
    v_accvgpr_read_b32 v251, a219
    v_lshlrev_b32 v244, 16, v245
    v_lshlrev_b32 v246, 16, v247
    v_lshlrev_b32 v248, 16, v249
    v_lshlrev_b32 v250, 16, v251
    v_and_b32 v245, s37, v245
    v_and_b32 v247, s37, v247
    v_and_b32 v249, s37, v249
    v_and_b32 v251, s37, v251
    v_pk_mul_f32 v[244:245], v[244:245], s[34:35]
    v_pk_mul_f32 v[246:247], v[246:247], s[34:35]
    v_pk_mul_f32 v[248:249], v[248:249], s[34:35]
    v_pk_mul_f32 v[250:251], v[250:251], s[34:35]
    v_cvt_pk_bf16_f32 v244, v244, v245
    v_cvt_pk_bf16_f32 v246, v246, v247
    v_cvt_pk_bf16_f32 v248, v248, v249
    v_cvt_pk_bf16_f32 v250, v250, v251
    v_accvgpr_write_b32 a216, v244
    v_accvgpr_write_b32 a217, v246
    v_accvgpr_write_b32 a218, v248
    v_accvgpr_write_b32 a219, v250
    v_accvgpr_read_b32 v245, a220
    v_accvgpr_read_b32 v247, a221
    v_accvgpr_read_b32 v249, a222
    v_accvgpr_read_b32 v251, a223
    v_lshlrev_b32 v244, 16, v245
    v_lshlrev_b32 v246, 16, v247
    v_lshlrev_b32 v248, 16, v249
    v_lshlrev_b32 v250, 16, v251
    v_and_b32 v245, s37, v245
    v_and_b32 v247, s37, v247
    v_and_b32 v249, s37, v249
    v_and_b32 v251, s37, v251
    v_pk_mul_f32 v[244:245], v[244:245], s[34:35]
    v_pk_mul_f32 v[246:247], v[246:247], s[34:35]
    v_pk_mul_f32 v[248:249], v[248:249], s[34:35]
    v_pk_mul_f32 v[250:251], v[250:251], s[34:35]
    v_cvt_pk_bf16_f32 v244, v244, v245
    v_cvt_pk_bf16_f32 v246, v246, v247
    v_cvt_pk_bf16_f32 v248, v248, v249
    v_cvt_pk_bf16_f32 v250, v250, v251
    v_accvgpr_write_b32 a220, v244
    v_accvgpr_write_b32 a221, v246
    v_accvgpr_write_b32 a222, v248
    v_accvgpr_write_b32 a223, v250
    v_mfma_f32_16x16x32_bf16 v[224:227], a[136:139], a[8:11], v[224:227]
    s_add_u32 m0, s99, 0
    s_add_u32 s42, s100, 16384
    v_exp_f32 v212, v212
    v_mfma_f32_16x16x32_bf16 v[224:227], a[140:143], a[12:15], v[224:227]
    buffer_load_dwordx4 v13, s[20:23], s42 offen offset:0 nt lds
    v_add_f32 v19, v19, v212
    s_branch L_b2g1_w3
L_qm2_w3:
    s_waitcnt lgkmcnt(4)
    v_mfma_f32_16x16x32_bf16 v[212:215], a[80:83], a[0:3], v[192:195]
    v_add_u32 v244, s99, v1
    v_add_u32 v245, s99, v2
    v_mfma_f32_16x16x32_bf16 v[212:215], a[84:87], a[4:7], v[212:215]
    v_add_u32 v246, s99, v3
    v_add_u32 v247, s99, v4
    v_mfma_f32_16x16x32_bf16 v[212:215], a[88:91], a[8:11], v[212:215]
    ds_read_b128 a[240:243], v244 offset:0
    ds_read_b128 a[244:247], v245 offset:0
    s_add_u32 m0, s99, 4096
    s_add_u32 s42, s100, 0
    v_mfma_f32_16x16x32_bf16 v[212:215], a[92:95], a[12:15], v[212:215]
    buffer_load_dwordx4 v13, s[20:23], s42 offen offset:0 nt lds
    v_mfma_f32_16x16x32_bf16 v[216:219], a[96:99], a[0:3], v[192:195]
    ds_read_b128 a[248:251], v246 offset:0
    v_mfma_f32_16x16x32_bf16 v[216:219], a[100:103], a[4:7], v[216:219]
    ds_read_b128 a[252:255], v247 offset:0
    v_mfma_f32_16x16x32_bf16 v[216:219], a[104:107], a[8:11], v[216:219]
    v_mfma_f32_16x16x32_bf16 v[216:219], a[108:111], a[12:15], v[216:219]
    v_mfma_f32_16x16x32_bf16 v[220:223], a[112:115], a[0:3], v[192:195]
    v_mfma_f32_16x16x32_bf16 v[220:223], a[116:119], a[4:7], v[220:223]
    buffer_load_dwordx4 v14, s[20:23], s42 offen offset:1024 nt lds
    v_mfma_f32_16x16x32_bf16 v[220:223], a[120:123], a[8:11], v[220:223]
    v_mfma_f32_16x16x32_bf16 v[220:223], a[124:127], a[12:15], v[220:223]
    s_waitcnt lgkmcnt(2)
    v_mfma_f32_16x16x32_bf16 v[224:227], a[128:131], a[0:3], v[192:195]
    v_mfma_f32_16x16x32_bf16 v[224:227], a[132:135], a[4:7], v[224:227]
    v_mfma_f32_16x16x32_bf16 v[224:227], a[136:139], a[8:11], v[224:227]
    v_exp_f32 v212, v212
    v_mfma_f32_16x16x32_bf16 v[224:227], a[140:143], a[12:15], v[224:227]
    buffer_load_dwordx4 v15, s[20:23], s42 offen offset:2048 nt lds
    v_add_f32 v19, v19, v212
    s_branch L_b2g1_w3
L_qm41_w3:
    s_cmp_eq_u32 s30, 1
    s_cbranch_scc1 L_qm1_w3
L_qm4_w3:
    s_waitcnt lgkmcnt(4)
    v_mfma_f32_16x16x32_bf16 v[212:215], a[80:83], a[0:3], v[192:195]
    v_mfma_f32_16x16x32_bf16 v[212:215], a[84:87], a[4:7], v[212:215]
    v_mfma_f32_16x16x32_bf16 v[212:215], a[88:91], a[8:11], v[212:215]
    s_add_u32 m0, s99, 0
    s_add_u32 s42, s100, 8192
    v_mfma_f32_16x16x32_bf16 v[212:215], a[92:95], a[12:15], v[212:215]
    buffer_load_dwordx4 v13, s[20:23], s42 offen offset:0 nt lds
    v_mfma_f32_16x16x32_bf16 v[216:219], a[96:99], a[0:3], v[192:195]
    v_mfma_f32_16x16x32_bf16 v[216:219], a[100:103], a[4:7], v[216:219]
    v_mfma_f32_16x16x32_bf16 v[216:219], a[104:107], a[8:11], v[216:219]
    v_mfma_f32_16x16x32_bf16 v[216:219], a[108:111], a[12:15], v[216:219]
    v_mfma_f32_16x16x32_bf16 v[220:223], a[112:115], a[0:3], v[192:195]
    v_mfma_f32_16x16x32_bf16 v[220:223], a[116:119], a[4:7], v[220:223]
    buffer_load_dwordx4 v14, s[20:23], s42 offen offset:1024 nt lds
    v_mfma_f32_16x16x32_bf16 v[220:223], a[120:123], a[8:11], v[220:223]
    v_mfma_f32_16x16x32_bf16 v[220:223], a[124:127], a[12:15], v[220:223]
    s_waitcnt lgkmcnt(0)
    v_mfma_f32_16x16x32_bf16 v[224:227], a[128:131], a[0:3], v[192:195]
    v_mfma_f32_16x16x32_bf16 v[224:227], a[132:135], a[4:7], v[224:227]
    v_mfma_f32_16x16x32_bf16 v[224:227], a[136:139], a[8:11], v[224:227]
    v_exp_f32 v212, v212
    v_mfma_f32_16x16x32_bf16 v[224:227], a[140:143], a[12:15], v[224:227]
    buffer_load_dwordx4 v15, s[20:23], s42 offen offset:2048 nt lds
    v_add_f32 v19, v19, v212
    s_branch L_b2g1_w3
L_qm1_w3:
    s_waitcnt lgkmcnt(4)
    v_mfma_f32_16x16x32_bf16 v[212:215], a[80:83], a[0:3], v[192:195]
    v_mfma_f32_16x16x32_bf16 v[212:215], a[84:87], a[4:7], v[212:215]
    v_mfma_f32_16x16x32_bf16 v[212:215], a[88:91], a[8:11], v[212:215]
    s_add_u32 m0, s99, 0
    s_add_u32 s42, s100, 4096
    v_mfma_f32_16x16x32_bf16 v[212:215], a[92:95], a[12:15], v[212:215]
    buffer_load_dwordx4 v15, s[20:23], s42 offen offset:2048 nt lds
    v_mfma_f32_16x16x32_bf16 v[216:219], a[96:99], a[0:3], v[192:195]
    v_mfma_f32_16x16x32_bf16 v[216:219], a[100:103], a[4:7], v[216:219]
    v_mfma_f32_16x16x32_bf16 v[216:219], a[104:107], a[8:11], v[216:219]
    v_mfma_f32_16x16x32_bf16 v[216:219], a[108:111], a[12:15], v[216:219]
    v_mfma_f32_16x16x32_bf16 v[220:223], a[112:115], a[0:3], v[192:195]
    v_mfma_f32_16x16x32_bf16 v[220:223], a[116:119], a[4:7], v[220:223]
    buffer_load_dwordx4 v16, s[20:23], s42 offen offset:3072 nt lds
    v_mfma_f32_16x16x32_bf16 v[220:223], a[120:123], a[8:11], v[220:223]
    v_mfma_f32_16x16x32_bf16 v[220:223], a[124:127], a[12:15], v[220:223]
    s_waitcnt lgkmcnt(0)
    v_mfma_f32_16x16x32_bf16 v[224:227], a[128:131], a[0:3], v[192:195]
    v_mfma_f32_16x16x32_bf16 v[224:227], a[132:135], a[4:7], v[224:227]
    v_mfma_f32_16x16x32_bf16 v[224:227], a[136:139], a[8:11], v[224:227]
    v_exp_f32 v212, v212
    v_mfma_f32_16x16x32_bf16 v[224:227], a[140:143], a[12:15], v[224:227]
    v_add_f32 v19, v19, v212
    s_branch L_b2g1_w3
L_exit_w3:
    s_cbranch_vccnz L_lastb_w3
    s_waitcnt lgkmcnt(4)
    v_mfma_f32_16x16x32_bf16 v[228:231], a[80:83], a[0:3], v[192:195]
    v_mfma_f32_16x16x32_bf16 v[228:231], a[84:87], a[4:7], v[228:231]
    s_and_b32 m0, s28, 0xffff
    v_mfma_f32_16x16x32_bf16 v[228:231], a[88:91], a[8:11], v[228:231]
    v_mfma_f32_16x16x32_bf16 v[228:231], a[92:95], a[12:15], v[228:231]
    v_add_u32 v252, s99, v1
    v_mfma_f32_16x16x32_bf16 v[232:235], a[96:99], a[0:3], v[192:195]
    v_mfma_f32_16x16x32_bf16 v[232:235], a[100:103], a[4:7], v[232:235]
    buffer_load_dwordx4 v13, s[12:15], s28 offen offset:0 nt lds
    v_mfma_f32_16x16x32_bf16 v[232:235], a[104:107], a[8:11], v[232:235]
    v_mfma_f32_16x16x32_bf16 v[232:235], a[108:111], a[12:15], v[232:235]
    v_add_u32 v253, s99, v2
    v_mfma_f32_16x16x32_bf16 v[236:239], a[112:115], a[0:3], v[192:195]
    v_mfma_f32_16x16x32_bf16 v[236:239], a[116:119], a[4:7], v[236:239]
    v_mfma_f32_16x16x32_bf16 v[236:239], a[120:123], a[8:11], v[236:239]
    v_mfma_f32_16x16x32_bf16 v[236:239], a[124:127], a[12:15], v[236:239]
    v_add_u32 v254, s99, v3
    s_waitcnt lgkmcnt(0)
    v_mfma_f32_16x16x32_bf16 v[240:243], a[128:131], a[0:3], v[192:195]
    v_mfma_f32_16x16x32_bf16 v[240:243], a[132:135], a[4:7], v[240:243]
    v_mfma_f32_16x16x32_bf16 v[240:243], a[136:139], a[8:11], v[240:243]
    v_exp_f32 v228, v228
    v_mfma_f32_16x16x32_bf16 v[240:243], a[140:143], a[12:15], v[240:243]
    v_add_f32 v19, v19, v228
    v_add_u32 v255, s99, v4
    ds_read_b128 a[0:3], v252 offset:4096
    ds_read_b128 a[4:7], v253 offset:4096
    ds_read_b128 a[8:11], v254 offset:4096
    ds_read_b128 a[12:15], v255 offset:4096
    v_exp_f32 v229, v229
    ds_read_b64_tr_b16 a[144:145], v5 offset:49152
    ds_read_b64_tr_b16 a[146:147], v5 offset:53248
    v_add_f32 v19, v19, v229
    v_cvt_pk_bf16_f32 v228, v228, v229
    v_exp_f32 v230, v230
    ds_read_b64_tr_b16 a[176:177], v5 offset:57344
    ds_read_b64_tr_b16 a[178:179], v5 offset:61440
    buffer_load_dwordx4 v14, s[12:15], s28 offen offset:1024 nt lds
    v_add_f32 v19, v19, v230
    v_exp_f32 v231, v231
    ds_read_b64_tr_b16 a[148:149], v6 offset:49152
    ds_read_b64_tr_b16 a[150:151], v6 offset:53248
    v_add_f32 v19, v19, v231
    v_cvt_pk_bf16_f32 v229, v230, v231
    v_exp_f32 v232, v232
    ds_read_b64_tr_b16 a[180:181], v6 offset:57344
    ds_read_b64_tr_b16 a[182:183], v6 offset:61440
    v_add_f32 v19, v19, v232
    v_exp_f32 v233, v233
    ds_read_b64_tr_b16 a[152:153], v7 offset:49152
    ds_read_b64_tr_b16 a[154:155], v7 offset:53248
    v_add_f32 v19, v19, v233
    v_cvt_pk_bf16_f32 v230, v232, v233
    v_exp_f32 v234, v234
    ds_read_b64_tr_b16 a[184:185], v7 offset:57344
    ds_read_b64_tr_b16 a[186:187], v7 offset:61440
    v_add_f32 v19, v19, v234
    buffer_load_dwordx4 v15, s[12:15], s28 offen offset:2048 nt lds
    v_exp_f32 v235, v235
    ds_read_b64_tr_b16 a[156:157], v8 offset:49152
    ds_read_b64_tr_b16 a[158:159], v8 offset:53248
    v_add_f32 v19, v19, v235
    v_cvt_pk_bf16_f32 v231, v234, v235
    s_waitcnt lgkmcnt(15)
    v_accvgpr_read_b32 v245, a0
    v_accvgpr_read_b32 v247, a1
    v_accvgpr_read_b32 v249, a2
    v_accvgpr_read_b32 v251, a3
    v_lshlrev_b32 v244, 16, v245
    v_lshlrev_b32 v246, 16, v247
    v_lshlrev_b32 v248, 16, v249
    v_lshlrev_b32 v250, 16, v251
    v_and_b32 v245, s37, v245
    v_and_b32 v247, s37, v247
    v_and_b32 v249, s37, v249
    v_and_b32 v251, s37, v251
    v_pk_mul_f32 v[244:245], v[244:245], s[34:35]
    v_pk_mul_f32 v[246:247], v[246:247], s[34:35]
    v_pk_mul_f32 v[248:249], v[248:249], s[34:35]
    v_pk_mul_f32 v[250:251], v[250:251], s[34:35]
    v_cvt_pk_bf16_f32 v244, v244, v245
    v_cvt_pk_bf16_f32 v246, v246, v247
    v_cvt_pk_bf16_f32 v248, v248, v249
    v_cvt_pk_bf16_f32 v250, v250, v251
    v_accvgpr_write_b32 a0, v244
    v_accvgpr_write_b32 a1, v246
    v_accvgpr_write_b32 a2, v248
    v_accvgpr_write_b32 a3, v250
    v_accvgpr_read_b32 v245, a4
    v_accvgpr_read_b32 v247, a5
    v_accvgpr_read_b32 v249, a6
    v_accvgpr_read_b32 v251, a7
    v_lshlrev_b32 v244, 16, v245
    v_lshlrev_b32 v246, 16, v247
    v_lshlrev_b32 v248, 16, v249
    v_lshlrev_b32 v250, 16, v251
    v_and_b32 v245, s37, v245
    v_and_b32 v247, s37, v247
    v_and_b32 v249, s37, v249
    v_and_b32 v251, s37, v251
    v_pk_mul_f32 v[244:245], v[244:245], s[34:35]
    v_pk_mul_f32 v[246:247], v[246:247], s[34:35]
    v_pk_mul_f32 v[248:249], v[248:249], s[34:35]
    v_pk_mul_f32 v[250:251], v[250:251], s[34:35]
    v_cvt_pk_bf16_f32 v244, v244, v245
    v_cvt_pk_bf16_f32 v246, v246, v247
    v_cvt_pk_bf16_f32 v248, v248, v249
    v_cvt_pk_bf16_f32 v250, v250, v251
    v_accvgpr_write_b32 a4, v244
    v_accvgpr_write_b32 a5, v246
    v_accvgpr_write_b32 a6, v248
    v_accvgpr_write_b32 a7, v250
    v_accvgpr_read_b32 v245, a8
    v_accvgpr_read_b32 v247, a9
    v_accvgpr_read_b32 v249, a10
    v_accvgpr_read_b32 v251, a11
    v_lshlrev_b32 v244, 16, v245
    v_lshlrev_b32 v246, 16, v247
    v_lshlrev_b32 v248, 16, v249
    v_lshlrev_b32 v250, 16, v251
    v_and_b32 v245, s37, v245
    v_and_b32 v247, s37, v247
    v_and_b32 v249, s37, v249
    v_and_b32 v251, s37, v251
    v_pk_mul_f32 v[244:245], v[244:245], s[34:35]
    v_pk_mul_f32 v[246:247], v[246:247], s[34:35]
    v_pk_mul_f32 v[248:249], v[248:249], s[34:35]
    v_pk_mul_f32 v[250:251], v[250:251], s[34:35]
    v_cvt_pk_bf16_f32 v244, v244, v245
    v_cvt_pk_bf16_f32 v246, v246, v247
    v_cvt_pk_bf16_f32 v248, v248, v249
    v_cvt_pk_bf16_f32 v250, v250, v251
    v_accvgpr_write_b32 a8, v244
    v_accvgpr_write_b32 a9, v246
    v_accvgpr_write_b32 a10, v248
    v_accvgpr_write_b32 a11, v250
    s_waitcnt lgkmcnt(14)
    v_accvgpr_read_b32 v245, a12
    v_accvgpr_read_b32 v247, a13
    v_accvgpr_read_b32 v249, a14
    v_accvgpr_read_b32 v251, a15
    v_lshlrev_b32 v244, 16, v245
    v_lshlrev_b32 v246, 16, v247
    v_lshlrev_b32 v248, 16, v249
    v_lshlrev_b32 v250, 16, v251
    v_and_b32 v245, s37, v245
    v_and_b32 v247, s37, v247
    v_and_b32 v249, s37, v249
    v_and_b32 v251, s37, v251
    v_pk_mul_f32 v[244:245], v[244:245], s[34:35]
    v_pk_mul_f32 v[246:247], v[246:247], s[34:35]
    v_pk_mul_f32 v[248:249], v[248:249], s[34:35]
    v_pk_mul_f32 v[250:251], v[250:251], s[34:35]
    v_cvt_pk_bf16_f32 v244, v244, v245
    v_cvt_pk_bf16_f32 v246, v246, v247
    v_cvt_pk_bf16_f32 v248, v248, v249
    v_cvt_pk_bf16_f32 v250, v250, v251
    v_accvgpr_write_b32 a12, v244
    v_accvgpr_write_b32 a13, v246
    v_accvgpr_write_b32 a14, v248
    v_accvgpr_write_b32 a15, v250
    v_exp_f32 v236, v236
    ds_read_b64_tr_b16 a[188:189], v8 offset:57344
    ds_read_b64_tr_b16 a[190:191], v8 offset:61440
    v_add_f32 v19, v19, v236
    v_mfma_f32_16x16x32_bf16 v[212:215], a[80:83], a[16:19], v[196:199]
    v_exp_f32 v237, v237
    v_mfma_f32_16x16x32_bf16 v[212:215], a[84:87], a[20:23], v[212:215]
    ds_read_b64_tr_b16 a[160:161], v9 offset:49152
    ds_read_b64_tr_b16 a[162:163], v9 offset:53248
    v_add_f32 v19, v19, v237
    v_cvt_pk_bf16_f32 v232, v236, v237
    v_mfma_f32_16x16x32_bf16 v[212:215], a[88:91], a[24:27], v[212:215]
    v_exp_f32 v238, v238
    v_mfma_f32_16x16x32_bf16 v[212:215], a[92:95], a[28:31], v[212:215]
    ds_read_b64_tr_b16 a[192:193], v9 offset:57344
    ds_read_b64_tr_b16 a[194:195], v9 offset:61440
    v_add_f32 v19, v19, v238
    v_mfma_f32_16x16x32_bf16 v[216:219], a[96:99], a[16:19], v[196:199]
    v_exp_f32 v239, v239
    v_mfma_f32_16x16x32_bf16 v[216:219], a[100:103], a[20:23], v[216:219]
    ds_read_b64_tr_b16 a[164:165], v10 offset:49152
    ds_read_b64_tr_b16 a[166:167], v10 offset:53248
    v_add_f32 v19, v19, v239
    v_cvt_pk_bf16_f32 v233, v238, v239
    v_mfma_f32_16x16x32_bf16 v[216:219], a[104:107], a[24:27], v[216:219]
    v_exp_f32 v240, v240
    v_mfma_f32_16x16x32_bf16 v[216:219], a[108:111], a[28:31], v[216:219]
    ds_read_b64_tr_b16 a[196:197], v10 offset:57344
    ds_read_b64_tr_b16 a[198:199], v10 offset:61440
    v_add_f32 v19, v19, v240
    v_mfma_f32_16x16x32_bf16 v[220:223], a[112:115], a[16:19], v[196:199]
    v_exp_f32 v241, v241
    v_mfma_f32_16x16x32_bf16 v[220:223], a[116:119], a[20:23], v[220:223]
    ds_read_b64_tr_b16 a[168:169], v11 offset:49152
    ds_read_b64_tr_b16 a[170:171], v11 offset:53248
    v_add_f32 v19, v19, v241
    v_cvt_pk_bf16_f32 v234, v240, v241
    v_mfma_f32_16x16x32_bf16 v[220:223], a[120:123], a[24:27], v[220:223]
    v_exp_f32 v242, v242
    v_mfma_f32_16x16x32_bf16 v[220:223], a[124:127], a[28:31], v[220:223]
    ds_read_b64_tr_b16 a[200:201], v11 offset:57344
    ds_read_b64_tr_b16 a[202:203], v11 offset:61440
    buffer_load_dwordx4 v16, s[12:15], s28 offen offset:3072 nt lds
    v_add_f32 v19, v19, v242
    v_mfma_f32_16x16x32_bf16 v[224:227], a[128:131], a[16:19], v[196:199]
    v_exp_f32 v243, v243
    v_mfma_f32_16x16x32_bf16 v[224:227], a[132:135], a[20:23], v[224:227]
    ds_read_b64_tr_b16 a[172:173], v12 offset:49152
    ds_read_b64_tr_b16 a[174:175], v12 offset:53248
    s_add_u32 m0, m0, 65536
    v_add_f32 v19, v19, v243
    v_cvt_pk_bf16_f32 v235, v242, v243
    v_mfma_f32_16x16x32_bf16 v[224:227], a[136:139], a[24:27], v[224:227]
    v_exp_f32 v212, v212
    v_mov_b32 v30, v19
    v_mfma_f32_16x16x32_bf16 v[224:227], a[140:143], a[28:31], v[224:227]
    ds_read_b64_tr_b16 a[204:205], v12 offset:57344
    ds_read_b64_tr_b16 a[206:207], v12 offset:61440
    v_add_f32 v20, v20, v212
    s_waitcnt vmcnt(12)
    s_waitcnt lgkmcnt(8)
    v_mfma_f32_16x16x32_bf16 v[32:35], a[144:147], v[228:231], v[32:35]
    ds_read_b128 a[16:19], v252 offset:0
    ds_read_b128 a[20:23], v253 offset:0
    ds_read_b128 a[24:27], v254 offset:0
    ds_read_b128 a[28:31], v255 offset:0
    v_exp_f32 v213, v213
    v_permlane16_swap_b32 v19, v30
    v_mfma_f32_16x16x32_bf16 v[32:35], a[176:179], v[232:235], v[32:35]
    v_add_f32 v20, v20, v213
    v_cvt_pk_bf16_f32 v212, v212, v213
    v_mfma_f32_16x16x32_bf16 v[36:39], a[148:151], v[228:231], v[36:39]
    v_exp_f32 v214, v214
    v_mfma_f32_16x16x32_bf16 v[36:39], a[180:183], v[232:235], v[36:39]
    v_add_f32 v20, v20, v214
    v_add_f32 v19, v19, v30
    v_mfma_f32_16x16x32_bf16 v[40:43], a[152:155], v[228:231], v[40:43]
    v_exp_f32 v215, v215
    v_mfma_f32_16x16x32_bf16 v[40:43], a[184:187], v[232:235], v[40:43]
    v_add_f32 v20, v20, v215
    v_cvt_pk_bf16_f32 v213, v214, v215
    v_mov_b32 v30, v19
    v_mfma_f32_16x16x32_bf16 v[44:47], a[156:159], v[228:231], v[44:47]
    v_exp_f32 v216, v216
    v_mfma_f32_16x16x32_bf16 v[44:47], a[188:191], v[232:235], v[44:47]
    buffer_load_dwordx4 v17, s[16:19], s28 offen offset:0 nt lds
    v_add_f32 v20, v20, v216
    v_permlane32_swap_b32 v19, v30
    v_mfma_f32_16x16x32_bf16 v[48:51], a[160:163], v[228:231], v[48:51]
    v_exp_f32 v217, v217
    v_mfma_f32_16x16x32_bf16 v[48:51], a[192:195], v[232:235], v[48:51]
    v_add_f32 v20, v20, v217
    v_cvt_pk_bf16_f32 v214, v216, v217
    v_add_f32 v19, v19, v30
    v_mfma_f32_16x16x32_bf16 v[52:55], a[164:167], v[228:231], v[52:55]
    v_exp_f32 v218, v218
    v_mfma_f32_16x16x32_bf16 v[52:55], a[196:199], v[232:235], v[52:55]
    v_add_f32 v20, v20, v218
    v_rcp_f32 v28, v19
    s_waitcnt lgkmcnt(0)
    v_mfma_f32_16x16x32_bf16 v[56:59], a[168:171], v[228:231], v[56:59]
    v_exp_f32 v219, v219
    v_mfma_f32_16x16x32_bf16 v[56:59], a[200:203], v[232:235], v[56:59]
    v_add_f32 v20, v20, v219
    v_cvt_pk_bf16_f32 v215, v218, v219
    v_cmp_nge_f32 s[96:97], s36, v19
    v_accvgpr_read_b32 v245, a16
    v_accvgpr_read_b32 v247, a17
    v_accvgpr_read_b32 v249, a18
    v_accvgpr_read_b32 v251, a19
    v_lshlrev_b32 v244, 16, v245
    v_lshlrev_b32 v246, 16, v247
    v_lshlrev_b32 v248, 16, v249
    v_lshlrev_b32 v250, 16, v251
    v_and_b32 v245, s37, v245
    v_and_b32 v247, s37, v247
    v_and_b32 v249, s37, v249
    v_and_b32 v251, s37, v251
    v_pk_mul_f32 v[244:245], v[244:245], s[34:35]
    v_pk_mul_f32 v[246:247], v[246:247], s[34:35]
    v_pk_mul_f32 v[248:249], v[248:249], s[34:35]
    v_pk_mul_f32 v[250:251], v[250:251], s[34:35]
    v_cvt_pk_bf16_f32 v244, v244, v245
    v_cvt_pk_bf16_f32 v246, v246, v247
    v_cvt_pk_bf16_f32 v248, v248, v249
    v_cvt_pk_bf16_f32 v250, v250, v251
    v_accvgpr_write_b32 a16, v244
    v_accvgpr_write_b32 a17, v246
    v_accvgpr_write_b32 a18, v248
    v_accvgpr_write_b32 a19, v250
    v_accvgpr_read_b32 v245, a20
    v_accvgpr_read_b32 v247, a21
    v_accvgpr_read_b32 v249, a22
    v_accvgpr_read_b32 v251, a23
    v_lshlrev_b32 v244, 16, v245
    v_lshlrev_b32 v246, 16, v247
    v_lshlrev_b32 v248, 16, v249
    v_lshlrev_b32 v250, 16, v251
    v_and_b32 v245, s37, v245
    v_and_b32 v247, s37, v247
    v_and_b32 v249, s37, v249
    v_and_b32 v251, s37, v251
    v_pk_mul_f32 v[244:245], v[244:245], s[34:35]
    v_pk_mul_f32 v[246:247], v[246:247], s[34:35]
    v_pk_mul_f32 v[248:249], v[248:249], s[34:35]
    v_pk_mul_f32 v[250:251], v[250:251], s[34:35]
    v_cvt_pk_bf16_f32 v244, v244, v245
    v_cvt_pk_bf16_f32 v246, v246, v247
    v_cvt_pk_bf16_f32 v248, v248, v249
    v_cvt_pk_bf16_f32 v250, v250, v251
    v_accvgpr_write_b32 a20, v244
    v_accvgpr_write_b32 a21, v246
    v_accvgpr_write_b32 a22, v248
    v_accvgpr_write_b32 a23, v250
    v_accvgpr_read_b32 v245, a24
    v_accvgpr_read_b32 v247, a25
    v_accvgpr_read_b32 v249, a26
    v_accvgpr_read_b32 v251, a27
    v_lshlrev_b32 v244, 16, v245
    v_lshlrev_b32 v246, 16, v247
    v_lshlrev_b32 v248, 16, v249
    v_lshlrev_b32 v250, 16, v251
    v_and_b32 v245, s37, v245
    v_and_b32 v247, s37, v247
    v_and_b32 v249, s37, v249
    v_and_b32 v251, s37, v251
    v_pk_mul_f32 v[244:245], v[244:245], s[34:35]
    v_pk_mul_f32 v[246:247], v[246:247], s[34:35]
    v_pk_mul_f32 v[248:249], v[248:249], s[34:35]
    v_pk_mul_f32 v[250:251], v[250:251], s[34:35]
    v_cvt_pk_bf16_f32 v244, v244, v245
    v_cvt_pk_bf16_f32 v246, v246, v247
    v_cvt_pk_bf16_f32 v248, v248, v249
    v_cvt_pk_bf16_f32 v250, v250, v251
    v_accvgpr_write_b32 a24, v244
    v_accvgpr_write_b32 a25, v246
    v_accvgpr_write_b32 a26, v248
    v_accvgpr_write_b32 a27, v250
    v_accvgpr_read_b32 v245, a28
    v_accvgpr_read_b32 v247, a29
    v_accvgpr_read_b32 v249, a30
    v_accvgpr_read_b32 v251, a31
    v_lshlrev_b32 v244, 16, v245
    v_lshlrev_b32 v246, 16, v247
    v_lshlrev_b32 v248, 16, v249
    v_lshlrev_b32 v250, 16, v251
    v_and_b32 v245, s37, v245
    v_and_b32 v247, s37, v247
    v_and_b32 v249, s37, v249
    v_and_b32 v251, s37, v251
    v_pk_mul_f32 v[244:245], v[244:245], s[34:35]
    v_pk_mul_f32 v[246:247], v[246:247], s[34:35]
    v_pk_mul_f32 v[248:249], v[248:249], s[34:35]
    v_pk_mul_f32 v[250:251], v[250:251], s[34:35]
    v_cvt_pk_bf16_f32 v244, v244, v245
    v_cvt_pk_bf16_f32 v246, v246, v247
    v_cvt_pk_bf16_f32 v248, v248, v249
    v_cvt_pk_bf16_f32 v250, v250, v251
    v_accvgpr_write_b32 a28, v244
    v_accvgpr_write_b32 a29, v246
    v_accvgpr_write_b32 a30, v248
    v_accvgpr_write_b32 a31, v250
    v_mfma_f32_16x16x32_bf16 v[60:63], a[172:175], v[228:231], v[60:63]
    v_exp_f32 v220, v220
    v_mfma_f32_16x16x32_bf16 v[60:63], a[204:207], v[232:235], v[60:63]
    buffer_load_dwordx4 v18, s[16:19], s28 offen offset:1024 nt lds
    v_add_f32 v20, v20, v220
    s_or_b64 s[38:39], s[38:39], s[96:97]
    v_mfma_f32_16x16x32_bf16 v[228:231], a[80:83], a[32:35], v[200:203]
    v_exp_f32 v221, v221
    v_mfma_f32_16x16x32_bf16 v[228:231], a[84:87], a[36:39], v[228:231]
    v_add_f32 v20, v20, v221
    v_cvt_pk_bf16_f32 v216, v220, v221
    v_pk_mul_f32 v[32:33], v[32:33], v[28:29] op_sel_hi:[1,0]
    v_pk_mul_f32 v[34:35], v[34:35], v[28:29] op_sel_hi:[1,0]
    v_pk_mul_f32 v[36:37], v[36:37], v[28:29] op_sel_hi:[1,0]
    v_pk_mul_f32 v[38:39], v[38:39], v[28:29] op_sel_hi:[1,0]
    v_pk_mul_f32 v[40:41], v[40:41], v[28:29] op_sel_hi:[1,0]
    v_pk_mul_f32 v[42:43], v[42:43], v[28:29] op_sel_hi:[1,0]
    v_pk_mul_f32 v[44:45], v[44:45], v[28:29] op_sel_hi:[1,0]
    v_pk_mul_f32 v[46:47], v[46:47], v[28:29] op_sel_hi:[1,0]
    v_cvt_pk_bf16_f32 v32, v32, v33
    v_cvt_pk_bf16_f32 v33, v34, v35
    v_cvt_pk_bf16_f32 v36, v36, v37
    v_cvt_pk_bf16_f32 v37, v38, v39
    v_cvt_pk_bf16_f32 v40, v40, v41
    v_cvt_pk_bf16_f32 v41, v42, v43
    v_cvt_pk_bf16_f32 v44, v44, v45
    v_cvt_pk_bf16_f32 v45, v46, v47
    v_pk_mul_f32 v[48:49], v[48:49], v[28:29] op_sel_hi:[1,0]
    v_pk_mul_f32 v[50:51], v[50:51], v[28:29] op_sel_hi:[1,0]
    v_pk_mul_f32 v[52:53], v[52:53], v[28:29] op_sel_hi:[1,0]
    v_pk_mul_f32 v[54:55], v[54:55], v[28:29] op_sel_hi:[1,0]
    v_pk_mul_f32 v[56:57], v[56:57], v[28:29] op_sel_hi:[1,0]
    v_pk_mul_f32 v[58:59], v[58:59], v[28:29] op_sel_hi:[1,0]
    v_pk_mul_f32 v[60:61], v[60:61], v[28:29] op_sel_hi:[1,0]
    v_pk_mul_f32 v[62:63], v[62:63], v[28:29] op_sel_hi:[1,0]
    v_cvt_pk_bf16_f32 v48, v48, v49
    v_cvt_pk_bf16_f32 v49, v50, v51
    v_cvt_pk_bf16_f32 v52, v52, v53
    v_cvt_pk_bf16_f32 v53, v54, v55
    v_cvt_pk_bf16_f32 v56, v56, v57
    v_cvt_pk_bf16_f32 v57, v58, v59
    v_cvt_pk_bf16_f32 v60, v60, v61
    v_cvt_pk_bf16_f32 v61, v62, v63
    v_mfma_f32_16x16x32_bf16 v[228:231], a[88:91], a[40:43], v[228:231]
    v_exp_f32 v222, v222
    v_mfma_f32_16x16x32_bf16 v[228:231], a[92:95], a[44:47], v[228:231]
    ds_write_b64 v24, v[32:33] offset:0
    v_add_f32 v20, v20, v222
    v_mfma_f32_16x16x32_bf16 v[232:235], a[96:99], a[32:35], v[200:203]
    v_exp_f32 v223, v223
    v_mfma_f32_16x16x32_bf16 v[232:235], a[100:103], a[36:39], v[232:235]
    v_add_f32 v20, v20, v223
    v_cvt_pk_bf16_f32 v217, v222, v223
    v_mfma_f32_16x16x32_bf16 v[232:235], a[104:107], a[40:43], v[232:235]
    v_exp_f32 v224, v224
    v_mfma_f32_16x16x32_bf16 v[232:235], a[108:111], a[44:47], v[232:235]
    ds_write_b64 v24, v[36:37] offset:32
    v_add_f32 v20, v20, v224
    v_mfma_f32_16x16x32_bf16 v[236:239], a[112:115], a[32:35], v[200:203]
    v_exp_f32 v225, v225
    v_mfma_f32_16x16x32_bf16 v[236:239], a[116:119], a[36:39], v[236:239]
    ds_write_b64 v24, v[40:41] offset:64
    v_add_f32 v20, v20, v225
    v_cvt_pk_bf16_f32 v218, v224, v225
    v_mfma_f32_16x16x32_bf16 v[236:239], a[120:123], a[40:43], v[236:239]
    v_exp_f32 v226, v226
    v_mfma_f32_16x16x32_bf16 v[236:239], a[124:127], a[44:47], v[236:239]
    buffer_load_dwordx4 v17, s[16:19], s28 offen offset:2048 nt lds
    ds_write_b64 v24, v[44:45] offset:96
    v_add_f32 v20, v20, v226
    v_mfma_f32_16x16x32_bf16 v[240:243], a[128:131], a[32:35], v[200:203]
    v_exp_f32 v227, v227
    v_mfma_f32_16x16x32_bf16 v[240:243], a[132:135], a[36:39], v[240:243]
    v_add_f32 v20, v20, v227
    v_cvt_pk_bf16_f32 v219, v226, v227
    v_mfma_f32_16x16x32_bf16 v[240:243], a[136:139], a[40:43], v[240:243]
    v_exp_f32 v228, v228
    v_mov_b32 v30, v20
    v_mfma_f32_16x16x32_bf16 v[240:243], a[140:143], a[44:47], v[240:243]
    ds_write_b64 v24, v[48:49] offset:128
    v_add_f32 v21, v21, v228
    v_mfma_f32_16x16x32_bf16 v[64:67], a[144:147], v[212:215], v[64:67]
    v_exp_f32 v229, v229
    v_permlane16_swap_b32 v20, v30
    v_mfma_f32_16x16x32_bf16 v[64:67], a[176:179], v[216:219], v[64:67]
    ds_write_b64 v24, v[52:53] offset:160
    v_add_f32 v21, v21, v229
    v_cvt_pk_bf16_f32 v228, v228, v229
    v_accvgpr_mov_b32 a32, a208
    v_accvgpr_mov_b32 a33, a209
    v_accvgpr_mov_b32 a34, a210
    v_accvgpr_mov_b32 a35, a211
    v_accvgpr_mov_b32 a36, a212
    v_accvgpr_mov_b32 a37, a213
    v_accvgpr_mov_b32 a38, a214
    v_accvgpr_mov_b32 a39, a215
    v_accvgpr_mov_b32 a40, a216
    v_accvgpr_mov_b32 a41, a217
    v_accvgpr_mov_b32 a42, a218
    v_accvgpr_mov_b32 a43, a219
    v_accvgpr_mov_b32 a44, a220
    v_accvgpr_mov_b32 a45, a221
    v_accvgpr_mov_b32 a46, a222
    v_accvgpr_mov_b32 a47, a223
    v_mfma_f32_16x16x32_bf16 v[68:71], a[148:151], v[212:215], v[68:71]
    v_exp_f32 v230, v230
    v_add_f32 v20, v20, v30
    v_mfma_f32_16x16x32_bf16 v[68:71], a[180:183], v[216:219], v[68:71]
    buffer_load_dwordx4 v18, s[16:19], s28 offen offset:3072 nt lds
    ds_write_b64 v24, v[56:57] offset:192
    v_add_f32 v21, v21, v230
    v_mfma_f32_16x16x32_bf16 v[72:75], a[152:155], v[212:215], v[72:75]
    v_exp_f32 v231, v231
    v_mov_b32 v30, v20
    v_mfma_f32_16x16x32_bf16 v[72:75], a[184:187], v[216:219], v[72:75]
    ds_write_b64 v24, v[60:61] offset:224
    s_add_u32 s28, s28, 16384
    v_add_f32 v21, v21, v231
    v_cvt_pk_bf16_f32 v229, v230, v231
    v_mfma_f32_16x16x32_bf16 v[76:79], a[156:159], v[212:215], v[76:79]
    v_exp_f32 v232, v232
    v_permlane32_swap_b32 v20, v30
    v_mfma_f32_16x16x32_bf16 v[76:79], a[188:191], v[216:219], v[76:79]
    ds_read_b128 v[32:35], v25 offset:0
    v_add_f32 v21, v21, v232
    v_mfma_f32_16x16x32_bf16 v[80:83], a[160:163], v[212:215], v[80:83]
    v_exp_f32 v233, v233
    v_add_f32 v20, v20, v30
    v_mfma_f32_16x16x32_bf16 v[80:83], a[192:195], v[216:219], v[80:83]
    v_add_f32 v21, v21, v233
    v_cvt_pk_bf16_f32 v230, v232, v233
    v_mfma_f32_16x16x32_bf16 v[84:87], a[164:167], v[212:215], v[84:87]
    v_exp_f32 v234, v234
    v_rcp_f32 v28, v20
    v_mfma_f32_16x16x32_bf16 v[84:87], a[196:199], v[216:219], v[84:87]
    ds_read_b128 v[36:39], v25 offset:1088
    v_add_f32 v21, v21, v234
    v_mfma_f32_16x16x32_bf16 v[88:91], a[168:171], v[212:215], v[88:91]
    ds_read_b128 v[40:43], v25 offset:2176
    v_exp_f32 v235, v235
    v_cmp_nge_f32 s[96:97], s36, v20
    v_mfma_f32_16x16x32_bf16 v[88:91], a[200:203], v[216:219], v[88:91]
    v_add_f32 v21, v21, v235
    v_cvt_pk_bf16_f32 v231, v234, v235
    v_mfma_f32_16x16x32_bf16 v[92:95], a[172:175], v[212:215], v[92:95]
    v_exp_f32 v236, v236
    s_or_b64 s[38:39], s[38:39], s[96:97]
    v_mfma_f32_16x16x32_bf16 v[92:95], a[204:207], v[216:219], v[92:95]
    ds_read_b128 v[44:47], v25 offset:3264
    v_add_f32 v21, v21, v236
    v_mfma_f32_16x16x32_bf16 v[212:215], a[80:83], a[48:51], v[204:207]
    v_exp_f32 v237, v237
    v_mfma_f32_16x16x32_bf16 v[212:215], a[84:87], a[52:55], v[212:215]
    v_add_f32 v21, v21, v237
    v_cvt_pk_bf16_f32 v232, v236, v237
    v_pk_mul_f32 v[64:65], v[64:65], v[28:29] op_sel_hi:[1,0]
    v_pk_mul_f32 v[66:67], v[66:67], v[28:29] op_sel_hi:[1,0]
    v_pk_mul_f32 v[68:69], v[68:69], v[28:29] op_sel_hi:[1,0]
    v_pk_mul_f32 v[70:71], v[70:71], v[28:29] op_sel_hi:[1,0]
    v_pk_mul_f32 v[72:73], v[72:73], v[28:29] op_sel_hi:[1,0]
    v_pk_mul_f32 v[74:75], v[74:75], v[28:29] op_sel_hi:[1,0]
    v_pk_mul_f32 v[76:77], v[76:77], v[28:29] op_sel_hi:[1,0]
    v_pk_mul_f32 v[78:79], v[78:79], v[28:29] op_sel_hi:[1,0]
    v_cvt_pk_bf16_f32 v64, v64, v65
    v_cvt_pk_bf16_f32 v65, v66, v67
    v_cvt_pk_bf16_f32 v68, v68, v69
    v_cvt_pk_bf16_f32 v69, v70, v71
    v_cvt_pk_bf16_f32 v72, v72, v73
    v_cvt_pk_bf16_f32 v73, v74, v75
    v_cvt_pk_bf16_f32 v76, v76, v77
    v_cvt_pk_bf16_f32 v77, v78, v79
    v_pk_mul_f32 v[80:81], v[80:81], v[28:29] op_sel_hi:[1,0]
    v_pk_mul_f32 v[82:83], v[82:83], v[28:29] op_sel_hi:[1,0]
    v_pk_mul_f32 v[84:85], v[84:85], v[28:29] op_sel_hi:[1,0]
    v_pk_mul_f32 v[86:87], v[86:87], v[28:29] op_sel_hi:[1,0]
    v_pk_mul_f32 v[88:89], v[88:89], v[28:29] op_sel_hi:[1,0]
    v_pk_mul_f32 v[90:91], v[90:91], v[28:29] op_sel_hi:[1,0]
    v_pk_mul_f32 v[92:93], v[92:93], v[28:29] op_sel_hi:[1,0]
    v_pk_mul_f32 v[94:95], v[94:95], v[28:29] op_sel_hi:[1,0]
    v_cvt_pk_bf16_f32 v80, v80, v81
    v_cvt_pk_bf16_f32 v81, v82, v83
    v_cvt_pk_bf16_f32 v84, v84, v85
    v_cvt_pk_bf16_f32 v85, v86, v87
    v_cvt_pk_bf16_f32 v88, v88, v89
    v_cvt_pk_bf16_f32 v89, v90, v91
    v_cvt_pk_bf16_f32 v92, v92, v93
    v_cvt_pk_bf16_f32 v93, v94, v95
    v_mfma_f32_16x16x32_bf16 v[212:215], a[88:91], a[56:59], v[212:215]
    v_exp_f32 v238, v238
    v_mfma_f32_16x16x32_bf16 v[212:215], a[92:95], a[60:63], v[212:215]
    ds_write_b64 v24, v[64:65] offset:0
    v_add_f32 v21, v21, v238
    v_mfma_f32_16x16x32_bf16 v[216:219], a[96:99], a[48:51], v[204:207]
    v_exp_f32 v239, v239
    v_mfma_f32_16x16x32_bf16 v[216:219], a[100:103], a[52:55], v[216:219]
    ds_write_b64 v24, v[68:69] offset:32
    v_add_f32 v21, v21, v239
    v_cvt_pk_bf16_f32 v233, v238, v239
    v_mfma_f32_16x16x32_bf16 v[216:219], a[104:107], a[56:59], v[216:219]
    v_exp_f32 v240, v240
    v_mfma_f32_16x16x32_bf16 v[216:219], a[108:111], a[60:63], v[216:219]
    ds_write_b64 v24, v[72:73] offset:64
    s_add_u32 s101, s100, 0
    v_add_f32 v21, v21, v240
    v_mfma_f32_16x16x32_bf16 v[220:223], a[112:115], a[48:51], v[204:207]
    v_exp_f32 v241, v241
    v_mfma_f32_16x16x32_bf16 v[220:223], a[116:119], a[52:55], v[220:223]
    ds_write_b64 v24, v[76:77] offset:96
    v_add_f32 v21, v21, v241
    v_cvt_pk_bf16_f32 v234, v240, v241
    v_mfma_f32_16x16x32_bf16 v[220:223], a[120:123], a[56:59], v[220:223]
    v_exp_f32 v242, v242
    v_mfma_f32_16x16x32_bf16 v[220:223], a[124:127], a[60:63], v[220:223]
    s_waitcnt lgkmcnt(3)
    buffer_store_dwordx4 v[32:35], v26, s[24:27], s101 offen offset:0 sc1
    ds_write_b64 v24, v[80:81] offset:128
    v_add_f32 v21, v21, v242
    v_mfma_f32_16x16x32_bf16 v[224:227], a[128:131], a[48:51], v[204:207]
    v_exp_f32 v243, v243
    v_mfma_f32_16x16x32_bf16 v[224:227], a[132:135], a[52:55], v[224:227]
    ds_write_b64 v24, v[84:85] offset:160
    v_add_f32 v21, v21, v243
    v_cvt_pk_bf16_f32 v235, v242, v243
    v_mfma_f32_16x16x32_bf16 v[224:227], a[136:139], a[56:59], v[224:227]
    v_exp_f32 v212, v212
    v_mov_b32 v30, v21
    v_mfma_f32_16x16x32_bf16 v[224:227], a[140:143], a[60:63], v[224:227]
    buffer_store_dwordx4 v[36:39], v26, s[24:27], s101 offen offset:1024 sc1
    ds_write_b64 v24, v[88:89] offset:192
    v_add_f32 v22, v22, v212
    v_mfma_f32_16x16x32_bf16 v[96:99], a[144:147], v[228:231], v[96:99]
    v_exp_f32 v213, v213
    v_permlane16_swap_b32 v21, v30
    v_mfma_f32_16x16x32_bf16 v[96:99], a[176:179], v[232:235], v[96:99]
    ds_write_b64 v24, v[92:93] offset:224
    v_add_f32 v22, v22, v213
    v_cvt_pk_bf16_f32 v212, v212, v213
    v_accvgpr_mov_b32 a48, a224
    v_accvgpr_mov_b32 a49, a225
    v_accvgpr_mov_b32 a50, a226
    v_accvgpr_mov_b32 a51, a227
    v_accvgpr_mov_b32 a52, a228
    v_accvgpr_mov_b32 a53, a229
    v_accvgpr_mov_b32 a54, a230
    v_accvgpr_mov_b32 a55, a231
    v_accvgpr_mov_b32 a56, a232
    v_accvgpr_mov_b32 a57, a233
    v_accvgpr_mov_b32 a58, a234
    v_accvgpr_mov_b32 a59, a235
    v_accvgpr_mov_b32 a60, a236
    v_accvgpr_mov_b32 a61, a237
    v_accvgpr_mov_b32 a62, a238
    v_accvgpr_mov_b32 a63, a239
    v_mfma_f32_16x16x32_bf16 v[100:103], a[148:151], v[228:231], v[100:103]
    v_exp_f32 v214, v214
    v_add_f32 v21, v21, v30
    v_mfma_f32_16x16x32_bf16 v[100:103], a[180:183], v[232:235], v[100:103]
    buffer_store_dwordx4 v[40:43], v26, s[24:27], s101 offen offset:2048 sc1
    v_add_f32 v22, v22, v214
    v_mfma_f32_16x16x32_bf16 v[104:107], a[152:155], v[228:231], v[104:107]
    v_exp_f32 v215, v215
    v_mov_b32 v30, v21
    v_mfma_f32_16x16x32_bf16 v[104:107], a[184:187], v[232:235], v[104:107]
    buffer_store_dwordx4 v[44:47], v26, s[24:27], s101 offen offset:3072 sc1
    v_add_f32 v22, v22, v215
    v_cvt_pk_bf16_f32 v213, v214, v215
    v_mfma_f32_16x16x32_bf16 v[108:111], a[156:159], v[228:231], v[108:111]
    v_exp_f32 v216, v216
    v_permlane32_swap_b32 v21, v30
    v_mfma_f32_16x16x32_bf16 v[108:111], a[188:191], v[232:235], v[108:111]
    ds_read_b128 v[64:67], v25 offset:0
    v_add_f32 v22, v22, v216
    v_mfma_f32_16x16x32_bf16 v[112:115], a[160:163], v[228:231], v[112:115]
    v_exp_f32 v217, v217
    v_add_f32 v21, v21, v30
    v_mfma_f32_16x16x32_bf16 v[112:115], a[192:195], v[232:235], v[112:115]
    v_add_f32 v22, v22, v217
    v_cvt_pk_bf16_f32 v214, v216, v217
    v_mfma_f32_16x16x32_bf16 v[116:119], a[164:167], v[228:231], v[116:119]
    v_exp_f32 v218, v218
    v_rcp_f32 v28, v21
    v_mfma_f32_16x16x32_bf16 v[116:119], a[196:199], v[232:235], v[116:119]
    ds_read_b128 v[68:71], v25 offset:1088
    v_add_f32 v22, v22, v218
    v_mfma_f32_16x16x32_bf16 v[120:123], a[168:171], v[228:231], v[120:123]
    ds_read_b128 v[72:75], v25 offset:2176
    v_exp_f32 v219, v219
    v_cmp_nge_f32 s[96:97], s36, v21
    v_mfma_f32_16x16x32_bf16 v[120:123], a[200:203], v[232:235], v[120:123]
    v_add_f32 v22, v22, v219
    v_cvt_pk_bf16_f32 v215, v218, v219
    v_mfma_f32_16x16x32_bf16 v[124:127], a[172:175], v[228:231], v[124:127]
    v_exp_f32 v220, v220
    s_or_b64 s[38:39], s[38:39], s[96:97]
    v_mfma_f32_16x16x32_bf16 v[124:127], a[204:207], v[232:235], v[124:127]
    ds_read_b128 v[76:79], v25 offset:3264
    v_add_f32 v22, v22, v220
    s_waitcnt vmcnt(8)
    s_barrier
    v_exp_f32 v221, v221
    ds_read_b128 a[80:83], v1 offset:0
    v_add_f32 v22, v22, v221
    v_cvt_pk_bf16_f32 v216, v220, v221
    v_pk_mul_f32 v[96:97], v[96:97], v[28:29] op_sel_hi:[1,0]
    v_pk_mul_f32 v[98:99], v[98:99], v[28:29] op_sel_hi:[1,0]
    v_pk_mul_f32 v[100:101], v[100:101], v[28:29] op_sel_hi:[1,0]
    v_pk_mul_f32 v[102:103], v[102:103], v[28:29] op_sel_hi:[1,0]
    v_pk_mul_f32 v[104:105], v[104:105], v[28:29] op_sel_hi:[1,0]
    v_pk_mul_f32 v[106:107], v[106:107], v[28:29] op_sel_hi:[1,0]
    v_pk_mul_f32 v[108:109], v[108:109], v[28:29] op_sel_hi:[1,0]
    v_pk_mul_f32 v[110:111], v[110:111], v[28:29] op_sel_hi:[1,0]
    v_cvt_pk_bf16_f32 v96, v96, v97
    v_cvt_pk_bf16_f32 v97, v98, v99
    v_cvt_pk_bf16_f32 v100, v100, v101
    v_cvt_pk_bf16_f32 v101, v102, v103
    v_cvt_pk_bf16_f32 v104, v104, v105
    v_cvt_pk_bf16_f32 v105, v106, v107
    v_cvt_pk_bf16_f32 v108, v108, v109
    v_cvt_pk_bf16_f32 v109, v110, v111
    v_pk_mul_f32 v[112:113], v[112:113], v[28:29] op_sel_hi:[1,0]
    v_pk_mul_f32 v[114:115], v[114:115], v[28:29] op_sel_hi:[1,0]
    v_pk_mul_f32 v[116:117], v[116:117], v[28:29] op_sel_hi:[1,0]
    v_pk_mul_f32 v[118:119], v[118:119], v[28:29] op_sel_hi:[1,0]
    v_pk_mul_f32 v[120:121], v[120:121], v[28:29] op_sel_hi:[1,0]
    v_pk_mul_f32 v[122:123], v[122:123], v[28:29] op_sel_hi:[1,0]
    v_pk_mul_f32 v[124:125], v[124:125], v[28:29] op_sel_hi:[1,0]
    v_pk_mul_f32 v[126:127], v[126:127], v[28:29] op_sel_hi:[1,0]
    v_cvt_pk_bf16_f32 v112, v112, v113
    v_cvt_pk_bf16_f32 v113, v114, v115
    v_cvt_pk_bf16_f32 v116, v116, v117
    v_cvt_pk_bf16_f32 v117, v118, v119
    v_cvt_pk_bf16_f32 v120, v120, v121
    v_cvt_pk_bf16_f32 v121, v122, v123
    v_cvt_pk_bf16_f32 v124, v124, v125
    v_cvt_pk_bf16_f32 v125, v126, v127
    ds_write_b64 v24, v[96:97] offset:0
    v_exp_f32 v222, v222
    ds_read_b128 a[84:87], v2 offset:0
    v_add_f32 v22, v22, v222
    ds_write_b64 v24, v[100:101] offset:32
    s_add_u32 s101, s100, 4096
    v_exp_f32 v223, v223
    ds_read_b128 a[88:91], v3 offset:0
    v_add_f32 v22, v22, v223
    v_cvt_pk_bf16_f32 v217, v222, v223
    s_waitcnt lgkmcnt(8)
    buffer_store_dwordx4 v[64:67], v26, s[24:27], s101 offen offset:0 sc1
    ds_write_b64 v24, v[104:105] offset:64
    v_exp_f32 v224, v224
    ds_read_b128 a[92:95], v4 offset:0
    v_add_f32 v22, v22, v224
    s_waitcnt lgkmcnt(9)
    buffer_store_dwordx4 v[68:71], v26, s[24:27], s101 offen offset:1024 sc1
    ds_write_b64 v24, v[108:109] offset:96
    v_exp_f32 v225, v225
    ds_read_b128 a[96:99], v1 offset:4096
    v_add_f32 v22, v22, v225
    v_cvt_pk_bf16_f32 v218, v224, v225
    s_waitcnt lgkmcnt(10)
    buffer_store_dwordx4 v[72:75], v26, s[24:27], s101 offen offset:2048 sc1
    ds_write_b64 v24, v[112:113] offset:128
    v_exp_f32 v226, v226
    ds_read_b128 a[100:103], v2 offset:4096
    v_add_f32 v22, v22, v226
    s_waitcnt lgkmcnt(11)
    buffer_store_dwordx4 v[76:79], v26, s[24:27], s101 offen offset:3072 sc1
    ds_write_b64 v24, v[116:117] offset:160
    v_exp_f32 v227, v227
    ds_read_b128 a[104:107], v3 offset:4096
    v_add_f32 v22, v22, v227
    v_cvt_pk_bf16_f32 v219, v226, v227
    ds_write_b64 v24, v[120:121] offset:192
    v_mov_b32 v30, v22
    ds_read_b128 a[108:111], v4 offset:4096
    v_mfma_f32_16x16x32_bf16 v[128:131], a[144:147], v[212:215], v[128:131]
    ds_write_b64 v24, v[124:125] offset:224
    v_permlane16_swap_b32 v22, v30
    v_mfma_f32_16x16x32_bf16 v[128:131], a[176:179], v[216:219], v[128:131]
    ds_read_b128 a[112:115], v1 offset:8192
    v_accvgpr_mov_b32 a64, a240
    v_accvgpr_mov_b32 a65, a241
    v_accvgpr_mov_b32 a66, a242
    v_accvgpr_mov_b32 a67, a243
    v_accvgpr_mov_b32 a68, a244
    v_accvgpr_mov_b32 a69, a245
    v_accvgpr_mov_b32 a70, a246
    v_accvgpr_mov_b32 a71, a247
    v_accvgpr_mov_b32 a72, a248
    v_accvgpr_mov_b32 a73, a249
    v_accvgpr_mov_b32 a74, a250
    v_accvgpr_mov_b32 a75, a251
    v_accvgpr_mov_b32 a76, a252
    v_accvgpr_mov_b32 a77, a253
    v_accvgpr_mov_b32 a78, a254
    v_accvgpr_mov_b32 a79, a255
    v_mfma_f32_16x16x32_bf16 v[132:135], a[148:151], v[212:215], v[132:135]
    ds_read_b128 v[96:99], v25 offset:0
    v_add_f32 v22, v22, v30
    v_mfma_f32_16x16x32_bf16 v[132:135], a[180:183], v[216:219], v[132:135]
    ds_read_b128 a[116:119], v2 offset:8192
    ds_read_b128 v[100:103], v25 offset:1088
    v_mfma_f32_16x16x32_bf16 v[136:139], a[152:155], v[212:215], v[136:139]
    ds_read_b128 v[104:107], v25 offset:2176
    v_mov_b32 v30, v22
    v_mfma_f32_16x16x32_bf16 v[136:139], a[184:187], v[216:219], v[136:139]
    ds_read_b128 a[120:123], v3 offset:8192
    ds_read_b128 v[108:111], v25 offset:3264
    v_mfma_f32_16x16x32_bf16 v[140:143], a[156:159], v[212:215], v[140:143]
    v_permlane32_swap_b32 v22, v30
    v_mfma_f32_16x16x32_bf16 v[140:143], a[188:191], v[216:219], v[140:143]
    ds_read_b128 a[124:127], v4 offset:8192
    v_mfma_f32_16x16x32_bf16 v[144:147], a[160:163], v[212:215], v[144:147]
    v_add_f32 v22, v22, v30
    v_mfma_f32_16x16x32_bf16 v[144:147], a[192:195], v[216:219], v[144:147]
    ds_read_b128 a[128:131], v1 offset:12288
    s_add_u32 s101, s100, 8192
    v_mfma_f32_16x16x32_bf16 v[148:151], a[164:167], v[212:215], v[148:151]
    s_waitcnt lgkmcnt(7)
    buffer_store_dwordx4 v[96:99], v26, s[24:27], s101 offen offset:0 sc1
    v_rcp_f32 v28, v22
    v_mfma_f32_16x16x32_bf16 v[148:151], a[196:199], v[216:219], v[148:151]
    ds_read_b128 a[132:135], v2 offset:12288
    s_waitcnt lgkmcnt(6)
    buffer_store_dwordx4 v[100:103], v26, s[24:27], s101 offen offset:1024 sc1
    v_mfma_f32_16x16x32_bf16 v[152:155], a[168:171], v[212:215], v[152:155]
    s_waitcnt lgkmcnt(5)
    buffer_store_dwordx4 v[104:107], v26, s[24:27], s101 offen offset:2048 sc1
    v_cmp_nge_f32 s[96:97], s36, v22
    v_mfma_f32_16x16x32_bf16 v[152:155], a[200:203], v[216:219], v[152:155]
    ds_read_b128 a[136:139], v3 offset:12288
    s_waitcnt lgkmcnt(4)
    buffer_store_dwordx4 v[108:111], v26, s[24:27], s101 offen offset:3072 sc1
    v_mfma_f32_16x16x32_bf16 v[156:159], a[172:175], v[212:215], v[156:159]
    s_or_b64 s[38:39], s[38:39], s[96:97]
    v_mfma_f32_16x16x32_bf16 v[156:159], a[204:207], v[216:219], v[156:159]
    ds_read_b128 a[140:143], v4 offset:12288
    s_mov_b32 s30, 14
    s_mov_b32 s40, 10
    s_mov_b64 vcc, -1
    v_mfma_f32_16x16x32_bf16 v[192:195], a[80:83], a[0:3], 0
    v_mul_f32 v128, v28, v128
    v_mul_f32 v129, v28, v129
    v_mfma_f32_16x16x32_bf16 v[192:195], a[84:87], a[4:7], v[192:195]
    v_mul_f32 v130, v28, v130
    v_mul_f32 v131, v28, v131
    v_mfma_f32_16x16x32_bf16 v[192:195], a[88:91], a[8:11], v[192:195]
    v_mul_f32 v132, v28, v132
    v_mul_f32 v133, v28, v133
    v_mfma_f32_16x16x32_bf16 v[192:195], a[92:95], a[12:15], v[192:195]
    v_mul_f32 v134, v28, v134
    v_mul_f32 v135, v28, v135
    v_mfma_f32_16x16x32_bf16 v[196:199], a[80:83], a[16:19], 0
    v_mul_f32 v136, v28, v136
    v_mul_f32 v137, v28, v137
    v_mfma_f32_16x16x32_bf16 v[196:199], a[84:87], a[20:23], v[196:199]
    v_mul_f32 v138, v28, v138
    v_mul_f32 v139, v28, v139
    v_mfma_f32_16x16x32_bf16 v[196:199], a[88:91], a[24:27], v[196:199]
    v_max3_f32 v244, v192, v193, v194
    v_max_f32 v244, v244, v195
    v_mfma_f32_16x16x32_bf16 v[196:199], a[92:95], a[28:31], v[196:199]
    v_mov_b32 v245, v244
    v_mul_f32 v140, v28, v140
    v_mfma_f32_16x16x32_bf16 v[200:203], a[80:83], a[32:35], 0
    v_mul_f32 v141, v28, v141
    v_permlane16_swap_b32 v244, v245
    v_mfma_f32_16x16x32_bf16 v[200:203], a[84:87], a[36:39], v[200:203]
    v_max_f32 v244, v244, v245
    v_mov_b32 v245, v244
    v_mfma_f32_16x16x32_bf16 v[200:203], a[88:91], a[40:43], v[200:203]
    v_mul_f32 v142, v28, v142
    v_mul_f32 v143, v28, v143
    v_mfma_f32_16x16x32_bf16 v[200:203], a[92:95], a[44:47], v[200:203]
    v_permlane32_swap_b32 v244, v245
    v_min_f32 v192, -v244, -v245
    v_mfma_f32_16x16x32_bf16 v[204:207], a[80:83], a[48:51], 0
    v_min_f32 v193, -v244, -v245
    v_min_f32 v194, -v244, -v245
    v_mfma_f32_16x16x32_bf16 v[204:207], a[84:87], a[52:55], v[204:207]
    v_min_f32 v195, -v244, -v245
    v_max3_f32 v246, v196, v197, v198
    v_mfma_f32_16x16x32_bf16 v[204:207], a[88:91], a[56:59], v[204:207]
    v_max_f32 v246, v246, v199
    v_mov_b32 v247, v246
    v_mfma_f32_16x16x32_bf16 v[204:207], a[92:95], a[60:63], v[204:207]
    v_cvt_pk_bf16_f32 v128, v128, v129
    v_cvt_pk_bf16_f32 v129, v130, v131
    v_mfma_f32_16x16x32_bf16 v[208:211], a[80:83], a[64:67], 0
    v_permlane16_swap_b32 v246, v247
    v_max_f32 v246, v246, v247
    v_mfma_f32_16x16x32_bf16 v[208:211], a[84:87], a[68:71], v[208:211]
    v_mov_b32 v247, v246
    v_cvt_pk_bf16_f32 v132, v132, v133
    v_mfma_f32_16x16x32_bf16 v[208:211], a[88:91], a[72:75], v[208:211]
    v_cvt_pk_bf16_f32 v133, v134, v135
    v_permlane32_swap_b32 v246, v247
    v_mfma_f32_16x16x32_bf16 v[208:211], a[92:95], a[76:79], v[208:211]
    v_min_f32 v196, -v246, -v247
    v_min_f32 v197, -v246, -v247
    v_min_f32 v198, -v246, -v247
    v_min_f32 v199, -v246, -v247
    v_max3_f32 v248, v200, v201, v202
    v_max_f32 v248, v248, v203
    v_mov_b32 v249, v248
    v_cvt_pk_bf16_f32 v136, v136, v137
    v_cvt_pk_bf16_f32 v137, v138, v139
    v_permlane16_swap_b32 v248, v249
    v_max_f32 v248, v248, v249
    v_mov_b32 v249, v248
    v_cvt_pk_bf16_f32 v140, v140, v141
    v_cvt_pk_bf16_f32 v141, v142, v143
    v_permlane32_swap_b32 v248, v249
    v_min_f32 v200, -v248, -v249
    v_min_f32 v201, -v248, -v249
    v_min_f32 v202, -v248, -v249
    v_min_f32 v203, -v248, -v249
    v_max3_f32 v250, v204, v205, v206
    v_max_f32 v250, v250, v207
    v_mov_b32 v251, v250
    v_mul_f32 v144, v28, v144
    v_mul_f32 v145, v28, v145
    v_permlane16_swap_b32 v250, v251
    v_max_f32 v250, v250, v251
    v_mov_b32 v251, v250
    v_mul_f32 v146, v28, v146
    v_mul_f32 v147, v28, v147
    v_permlane32_swap_b32 v250, v251
    v_min_f32 v204, -v250, -v251
    v_min_f32 v205, -v250, -v251
    v_min_f32 v206, -v250, -v251
    v_min_f32 v207, -v250, -v251
    v_max3_f32 v252, v208, v209, v210
    v_max_f32 v252, v252, v211
    v_mov_b32 v253, v252
    v_mul_f32 v148, v28, v148
    v_mul_f32 v149, v28, v149
    v_permlane16_swap_b32 v252, v253
    v_max_f32 v252, v252, v253
    v_mov_b32 v253, v252
    v_mul_f32 v150, v28, v150
    v_mul_f32 v151, v28, v151
    v_permlane32_swap_b32 v252, v253
    v_min_f32 v208, -v252, -v253
    v_min_f32 v209, -v252, -v253
    v_min_f32 v210, -v252, -v253
    v_min_f32 v211, -v252, -v253
    v_pk_mul_f32 v[152:153], v[152:153], v[28:29] op_sel_hi:[1,0]
    v_pk_mul_f32 v[154:155], v[154:155], v[28:29] op_sel_hi:[1,0]
    v_pk_mul_f32 v[156:157], v[156:157], v[28:29] op_sel_hi:[1,0]
    v_pk_mul_f32 v[158:159], v[158:159], v[28:29] op_sel_hi:[1,0]
    v_cvt_pk_bf16_f32 v144, v144, v145
    v_cvt_pk_bf16_f32 v145, v146, v147
    v_cvt_pk_bf16_f32 v148, v148, v149
    v_cvt_pk_bf16_f32 v149, v150, v151
    v_cvt_pk_bf16_f32 v152, v152, v153
    v_cvt_pk_bf16_f32 v153, v154, v155
    v_cvt_pk_bf16_f32 v156, v156, v157
    v_cvt_pk_bf16_f32 v157, v158, v159
    s_cmp_lg_u32 s32, 3
    s_cbranch_scc1 L_ndb_w3
    v_mov_b32 v208, 0xf149f2ca
    v_mov_b32 v209, 0xf149f2ca
    v_mov_b32 v210, 0xf149f2ca
    v_mov_b32 v211, 0xf149f2ca
L_ndb_w3:
    s_nop 1
    v_mfma_f32_16x16x32_bf16 v[212:215], a[80:83], a[0:3], v[192:195]
    v_mfma_f32_16x16x32_bf16 v[212:215], a[84:87], a[4:7], v[212:215]
    v_mfma_f32_16x16x32_bf16 v[212:215], a[88:91], a[8:11], v[212:215]
    v_mfma_f32_16x16x32_bf16 v[212:215], a[92:95], a[12:15], v[212:215]
    ds_write_b64 v24, v[128:129] offset:0
    v_mfma_f32_16x16x32_bf16 v[216:219], a[96:99], a[0:3], v[192:195]
    v_mfma_f32_16x16x32_bf16 v[216:219], a[100:103], a[4:7], v[216:219]
    v_mfma_f32_16x16x32_bf16 v[216:219], a[104:107], a[8:11], v[216:219]
    v_mfma_f32_16x16x32_bf16 v[216:219], a[108:111], a[12:15], v[216:219]
    ds_write_b64 v24, v[132:133] offset:32
    v_mfma_f32_16x16x32_bf16 v[220:223], a[112:115], a[0:3], v[192:195]
    v_mfma_f32_16x16x32_bf16 v[220:223], a[116:119], a[4:7], v[220:223]
    ds_write_b64 v24, v[136:137] offset:64
    v_mfma_f32_16x16x32_bf16 v[220:223], a[120:123], a[8:11], v[220:223]
    s_waitcnt lgkmcnt(3)
    v_mfma_f32_16x16x32_bf16 v[220:223], a[124:127], a[12:15], v[220:223]
    ds_write_b64 v24, v[140:141] offset:96
    v_mfma_f32_16x16x32_bf16 v[224:227], a[128:131], a[0:3], v[192:195]
    v_mfma_f32_16x16x32_bf16 v[224:227], a[132:135], a[4:7], v[224:227]
    ds_write_b64 v24, v[144:145] offset:128
    v_mfma_f32_16x16x32_bf16 v[224:227], a[136:139], a[8:11], v[224:227]
    v_exp_f32 v212, v212
    v_mfma_f32_16x16x32_bf16 v[224:227], a[140:143], a[12:15], v[224:227]
    ds_write_b64 v24, v[148:149] offset:160
    v_mov_b32 v19, v212
    v_exp_f32 v213, v213
    ds_read_b64_tr_b16 a[144:145], v5 offset:0
    ds_read_b64_tr_b16 a[146:147], v5 offset:4096
    ds_write_b64 v24, v[152:153] offset:192
    v_add_f32 v19, v19, v213
    v_cvt_pk_bf16_f32 v212, v212, v213
    v_exp_f32 v214, v214
    ds_read_b64_tr_b16 a[176:177], v5 offset:8192
    ds_read_b64_tr_b16 a[178:179], v5 offset:12288
    ds_write_b64 v24, v[156:157] offset:224
    v_add_f32 v19, v19, v214
    v_exp_f32 v215, v215
    ds_read_b64_tr_b16 a[148:149], v6 offset:0
    ds_read_b64_tr_b16 a[150:151], v6 offset:4096
    ds_read_b128 a[224:227], v25 offset:0
    v_add_f32 v19, v19, v215
    v_cvt_pk_bf16_f32 v213, v214, v215
    ds_read_b128 a[228:231], v25 offset:1088
    v_exp_f32 v216, v216
    ds_read_b64_tr_b16 a[180:181], v6 offset:8192
    ds_read_b64_tr_b16 a[182:183], v6 offset:12288
    ds_read_b128 a[232:235], v25 offset:2176
    v_add_f32 v19, v19, v216
    ds_read_b128 a[236:239], v25 offset:3264
    v_exp_f32 v217, v217
    ds_read_b64_tr_b16 a[152:153], v7 offset:0
    ds_read_b64_tr_b16 a[154:155], v7 offset:4096
    v_add_f32 v19, v19, v217
    v_cvt_pk_bf16_f32 v214, v216, v217
    v_exp_f32 v218, v218
    ds_read_b64_tr_b16 a[184:185], v7 offset:8192
    ds_read_b64_tr_b16 a[186:187], v7 offset:12288
    v_add_f32 v19, v19, v218
    v_exp_f32 v219, v219
    ds_read_b64_tr_b16 a[156:157], v8 offset:0
    ds_read_b64_tr_b16 a[158:159], v8 offset:4096
    v_add_f32 v19, v19, v219
    v_cvt_pk_bf16_f32 v215, v218, v219
    v_exp_f32 v220, v220
    ds_read_b64_tr_b16 a[188:189], v8 offset:8192
    ds_read_b64_tr_b16 a[190:191], v8 offset:12288
    v_add_f32 v19, v19, v220
    v_mfma_f32_16x16x32_bf16 v[228:231], a[80:83], a[16:19], v[196:199]
    v_exp_f32 v221, v221
    v_mfma_f32_16x16x32_bf16 v[228:231], a[84:87], a[20:23], v[228:231]
    ds_read_b64_tr_b16 a[160:161], v9 offset:0
    ds_read_b64_tr_b16 a[162:163], v9 offset:4096
    v_add_f32 v19, v19, v221
    v_cvt_pk_bf16_f32 v216, v220, v221
    v_mfma_f32_16x16x32_bf16 v[228:231], a[88:91], a[24:27], v[228:231]
    v_exp_f32 v222, v222
    v_mfma_f32_16x16x32_bf16 v[228:231], a[92:95], a[28:31], v[228:231]
    ds_read_b64_tr_b16 a[192:193], v9 offset:8192
    ds_read_b64_tr_b16 a[194:195], v9 offset:12288
    v_add_f32 v19, v19, v222
    v_mfma_f32_16x16x32_bf16 v[232:235], a[96:99], a[16:19], v[196:199]
    v_exp_f32 v223, v223
    v_mfma_f32_16x16x32_bf16 v[232:235], a[100:103], a[20:23], v[232:235]
    ds_read_b64_tr_b16 a[164:165], v10 offset:0
    ds_read_b64_tr_b16 a[166:167], v10 offset:4096
    v_add_f32 v19, v19, v223
    v_cvt_pk_bf16_f32 v217, v222, v223
    v_mfma_f32_16x16x32_bf16 v[232:235], a[104:107], a[24:27], v[232:235]
    v_exp_f32 v224, v224
    v_mfma_f32_16x16x32_bf16 v[232:235], a[108:111], a[28:31], v[232:235]
    ds_read_b64_tr_b16 a[196:197], v10 offset:8192
    ds_read_b64_tr_b16 a[198:199], v10 offset:12288
    v_add_f32 v19, v19, v224
    v_mfma_f32_16x16x32_bf16 v[236:239], a[112:115], a[16:19], v[196:199]
    v_exp_f32 v225, v225
    v_mfma_f32_16x16x32_bf16 v[236:239], a[116:119], a[20:23], v[236:239]
    ds_read_b64_tr_b16 a[168:169], v11 offset:0
    ds_read_b64_tr_b16 a[170:171], v11 offset:4096
    v_add_f32 v19, v19, v225
    v_cvt_pk_bf16_f32 v218, v224, v225
    v_mfma_f32_16x16x32_bf16 v[236:239], a[120:123], a[24:27], v[236:239]
    v_exp_f32 v226, v226
    v_mfma_f32_16x16x32_bf16 v[236:239], a[124:127], a[28:31], v[236:239]
    ds_read_b64_tr_b16 a[200:201], v11 offset:8192
    ds_read_b64_tr_b16 a[202:203], v11 offset:12288
    v_add_f32 v19, v19, v226
    v_mfma_f32_16x16x32_bf16 v[240:243], a[128:131], a[16:19], v[196:199]
    v_exp_f32 v227, v227
    v_mfma_f32_16x16x32_bf16 v[240:243], a[132:135], a[20:23], v[240:243]
    ds_read_b64_tr_b16 a[172:173], v12 offset:0
    ds_read_b64_tr_b16 a[174:175], v12 offset:4096
    v_add_f32 v19, v19, v227
    v_cvt_pk_bf16_f32 v219, v226, v227
    v_mfma_f32_16x16x32_bf16 v[240:243], a[136:139], a[24:27], v[240:243]
    v_exp_f32 v228, v228
    v_mfma_f32_16x16x32_bf16 v[240:243], a[140:143], a[28:31], v[240:243]
    ds_read_b64_tr_b16 a[204:205], v12 offset:8192
    ds_read_b64_tr_b16 a[206:207], v12 offset:12288
    v_mov_b32 v20, v228
    s_waitcnt lgkmcnt(8)
    v_mfma_f32_16x16x32_bf16 v[32:35], a[144:147], v[212:215], 0
    v_exp_f32 v229, v229
    v_mfma_f32_16x16x32_bf16 v[32:35], a[176:179], v[216:219], v[32:35]
    v_add_f32 v20, v20, v229
    v_cvt_pk_bf16_f32 v228, v228, v229
    v_mfma_f32_16x16x32_bf16 v[36:39], a[148:151], v[212:215], 0
    v_exp_f32 v230, v230
    v_mfma_f32_16x16x32_bf16 v[36:39], a[180:183], v[216:219], v[36:39]
    s_and_b32 m0, s28, 0xffff
    v_add_f32 v20, v20, v230
    v_mfma_f32_16x16x32_bf16 v[40:43], a[152:155], v[212:215], 0
    v_exp_f32 v231, v231
    v_mfma_f32_16x16x32_bf16 v[40:43], a[184:187], v[216:219], v[40:43]
    v_add_f32 v20, v20, v231
    v_cvt_pk_bf16_f32 v229, v230, v231
    v_mfma_f32_16x16x32_bf16 v[44:47], a[156:159], v[212:215], 0
    v_exp_f32 v232, v232
    v_mfma_f32_16x16x32_bf16 v[44:47], a[188:191], v[216:219], v[44:47]
    buffer_load_dwordx4 v13, s[12:15], s28 offen offset:0 nt lds
    v_add_f32 v20, v20, v232
    v_mfma_f32_16x16x32_bf16 v[48:51], a[160:163], v[212:215], 0
    v_exp_f32 v233, v233
    v_mfma_f32_16x16x32_bf16 v[48:51], a[192:195], v[216:219], v[48:51]
    v_add_f32 v20, v20, v233
    v_cvt_pk_bf16_f32 v230, v232, v233
    v_mfma_f32_16x16x32_bf16 v[52:55], a[164:167], v[212:215], 0
    v_exp_f32 v234, v234
    v_mfma_f32_16x16x32_bf16 v[52:55], a[196:199], v[216:219], v[52:55]
    v_add_f32 v20, v20, v234
    s_waitcnt lgkmcnt(0)
    v_mfma_f32_16x16x32_bf16 v[56:59], a[168:171], v[212:215], 0
    v_exp_f32 v235, v235
    v_mfma_f32_16x16x32_bf16 v[56:59], a[200:203], v[216:219], v[56:59]
    v_add_f32 v20, v20, v235
    v_cvt_pk_bf16_f32 v231, v234, v235
    v_mfma_f32_16x16x32_bf16 v[60:63], a[172:175], v[212:215], 0
    v_exp_f32 v236, v236
    v_mfma_f32_16x16x32_bf16 v[60:63], a[204:207], v[216:219], v[60:63]
    buffer_load_dwordx4 v14, s[12:15], s28 offen offset:1024 nt lds
    v_add_f32 v20, v20, v236
    v_mfma_f32_16x16x32_bf16 v[212:215], a[80:83], a[32:35], v[200:203]
    v_exp_f32 v237, v237
    v_mfma_f32_16x16x32_bf16 v[212:215], a[84:87], a[36:39], v[212:215]
    v_add_f32 v20, v20, v237
    v_cvt_pk_bf16_f32 v232, v236, v237
    v_mfma_f32_16x16x32_bf16 v[212:215], a[88:91], a[40:43], v[212:215]
    v_exp_f32 v238, v238
    v_mfma_f32_16x16x32_bf16 v[212:215], a[92:95], a[44:47], v[212:215]
    buffer_load_dwordx4 v15, s[12:15], s28 offen offset:2048 nt lds
    v_add_f32 v20, v20, v238
    v_mfma_f32_16x16x32_bf16 v[216:219], a[96:99], a[32:35], v[200:203]
    v_exp_f32 v239, v239
    v_mfma_f32_16x16x32_bf16 v[216:219], a[100:103], a[36:39], v[216:219]
    v_add_f32 v20, v20, v239
    v_cvt_pk_bf16_f32 v233, v238, v239
    v_mfma_f32_16x16x32_bf16 v[216:219], a[104:107], a[40:43], v[216:219]
    v_exp_f32 v240, v240
    v_mfma_f32_16x16x32_bf16 v[216:219], a[108:111], a[44:47], v[216:219]
    buffer_load_dwordx4 v16, s[12:15], s28 offen offset:3072 nt lds
    v_add_f32 v20, v20, v240
    v_mfma_f32_16x16x32_bf16 v[220:223], a[112:115], a[32:35], v[200:203]
    v_exp_f32 v241, v241
    v_mfma_f32_16x16x32_bf16 v[220:223], a[116:119], a[36:39], v[220:223]
    v_add_f32 v20, v20, v241
    v_cvt_pk_bf16_f32 v234, v240, v241
    v_mfma_f32_16x16x32_bf16 v[220:223], a[120:123], a[40:43], v[220:223]
    v_exp_f32 v242, v242
    v_mfma_f32_16x16x32_bf16 v[220:223], a[124:127], a[44:47], v[220:223]
    s_add_u32 m0, m0, 65536
    v_add_f32 v20, v20, v242
    v_mfma_f32_16x16x32_bf16 v[224:227], a[128:131], a[32:35], v[200:203]
    v_exp_f32 v243, v243
    v_mfma_f32_16x16x32_bf16 v[224:227], a[132:135], a[36:39], v[224:227]
    v_add_f32 v20, v20, v243
    v_cvt_pk_bf16_f32 v235, v242, v243
    v_mfma_f32_16x16x32_bf16 v[224:227], a[136:139], a[40:43], v[224:227]
    v_exp_f32 v212, v212
    v_mfma_f32_16x16x32_bf16 v[224:227], a[140:143], a[44:47], v[224:227]
    buffer_load_dwordx4 v17, s[16:19], s28 offen offset:0 nt lds
    v_mov_b32 v21, v212
    v_mfma_f32_16x16x32_bf16 v[64:67], a[144:147], v[228:231], 0
    v_exp_f32 v213, v213
    v_mfma_f32_16x16x32_bf16 v[64:67], a[176:179], v[232:235], v[64:67]
    v_add_f32 v21, v21, v213
    v_cvt_pk_bf16_f32 v212, v212, v213
    v_mfma_f32_16x16x32_bf16 v[68:71], a[148:151], v[228:231], 0
    v_exp_f32 v214, v214
    v_mfma_f32_16x16x32_bf16 v[68:71], a[180:183], v[232:235], v[68:71]
    buffer_load_dwordx4 v18, s[16:19], s28 offen offset:1024 nt lds
    v_add_f32 v21, v21, v214
    v_mfma_f32_16x16x32_bf16 v[72:75], a[152:155], v[228:231], 0
    v_exp_f32 v215, v215
    v_mfma_f32_16x16x32_bf16 v[72:75], a[184:187], v[232:235], v[72:75]
    v_add_f32 v21, v21, v215
    v_cvt_pk_bf16_f32 v213, v214, v215
    v_mfma_f32_16x16x32_bf16 v[76:79], a[156:159], v[228:231], 0
    v_exp_f32 v216, v216
    v_mfma_f32_16x16x32_bf16 v[76:79], a[188:191], v[232:235], v[76:79]
    buffer_load_dwordx4 v17, s[16:19], s28 offen offset:2048 nt lds
    v_add_f32 v21, v21, v216
    v_mfma_f32_16x16x32_bf16 v[80:83], a[160:163], v[228:231], 0
    v_exp_f32 v217, v217
    v_mfma_f32_16x16x32_bf16 v[80:83], a[192:195], v[232:235], v[80:83]
    v_add_f32 v21, v21, v217
    v_cvt_pk_bf16_f32 v214, v216, v217
    v_mfma_f32_16x16x32_bf16 v[84:87], a[164:167], v[228:231], 0
    v_exp_f32 v218, v218
    v_mfma_f32_16x16x32_bf16 v[84:87], a[196:199], v[232:235], v[84:87]
    buffer_load_dwordx4 v18, s[16:19], s28 offen offset:3072 nt lds
    v_add_f32 v21, v21, v218
    v_mfma_f32_16x16x32_bf16 v[88:91], a[168:171], v[228:231], 0
    v_exp_f32 v219, v219
    v_mfma_f32_16x16x32_bf16 v[88:91], a[200:203], v[232:235], v[88:91]
    v_add_f32 v21, v21, v219
    v_cvt_pk_bf16_f32 v215, v218, v219
    v_mfma_f32_16x16x32_bf16 v[92:95], a[172:175], v[228:231], 0
    v_exp_f32 v220, v220
    v_mfma_f32_16x16x32_bf16 v[92:95], a[204:207], v[232:235], v[92:95]
    s_add_u32 s28, s28, 16384
    v_add_f32 v21, v21, v220
    v_mfma_f32_16x16x32_bf16 v[228:231], a[80:83], a[48:51], v[204:207]
    v_exp_f32 v221, v221
    v_mfma_f32_16x16x32_bf16 v[228:231], a[84:87], a[52:55], v[228:231]
    v_add_f32 v21, v21, v221
    v_cvt_pk_bf16_f32 v216, v220, v221
    v_mfma_f32_16x16x32_bf16 v[228:231], a[88:91], a[56:59], v[228:231]
    v_exp_f32 v222, v222
    v_mfma_f32_16x16x32_bf16 v[228:231], a[92:95], a[60:63], v[228:231]
    v_add_f32 v21, v21, v222
    v_mfma_f32_16x16x32_bf16 v[232:235], a[96:99], a[48:51], v[204:207]
    v_exp_f32 v223, v223
    v_mfma_f32_16x16x32_bf16 v[232:235], a[100:103], a[52:55], v[232:235]
    v_add_f32 v21, v21, v223
    v_cvt_pk_bf16_f32 v217, v222, v223
    v_mfma_f32_16x16x32_bf16 v[232:235], a[104:107], a[56:59], v[232:235]
    v_exp_f32 v224, v224
    v_mfma_f32_16x16x32_bf16 v[232:235], a[108:111], a[60:63], v[232:235]
    v_add_f32 v21, v21, v224
    v_mfma_f32_16x16x32_bf16 v[236:239], a[112:115], a[48:51], v[204:207]
    v_exp_f32 v225, v225
    v_mfma_f32_16x16x32_bf16 v[236:239], a[116:119], a[52:55], v[236:239]
    v_add_f32 v21, v21, v225
    v_cvt_pk_bf16_f32 v218, v224, v225
    v_mfma_f32_16x16x32_bf16 v[236:239], a[120:123], a[56:59], v[236:239]
    v_exp_f32 v226, v226
    v_mfma_f32_16x16x32_bf16 v[236:239], a[124:127], a[60:63], v[236:239]
    v_add_f32 v21, v21, v226
    v_mfma_f32_16x16x32_bf16 v[240:243], a[128:131], a[48:51], v[204:207]
    v_exp_f32 v227, v227
    v_mfma_f32_16x16x32_bf16 v[240:243], a[132:135], a[52:55], v[240:243]
    v_add_f32 v21, v21, v227
    v_cvt_pk_bf16_f32 v219, v226, v227
    v_mfma_f32_16x16x32_bf16 v[240:243], a[136:139], a[56:59], v[240:243]
    v_exp_f32 v228, v228
    v_mfma_f32_16x16x32_bf16 v[240:243], a[140:143], a[60:63], v[240:243]
    v_mov_b32 v22, v228
    v_mfma_f32_16x16x32_bf16 v[96:99], a[144:147], v[212:215], 0
    v_exp_f32 v229, v229
    v_mfma_f32_16x16x32_bf16 v[96:99], a[176:179], v[216:219], v[96:99]
    v_add_f32 v22, v22, v229
    v_cvt_pk_bf16_f32 v228, v228, v229
    v_mfma_f32_16x16x32_bf16 v[100:103], a[148:151], v[212:215], 0
    v_exp_f32 v230, v230
    v_mfma_f32_16x16x32_bf16 v[100:103], a[180:183], v[216:219], v[100:103]
    v_add_f32 v22, v22, v230
    v_mfma_f32_16x16x32_bf16 v[104:107], a[152:155], v[212:215], 0
    v_exp_f32 v231, v231
    v_mfma_f32_16x16x32_bf16 v[104:107], a[184:187], v[216:219], v[104:107]
    v_add_f32 v22, v22, v231
    v_cvt_pk_bf16_f32 v229, v230, v231
    v_mfma_f32_16x16x32_bf16 v[108:111], a[156:159], v[212:215], 0
    v_exp_f32 v232, v232
    v_mfma_f32_16x16x32_bf16 v[108:111], a[188:191], v[216:219], v[108:111]
    v_add_f32 v22, v22, v232
    v_mfma_f32_16x16x32_bf16 v[112:115], a[160:163], v[212:215], 0
    v_exp_f32 v233, v233
    v_mfma_f32_16x16x32_bf16 v[112:115], a[192:195], v[216:219], v[112:115]
    v_add_f32 v22, v22, v233
    v_cvt_pk_bf16_f32 v230, v232, v233
    v_mfma_f32_16x16x32_bf16 v[116:119], a[164:167], v[212:215], 0
    v_exp_f32 v234, v234
    v_mfma_f32_16x16x32_bf16 v[116:119], a[196:199], v[216:219], v[116:119]
    v_add_f32 v22, v22, v234
    v_mfma_f32_16x16x32_bf16 v[120:123], a[168:171], v[212:215], 0
    v_exp_f32 v235, v235
    v_mfma_f32_16x16x32_bf16 v[120:123], a[200:203], v[216:219], v[120:123]
    v_add_f32 v22, v22, v235
    v_cvt_pk_bf16_f32 v231, v234, v235
    v_mfma_f32_16x16x32_bf16 v[124:127], a[172:175], v[212:215], 0
    v_exp_f32 v236, v236
    v_mfma_f32_16x16x32_bf16 v[124:127], a[204:207], v[216:219], v[124:127]
    v_add_f32 v22, v22, v236
    s_waitcnt vmcnt(8)
    s_barrier
    v_exp_f32 v237, v237
    ds_read_b128 a[80:83], v1 offset:16384
    v_add_f32 v22, v22, v237
    v_cvt_pk_bf16_f32 v232, v236, v237
    v_exp_f32 v238, v238
    ds_read_b128 a[84:87], v2 offset:16384
    v_add_f32 v22, v22, v238
    v_exp_f32 v239, v239
    ds_read_b128 a[88:91], v3 offset:16384
    v_add_f32 v22, v22, v239
    v_cvt_pk_bf16_f32 v233, v238, v239
    v_exp_f32 v240, v240
    ds_read_b128 a[92:95], v4 offset:16384
    v_add_f32 v22, v22, v240
    v_exp_f32 v241, v241
    ds_read_b128 a[96:99], v1 offset:20480
    v_add_f32 v22, v22, v241
    v_cvt_pk_bf16_f32 v234, v240, v241
    v_exp_f32 v242, v242
    ds_read_b128 a[100:103], v2 offset:20480
    v_add_f32 v22, v22, v242
    v_exp_f32 v243, v243
    ds_read_b128 a[104:107], v3 offset:20480
    v_add_f32 v22, v22, v243
    v_cvt_pk_bf16_f32 v235, v242, v243
    ds_read_b128 a[108:111], v4 offset:20480
    v_mfma_f32_16x16x32_bf16 v[128:131], a[144:147], v[228:231], 0
    v_mfma_f32_16x16x32_bf16 v[128:131], a[176:179], v[232:235], v[128:131]
    ds_read_b128 a[112:115], v1 offset:24576
    v_mfma_f32_16x16x32_bf16 v[132:135], a[148:151], v[228:231], 0
    v_mfma_f32_16x16x32_bf16 v[132:135], a[180:183], v[232:235], v[132:135]
    ds_read_b128 a[116:119], v2 offset:24576
    v_mfma_f32_16x16x32_bf16 v[136:139], a[152:155], v[228:231], 0
    v_mfma_f32_16x16x32_bf16 v[136:139], a[184:187], v[232:235], v[136:139]
    ds_read_b128 a[120:123], v3 offset:24576
    v_mfma_f32_16x16x32_bf16 v[140:143], a[156:159], v[228:231], 0
    v_mfma_f32_16x16x32_bf16 v[140:143], a[188:191], v[232:235], v[140:143]
    ds_read_b128 a[124:127], v4 offset:24576
    v_mfma_f32_16x16x32_bf16 v[144:147], a[160:163], v[228:231], 0
    v_mfma_f32_16x16x32_bf16 v[144:147], a[192:195], v[232:235], v[144:147]
    ds_read_b128 a[128:131], v1 offset:28672
    v_mfma_f32_16x16x32_bf16 v[148:151], a[164:167], v[228:231], 0
    v_mfma_f32_16x16x32_bf16 v[148:151], a[196:199], v[232:235], v[148:151]
    ds_read_b128 a[132:135], v2 offset:28672
    v_mfma_f32_16x16x32_bf16 v[152:155], a[168:171], v[228:231], 0
    v_mfma_f32_16x16x32_bf16 v[152:155], a[200:203], v[232:235], v[152:155]
    ds_read_b128 a[136:139], v3 offset:28672
    v_mfma_f32_16x16x32_bf16 v[156:159], a[172:175], v[228:231], 0
    v_mfma_f32_16x16x32_bf16 v[156:159], a[204:207], v[232:235], v[156:159]
    ds_read_b128 a[140:143], v4 offset:28672
    s_branch L_b1_w3
L_lastb_w3:
    s_waitcnt lgkmcnt(4)
    v_mfma_f32_16x16x32_bf16 v[228:231], a[80:83], a[0:3], v[192:195]
    v_mfma_f32_16x16x32_bf16 v[228:231], a[84:87], a[4:7], v[228:231]
    v_mfma_f32_16x16x32_bf16 v[228:231], a[88:91], a[8:11], v[228:231]
    v_mfma_f32_16x16x32_bf16 v[228:231], a[92:95], a[12:15], v[228:231]
    s_waitcnt vmcnt(0)
    v_mfma_f32_16x16x32_bf16 v[232:235], a[96:99], a[0:3], v[192:195]
    v_mfma_f32_16x16x32_bf16 v[232:235], a[100:103], a[4:7], v[232:235]
    v_mfma_f32_16x16x32_bf16 v[232:235], a[104:107], a[8:11], v[232:235]
    v_mfma_f32_16x16x32_bf16 v[232:235], a[108:111], a[12:15], v[232:235]
    v_mfma_f32_16x16x32_bf16 v[236:239], a[112:115], a[0:3], v[192:195]
    v_mfma_f32_16x16x32_bf16 v[236:239], a[116:119], a[4:7], v[236:239]
    v_mfma_f32_16x16x32_bf16 v[236:239], a[120:123], a[8:11], v[236:239]
    v_mfma_f32_16x16x32_bf16 v[236:239], a[124:127], a[12:15], v[236:239]
    s_waitcnt lgkmcnt(0)
    v_mfma_f32_16x16x32_bf16 v[240:243], a[128:131], a[0:3], v[192:195]
    v_mfma_f32_16x16x32_bf16 v[240:243], a[132:135], a[4:7], v[240:243]
    v_mfma_f32_16x16x32_bf16 v[240:243], a[136:139], a[8:11], v[240:243]
    v_exp_f32 v228, v228
    v_mfma_f32_16x16x32_bf16 v[240:243], a[140:143], a[12:15], v[240:243]
    v_add_f32 v19, v19, v228
    v_exp_f32 v229, v229
    ds_read_b64_tr_b16 a[144:145], v5 offset:49152
    ds_read_b64_tr_b16 a[146:147], v5 offset:53248
    v_add_f32 v19, v19, v229
    v_cvt_pk_bf16_f32 v228, v228, v229
    v_exp_f32 v230, v230
    ds_read_b64_tr_b16 a[176:177], v5 offset:57344
    ds_read_b64_tr_b16 a[178:179], v5 offset:61440
    v_add_f32 v19, v19, v230
    v_exp_f32 v231, v231
    ds_read_b64_tr_b16 a[148:149], v6 offset:49152
    ds_read_b64_tr_b16 a[150:151], v6 offset:53248
    v_add_f32 v19, v19, v231
    v_cvt_pk_bf16_f32 v229, v230, v231
    v_exp_f32 v232, v232
    ds_read_b64_tr_b16 a[180:181], v6 offset:57344
    ds_read_b64_tr_b16 a[182:183], v6 offset:61440
    v_add_f32 v19, v19, v232
    v_exp_f32 v233, v233
    ds_read_b64_tr_b16 a[152:153], v7 offset:49152
    ds_read_b64_tr_b16 a[154:155], v7 offset:53248
    v_add_f32 v19, v19, v233
    v_cvt_pk_bf16_f32 v230, v232, v233
    v_exp_f32 v234, v234
    ds_read_b64_tr_b16 a[184:185], v7 offset:57344
    ds_read_b64_tr_b16 a[186:187], v7 offset:61440
    v_add_f32 v19, v19, v234
    v_exp_f32 v235, v235
    ds_read_b64_tr_b16 a[156:157], v8 offset:49152
    ds_read_b64_tr_b16 a[158:159], v8 offset:53248
    v_add_f32 v19, v19, v235
    v_cvt_pk_bf16_f32 v231, v234, v235
    v_exp_f32 v236, v236
    ds_read_b64_tr_b16 a[188:189], v8 offset:57344
    ds_read_b64_tr_b16 a[190:191], v8 offset:61440
    v_add_f32 v19, v19, v236
    v_mfma_f32_16x16x32_bf16 v[212:215], a[80:83], a[16:19], v[196:199]
    v_exp_f32 v237, v237
    v_mfma_f32_16x16x32_bf16 v[212:215], a[84:87], a[20:23], v[212:215]
    ds_read_b64_tr_b16 a[160:161], v9 offset:49152
    ds_read_b64_tr_b16 a[162:163], v9 offset:53248
    v_add_f32 v19, v19, v237
    v_cvt_pk_bf16_f32 v232, v236, v237
    v_mfma_f32_16x16x32_bf16 v[212:215], a[88:91], a[24:27], v[212:215]
    v_exp_f32 v238, v238
    v_mfma_f32_16x16x32_bf16 v[212:215], a[92:95], a[28:31], v[212:215]
    ds_read_b64_tr_b16 a[192:193], v9 offset:57344
    ds_read_b64_tr_b16 a[194:195], v9 offset:61440
    v_add_f32 v19, v19, v238
    v_mfma_f32_16x16x32_bf16 v[216:219], a[96:99], a[16:19], v[196:199]
    v_exp_f32 v239, v239
    v_mfma_f32_16x16x32_bf16 v[216:219], a[100:103], a[20:23], v[216:219]
    ds_read_b64_tr_b16 a[164:165], v10 offset:49152
    ds_read_b64_tr_b16 a[166:167], v10 offset:53248
    v_add_f32 v19, v19, v239
    v_cvt_pk_bf16_f32 v233, v238, v239
    v_mfma_f32_16x16x32_bf16 v[216:219], a[104:107], a[24:27], v[216:219]
    v_exp_f32 v240, v240
    v_mfma_f32_16x16x32_bf16 v[216:219], a[108:111], a[28:31], v[216:219]
    ds_read_b64_tr_b16 a[196:197], v10 offset:57344
    ds_read_b64_tr_b16 a[198:199], v10 offset:61440
    v_add_f32 v19, v19, v240
    v_mfma_f32_16x16x32_bf16 v[220:223], a[112:115], a[16:19], v[196:199]
    v_exp_f32 v241, v241
    v_mfma_f32_16x16x32_bf16 v[220:223], a[116:119], a[20:23], v[220:223]
    ds_read_b64_tr_b16 a[168:169], v11 offset:49152
    ds_read_b64_tr_b16 a[170:171], v11 offset:53248
    v_add_f32 v19, v19, v241
    v_cvt_pk_bf16_f32 v234, v240, v241
    v_mfma_f32_16x16x32_bf16 v[220:223], a[120:123], a[24:27], v[220:223]
    v_exp_f32 v242, v242
    v_mfma_f32_16x16x32_bf16 v[220:223], a[124:127], a[28:31], v[220:223]
    ds_read_b64_tr_b16 a[200:201], v11 offset:57344
    ds_read_b64_tr_b16 a[202:203], v11 offset:61440
    v_add_f32 v19, v19, v242
    v_mfma_f32_16x16x32_bf16 v[224:227], a[128:131], a[16:19], v[196:199]
    v_exp_f32 v243, v243
    v_mfma_f32_16x16x32_bf16 v[224:227], a[132:135], a[20:23], v[224:227]
    ds_read_b64_tr_b16 a[172:173], v12 offset:49152
    ds_read_b64_tr_b16 a[174:175], v12 offset:53248
    v_add_f32 v19, v19, v243
    v_cvt_pk_bf16_f32 v235, v242, v243
    v_mfma_f32_16x16x32_bf16 v[224:227], a[136:139], a[24:27], v[224:227]
    v_exp_f32 v212, v212
    v_mov_b32 v30, v19
    v_mfma_f32_16x16x32_bf16 v[224:227], a[140:143], a[28:31], v[224:227]
    ds_read_b64_tr_b16 a[204:205], v12 offset:57344
    ds_read_b64_tr_b16 a[206:207], v12 offset:61440
    v_add_f32 v20, v20, v212
    s_waitcnt lgkmcnt(8)
    v_mfma_f32_16x16x32_bf16 v[32:35], a[144:147], v[228:231], v[32:35]
    v_exp_f32 v213, v213
    v_permlane16_swap_b32 v19, v30
    v_mfma_f32_16x16x32_bf16 v[32:35], a[176:179], v[232:235], v[32:35]
    v_add_f32 v20, v20, v213
    v_cvt_pk_bf16_f32 v212, v212, v213
    v_mfma_f32_16x16x32_bf16 v[36:39], a[148:151], v[228:231], v[36:39]
    v_exp_f32 v214, v214
    v_mfma_f32_16x16x32_bf16 v[36:39], a[180:183], v[232:235], v[36:39]
    v_add_f32 v20, v20, v214
    v_add_f32 v19, v19, v30
    v_mfma_f32_16x16x32_bf16 v[40:43], a[152:155], v[228:231], v[40:43]
    v_exp_f32 v215, v215
    v_mfma_f32_16x16x32_bf16 v[40:43], a[184:187], v[232:235], v[40:43]
    v_add_f32 v20, v20, v215
    v_cvt_pk_bf16_f32 v213, v214, v215
    v_mov_b32 v30, v19
    v_mfma_f32_16x16x32_bf16 v[44:47], a[156:159], v[228:231], v[44:47]
    v_exp_f32 v216, v216
    v_mfma_f32_16x16x32_bf16 v[44:47], a[188:191], v[232:235], v[44:47]
    v_add_f32 v20, v20, v216
    v_permlane32_swap_b32 v19, v30
    v_mfma_f32_16x16x32_bf16 v[48:51], a[160:163], v[228:231], v[48:51]
    v_exp_f32 v217, v217
    v_mfma_f32_16x16x32_bf16 v[48:51], a[192:195], v[232:235], v[48:51]
    v_add_f32 v20, v20, v217
    v_cvt_pk_bf16_f32 v214, v216, v217
    v_add_f32 v19, v19, v30
    v_mfma_f32_16x16x32_bf16 v[52:55], a[164:167], v[228:231], v[52:55]
    v_exp_f32 v218, v218
    v_mfma_f32_16x16x32_bf16 v[52:55], a[196:199], v[232:235], v[52:55]
    v_add_f32 v20, v20, v218
    v_rcp_f32 v28, v19
    s_waitcnt lgkmcnt(0)
    v_mfma_f32_16x16x32_bf16 v[56:59], a[168:171], v[228:231], v[56:59]
    v_exp_f32 v219, v219
    v_mfma_f32_16x16x32_bf16 v[56:59], a[200:203], v[232:235], v[56:59]
    v_add_f32 v20, v20, v219
    v_cvt_pk_bf16_f32 v215, v218, v219
    v_cmp_nge_f32 s[96:97], s36, v19
    v_mfma_f32_16x16x32_bf16 v[60:63], a[172:175], v[228:231], v[60:63]
    v_exp_f32 v220, v220
    v_mfma_f32_16x16x32_bf16 v[60:63], a[204:207], v[232:235], v[60:63]
    v_add_f32 v20, v20, v220
    s_or_b64 s[90:91], s[90:91], s[96:97]
    v_mfma_f32_16x16x32_bf16 v[228:231], a[80:83], a[32:35], v[200:203]
    v_exp_f32 v221, v221
    v_mfma_f32_16x16x32_bf16 v[228:231], a[84:87], a[36:39], v[228:231]
    v_add_f32 v20, v20, v221
    v_cvt_pk_bf16_f32 v216, v220, v221
    v_pk_mul_f32 v[32:33], v[32:33], v[28:29] op_sel_hi:[1,0]
    v_pk_mul_f32 v[34:35], v[34:35], v[28:29] op_sel_hi:[1,0]
    v_pk_mul_f32 v[36:37], v[36:37], v[28:29] op_sel_hi:[1,0]
    v_pk_mul_f32 v[38:39], v[38:39], v[28:29] op_sel_hi:[1,0]
    v_pk_mul_f32 v[40:41], v[40:41], v[28:29] op_sel_hi:[1,0]
    v_pk_mul_f32 v[42:43], v[42:43], v[28:29] op_sel_hi:[1,0]
    v_pk_mul_f32 v[44:45], v[44:45], v[28:29] op_sel_hi:[1,0]
    v_pk_mul_f32 v[46:47], v[46:47], v[28:29] op_sel_hi:[1,0]
    v_cvt_pk_bf16_f32 v32, v32, v33
    v_cvt_pk_bf16_f32 v33, v34, v35
    v_cvt_pk_bf16_f32 v36, v36, v37
    v_cvt_pk_bf16_f32 v37, v38, v39
    v_cvt_pk_bf16_f32 v40, v40, v41
    v_cvt_pk_bf16_f32 v41, v42, v43
    v_cvt_pk_bf16_f32 v44, v44, v45
    v_cvt_pk_bf16_f32 v45, v46, v47
    v_pk_mul_f32 v[48:49], v[48:49], v[28:29] op_sel_hi:[1,0]
    v_pk_mul_f32 v[50:51], v[50:51], v[28:29] op_sel_hi:[1,0]
    v_pk_mul_f32 v[52:53], v[52:53], v[28:29] op_sel_hi:[1,0]
    v_pk_mul_f32 v[54:55], v[54:55], v[28:29] op_sel_hi:[1,0]
    v_pk_mul_f32 v[56:57], v[56:57], v[28:29] op_sel_hi:[1,0]
    v_pk_mul_f32 v[58:59], v[58:59], v[28:29] op_sel_hi:[1,0]
    v_pk_mul_f32 v[60:61], v[60:61], v[28:29] op_sel_hi:[1,0]
    v_pk_mul_f32 v[62:63], v[62:63], v[28:29] op_sel_hi:[1,0]
    v_cvt_pk_bf16_f32 v48, v48, v49
    v_cvt_pk_bf16_f32 v49, v50, v51
    v_cvt_pk_bf16_f32 v52, v52, v53
    v_cvt_pk_bf16_f32 v53, v54, v55
    v_cvt_pk_bf16_f32 v56, v56, v57
    v_cvt_pk_bf16_f32 v57, v58, v59
    v_cvt_pk_bf16_f32 v60, v60, v61
    v_cvt_pk_bf16_f32 v61, v62, v63
    v_mfma_f32_16x16x32_bf16 v[228:231], a[88:91], a[40:43], v[228:231]
    v_exp_f32 v222, v222
    v_mfma_f32_16x16x32_bf16 v[228:231], a[92:95], a[44:47], v[228:231]
    ds_write_b64 v24, v[32:33] offset:0
    v_add_f32 v20, v20, v222
    v_mfma_f32_16x16x32_bf16 v[232:235], a[96:99], a[32:35], v[200:203]
    v_exp_f32 v223, v223
    v_mfma_f32_16x16x32_bf16 v[232:235], a[100:103], a[36:39], v[232:235]
    v_add_f32 v20, v20, v223
    v_cvt_pk_bf16_f32 v217, v222, v223
    v_mfma_f32_16x16x32_bf16 v[232:235], a[104:107], a[40:43], v[232:235]
    v_exp_f32 v224, v224
    v_mfma_f32_16x16x32_bf16 v[232:235], a[108:111], a[44:47], v[232:235]
    ds_write_b64 v24, v[36:37] offset:32
    v_add_f32 v20, v20, v224
    v_mfma_f32_16x16x32_bf16 v[236:239], a[112:115], a[32:35], v[200:203]
    v_exp_f32 v225, v225
    v_mfma_f32_16x16x32_bf16 v[236:239], a[116:119], a[36:39], v[236:239]
    v_add_f32 v20, v20, v225
    v_cvt_pk_bf16_f32 v218, v224, v225
    v_mfma_f32_16x16x32_bf16 v[236:239], a[120:123], a[40:43], v[236:239]
    v_exp_f32 v226, v226
    v_mfma_f32_16x16x32_bf16 v[236:239], a[124:127], a[44:47], v[236:239]
    ds_write_b64 v24, v[40:41] offset:64
    v_add_f32 v20, v20, v226
    v_mfma_f32_16x16x32_bf16 v[240:243], a[128:131], a[32:35], v[200:203]
    v_exp_f32 v227, v227
    v_mfma_f32_16x16x32_bf16 v[240:243], a[132:135], a[36:39], v[240:243]
    ds_write_b64 v24, v[44:45] offset:96
    v_add_f32 v20, v20, v227
    v_cvt_pk_bf16_f32 v219, v226, v227
    v_mfma_f32_16x16x32_bf16 v[240:243], a[136:139], a[40:43], v[240:243]
    v_exp_f32 v228, v228
    v_mov_b32 v30, v20
    v_mfma_f32_16x16x32_bf16 v[240:243], a[140:143], a[44:47], v[240:243]
    ds_write_b64 v24, v[48:49] offset:128
    v_add_f32 v21, v21, v228
    v_mfma_f32_16x16x32_bf16 v[64:67], a[144:147], v[212:215], v[64:67]
    v_exp_f32 v229, v229
    v_permlane16_swap_b32 v20, v30
    v_mfma_f32_16x16x32_bf16 v[64:67], a[176:179], v[216:219], v[64:67]
    ds_write_b64 v24, v[52:53] offset:160
    v_add_f32 v21, v21, v229
    v_cvt_pk_bf16_f32 v228, v228, v229
    v_mfma_f32_16x16x32_bf16 v[68:71], a[148:151], v[212:215], v[68:71]
    v_exp_f32 v230, v230
    v_add_f32 v20, v20, v30
    v_mfma_f32_16x16x32_bf16 v[68:71], a[180:183], v[216:219], v[68:71]
    ds_write_b64 v24, v[56:57] offset:192
    v_add_f32 v21, v21, v230
    v_mfma_f32_16x16x32_bf16 v[72:75], a[152:155], v[212:215], v[72:75]
    v_exp_f32 v231, v231
    v_mov_b32 v30, v20
    v_mfma_f32_16x16x32_bf16 v[72:75], a[184:187], v[216:219], v[72:75]
    ds_write_b64 v24, v[60:61] offset:224
    v_add_f32 v21, v21, v231
    v_cvt_pk_bf16_f32 v229, v230, v231
    v_mfma_f32_16x16x32_bf16 v[76:79], a[156:159], v[212:215], v[76:79]
    v_exp_f32 v232, v232
    v_permlane32_swap_b32 v20, v30
    v_mfma_f32_16x16x32_bf16 v[76:79], a[188:191], v[216:219], v[76:79]
    ds_read_b128 v[32:35], v25 offset:0
    v_add_f32 v21, v21, v232
    v_mfma_f32_16x16x32_bf16 v[80:83], a[160:163], v[212:215], v[80:83]
    v_exp_f32 v233, v233
    v_add_f32 v20, v20, v30
    v_mfma_f32_16x16x32_bf16 v[80:83], a[192:195], v[216:219], v[80:83]
    v_add_f32 v21, v21, v233
    v_cvt_pk_bf16_f32 v230, v232, v233
    v_mfma_f32_16x16x32_bf16 v[84:87], a[164:167], v[212:215], v[84:87]
    v_exp_f32 v234, v234
    v_rcp_f32 v28, v20
    v_mfma_f32_16x16x32_bf16 v[84:87], a[196:199], v[216:219], v[84:87]
    ds_read_b128 v[36:39], v25 offset:1088
    v_add_f32 v21, v21, v234
    v_mfma_f32_16x16x32_bf16 v[88:91], a[168:171], v[212:215], v[88:91]
    ds_read_b128 v[40:43], v25 offset:2176
    v_exp_f32 v235, v235
    v_cmp_nge_f32 s[96:97], s36, v20
    v_mfma_f32_16x16x32_bf16 v[88:91], a[200:203], v[216:219], v[88:91]
    v_add_f32 v21, v21, v235
    v_cvt_pk_bf16_f32 v231, v234, v235
    v_mfma_f32_16x16x32_bf16 v[92:95], a[172:175], v[212:215], v[92:95]
    v_exp_f32 v236, v236
    s_or_b64 s[90:91], s[90:91], s[96:97]
    v_mfma_f32_16x16x32_bf16 v[92:95], a[204:207], v[216:219], v[92:95]
    ds_read_b128 v[44:47], v25 offset:3264
    v_add_f32 v21, v21, v236
    v_mfma_f32_16x16x32_bf16 v[212:215], a[80:83], a[48:51], v[204:207]
    v_exp_f32 v237, v237
    v_mfma_f32_16x16x32_bf16 v[212:215], a[84:87], a[52:55], v[212:215]
    v_add_f32 v21, v21, v237
    v_cvt_pk_bf16_f32 v232, v236, v237
    v_pk_mul_f32 v[64:65], v[64:65], v[28:29] op_sel_hi:[1,0]
    v_pk_mul_f32 v[66:67], v[66:67], v[28:29] op_sel_hi:[1,0]
    v_pk_mul_f32 v[68:69], v[68:69], v[28:29] op_sel_hi:[1,0]
    v_pk_mul_f32 v[70:71], v[70:71], v[28:29] op_sel_hi:[1,0]
    v_pk_mul_f32 v[72:73], v[72:73], v[28:29] op_sel_hi:[1,0]
    v_pk_mul_f32 v[74:75], v[74:75], v[28:29] op_sel_hi:[1,0]
    v_pk_mul_f32 v[76:77], v[76:77], v[28:29] op_sel_hi:[1,0]
    v_pk_mul_f32 v[78:79], v[78:79], v[28:29] op_sel_hi:[1,0]
    v_cvt_pk_bf16_f32 v64, v64, v65
    v_cvt_pk_bf16_f32 v65, v66, v67
    v_cvt_pk_bf16_f32 v68, v68, v69
    v_cvt_pk_bf16_f32 v69, v70, v71
    v_cvt_pk_bf16_f32 v72, v72, v73
    v_cvt_pk_bf16_f32 v73, v74, v75
    v_cvt_pk_bf16_f32 v76, v76, v77
    v_cvt_pk_bf16_f32 v77, v78, v79
    v_pk_mul_f32 v[80:81], v[80:81], v[28:29] op_sel_hi:[1,0]
    v_pk_mul_f32 v[82:83], v[82:83], v[28:29] op_sel_hi:[1,0]
    v_pk_mul_f32 v[84:85], v[84:85], v[28:29] op_sel_hi:[1,0]
    v_pk_mul_f32 v[86:87], v[86:87], v[28:29] op_sel_hi:[1,0]
    v_pk_mul_f32 v[88:89], v[88:89], v[28:29] op_sel_hi:[1,0]
    v_pk_mul_f32 v[90:91], v[90:91], v[28:29] op_sel_hi:[1,0]
    v_pk_mul_f32 v[92:93], v[92:93], v[28:29] op_sel_hi:[1,0]
    v_pk_mul_f32 v[94:95], v[94:95], v[28:29] op_sel_hi:[1,0]
    v_cvt_pk_bf16_f32 v80, v80, v81
    v_cvt_pk_bf16_f32 v81, v82, v83
    v_cvt_pk_bf16_f32 v84, v84, v85
    v_cvt_pk_bf16_f32 v85, v86, v87
    v_cvt_pk_bf16_f32 v88, v88, v89
    v_cvt_pk_bf16_f32 v89, v90, v91
    v_cvt_pk_bf16_f32 v92, v92, v93
    v_cvt_pk_bf16_f32 v93, v94, v95
    v_mfma_f32_16x16x32_bf16 v[212:215], a[88:91], a[56:59], v[212:215]
    v_exp_f32 v238, v238
    v_mfma_f32_16x16x32_bf16 v[212:215], a[92:95], a[60:63], v[212:215]
    ds_write_b64 v24, v[64:65] offset:0
    v_add_f32 v21, v21, v238
    v_mfma_f32_16x16x32_bf16 v[216:219], a[96:99], a[48:51], v[204:207]
    v_exp_f32 v239, v239
    v_mfma_f32_16x16x32_bf16 v[216:219], a[100:103], a[52:55], v[216:219]
    ds_write_b64 v24, v[68:69] offset:32
    v_add_f32 v21, v21, v239
    v_cvt_pk_bf16_f32 v233, v238, v239
    v_mfma_f32_16x16x32_bf16 v[216:219], a[104:107], a[56:59], v[216:219]
    v_exp_f32 v240, v240
    v_mfma_f32_16x16x32_bf16 v[216:219], a[108:111], a[60:63], v[216:219]
    ds_write_b64 v24, v[72:73] offset:64
    s_add_u32 s101, s100, 0
    v_add_f32 v21, v21, v240
    v_mfma_f32_16x16x32_bf16 v[220:223], a[112:115], a[48:51], v[204:207]
    v_exp_f32 v241, v241
    v_mfma_f32_16x16x32_bf16 v[220:223], a[116:119], a[52:55], v[220:223]
    ds_write_b64 v24, v[76:77] offset:96
    v_add_f32 v21, v21, v241
    v_cvt_pk_bf16_f32 v234, v240, v241
    v_mfma_f32_16x16x32_bf16 v[220:223], a[120:123], a[56:59], v[220:223]
    v_exp_f32 v242, v242
    v_mfma_f32_16x16x32_bf16 v[220:223], a[124:127], a[60:63], v[220:223]
    s_waitcnt lgkmcnt(3)
    buffer_store_dwordx4 v[32:35], v26, s[92:95], s101 offen offset:0 sc1
    ds_write_b64 v24, v[80:81] offset:128
    v_add_f32 v21, v21, v242
    v_mfma_f32_16x16x32_bf16 v[224:227], a[128:131], a[48:51], v[204:207]
    v_exp_f32 v243, v243
    v_mfma_f32_16x16x32_bf16 v[224:227], a[132:135], a[52:55], v[224:227]
    ds_write_b64 v24, v[84:85] offset:160
    v_add_f32 v21, v21, v243
    v_cvt_pk_bf16_f32 v235, v242, v243
    v_mfma_f32_16x16x32_bf16 v[224:227], a[136:139], a[56:59], v[224:227]
    v_exp_f32 v212, v212
    v_mov_b32 v30, v21
    v_mfma_f32_16x16x32_bf16 v[224:227], a[140:143], a[60:63], v[224:227]
    buffer_store_dwordx4 v[36:39], v26, s[92:95], s101 offen offset:1024 sc1
    ds_write_b64 v24, v[88:89] offset:192
    v_add_f32 v22, v22, v212
    v_mfma_f32_16x16x32_bf16 v[96:99], a[144:147], v[228:231], v[96:99]
    v_exp_f32 v213, v213
    v_permlane16_swap_b32 v21, v30
    v_mfma_f32_16x16x32_bf16 v[96:99], a[176:179], v[232:235], v[96:99]
    ds_write_b64 v24, v[92:93] offset:224
    v_add_f32 v22, v22, v213
    v_cvt_pk_bf16_f32 v212, v212, v213
    v_mfma_f32_16x16x32_bf16 v[100:103], a[148:151], v[228:231], v[100:103]
    v_exp_f32 v214, v214
    v_add_f32 v21, v21, v30
    v_mfma_f32_16x16x32_bf16 v[100:103], a[180:183], v[232:235], v[100:103]
    buffer_store_dwordx4 v[40:43], v26, s[92:95], s101 offen offset:2048 sc1
    v_add_f32 v22, v22, v214
    v_mfma_f32_16x16x32_bf16 v[104:107], a[152:155], v[228:231], v[104:107]
    v_exp_f32 v215, v215
    v_mov_b32 v30, v21
    v_mfma_f32_16x16x32_bf16 v[104:107], a[184:187], v[232:235], v[104:107]
    buffer_store_dwordx4 v[44:47], v26, s[92:95], s101 offen offset:3072 sc1
    v_add_f32 v22, v22, v215
    v_cvt_pk_bf16_f32 v213, v214, v215
    v_mfma_f32_16x16x32_bf16 v[108:111], a[156:159], v[228:231], v[108:111]
    v_exp_f32 v216, v216
    v_permlane32_swap_b32 v21, v30
    v_mfma_f32_16x16x32_bf16 v[108:111], a[188:191], v[232:235], v[108:111]
    ds_read_b128 v[64:67], v25 offset:0
    v_add_f32 v22, v22, v216
    v_mfma_f32_16x16x32_bf16 v[112:115], a[160:163], v[228:231], v[112:115]
    v_exp_f32 v217, v217
    v_add_f32 v21, v21, v30
    v_mfma_f32_16x16x32_bf16 v[112:115], a[192:195], v[232:235], v[112:115]
    v_add_f32 v22, v22, v217
    v_cvt_pk_bf16_f32 v214, v216, v217
    v_mfma_f32_16x16x32_bf16 v[116:119], a[164:167], v[228:231], v[116:119]
    v_exp_f32 v218, v218
    v_rcp_f32 v28, v21
    v_mfma_f32_16x16x32_bf16 v[116:119], a[196:199], v[232:235], v[116:119]
    ds_read_b128 v[68:71], v25 offset:1088
    v_add_f32 v22, v22, v218
    v_mfma_f32_16x16x32_bf16 v[120:123], a[168:171], v[228:231], v[120:123]
    ds_read_b128 v[72:75], v25 offset:2176
    v_exp_f32 v219, v219
    v_cmp_nge_f32 s[96:97], s36, v21
    v_mfma_f32_16x16x32_bf16 v[120:123], a[200:203], v[232:235], v[120:123]
    v_add_f32 v22, v22, v219
    v_cvt_pk_bf16_f32 v215, v218, v219
    v_mfma_f32_16x16x32_bf16 v[124:127], a[172:175], v[228:231], v[124:127]
    v_exp_f32 v220, v220
    s_or_b64 s[90:91], s[90:91], s[96:97]
    v_mfma_f32_16x16x32_bf16 v[124:127], a[204:207], v[232:235], v[124:127]
    ds_read_b128 v[76:79], v25 offset:3264
    v_add_f32 v22, v22, v220
    s_barrier
    v_exp_f32 v221, v221
    s_nop 0
    v_add_f32 v22, v22, v221
    v_cvt_pk_bf16_f32 v216, v220, v221
    v_pk_mul_f32 v[96:97], v[96:97], v[28:29] op_sel_hi:[1,0]
    v_pk_mul_f32 v[98:99], v[98:99], v[28:29] op_sel_hi:[1,0]
    v_pk_mul_f32 v[100:101], v[100:101], v[28:29] op_sel_hi:[1,0]
    v_pk_mul_f32 v[102:103], v[102:103], v[28:29] op_sel_hi:[1,0]
    v_pk_mul_f32 v[104:105], v[104:105], v[28:29] op_sel_hi:[1,0]
    v_pk_mul_f32 v[106:107], v[106:107], v[28:29] op_sel_hi:[1,0]
    v_pk_mul_f32 v[108:109], v[108:109], v[28:29] op_sel_hi:[1,0]
    v_pk_mul_f32 v[110:111], v[110:111], v[28:29] op_sel_hi:[1,0]
    v_cvt_pk_bf16_f32 v96, v96, v97
    v_cvt_pk_bf16_f32 v97, v98, v99
    v_cvt_pk_bf16_f32 v100, v100, v101
    v_cvt_pk_bf16_f32 v101, v102, v103
    v_cvt_pk_bf16_f32 v104, v104, v105
    v_cvt_pk_bf16_f32 v105, v106, v107
    v_cvt_pk_bf16_f32 v108, v108, v109
    v_cvt_pk_bf16_f32 v109, v110, v111
    v_pk_mul_f32 v[112:113], v[112:113], v[28:29] op_sel_hi:[1,0]
    v_pk_mul_f32 v[114:115], v[114:115], v[28:29] op_sel_hi:[1,0]
    v_pk_mul_f32 v[116:117], v[116:117], v[28:29] op_sel_hi:[1,0]
    v_pk_mul_f32 v[118:119], v[118:119], v[28:29] op_sel_hi:[1,0]
    v_pk_mul_f32 v[120:121], v[120:121], v[28:29] op_sel_hi:[1,0]
    v_pk_mul_f32 v[122:123], v[122:123], v[28:29] op_sel_hi:[1,0]
    v_pk_mul_f32 v[124:125], v[124:125], v[28:29] op_sel_hi:[1,0]
    v_pk_mul_f32 v[126:127], v[126:127], v[28:29] op_sel_hi:[1,0]
    v_cvt_pk_bf16_f32 v112, v112, v113
    v_cvt_pk_bf16_f32 v113, v114, v115
    v_cvt_pk_bf16_f32 v116, v116, v117
    v_cvt_pk_bf16_f32 v117, v118, v119
    v_cvt_pk_bf16_f32 v120, v120, v121
    v_cvt_pk_bf16_f32 v121, v122, v123
    v_cvt_pk_bf16_f32 v124, v124, v125
    v_cvt_pk_bf16_f32 v125, v126, v127
    v_exp_f32 v222, v222
    ds_write_b64 v24, v[96:97] offset:0
    v_add_f32 v22, v22, v222
    v_exp_f32 v223, v223
    ds_write_b64 v24, v[100:101] offset:32
    v_add_f32 v22, v22, v223
    v_cvt_pk_bf16_f32 v217, v222, v223
    v_exp_f32 v224, v224
    ds_write_b64 v24, v[104:105] offset:64
    s_add_u32 s101, s100, 4096
    v_add_f32 v22, v22, v224
    v_exp_f32 v225, v225
    ds_write_b64 v24, v[108:109] offset:96
    v_add_f32 v22, v22, v225
    v_cvt_pk_bf16_f32 v218, v224, v225
    v_exp_f32 v226, v226
    s_waitcnt lgkmcnt(7)
    buffer_store_dwordx4 v[64:67], v26, s[92:95], s101 offen offset:0 sc1
    ds_write_b64 v24, v[112:113] offset:128
    v_add_f32 v22, v22, v226
    v_exp_f32 v227, v227
    ds_write_b64 v24, v[116:117] offset:160
    v_add_f32 v22, v22, v227
    v_cvt_pk_bf16_f32 v219, v226, v227
    v_mov_b32 v30, v22
    s_waitcnt lgkmcnt(8)
    buffer_store_dwordx4 v[68:71], v26, s[92:95], s101 offen offset:1024 sc1
    ds_write_b64 v24, v[120:121] offset:192
    v_mfma_f32_16x16x32_bf16 v[128:131], a[144:147], v[212:215], v[128:131]
    v_permlane16_swap_b32 v22, v30
    v_mfma_f32_16x16x32_bf16 v[128:131], a[176:179], v[216:219], v[128:131]
    ds_write_b64 v24, v[124:125] offset:224
    v_mfma_f32_16x16x32_bf16 v[132:135], a[148:151], v[212:215], v[132:135]
    v_add_f32 v22, v22, v30
    v_mfma_f32_16x16x32_bf16 v[132:135], a[180:183], v[216:219], v[132:135]
    s_waitcnt lgkmcnt(9)
    buffer_store_dwordx4 v[72:75], v26, s[92:95], s101 offen offset:2048 sc1
    ds_read_b128 v[96:99], v25 offset:0
    v_mfma_f32_16x16x32_bf16 v[136:139], a[152:155], v[212:215], v[136:139]
    ds_read_b128 v[100:103], v25 offset:1088
    v_mov_b32 v30, v22
    v_mfma_f32_16x16x32_bf16 v[136:139], a[184:187], v[216:219], v[136:139]
    s_waitcnt lgkmcnt(10)
    buffer_store_dwordx4 v[76:79], v26, s[92:95], s101 offen offset:3072 sc1
    ds_read_b128 v[104:107], v25 offset:2176
    v_mfma_f32_16x16x32_bf16 v[140:143], a[156:159], v[212:215], v[140:143]
    ds_read_b128 v[108:111], v25 offset:3264
    v_mfma_f32_16x16x32_bf16 v[140:143], a[188:191], v[216:219], v[140:143]
    v_permlane32_swap_b32 v22, v30
    v_mfma_f32_16x16x32_bf16 v[144:147], a[160:163], v[212:215], v[144:147]
    v_mfma_f32_16x16x32_bf16 v[144:147], a[192:195], v[216:219], v[144:147]
    v_add_f32 v22, v22, v30
    v_mfma_f32_16x16x32_bf16 v[148:151], a[164:167], v[212:215], v[148:151]
    v_mfma_f32_16x16x32_bf16 v[148:151], a[196:199], v[216:219], v[148:151]
    s_add_u32 s101, s100, 8192
    v_rcp_f32 v28, v22
    v_mfma_f32_16x16x32_bf16 v[152:155], a[168:171], v[212:215], v[152:155]
    s_waitcnt lgkmcnt(2)
    buffer_store_dwordx4 v[96:99], v26, s[92:95], s101 offen offset:0 sc1
    v_mfma_f32_16x16x32_bf16 v[152:155], a[200:203], v[216:219], v[152:155]
    buffer_store_dwordx4 v[100:103], v26, s[92:95], s101 offen offset:1024 sc1
    v_cmp_nge_f32 s[96:97], s36, v22
    v_mfma_f32_16x16x32_bf16 v[156:159], a[172:175], v[212:215], v[156:159]
    s_waitcnt lgkmcnt(0)
    buffer_store_dwordx4 v[104:107], v26, s[92:95], s101 offen offset:2048 sc1
    v_mfma_f32_16x16x32_bf16 v[156:159], a[204:207], v[216:219], v[156:159]
    buffer_store_dwordx4 v[108:111], v26, s[92:95], s101 offen offset:3072 sc1
    s_or_b64 s[90:91], s[90:91], s[96:97]
    v_pk_mul_f32 v[128:129], v[128:129], v[28:29] op_sel_hi:[1,0]
    v_pk_mul_f32 v[130:131], v[130:131], v[28:29] op_sel_hi:[1,0]
    v_pk_mul_f32 v[132:133], v[132:133], v[28:29] op_sel_hi:[1,0]
    v_pk_mul_f32 v[134:135], v[134:135], v[28:29] op_sel_hi:[1,0]
    v_pk_mul_f32 v[136:137], v[136:137], v[28:29] op_sel_hi:[1,0]
    v_pk_mul_f32 v[138:139], v[138:139], v[28:29] op_sel_hi:[1,0]
    v_pk_mul_f32 v[140:141], v[140:141], v[28:29] op_sel_hi:[1,0]
    v_pk_mul_f32 v[142:143], v[142:143], v[28:29] op_sel_hi:[1,0]
    v_cvt_pk_bf16_f32 v128, v128, v129
    v_cvt_pk_bf16_f32 v129, v130, v131
    v_cvt_pk_bf16_f32 v132, v132, v133
    v_cvt_pk_bf16_f32 v133, v134, v135
    v_cvt_pk_bf16_f32 v136, v136, v137
    v_cvt_pk_bf16_f32 v137, v138, v139
    v_cvt_pk_bf16_f32 v140, v140, v141
    v_cvt_pk_bf16_f32 v141, v142, v143
    v_pk_mul_f32 v[144:145], v[144:145], v[28:29] op_sel_hi:[1,0]
    v_pk_mul_f32 v[146:147], v[146:147], v[28:29] op_sel_hi:[1,0]
    v_pk_mul_f32 v[148:149], v[148:149], v[28:29] op_sel_hi:[1,0]
    v_pk_mul_f32 v[150:151], v[150:151], v[28:29] op_sel_hi:[1,0]
    v_pk_mul_f32 v[152:153], v[152:153], v[28:29] op_sel_hi:[1,0]
    v_pk_mul_f32 v[154:155], v[154:155], v[28:29] op_sel_hi:[1,0]
    v_pk_mul_f32 v[156:157], v[156:157], v[28:29] op_sel_hi:[1,0]
    v_pk_mul_f32 v[158:159], v[158:159], v[28:29] op_sel_hi:[1,0]
    v_cvt_pk_bf16_f32 v144, v144, v145
    v_cvt_pk_bf16_f32 v145, v146, v147
    v_cvt_pk_bf16_f32 v148, v148, v149
    v_cvt_pk_bf16_f32 v149, v150, v151
    v_cvt_pk_bf16_f32 v152, v152, v153
    v_cvt_pk_bf16_f32 v153, v154, v155
    v_cvt_pk_bf16_f32 v156, v156, v157
    v_cvt_pk_bf16_f32 v157, v158, v159
    ds_write_b64 v24, v[128:129] offset:0
    ds_write_b64 v24, v[132:133] offset:32
    ds_write_b64 v24, v[136:137] offset:64
    ds_write_b64 v24, v[140:141] offset:96
    ds_write_b64 v24, v[144:145] offset:128
    ds_write_b64 v24, v[148:149] offset:160
    ds_write_b64 v24, v[152:153] offset:192
    ds_write_b64 v24, v[156:157] offset:224
    ds_read_b128 v[128:131], v25 offset:0
    ds_read_b128 v[132:135], v25 offset:1088
    ds_read_b128 v[136:139], v25 offset:2176
    ds_read_b128 v[140:143], v25 offset:3264
    s_add_u32 s101, s100, 12288
    s_waitcnt lgkmcnt(3)
    buffer_store_dwordx4 v[128:131], v26, s[92:95], s101 offen offset:0 sc1
    s_waitcnt lgkmcnt(2)
    buffer_store_dwordx4 v[132:135], v26, s[92:95], s101 offen offset:1024 sc1
    s_waitcnt lgkmcnt(1)
    buffer_store_dwordx4 v[136:139], v26, s[92:95], s101 offen offset:2048 sc1
    s_waitcnt lgkmcnt(0)
    buffer_store_dwordx4 v[140:143], v26, s[92:95], s101 offen offset:3072 sc1
L_slow:
    s_or_b64 s[96:97], s[38:39], s[90:91]
    s_cbranch_scc0 L_fin
    s_waitcnt vmcnt(0) lgkmcnt(0)
    s_lshl_b32 s41, s29, 2
    v_add_u32 v1, s41, v1
    v_add_u32 v2, s41, v2
    v_add_u32 v3, s41, v3
    v_add_u32 v4, s41, v4
    v_add_u32 v5, s41, v5
    v_add_u32 v6, s41, v6
    v_add_u32 v7, s41, v7
    v_add_u32 v8, s41, v8
    v_add_u32 v9, s41, v9
    v_add_u32 v10, s41, v10
    v_add_u32 v11, s41, v11
    v_add_u32 v12, s41, v12
    s_mov_b32 s29, s41
    s_mov_b32 s31, 0
L_sp_head:
    s_cmp_eq_u32 s31, 0
    s_cselect_b64 s[96:97], s[38:39], s[90:91]
    s_cmp_eq_u64 s[96:97], 0
    s_cbranch_scc1 L_sp_next
    s_lshl_b32 s42, s2, 1
    s_add_u32 s42, s42, s31
    s_mul_i32 s42, s42, 77824
    s_add_u32 s20, s4, s42
    s_addc_u32 s21, s5, 0
    s_and_b32 s21, s21, 0xffff
    s_mov_b32 s22, 77824
    s_add_u32 s24, s10, s42
    s_addc_u32 s25, s11, 0
    s_and_b32 s25, s25, 0xffff
    s_mov_b32 s26, 77824
    s_add_u32 m0, s29, 0
    s_add_u32 s42, s100, 0
    buffer_load_dwordx4 v13, s[20:23], s42 offen offset:0 nt lds
    buffer_load_dwordx4 v14, s[20:23], s42 offen offset:1024 nt lds
    buffer_load_dwordx4 v15, s[20:23], s42 offen offset:2048 nt lds
    buffer_load_dwordx4 v16, s[20:23], s42 offen offset:3072 nt lds
    s_waitcnt vmcnt(0)
    ds_read_b128 v[32:35], v1 offset:0
    ds_read_b128 v[36:39], v2 offset:0
    ds_read_b128 v[40:43], v3 offset:0
    ds_read_b128 v[44:47], v4 offset:0
    s_waitcnt lgkmcnt(3)
    v_lshlrev_b32 v244, 16, v32
    v_lshlrev_b32 v246, 16, v33
    v_lshlrev_b32 v248, 16, v34
    v_lshlrev_b32 v250, 16, v35
    v_and_b32 v245, s37, v32
    v_and_b32 v247, s37, v33
    v_and_b32 v249, s37, v34
    v_and_b32 v251, s37, v35
    v_pk_mul_f32 v[244:245], v[244:245], s[34:35]
    v_pk_mul_f32 v[246:247], v[246:247], s[34:35]
    v_pk_mul_f32 v[248:249], v[248:249], s[34:35]
    v_pk_mul_f32 v[250:251], v[250:251], s[34:35]
    v_cvt_pk_bf16_f32 v244, v244, v245
    v_cvt_pk_bf16_f32 v246, v246, v247
    v_cvt_pk_bf16_f32 v248, v248, v249
    v_cvt_pk_bf16_f32 v250, v250, v251
    v_accvgpr_write_b32 a0, v244
    v_accvgpr_write_b32 a1, v246
    v_accvgpr_write_b32 a2, v248
    v_accvgpr_write_b32 a3, v250
    s_waitcnt lgkmcnt(2)
    v_lshlrev_b32 v244, 16, v36
    v_lshlrev_b32 v246, 16, v37
    v_lshlrev_b32 v248, 16, v38
    v_lshlrev_b32 v250, 16, v39
    v_and_b32 v245, s37, v36
    v_and_b32 v247, s37, v37
    v_and_b32 v249, s37, v38
    v_and_b32 v251, s37, v39
    v_pk_mul_f32 v[244:245], v[244:245], s[34:35]
    v_pk_mul_f32 v[246:247], v[246:247], s[34:35]
    v_pk_mul_f32 v[248:249], v[248:249], s[34:35]
    v_pk_mul_f32 v[250:251], v[250:251], s[34:35]
    v_cvt_pk_bf16_f32 v244, v244, v245
    v_cvt_pk_bf16_f32 v246, v246, v247
    v_cvt_pk_bf16_f32 v248, v248, v249
    v_cvt_pk_bf16_f32 v250, v250, v251
    v_accvgpr_write_b32 a4, v244
    v_accvgpr_write_b32 a5, v246
    v_accvgpr_write_b32 a6, v248
    v_accvgpr_write_b32 a7, v250
    s_waitcnt lgkmcnt(1)
    v_lshlrev_b32 v244, 16, v40
    v_lshlrev_b32 v246, 16, v41
    v_lshlrev_b32 v248, 16, v42
    v_lshlrev_b32 v250, 16, v43
    v_and_b32 v245, s37, v40
    v_and_b32 v247, s37, v41
    v_and_b32 v249, s37, v42
    v_and_b32 v251, s37, v43
    v_pk_mul_f32 v[244:245], v[244:245], s[34:35]
    v_pk_mul_f32 v[246:247], v[246:247], s[34:35]
    v_pk_mul_f32 v[248:249], v[248:249], s[34:35]
    v_pk_mul_f32 v[250:251], v[250:251], s[34:35]
    v_cvt_pk_bf16_f32 v244, v244, v245
    v_cvt_pk_bf16_f32 v246, v246, v247
    v_cvt_pk_bf16_f32 v248, v248, v249
    v_cvt_pk_bf16_f32 v250, v250, v251
    v_accvgpr_write_b32 a8, v244
    v_accvgpr_write_b32 a9, v246
    v_accvgpr_write_b32 a10, v248
    v_accvgpr_write_b32 a11, v250
    s_waitcnt lgkmcnt(0)
    v_lshlrev_b32 v244, 16, v44
    v_lshlrev_b32 v246, 16, v45
    v_lshlrev_b32 v248, 16, v46
    v_lshlrev_b32 v250, 16, v47
    v_and_b32 v245, s37, v44
    v_and_b32 v247, s37, v45
    v_and_b32 v249, s37, v46
    v_and_b32 v251, s37, v47
    v_pk_mul_f32 v[244:245], v[244:245], s[34:35]
    v_pk_mul_f32 v[246:247], v[246:247], s[34:35]
    v_pk_mul_f32 v[248:249], v[248:249], s[34:35]
    v_pk_mul_f32 v[250:251], v[250:251], s[34:35]
    v_cvt_pk_bf16_f32 v244, v244, v245
    v_cvt_pk_bf16_f32 v246, v246, v247
    v_cvt_pk_bf16_f32 v248, v248, v249
    v_cvt_pk_bf16_f32 v250, v250, v251
    v_accvgpr_write_b32 a12, v244
    v_accvgpr_write_b32 a13, v246
    v_accvgpr_write_b32 a14, v248
    v_accvgpr_write_b32 a15, v250
    s_add_u32 m0, s29, 0
    s_add_u32 s42, s100, 4096
    buffer_load_dwordx4 v13, s[20:23], s42 offen offset:0 nt lds
    buffer_load_dwordx4 v14, s[20:23], s42 offen offset:1024 nt lds
    buffer_load_dwordx4 v15, s[20:23], s42 offen offset:2048 nt lds
    buffer_load_dwordx4 v16, s[20:23], s42 offen offset:3072 nt lds
    s_waitcnt vmcnt(0)
    ds_read_b128 v[32:35], v1 offset:0
    ds_read_b128 v[36:39], v2 offset:0
    ds_read_b128 v[40:43], v3 offset:0
    ds_read_b128 v[44:47], v4 offset:0
    s_waitcnt lgkmcnt(3)
    v_lshlrev_b32 v244, 16, v32
    v_lshlrev_b32 v246, 16, v33
    v_lshlrev_b32 v248, 16, v34
    v_lshlrev_b32 v250, 16, v35
    v_and_b32 v245, s37, v32
    v_and_b32 v247, s37, v33
    v_and_b32 v249, s37, v34
    v_and_b32 v251, s37, v35
    v_pk_mul_f32 v[244:245], v[244:245], s[34:35]
    v_pk_mul_f32 v[246:247], v[246:247], s[34:35]
    v_pk_mul_f32 v[248:249], v[248:249], s[34:35]
    v_pk_mul_f32 v[250:251], v[250:251], s[34:35]
    v_cvt_pk_bf16_f32 v244, v244, v245
    v_cvt_pk_bf16_f32 v246, v246, v247
    v_cvt_pk_bf16_f32 v248, v248, v249
    v_cvt_pk_bf16_f32 v250, v250, v251
    v_accvgpr_write_b32 a16, v244
    v_accvgpr_write_b32 a17, v246
    v_accvgpr_write_b32 a18, v248
    v_accvgpr_write_b32 a19, v250
    s_waitcnt lgkmcnt(2)
    v_lshlrev_b32 v244, 16, v36
    v_lshlrev_b32 v246, 16, v37
    v_lshlrev_b32 v248, 16, v38
    v_lshlrev_b32 v250, 16, v39
    v_and_b32 v245, s37, v36
    v_and_b32 v247, s37, v37
    v_and_b32 v249, s37, v38
    v_and_b32 v251, s37, v39
    v_pk_mul_f32 v[244:245], v[244:245], s[34:35]
    v_pk_mul_f32 v[246:247], v[246:247], s[34:35]
    v_pk_mul_f32 v[248:249], v[248:249], s[34:35]
    v_pk_mul_f32 v[250:251], v[250:251], s[34:35]
    v_cvt_pk_bf16_f32 v244, v244, v245
    v_cvt_pk_bf16_f32 v246, v246, v247
    v_cvt_pk_bf16_f32 v248, v248, v249
    v_cvt_pk_bf16_f32 v250, v250, v251
    v_accvgpr_write_b32 a20, v244
    v_accvgpr_write_b32 a21, v246
    v_accvgpr_write_b32 a22, v248
    v_accvgpr_write_b32 a23, v250
    s_waitcnt lgkmcnt(1)
    v_lshlrev_b32 v244, 16, v40
    v_lshlrev_b32 v246, 16, v41
    v_lshlrev_b32 v248, 16, v42
    v_lshlrev_b32 v250, 16, v43
    v_and_b32 v245, s37, v40
    v_and_b32 v247, s37, v41
    v_and_b32 v249, s37, v42
    v_and_b32 v251, s37, v43
    v_pk_mul_f32 v[244:245], v[244:245], s[34:35]
    v_pk_mul_f32 v[246:247], v[246:247], s[34:35]
    v_pk_mul_f32 v[248:249], v[248:249], s[34:35]
    v_pk_mul_f32 v[250:251], v[250:251], s[34:35]
    v_cvt_pk_bf16_f32 v244, v244, v245
    v_cvt_pk_bf16_f32 v246, v246, v247
    v_cvt_pk_bf16_f32 v248, v248, v249
    v_cvt_pk_bf16_f32 v250, v250, v251
    v_accvgpr_write_b32 a24, v244
    v_accvgpr_write_b32 a25, v246
    v_accvgpr_write_b32 a26, v248
    v_accvgpr_write_b32 a27, v250
    s_waitcnt lgkmcnt(0)
    v_lshlrev_b32 v244, 16, v44
    v_lshlrev_b32 v246, 16, v45
    v_lshlrev_b32 v248, 16, v46
    v_lshlrev_b32 v250, 16, v47
    v_and_b32 v245, s37, v44
    v_and_b32 v247, s37, v45
    v_and_b32 v249, s37, v46
    v_and_b32 v251, s37, v47
    v_pk_mul_f32 v[244:245], v[244:245], s[34:35]
    v_pk_mul_f32 v[246:247], v[246:247], s[34:35]
    v_pk_mul_f32 v[248:249], v[248:249], s[34:35]
    v_pk_mul_f32 v[250:251], v[250:251], s[34:35]
    v_cvt_pk_bf16_f32 v244, v244, v245
    v_cvt_pk_bf16_f32 v246, v246, v247
    v_cvt_pk_bf16_f32 v248, v248, v249
    v_cvt_pk_bf16_f32 v250, v250, v251
    v_accvgpr_write_b32 a28, v244
    v_accvgpr_write_b32 a29, v246
    v_accvgpr_write_b32 a30, v248
    v_accvgpr_write_b32 a31, v250
    s_add_u32 m0, s29, 0
    s_add_u32 s42, s100, 8192
    buffer_load_dwordx4 v13, s[20:23], s42 offen offset:0 nt lds
    buffer_load_dwordx4 v14, s[20:23], s42 offen offset:1024 nt lds
    buffer_load_dwordx4 v15, s[20:23], s42 offen offset:2048 nt lds
    buffer_load_dwordx4 v16, s[20:23], s42 offen offset:3072 nt lds
    s_waitcnt vmcnt(0)
    ds_read_b128 v[32:35], v1 offset:0
    ds_read_b128 v[36:39], v2 offset:0
    ds_read_b128 v[40:43], v3 offset:0
    ds_read_b128 v[44:47], v4 offset:0
    s_waitcnt lgkmcnt(3)
    v_lshlrev_b32 v244, 16, v32
    v_lshlrev_b32 v246, 16, v33
    v_lshlrev_b32 v248, 16, v34
    v_lshlrev_b32 v250, 16, v35
    v_and_b32 v245, s37, v32
    v_and_b32 v247, s37, v33
    v_and_b32 v249, s37, v34
    v_and_b32 v251, s37, v35
    v_pk_mul_f32 v[244:245], v[244:245], s[34:35]
    v_pk_mul_f32 v[246:247], v[246:247], s[34:35]
    v_pk_mul_f32 v[248:249], v[248:249], s[34:35]
    v_pk_mul_f32 v[250:251], v[250:251], s[34:35]
    v_cvt_pk_bf16_f32 v244, v244, v245
    v_cvt_pk_bf16_f32 v246, v246, v247
    v_cvt_pk_bf16_f32 v248, v248, v249
    v_cvt_pk_bf16_f32 v250, v250, v251
    v_accvgpr_write_b32 a32, v244
    v_accvgpr_write_b32 a33, v246
    v_accvgpr_write_b32 a34, v248
    v_accvgpr_write_b32 a35, v250
    s_waitcnt lgkmcnt(2)
    v_lshlrev_b32 v244, 16, v36
    v_lshlrev_b32 v246, 16, v37
    v_lshlrev_b32 v248, 16, v38
    v_lshlrev_b32 v250, 16, v39
    v_and_b32 v245, s37, v36
    v_and_b32 v247, s37, v37
    v_and_b32 v249, s37, v38
    v_and_b32 v251, s37, v39
    v_pk_mul_f32 v[244:245], v[244:245], s[34:35]
    v_pk_mul_f32 v[246:247], v[246:247], s[34:35]
    v_pk_mul_f32 v[248:249], v[248:249], s[34:35]
    v_pk_mul_f32 v[250:251], v[250:251], s[34:35]
    v_cvt_pk_bf16_f32 v244, v244, v245
    v_cvt_pk_bf16_f32 v246, v246, v247
    v_cvt_pk_bf16_f32 v248, v248, v249
    v_cvt_pk_bf16_f32 v250, v250, v251
    v_accvgpr_write_b32 a36, v244
    v_accvgpr_write_b32 a37, v246
    v_accvgpr_write_b32 a38, v248
    v_accvgpr_write_b32 a39, v250
    s_waitcnt lgkmcnt(1)
    v_lshlrev_b32 v244, 16, v40
    v_lshlrev_b32 v246, 16, v41
    v_lshlrev_b32 v248, 16, v42
    v_lshlrev_b32 v250, 16, v43
    v_and_b32 v245, s37, v40
    v_and_b32 v247, s37, v41
    v_and_b32 v249, s37, v42
    v_and_b32 v251, s37, v43
    v_pk_mul_f32 v[244:245], v[244:245], s[34:35]
    v_pk_mul_f32 v[246:247], v[246:247], s[34:35]
    v_pk_mul_f32 v[248:249], v[248:249], s[34:35]
    v_pk_mul_f32 v[250:251], v[250:251], s[34:35]
    v_cvt_pk_bf16_f32 v244, v244, v245
    v_cvt_pk_bf16_f32 v246, v246, v247
    v_cvt_pk_bf16_f32 v248, v248, v249
    v_cvt_pk_bf16_f32 v250, v250, v251
    v_accvgpr_write_b32 a40, v244
    v_accvgpr_write_b32 a41, v246
    v_accvgpr_write_b32 a42, v248
    v_accvgpr_write_b32 a43, v250
    s_waitcnt lgkmcnt(0)
    v_lshlrev_b32 v244, 16, v44
    v_lshlrev_b32 v246, 16, v45
    v_lshlrev_b32 v248, 16, v46
    v_lshlrev_b32 v250, 16, v47
    v_and_b32 v245, s37, v44
    v_and_b32 v247, s37, v45
    v_and_b32 v249, s37, v46
    v_and_b32 v251, s37, v47
    v_pk_mul_f32 v[244:245], v[244:245], s[34:35]
    v_pk_mul_f32 v[246:247], v[246:247], s[34:35]
    v_pk_mul_f32 v[248:249], v[248:249], s[34:35]
    v_pk_mul_f32 v[250:251], v[250:251], s[34:35]
    v_cvt_pk_bf16_f32 v244, v244, v245
    v_cvt_pk_bf16_f32 v246, v246, v247
    v_cvt_pk_bf16_f32 v248, v248, v249
    v_cvt_pk_bf16_f32 v250, v250, v251
    v_accvgpr_write_b32 a44, v244
    v_accvgpr_write_b32 a45, v246
    v_accvgpr_write_b32 a46, v248
    v_accvgpr_write_b32 a47, v250
    s_add_u32 m0, s29, 0
    s_add_u32 s42, s100, 12288
    buffer_load_dwordx4 v13, s[20:23], s42 offen offset:0 nt lds
    buffer_load_dwordx4 v14, s[20:23], s42 offen offset:1024 nt lds
    buffer_load_dwordx4 v15, s[20:23], s42 offen offset:2048 nt lds
    buffer_load_dwordx4 v16, s[20:23], s42 offen offset:3072 nt lds
    s_waitcnt vmcnt(0)
    ds_read_b128 v[32:35], v1 offset:0
    ds_read_b128 v[36:39], v2 offset:0
    ds_read_b128 v[40:43], v3 offset:0
    ds_read_b128 v[44:47], v4 offset:0
    s_waitcnt lgkmcnt(3)
    v_lshlrev_b32 v244, 16, v32
    v_lshlrev_b32 v246, 16, v33
    v_lshlrev_b32 v248, 16, v34
    v_lshlrev_b32 v250, 16, v35
    v_and_b32 v245, s37, v32
    v_and_b32 v247, s37, v33
    v_and_b32 v249, s37, v34
    v_and_b32 v251, s37, v35
    v_pk_mul_f32 v[244:245], v[244:245], s[34:35]
    v_pk_mul_f32 v[246:247], v[246:247], s[34:35]
    v_pk_mul_f32 v[248:249], v[248:249], s[34:35]
    v_pk_mul_f32 v[250:251], v[250:251], s[34:35]
    v_cvt_pk_bf16_f32 v244, v244, v245
    v_cvt_pk_bf16_f32 v246, v246, v247
    v_cvt_pk_bf16_f32 v248, v248, v249
    v_cvt_pk_bf16_f32 v250, v250, v251
    v_accvgpr_write_b32 a48, v244
    v_accvgpr_write_b32 a49, v246
    v_accvgpr_write_b32 a50, v248
    v_accvgpr_write_b32 a51, v250
    s_waitcnt lgkmcnt(2)
    v_lshlrev_b32 v244, 16, v36
    v_lshlrev_b32 v246, 16, v37
    v_lshlrev_b32 v248, 16, v38
    v_lshlrev_b32 v250, 16, v39
    v_and_b32 v245, s37, v36
    v_and_b32 v247, s37, v37
    v_and_b32 v249, s37, v38
    v_and_b32 v251, s37, v39
    v_pk_mul_f32 v[244:245], v[244:245], s[34:35]
    v_pk_mul_f32 v[246:247], v[246:247], s[34:35]
    v_pk_mul_f32 v[248:249], v[248:249], s[34:35]
    v_pk_mul_f32 v[250:251], v[250:251], s[34:35]
    v_cvt_pk_bf16_f32 v244, v244, v245
    v_cvt_pk_bf16_f32 v246, v246, v247
    v_cvt_pk_bf16_f32 v248, v248, v249
    v_cvt_pk_bf16_f32 v250, v250, v251
    v_accvgpr_write_b32 a52, v244
    v_accvgpr_write_b32 a53, v246
    v_accvgpr_write_b32 a54, v248
    v_accvgpr_write_b32 a55, v250
    s_waitcnt lgkmcnt(1)
    v_lshlrev_b32 v244, 16, v40
    v_lshlrev_b32 v246, 16, v41
    v_lshlrev_b32 v248, 16, v42
    v_lshlrev_b32 v250, 16, v43
    v_and_b32 v245, s37, v40
    v_and_b32 v247, s37, v41
    v_and_b32 v249, s37, v42
    v_and_b32 v251, s37, v43
    v_pk_mul_f32 v[244:245], v[244:245], s[34:35]
    v_pk_mul_f32 v[246:247], v[246:247], s[34:35]
    v_pk_mul_f32 v[248:249], v[248:249], s[34:35]
    v_pk_mul_f32 v[250:251], v[250:251], s[34:35]
    v_cvt_pk_bf16_f32 v244, v244, v245
    v_cvt_pk_bf16_f32 v246, v246, v247
    v_cvt_pk_bf16_f32 v248, v248, v249
    v_cvt_pk_bf16_f32 v250, v250, v251
    v_accvgpr_write_b32 a56, v244
    v_accvgpr_write_b32 a57, v246
    v_accvgpr_write_b32 a58, v248
    v_accvgpr_write_b32 a59, v250
    s_waitcnt lgkmcnt(0)
    v_lshlrev_b32 v244, 16, v44
    v_lshlrev_b32 v246, 16, v45
    v_lshlrev_b32 v248, 16, v46
    v_lshlrev_b32 v250, 16, v47
    v_and_b32 v245, s37, v44
    v_and_b32 v247, s37, v45
    v_and_b32 v249, s37, v46
    v_and_b32 v251, s37, v47
    v_pk_mul_f32 v[244:245], v[244:245], s[34:35]
    v_pk_mul_f32 v[246:247], v[246:247], s[34:35]
    v_pk_mul_f32 v[248:249], v[248:249], s[34:35]
    v_pk_mul_f32 v[250:251], v[250:251], s[34:35]
    v_cvt_pk_bf16_f32 v244, v244, v245
    v_cvt_pk_bf16_f32 v246, v246, v247
    v_cvt_pk_bf16_f32 v248, v248, v249
    v_cvt_pk_bf16_f32 v250, v250, v251
    v_accvgpr_write_b32 a60, v244
    v_accvgpr_write_b32 a61, v246
    v_accvgpr_write_b32 a62, v248
    v_accvgpr_write_b32 a63, v250
    s_add_u32 m0, s29, 0
    s_add_u32 s42, s100, 16384
    buffer_load_dwordx4 v13, s[20:23], s42 offen offset:0 nt lds
    buffer_load_dwordx4 v14, s[20:23], s42 offen offset:1024 nt lds
    buffer_load_dwordx4 v15, s[20:23], s42 offen offset:2048 nt lds
    buffer_load_dwordx4 v16, s[20:23], s42 offen offset:3072 nt lds
    s_waitcnt vmcnt(0)
    ds_read_b128 v[32:35], v1 offset:0
    ds_read_b128 v[36:39], v2 offset:0
    ds_read_b128 v[40:43], v3 offset:0
    ds_read_b128 v[44:47], v4 offset:0
    s_waitcnt lgkmcnt(3)
    v_lshlrev_b32 v244, 16, v32
    v_lshlrev_b32 v246, 16, v33
    v_lshlrev_b32 v248, 16, v34
    v_lshlrev_b32 v250, 16, v35
    v_and_b32 v245, s37, v32
    v_and_b32 v247, s37, v33
    v_and_b32 v249, s37, v34
    v_and_b32 v251, s37, v35
    v_pk_mul_f32 v[244:245], v[244:245], s[34:35]
    v_pk_mul_f32 v[246:247], v[246:247], s[34:35]
    v_pk_mul_f32 v[248:249], v[248:249], s[34:35]
    v_pk_mul_f32 v[250:251], v[250:251], s[34:35]
    v_cvt_pk_bf16_f32 v244, v244, v245
    v_cvt_pk_bf16_f32 v246, v246, v247
    v_cvt_pk_bf16_f32 v248, v248, v249
    v_cvt_pk_bf16_f32 v250, v250, v251
    v_accvgpr_write_b32 a64, v244
    v_accvgpr_write_b32 a65, v246
    v_accvgpr_write_b32 a66, v248
    v_accvgpr_write_b32 a67, v250
    s_waitcnt lgkmcnt(2)
    v_lshlrev_b32 v244, 16, v36
    v_lshlrev_b32 v246, 16, v37
    v_lshlrev_b32 v248, 16, v38
    v_lshlrev_b32 v250, 16, v39
    v_and_b32 v245, s37, v36
    v_and_b32 v247, s37, v37
    v_and_b32 v249, s37, v38
    v_and_b32 v251, s37, v39
    v_pk_mul_f32 v[244:245], v[244:245], s[34:35]
    v_pk_mul_f32 v[246:247], v[246:247], s[34:35]
    v_pk_mul_f32 v[248:249], v[248:249], s[34:35]
    v_pk_mul_f32 v[250:251], v[250:251], s[34:35]
    v_cvt_pk_bf16_f32 v244, v244, v245
    v_cvt_pk_bf16_f32 v246, v246, v247
    v_cvt_pk_bf16_f32 v248, v248, v249
    v_cvt_pk_bf16_f32 v250, v250, v251
    v_accvgpr_write_b32 a68, v244
    v_accvgpr_write_b32 a69, v246
    v_accvgpr_write_b32 a70, v248
    v_accvgpr_write_b32 a71, v250
    s_waitcnt lgkmcnt(1)
    v_lshlrev_b32 v244, 16, v40
    v_lshlrev_b32 v246, 16, v41
    v_lshlrev_b32 v248, 16, v42
    v_lshlrev_b32 v250, 16, v43
    v_and_b32 v245, s37, v40
    v_and_b32 v247, s37, v41
    v_and_b32 v249, s37, v42
    v_and_b32 v251, s37, v43
    v_pk_mul_f32 v[244:245], v[244:245], s[34:35]
    v_pk_mul_f32 v[246:247], v[246:247], s[34:35]
    v_pk_mul_f32 v[248:249], v[248:249], s[34:35]
    v_pk_mul_f32 v[250:251], v[250:251], s[34:35]
    v_cvt_pk_bf16_f32 v244, v244, v245
    v_cvt_pk_bf16_f32 v246, v246, v247
    v_cvt_pk_bf16_f32 v248, v248, v249
    v_cvt_pk_bf16_f32 v250, v250, v251
    v_accvgpr_write_b32 a72, v244
    v_accvgpr_write_b32 a73, v246
    v_accvgpr_write_b32 a74, v248
    v_accvgpr_write_b32 a75, v250
    s_waitcnt lgkmcnt(0)
    v_lshlrev_b32 v244, 16, v44
    v_lshlrev_b32 v246, 16, v45
    v_lshlrev_b32 v248, 16, v46
    v_lshlrev_b32 v250, 16, v47
    v_and_b32 v245, s37, v44
    v_and_b32 v247, s37, v45
    v_and_b32 v249, s37, v46
    v_and_b32 v251, s37, v47
    v_pk_mul_f32 v[244:245], v[244:245], s[34:35]
    v_pk_mul_f32 v[246:247], v[246:247], s[34:35]
    v_pk_mul_f32 v[248:249], v[248:249], s[34:35]
    v_pk_mul_f32 v[250:251], v[250:251], s[34:35]
    v_cvt_pk_bf16_f32 v244, v244, v245
    v_cvt_pk_bf16_f32 v246, v246, v247
    v_cvt_pk_bf16_f32 v248, v248, v249
    v_cvt_pk_bf16_f32 v250, v250, v251
    v_accvgpr_write_b32 a76, v244
    v_accvgpr_write_b32 a77, v246
    v_accvgpr_write_b32 a78, v248
    v_accvgpr_write_b32 a79, v250
    v_mov_b32 v19, 0xff800000
    v_mov_b32 v192, 0
    v_mov_b32 v193, 0
    v_mov_b32 v194, 0
    v_mov_b32 v195, 0
    v_mov_b32 v20, 0xff800000
    v_mov_b32 v196, 0
    v_mov_b32 v197, 0
    v_mov_b32 v198, 0
    v_mov_b32 v199, 0
    v_mov_b32 v21, 0xff800000
    v_mov_b32 v200, 0
    v_mov_b32 v201, 0
    v_mov_b32 v202, 0
    v_mov_b32 v203, 0
    v_mov_b32 v22, 0xff800000
    v_mov_b32 v204, 0
    v_mov_b32 v205, 0
    v_mov_b32 v206, 0
    v_mov_b32 v207, 0
    v_mov_b32 v23, 0xff800000
    v_mov_b32 v208, 0
    v_mov_b32 v209, 0
    v_mov_b32 v210, 0
    v_mov_b32 v211, 0
    s_lshl_b32 s28, s31, 18
    s_mov_b32 s30, 16
L_sp1:
    s_add_u32 m0, s29, 0
    s_add_u32 s42, s28, 0
    buffer_load_dwordx4 v13, s[12:15], s42 offen offset:0 lds
    buffer_load_dwordx4 v14, s[12:15], s42 offen offset:1024 lds
    buffer_load_dwordx4 v15, s[12:15], s42 offen offset:2048 lds
    buffer_load_dwordx4 v16, s[12:15], s42 offen offset:3072 lds
    s_add_u32 m0, s29, 4096
    s_add_u32 s42, s28, 4096
    buffer_load_dwordx4 v13, s[12:15], s42 offen offset:0 lds
    buffer_load_dwordx4 v14, s[12:15], s42 offen offset:1024 lds
    buffer_load_dwordx4 v15, s[12:15], s42 offen offset:2048 lds
    buffer_load_dwordx4 v16, s[12:15], s42 offen offset:3072 lds
    s_add_u32 m0, s29, 8192
    s_add_u32 s42, s28, 8192
    buffer_load_dwordx4 v13, s[12:15], s42 offen offset:0 lds
    buffer_load_dwordx4 v14, s[12:15], s42 offen offset:1024 lds
    buffer_load_dwordx4 v15, s[12:15], s42 offen offset:2048 lds
    buffer_load_dwordx4 v16, s[12:15], s42 offen offset:3072 lds
    s_add_u32 m0, s29, 12288
    s_add_u32 s42, s28, 12288
    buffer_load_dwordx4 v13, s[12:15], s42 offen offset:0 lds
    buffer_load_dwordx4 v14, s[12:15], s42 offen offset:1024 lds
    buffer_load_dwordx4 v15, s[12:15], s42 offen offset:2048 lds
    buffer_load_dwordx4 v16, s[12:15], s42 offen offset:3072 lds
    s_waitcnt vmcnt(0)
    ds_read_b128 a[80:83], v1 offset:0
    ds_read_b128 a[84:87], v2 offset:0
    ds_read_b128 a[88:91], v3 offset:0
    ds_read_b128 a[92:95], v4 offset:0
    ds_read_b128 a[96:99], v1 offset:4096
    ds_read_b128 a[100:103], v2 offset:4096
    ds_read_b128 a[104:107], v3 offset:4096
    ds_read_b128 a[108:111], v4 offset:4096
    ds_read_b128 a[112:115], v1 offset:8192
    ds_read_b128 a[116:119], v2 offset:8192
    ds_read_b128 a[120:123], v3 offset:8192
    ds_read_b128 a[124:127], v4 offset:8192
    ds_read_b128 a[128:131], v1 offset:12288
    ds_read_b128 a[132:135], v2 offset:12288
    ds_read_b128 a[136:139], v3 offset:12288
    ds_read_b128 a[140:143], v4 offset:12288
    s_waitcnt lgkmcnt(15)
    v_mfma_f32_16x16x32_bf16 v[212:215], a[80:83], a[0:3], v[192:195]
    s_waitcnt lgkmcnt(14)
    v_mfma_f32_16x16x32_bf16 v[212:215], a[84:87], a[4:7], v[212:215]
    s_waitcnt lgkmcnt(13)
    v_mfma_f32_16x16x32_bf16 v[212:215], a[88:91], a[8:11], v[212:215]
    s_waitcnt lgkmcnt(12)
    v_mfma_f32_16x16x32_bf16 v[212:215], a[92:95], a[12:15], v[212:215]
    s_waitcnt lgkmcnt(11)
    v_mfma_f32_16x16x32_bf16 v[216:219], a[96:99], a[0:3], v[192:195]
    s_waitcnt lgkmcnt(10)
    v_mfma_f32_16x16x32_bf16 v[216:219], a[100:103], a[4:7], v[216:219]
    s_waitcnt lgkmcnt(9)
    v_mfma_f32_16x16x32_bf16 v[216:219], a[104:107], a[8:11], v[216:219]
    s_waitcnt lgkmcnt(8)
    v_mfma_f32_16x16x32_bf16 v[216:219], a[108:111], a[12:15], v[216:219]
    s_waitcnt lgkmcnt(0)
    v_mfma_f32_16x16x32_bf16 v[220:223], a[112:115], a[0:3], v[192:195]
    v_mfma_f32_16x16x32_bf16 v[220:223], a[116:119], a[4:7], v[220:223]
    v_mfma_f32_16x16x32_bf16 v[220:223], a[120:123], a[8:11], v[220:223]
    v_mfma_f32_16x16x32_bf16 v[220:223], a[124:127], a[12:15], v[220:223]
    v_mfma_f32_16x16x32_bf16 v[224:227], a[128:131], a[0:3], v[192:195]
    v_mfma_f32_16x16x32_bf16 v[224:227], a[132:135], a[4:7], v[224:227]
    v_mfma_f32_16x16x32_bf16 v[224:227], a[136:139], a[8:11], v[224:227]
    v_mfma_f32_16x16x32_bf16 v[224:227], a[140:143], a[12:15], v[224:227]
    v_max3_f32 v19, v19, v212, v213
    v_max3_f32 v19, v19, v214, v215
    v_max3_f32 v19, v19, v216, v217
    v_max3_f32 v19, v19, v218, v219
    v_max3_f32 v19, v19, v220, v221
    v_max3_f32 v19, v19, v222, v223
    s_nop 1
    v_max3_f32 v19, v19, v224, v225
    v_max3_f32 v19, v19, v226, v227
    v_mfma_f32_16x16x32_bf16 v[212:215], a[80:83], a[16:19], v[196:199]
    v_mfma_f32_16x16x32_bf16 v[212:215], a[84:87], a[20:23], v[212:215]
    v_mfma_f32_16x16x32_bf16 v[212:215], a[88:91], a[24:27], v[212:215]
    v_mfma_f32_16x16x32_bf16 v[212:215], a[92:95], a[28:31], v[212:215]
    v_mfma_f32_16x16x32_bf16 v[216:219], a[96:99], a[16:19], v[196:199]
    v_mfma_f32_16x16x32_bf16 v[216:219], a[100:103], a[20:23], v[216:219]
    v_mfma_f32_16x16x32_bf16 v[216:219], a[104:107], a[24:27], v[216:219]
    v_mfma_f32_16x16x32_bf16 v[216:219], a[108:111], a[28:31], v[216:219]
    v_mfma_f32_16x16x32_bf16 v[220:223], a[112:115], a[16:19], v[196:199]
    v_mfma_f32_16x16x32_bf16 v[220:223], a[116:119], a[20:23], v[220:223]
    v_mfma_f32_16x16x32_bf16 v[220:223], a[120:123], a[24:27], v[220:223]
    v_mfma_f32_16x16x32_bf16 v[220:223], a[124:127], a[28:31], v[220:223]
    v_mfma_f32_16x16x32_bf16 v[224:227], a[128:131], a[16:19], v[196:199]
    v_mfma_f32_16x16x32_bf16 v[224:227], a[132:135], a[20:23], v[224:227]
    v_mfma_f32_16x16x32_bf16 v[224:227], a[136:139], a[24:27], v[224:227]
    v_mfma_f32_16x16x32_bf16 v[224:227], a[140:143], a[28:31], v[224:227]
    v_max3_f32 v20, v20, v212, v213
    v_max3_f32 v20, v20, v214, v215
    v_max3_f32 v20, v20, v216, v217
    v_max3_f32 v20, v20, v218, v219
    v_max3_f32 v20, v20, v220, v221
    v_max3_f32 v20, v20, v222, v223
    s_nop 1
    v_max3_f32 v20, v20, v224, v225
    v_max3_f32 v20, v20, v226, v227
    v_mfma_f32_16x16x32_bf16 v[212:215], a[80:83], a[32:35], v[200:203]
    v_mfma_f32_16x16x32_bf16 v[212:215], a[84:87], a[36:39], v[212:215]
    v_mfma_f32_16x16x32_bf16 v[212:215], a[88:91], a[40:43], v[212:215]
    v_mfma_f32_16x16x32_bf16 v[212:215], a[92:95], a[44:47], v[212:215]
    v_mfma_f32_16x16x32_bf16 v[216:219], a[96:99], a[32:35], v[200:203]
    v_mfma_f32_16x16x32_bf16 v[216:219], a[100:103], a[36:39], v[216:219]
    v_mfma_f32_16x16x32_bf16 v[216:219], a[104:107], a[40:43], v[216:219]
    v_mfma_f32_16x16x32_bf16 v[216:219], a[108:111], a[44:47], v[216:219]
    v_mfma_f32_16x16x32_bf16 v[220:223], a[112:115], a[32:35], v[200:203]
    v_mfma_f32_16x16x32_bf16 v[220:223], a[116:119], a[36:39], v[220:223]
    v_mfma_f32_16x16x32_bf16 v[220:223], a[120:123], a[40:43], v[220:223]
    v_mfma_f32_16x16x32_bf16 v[220:223], a[124:127], a[44:47], v[220:223]
    v_mfma_f32_16x16x32_bf16 v[224:227], a[128:131], a[32:35], v[200:203]
    v_mfma_f32_16x16x32_bf16 v[224:227], a[132:135], a[36:39], v[224:227]
    v_mfma_f32_16x16x32_bf16 v[224:227], a[136:139], a[40:43], v[224:227]
    v_mfma_f32_16x16x32_bf16 v[224:227], a[140:143], a[44:47], v[224:227]
    v_max3_f32 v21, v21, v212, v213
    v_max3_f32 v21, v21, v214, v215
    v_max3_f32 v21, v21, v216, v217
    v_max3_f32 v21, v21, v218, v219
    v_max3_f32 v21, v21, v220, v221
    v_max3_f32 v21, v21, v222, v223
    s_nop 1
    v_max3_f32 v21, v21, v224, v225
    v_max3_f32 v21, v21, v226, v227
    v_mfma_f32_16x16x32_bf16 v[212:215], a[80:83], a[48:51], v[204:207]
    v_mfma_f32_16x16x32_bf16 v[212:215], a[84:87], a[52:55], v[212:215]
    v_mfma_f32_16x16x32_bf16 v[212:215], a[88:91], a[56:59], v[212:215]
    v_mfma_f32_16x16x32_bf16 v[212:215], a[92:95], a[60:63], v[212:215]
    v_mfma_f32_16x16x32_bf16 v[216:219], a[96:99], a[48:51], v[204:207]
    v_mfma_f32_16x16x32_bf16 v[216:219], a[100:103], a[52:55], v[216:219]
    v_mfma_f32_16x16x32_bf16 v[216:219], a[104:107], a[56:59], v[216:219]
    v_mfma_f32_16x16x32_bf16 v[216:219], a[108:111], a[60:63], v[216:219]
    v_mfma_f32_16x16x32_bf16 v[220:223], a[112:115], a[48:51], v[204:207]
    v_mfma_f32_16x16x32_bf16 v[220:223], a[116:119], a[52:55], v[220:223]
    v_mfma_f32_16x16x32_bf16 v[220:223], a[120:123], a[56:59], v[220:223]
    v_mfma_f32_16x16x32_bf16 v[220:223], a[124:127], a[60:63], v[220:223]
    v_mfma_f32_16x16x32_bf16 v[224:227], a[128:131], a[48:51], v[204:207]
    v_mfma_f32_16x16x32_bf16 v[224:227], a[132:135], a[52:55], v[224:227]
    v_mfma_f32_16x16x32_bf16 v[224:227], a[136:139], a[56:59], v[224:227]
    v_mfma_f32_16x16x32_bf16 v[224:227], a[140:143], a[60:63], v[224:227]
    v_max3_f32 v22, v22, v212, v213
    v_max3_f32 v22, v22, v214, v215
    v_max3_f32 v22, v22, v216, v217
    v_max3_f32 v22, v22, v218, v219
    v_max3_f32 v22, v22, v220, v221
    v_max3_f32 v22, v22, v222, v223
    s_nop 1
    v_max3_f32 v22, v22, v224, v225
    v_max3_f32 v22, v22, v226, v227
    v_mfma_f32_16x16x32_bf16 v[212:215], a[80:83], a[64:67], v[208:211]
    v_mfma_f32_16x16x32_bf16 v[212:215], a[84:87], a[68:71], v[212:215]
    v_mfma_f32_16x16x32_bf16 v[212:215], a[88:91], a[72:75], v[212:215]
    v_mfma_f32_16x16x32_bf16 v[212:215], a[92:95], a[76:79], v[212:215]
    v_mfma_f32_16x16x32_bf16 v[216:219], a[96:99], a[64:67], v[208:211]
    v_mfma_f32_16x16x32_bf16 v[216:219], a[100:103], a[68:71], v[216:219]
    v_mfma_f32_16x16x32_bf16 v[216:219], a[104:107], a[72:75], v[216:219]
    v_mfma_f32_16x16x32_bf16 v[216:219], a[108:111], a[76:79], v[216:219]
    v_mfma_f32_16x16x32_bf16 v[220:223], a[112:115], a[64:67], v[208:211]
    v_mfma_f32_16x16x32_bf16 v[220:223], a[116:119], a[68:71], v[220:223]
    v_mfma_f32_16x16x32_bf16 v[220:223], a[120:123], a[72:75], v[220:223]
    v_mfma_f32_16x16x32_bf16 v[220:223], a[124:127], a[76:79], v[220:223]
    v_mfma_f32_16x16x32_bf16 v[224:227], a[128:131], a[64:67], v[208:211]
    v_mfma_f32_16x16x32_bf16 v[224:227], a[132:135], a[68:71], v[224:227]
    v_mfma_f32_16x16x32_bf16 v[224:227], a[136:139], a[72:75], v[224:227]
    v_mfma_f32_16x16x32_bf16 v[224:227], a[140:143], a[76:79], v[224:227]
    v_max3_f32 v23, v23, v212, v213
    v_max3_f32 v23, v23, v214, v215
    v_max3_f32 v23, v23, v216, v217
    v_max3_f32 v23, v23, v218, v219
    v_max3_f32 v23, v23, v220, v221
    v_max3_f32 v23, v23, v222, v223
    s_nop 1
    v_max3_f32 v23, v23, v224, v225
    v_max3_f32 v23, v23, v226, v227
    s_add_u32 s28, s28, 16384
    s_sub_u32 s30, s30, 1
    s_cmp_lg_u32 s30, 0
    s_cbranch_scc1 L_sp1
    v_mov_b32 v30, v19
    s_nop 1
    v_permlane16_swap_b32 v19, v30
    v_max_f32 v19, v19, v30
    v_mov_b32 v30, v19
    s_nop 1
    v_permlane32_swap_b32 v19, v30
    v_min_f32 v192, -v19, -v30
    v_min_f32 v193, -v19, -v30
    v_min_f32 v194, -v19, -v30
    v_min_f32 v195, -v19, -v30
    v_mov_b32 v19, 0
    v_mov_b32 v30, v20
    s_nop 1
    v_permlane16_swap_b32 v20, v30
    v_max_f32 v20, v20, v30
    v_mov_b32 v30, v20
    s_nop 1
    v_permlane32_swap_b32 v20, v30
    v_min_f32 v196, -v20, -v30
    v_min_f32 v197, -v20, -v30
    v_min_f32 v198, -v20, -v30
    v_min_f32 v199, -v20, -v30
    v_mov_b32 v20, 0
    v_mov_b32 v30, v21
    s_nop 1
    v_permlane16_swap_b32 v21, v30
    v_max_f32 v21, v21, v30
    v_mov_b32 v30, v21
    s_nop 1
    v_permlane32_swap_b32 v21, v30
    v_min_f32 v200, -v21, -v30
    v_min_f32 v201, -v21, -v30
    v_min_f32 v202, -v21, -v30
    v_min_f32 v203, -v21, -v30
    v_mov_b32 v21, 0
    v_mov_b32 v30, v22
    s_nop 1
    v_permlane16_swap_b32 v22, v30
    v_max_f32 v22, v22, v30
    v_mov_b32 v30, v22
    s_nop 1
    v_permlane32_swap_b32 v22, v30
    v_min_f32 v204, -v22, -v30
    v_min_f32 v205, -v22, -v30
    v_min_f32 v206, -v22, -v30
    v_min_f32 v207, -v22, -v30
    v_mov_b32 v22, 0
    v_mov_b32 v30, v23
    s_nop 1
    v_permlane16_swap_b32 v23, v30
    v_max_f32 v23, v23, v30
    v_mov_b32 v30, v23
    s_nop 1
    v_permlane32_swap_b32 v23, v30
    v_min_f32 v208, -v23, -v30
    v_min_f32 v209, -v23, -v30
    v_min_f32 v210, -v23, -v30
    v_min_f32 v211, -v23, -v30
    v_mov_b32 v23, 0
    v_mov_b64 v[32:33], 0
    v_mov_b64 v[34:35], 0
    v_mov_b64 v[36:37], 0
    v_mov_b64 v[38:39], 0
    v_mov_b64 v[40:41], 0
    v_mov_b64 v[42:43], 0
    v_mov_b64 v[44:45], 0
    v_mov_b64 v[46:47], 0
    v_mov_b64 v[48:49], 0
    v_mov_b64 v[50:51], 0
    v_mov_b64 v[52:53], 0
    v_mov_b64 v[54:55], 0
    v_mov_b64 v[56:57], 0
    v_mov_b64 v[58:59], 0
    v_mov_b64 v[60:61], 0
    v_mov_b64 v[62:63], 0
    v_mov_b64 v[64:65], 0
    v_mov_b64 v[66:67], 0
    v_mov_b64 v[68:69], 0
    v_mov_b64 v[70:71], 0
    v_mov_b64 v[72:73], 0
    v_mov_b64 v[74:75], 0
    v_mov_b64 v[76:77], 0
    v_mov_b64 v[78:79], 0
    v_mov_b64 v[80:81], 0
    v_mov_b64 v[82:83], 0
    v_mov_b64 v[84:85], 0
    v_mov_b64 v[86:87], 0
    v_mov_b64 v[88:89], 0
    v_mov_b64 v[90:91], 0
    v_mov_b64 v[92:93], 0
    v_mov_b64 v[94:95], 0
    v_mov_b64 v[96:97], 0
    v_mov_b64 v[98:99], 0
    v_mov_b64 v[100:101], 0
    v_mov_b64 v[102:103], 0
    v_mov_b64 v[104:105], 0
    v_mov_b64 v[106:107], 0
    v_mov_b64 v[108:109], 0
    v_mov_b64 v[110:111], 0
    v_mov_b64 v[112:113], 0
    v_mov_b64 v[114:115], 0
    v_mov_b64 v[116:117], 0
    v_mov_b64 v[118:119], 0
    v_mov_b64 v[120:121], 0
    v_mov_b64 v[122:123], 0
    v_mov_b64 v[124:125], 0
    v_mov_b64 v[126:127], 0
    v_mov_b64 v[128:129], 0
    v_mov_b64 v[130:131], 0
    v_mov_b64 v[132:133], 0
    v_mov_b64 v[134:135], 0
    v_mov_b64 v[136:137], 0
    v_mov_b64 v[138:139], 0
    v_mov_b64 v[140:141], 0
    v_mov_b64 v[142:143], 0
    v_mov_b64 v[144:145], 0
    v_mov_b64 v[146:147], 0
    v_mov_b64 v[148:149], 0
    v_mov_b64 v[150:151], 0
    v_mov_b64 v[152:153], 0
    v_mov_b64 v[154:155], 0
    v_mov_b64 v[156:157], 0
    v_mov_b64 v[158:159], 0
    v_mov_b64 v[160:161], 0
    v_mov_b64 v[162:163], 0
    v_mov_b64 v[164:165], 0
    v_mov_b64 v[166:167], 0
    v_mov_b64 v[168:169], 0
    v_mov_b64 v[170:171], 0
    v_mov_b64 v[172:173], 0
    v_mov_b64 v[174:175], 0
    v_mov_b64 v[176:177], 0
    v_mov_b64 v[178:179], 0
    v_mov_b64 v[180:181], 0
    v_mov_b64 v[182:183], 0
    v_mov_b64 v[184:185], 0
    v_mov_b64 v[186:187], 0
    v_mov_b64 v[188:189], 0
    v_mov_b64 v[190:191], 0
    s_lshl_b32 s28, s31, 18
    s_mov_b32 s30, 16
L_sp2:
    s_add_u32 m0, s29, 0
    s_add_u32 s42, s28, 0
    buffer_load_dwordx4 v13, s[12:15], s42 offen offset:0 lds
    buffer_load_dwordx4 v14, s[12:15], s42 offen offset:1024 lds
    buffer_load_dwordx4 v15, s[12:15], s42 offen offset:2048 lds
    buffer_load_dwordx4 v16, s[12:15], s42 offen offset:3072 lds
    s_add_u32 m0, s29, 4096
    s_add_u32 s42, s28, 4096
    buffer_load_dwordx4 v13, s[12:15], s42 offen offset:0 lds
    buffer_load_dwordx4 v14, s[12:15], s42 offen offset:1024 lds
    buffer_load_dwordx4 v15, s[12:15], s42 offen offset:2048 lds
    buffer_load_dwordx4 v16, s[12:15], s42 offen offset:3072 lds
    s_add_u32 m0, s29, 8192
    s_add_u32 s42, s28, 8192
    buffer_load_dwordx4 v13, s[12:15], s42 offen offset:0 lds
    buffer_load_dwordx4 v14, s[12:15], s42 offen offset:1024 lds
    buffer_load_dwordx4 v15, s[12:15], s42 offen offset:2048 lds
    buffer_load_dwordx4 v16, s[12:15], s42 offen offset:3072 lds
    s_add_u32 m0, s29, 12288
    s_add_u32 s42, s28, 12288
    buffer_load_dwordx4 v13, s[12:15], s42 offen offset:0 lds
    buffer_load_dwordx4 v14, s[12:15], s42 offen offset:1024 lds
    buffer_load_dwordx4 v15, s[12:15], s42 offen offset:2048 lds
    buffer_load_dwordx4 v16, s[12:15], s42 offen offset:3072 lds
    s_add_u32 m0, s29, 65536
    s_add_u32 s42, s28, 0
    buffer_load_dwordx4 v17, s[16:19], s42 offen offset:0 lds
    buffer_load_dwordx4 v18, s[16:19], s42 offen offset:1024 lds
    buffer_load_dwordx4 v17, s[16:19], s42 offen offset:2048 lds
    buffer_load_dwordx4 v18, s[16:19], s42 offen offset:3072 lds
    s_add_u32 m0, s29, 69632
    s_add_u32 s42, s28, 4096
    buffer_load_dwordx4 v17, s[16:19], s42 offen offset:0 lds
    buffer_load_dwordx4 v18, s[16:19], s42 offen offset:1024 lds
    buffer_load_dwordx4 v17, s[16:19], s42 offen offset:2048 lds
    buffer_load_dwordx4 v18, s[16:19], s42 offen offset:3072 lds
    s_add_u32 m0, s29, 73728
    s_add_u32 s42, s28, 8192
    buffer_load_dwordx4 v17, s[16:19], s42 offen offset:0 lds
    buffer_load_dwordx4 v18, s[16:19], s42 offen offset:1024 lds
    buffer_load_dwordx4 v17, s[16:19], s42 offen offset:2048 lds
    buffer_load_dwordx4 v18, s[16:19], s42 offen offset:3072 lds
    s_add_u32 m0, s29, 77824
    s_add_u32 s42, s28, 12288
    buffer_load_dwordx4 v17, s[16:19], s42 offen offset:0 lds
    buffer_load_dwordx4 v18, s[16:19], s42 offen offset:1024 lds
    buffer_load_dwordx4 v17, s[16:19], s42 offen offset:2048 lds
    buffer_load_dwordx4 v18, s[16:19], s42 offen offset:3072 lds
    s_waitcnt vmcnt(0)
    ds_read_b128 a[80:83], v1 offset:0
    ds_read_b128 a[84:87], v2 offset:0
    ds_read_b128 a[88:91], v3 offset:0
    ds_read_b128 a[92:95], v4 offset:0
    ds_read_b128 a[96:99], v1 offset:4096
    ds_read_b128 a[100:103], v2 offset:4096
    ds_read_b128 a[104:107], v3 offset:4096
    ds_read_b128 a[108:111], v4 offset:4096
    ds_read_b128 a[112:115], v1 offset:8192
    ds_read_b128 a[116:119], v2 offset:8192
    ds_read_b128 a[120:123], v3 offset:8192
    ds_read_b128 a[124:127], v4 offset:8192
    ds_read_b128 a[128:131], v1 offset:12288
    ds_read_b128 a[132:135], v2 offset:12288
    ds_read_b128 a[136:139], v3 offset:12288
    ds_read_b128 a[140:143], v4 offset:12288
    ds_read_b64_tr_b16 a[144:145], v5 offset:0
    ds_read_b64_tr_b16 a[146:147], v5 offset:4096
    ds_read_b64_tr_b16 a[176:177], v5 offset:8192
    ds_read_b64_tr_b16 a[178:179], v5 offset:12288
    ds_read_b64_tr_b16 a[148:149], v6 offset:0
    ds_read_b64_tr_b16 a[150:151], v6 offset:4096
    ds_read_b64_tr_b16 a[180:181], v6 offset:8192
    ds_read_b64_tr_b16 a[182:183], v6 offset:12288
    ds_read_b64_tr_b16 a[152:153], v7 offset:0
    ds_read_b64_tr_b16 a[154:155], v7 offset:4096
    ds_read_b64_tr_b16 a[184:185], v7 offset:8192
    ds_read_b64_tr_b16 a[186:187], v7 offset:12288
    ds_read_b64_tr_b16 a[156:157], v8 offset:0
    ds_read_b64_tr_b16 a[158:159], v8 offset:4096
    ds_read_b64_tr_b16 a[188:189], v8 offset:8192
    ds_read_b64_tr_b16 a[190:191], v8 offset:12288
    ds_read_b64_tr_b16 a[160:161], v9 offset:0
    ds_read_b64_tr_b16 a[162:163], v9 offset:4096
    ds_read_b64_tr_b16 a[192:193], v9 offset:8192
    ds_read_b64_tr_b16 a[194:195], v9 offset:12288
    ds_read_b64_tr_b16 a[164:165], v10 offset:0
    ds_read_b64_tr_b16 a[166:167], v10 offset:4096
    ds_read_b64_tr_b16 a[196:197], v10 offset:8192
    ds_read_b64_tr_b16 a[198:199], v10 offset:12288
    ds_read_b64_tr_b16 a[168:169], v11 offset:0
    ds_read_b64_tr_b16 a[170:171], v11 offset:4096
    ds_read_b64_tr_b16 a[200:201], v11 offset:8192
    ds_read_b64_tr_b16 a[202:203], v11 offset:12288
    ds_read_b64_tr_b16 a[172:173], v12 offset:0
    ds_read_b64_tr_b16 a[174:175], v12 offset:4096
    ds_read_b64_tr_b16 a[204:205], v12 offset:8192
    ds_read_b64_tr_b16 a[206:207], v12 offset:12288
    s_waitcnt lgkmcnt(15)
    v_mfma_f32_16x16x32_bf16 v[212:215], a[80:83], a[0:3], v[192:195]
    v_mfma_f32_16x16x32_bf16 v[212:215], a[84:87], a[4:7], v[212:215]
    v_mfma_f32_16x16x32_bf16 v[212:215], a[88:91], a[8:11], v[212:215]
    v_mfma_f32_16x16x32_bf16 v[212:215], a[92:95], a[12:15], v[212:215]
    v_mfma_f32_16x16x32_bf16 v[216:219], a[96:99], a[0:3], v[192:195]
    v_mfma_f32_16x16x32_bf16 v[216:219], a[100:103], a[4:7], v[216:219]
    v_mfma_f32_16x16x32_bf16 v[216:219], a[104:107], a[8:11], v[216:219]
    v_mfma_f32_16x16x32_bf16 v[216:219], a[108:111], a[12:15], v[216:219]
    v_mfma_f32_16x16x32_bf16 v[220:223], a[112:115], a[0:3], v[192:195]
    v_mfma_f32_16x16x32_bf16 v[220:223], a[116:119], a[4:7], v[220:223]
    v_mfma_f32_16x16x32_bf16 v[220:223], a[120:123], a[8:11], v[220:223]
    v_mfma_f32_16x16x32_bf16 v[220:223], a[124:127], a[12:15], v[220:223]
    v_mfma_f32_16x16x32_bf16 v[224:227], a[128:131], a[0:3], v[192:195]
    v_mfma_f32_16x16x32_bf16 v[224:227], a[132:135], a[4:7], v[224:227]
    v_mfma_f32_16x16x32_bf16 v[224:227], a[136:139], a[8:11], v[224:227]
    v_mfma_f32_16x16x32_bf16 v[224:227], a[140:143], a[12:15], v[224:227]
    v_exp_f32 v212, v212
    s_nop 0
    v_add_f32 v19, v19, v212
    v_exp_f32 v213, v213
    s_nop 0
    v_add_f32 v19, v19, v213
    v_cvt_pk_bf16_f32 v212, v212, v213
    v_exp_f32 v214, v214
    s_nop 0
    v_add_f32 v19, v19, v214
    v_exp_f32 v215, v215
    s_nop 0
    v_add_f32 v19, v19, v215
    v_cvt_pk_bf16_f32 v213, v214, v215
    v_exp_f32 v216, v216
    s_nop 0
    v_add_f32 v19, v19, v216
    v_exp_f32 v217, v217
    s_nop 0
    v_add_f32 v19, v19, v217
    v_cvt_pk_bf16_f32 v214, v216, v217
    v_exp_f32 v218, v218
    s_nop 0
    v_add_f32 v19, v19, v218
    v_exp_f32 v219, v219
    s_nop 0
    v_add_f32 v19, v19, v219
    v_cvt_pk_bf16_f32 v215, v218, v219
    v_exp_f32 v220, v220
    s_nop 0
    v_add_f32 v19, v19, v220
    v_exp_f32 v221, v221
    s_nop 0
    v_add_f32 v19, v19, v221
    v_cvt_pk_bf16_f32 v216, v220, v221
    v_exp_f32 v222, v222
    s_nop 0
    v_add_f32 v19, v19, v222
    v_exp_f32 v223, v223
    s_nop 0
    v_add_f32 v19, v19, v223
    v_cvt_pk_bf16_f32 v217, v222, v223
    v_exp_f32 v224, v224
    s_nop 0
    v_add_f32 v19, v19, v224
    v_exp_f32 v225, v225
    s_nop 0
    v_add_f32 v19, v19, v225
    v_cvt_pk_bf16_f32 v218, v224, v225
    v_exp_f32 v226, v226
    s_nop 0
    v_add_f32 v19, v19, v226
    v_exp_f32 v227, v227
    s_nop 0
    v_add_f32 v19, v19, v227
    v_cvt_pk_bf16_f32 v219, v226, v227
    v_mfma_f32_16x16x32_bf16 v[32:35], a[144:147], v[212:215], v[32:35]
    s_nop 0
    v_mfma_f32_16x16x32_bf16 v[32:35], a[176:179], v[216:219], v[32:35]
    v_mfma_f32_16x16x32_bf16 v[36:39], a[148:151], v[212:215], v[36:39]
    v_mfma_f32_16x16x32_bf16 v[36:39], a[180:183], v[216:219], v[36:39]
    v_mfma_f32_16x16x32_bf16 v[40:43], a[152:155], v[212:215], v[40:43]
    v_mfma_f32_16x16x32_bf16 v[40:43], a[184:187], v[216:219], v[40:43]
    v_mfma_f32_16x16x32_bf16 v[44:47], a[156:159], v[212:215], v[44:47]
    v_mfma_f32_16x16x32_bf16 v[44:47], a[188:191], v[216:219], v[44:47]
    s_waitcnt lgkmcnt(0)
    v_mfma_f32_16x16x32_bf16 v[48:51], a[160:163], v[212:215], v[48:51]
    v_mfma_f32_16x16x32_bf16 v[48:51], a[192:195], v[216:219], v[48:51]
    v_mfma_f32_16x16x32_bf16 v[52:55], a[164:167], v[212:215], v[52:55]
    v_mfma_f32_16x16x32_bf16 v[52:55], a[196:199], v[216:219], v[52:55]
    v_mfma_f32_16x16x32_bf16 v[56:59], a[168:171], v[212:215], v[56:59]
    v_mfma_f32_16x16x32_bf16 v[56:59], a[200:203], v[216:219], v[56:59]
    v_mfma_f32_16x16x32_bf16 v[60:63], a[172:175], v[212:215], v[60:63]
    v_mfma_f32_16x16x32_bf16 v[60:63], a[204:207], v[216:219], v[60:63]
    v_mfma_f32_16x16x32_bf16 v[212:215], a[80:83], a[16:19], v[196:199]
    v_mfma_f32_16x16x32_bf16 v[212:215], a[84:87], a[20:23], v[212:215]
    v_mfma_f32_16x16x32_bf16 v[212:215], a[88:91], a[24:27], v[212:215]
    v_mfma_f32_16x16x32_bf16 v[212:215], a[92:95], a[28:31], v[212:215]
    v_mfma_f32_16x16x32_bf16 v[216:219], a[96:99], a[16:19], v[196:199]
    v_mfma_f32_16x16x32_bf16 v[216:219], a[100:103], a[20:23], v[216:219]
    v_mfma_f32_16x16x32_bf16 v[216:219], a[104:107], a[24:27], v[216:219]
    v_mfma_f32_16x16x32_bf16 v[216:219], a[108:111], a[28:31], v[216:219]
    v_mfma_f32_16x16x32_bf16 v[220:223], a[112:115], a[16:19], v[196:199]
    v_mfma_f32_16x16x32_bf16 v[220:223], a[116:119], a[20:23], v[220:223]
    v_mfma_f32_16x16x32_bf16 v[220:223], a[120:123], a[24:27], v[220:223]
    v_mfma_f32_16x16x32_bf16 v[220:223], a[124:127], a[28:31], v[220:223]
    v_mfma_f32_16x16x32_bf16 v[224:227], a[128:131], a[16:19], v[196:199]
    v_mfma_f32_16x16x32_bf16 v[224:227], a[132:135], a[20:23], v[224:227]
    v_mfma_f32_16x16x32_bf16 v[224:227], a[136:139], a[24:27], v[224:227]
    v_mfma_f32_16x16x32_bf16 v[224:227], a[140:143], a[28:31], v[224:227]
    v_exp_f32 v212, v212
    s_nop 0
    v_add_f32 v20, v20, v212
    v_exp_f32 v213, v213
    s_nop 0
    v_add_f32 v20, v20, v213
    v_cvt_pk_bf16_f32 v212, v212, v213
    v_exp_f32 v214, v214
    s_nop 0
    v_add_f32 v20, v20, v214
    v_exp_f32 v215, v215
    s_nop 0
    v_add_f32 v20, v20, v215
    v_cvt_pk_bf16_f32 v213, v214, v215
    v_exp_f32 v216, v216
    s_nop 0
    v_add_f32 v20, v20, v216
    v_exp_f32 v217, v217
    s_nop 0
    v_add_f32 v20, v20, v217
    v_cvt_pk_bf16_f32 v214, v216, v217
    v_exp_f32 v218, v218
    s_nop 0
    v_add_f32 v20, v20, v218
    v_exp_f32 v219, v219
    s_nop 0
    v_add_f32 v20, v20, v219
    v_cvt_pk_bf16_f32 v215, v218, v219
    v_exp_f32 v220, v220
    s_nop 0
    v_add_f32 v20, v20, v220
    v_exp_f32 v221, v221
    s_nop 0
    v_add_f32 v20, v20, v221
    v_cvt_pk_bf16_f32 v216, v220, v221
    v_exp_f32 v222, v222
    s_nop 0
    v_add_f32 v20, v20, v222
    v_exp_f32 v223, v223
    s_nop 0
    v_add_f32 v20, v20, v223
    v_cvt_pk_bf16_f32 v217, v222, v223
    v_exp_f32 v224, v224
    s_nop 0
    v_add_f32 v20, v20, v224
    v_exp_f32 v225, v225
    s_nop 0
    v_add_f32 v20, v20, v225
    v_cvt_pk_bf16_f32 v218, v224, v225
    v_exp_f32 v226, v226
    s_nop 0
    v_add_f32 v20, v20, v226
    v_exp_f32 v227, v227
    s_nop 0
    v_add_f32 v20, v20, v227
    v_cvt_pk_bf16_f32 v219, v226, v227
    v_mfma_f32_16x16x32_bf16 v[64:67], a[144:147], v[212:215], v[64:67]
    s_nop 0
    v_mfma_f32_16x16x32_bf16 v[64:67], a[176:179], v[216:219], v[64:67]
    v_mfma_f32_16x16x32_bf16 v[68:71], a[148:151], v[212:215], v[68:71]
    v_mfma_f32_16x16x32_bf16 v[68:71], a[180:183], v[216:219], v[68:71]
    v_mfma_f32_16x16x32_bf16 v[72:75], a[152:155], v[212:215], v[72:75]
    v_mfma_f32_16x16x32_bf16 v[72:75], a[184:187], v[216:219], v[72:75]
    v_mfma_f32_16x16x32_bf16 v[76:79], a[156:159], v[212:215], v[76:79]
    v_mfma_f32_16x16x32_bf16 v[76:79], a[188:191], v[216:219], v[76:79]
    v_mfma_f32_16x16x32_bf16 v[80:83], a[160:163], v[212:215], v[80:83]
    v_mfma_f32_16x16x32_bf16 v[80:83], a[192:195], v[216:219], v[80:83]
    v_mfma_f32_16x16x32_bf16 v[84:87], a[164:167], v[212:215], v[84:87]
    v_mfma_f32_16x16x32_bf16 v[84:87], a[196:199], v[216:219], v[84:87]
    v_mfma_f32_16x16x32_bf16 v[88:91], a[168:171], v[212:215], v[88:91]
    v_mfma_f32_16x16x32_bf16 v[88:91], a[200:203], v[216:219], v[88:91]
    v_mfma_f32_16x16x32_bf16 v[92:95], a[172:175], v[212:215], v[92:95]
    v_mfma_f32_16x16x32_bf16 v[92:95], a[204:207], v[216:219], v[92:95]
    v_mfma_f32_16x16x32_bf16 v[212:215], a[80:83], a[32:35], v[200:203]
    v_mfma_f32_16x16x32_bf16 v[212:215], a[84:87], a[36:39], v[212:215]
    v_mfma_f32_16x16x32_bf16 v[212:215], a[88:91], a[40:43], v[212:215]
    v_mfma_f32_16x16x32_bf16 v[212:215], a[92:95], a[44:47], v[212:215]
    v_mfma_f32_16x16x32_bf16 v[216:219], a[96:99], a[32:35], v[200:203]
    v_mfma_f32_16x16x32_bf16 v[216:219], a[100:103], a[36:39], v[216:219]
    v_mfma_f32_16x16x32_bf16 v[216:219], a[104:107], a[40:43], v[216:219]
    v_mfma_f32_16x16x32_bf16 v[216:219], a[108:111], a[44:47], v[216:219]
    v_mfma_f32_16x16x32_bf16 v[220:223], a[112:115], a[32:35], v[200:203]
    v_mfma_f32_16x16x32_bf16 v[220:223], a[116:119], a[36:39], v[220:223]
    v_mfma_f32_16x16x32_bf16 v[220:223], a[120:123], a[40:43], v[220:223]
    v_mfma_f32_16x16x32_bf16 v[220:223], a[124:127], a[44:47], v[220:223]
    v_mfma_f32_16x16x32_bf16 v[224:227], a[128:131], a[32:35], v[200:203]
    v_mfma_f32_16x16x32_bf16 v[224:227], a[132:135], a[36:39], v[224:227]
    v_mfma_f32_16x16x32_bf16 v[224:227], a[136:139], a[40:43], v[224:227]
    v_mfma_f32_16x16x32_bf16 v[224:227], a[140:143], a[44:47], v[224:227]
    v_exp_f32 v212, v212
    s_nop 0
    v_add_f32 v21, v21, v212
    v_exp_f32 v213, v213
    s_nop 0
    v_add_f32 v21, v21, v213
    v_cvt_pk_bf16_f32 v212, v212, v213
    v_exp_f32 v214, v214
    s_nop 0
    v_add_f32 v21, v21, v214
    v_exp_f32 v215, v215
    s_nop 0
    v_add_f32 v21, v21, v215
    v_cvt_pk_bf16_f32 v213, v214, v215
    v_exp_f32 v216, v216
    s_nop 0
    v_add_f32 v21, v21, v216
    v_exp_f32 v217, v217
    s_nop 0
    v_add_f32 v21, v21, v217
    v_cvt_pk_bf16_f32 v214, v216, v217
    v_exp_f32 v218, v218
    s_nop 0
    v_add_f32 v21, v21, v218
    v_exp_f32 v219, v219
    s_nop 0
    v_add_f32 v21, v21, v219
    v_cvt_pk_bf16_f32 v215, v218, v219
    v_exp_f32 v220, v220
    s_nop 0
    v_add_f32 v21, v21, v220
    v_exp_f32 v221, v221
    s_nop 0
    v_add_f32 v21, v21, v221
    v_cvt_pk_bf16_f32 v216, v220, v221
    v_exp_f32 v222, v222
    s_nop 0
    v_add_f32 v21, v21, v222
    v_exp_f32 v223, v223
    s_nop 0
    v_add_f32 v21, v21, v223
    v_cvt_pk_bf16_f32 v217, v222, v223
    v_exp_f32 v224, v224
    s_nop 0
    v_add_f32 v21, v21, v224
    v_exp_f32 v225, v225
    s_nop 0
    v_add_f32 v21, v21, v225
    v_cvt_pk_bf16_f32 v218, v224, v225
    v_exp_f32 v226, v226
    s_nop 0
    v_add_f32 v21, v21, v226
    v_exp_f32 v227, v227
    s_nop 0
    v_add_f32 v21, v21, v227
    v_cvt_pk_bf16_f32 v219, v226, v227
    v_mfma_f32_16x16x32_bf16 v[96:99], a[144:147], v[212:215], v[96:99]
    s_nop 0
    v_mfma_f32_16x16x32_bf16 v[96:99], a[176:179], v[216:219], v[96:99]
    v_mfma_f32_16x16x32_bf16 v[100:103], a[148:151], v[212:215], v[100:103]
    v_mfma_f32_16x16x32_bf16 v[100:103], a[180:183], v[216:219], v[100:103]
    v_mfma_f32_16x16x32_bf16 v[104:107], a[152:155], v[212:215], v[104:107]
    v_mfma_f32_16x16x32_bf16 v[104:107], a[184:187], v[216:219], v[104:107]
    v_mfma_f32_16x16x32_bf16 v[108:111], a[156:159], v[212:215], v[108:111]
    v_mfma_f32_16x16x32_bf16 v[108:111], a[188:191], v[216:219], v[108:111]
    v_mfma_f32_16x16x32_bf16 v[112:115], a[160:163], v[212:215], v[112:115]
    v_mfma_f32_16x16x32_bf16 v[112:115], a[192:195], v[216:219], v[112:115]
    v_mfma_f32_16x16x32_bf16 v[116:119], a[164:167], v[212:215], v[116:119]
    v_mfma_f32_16x16x32_bf16 v[116:119], a[196:199], v[216:219], v[116:119]
    v_mfma_f32_16x16x32_bf16 v[120:123], a[168:171], v[212:215], v[120:123]
    v_mfma_f32_16x16x32_bf16 v[120:123], a[200:203], v[216:219], v[120:123]
    v_mfma_f32_16x16x32_bf16 v[124:127], a[172:175], v[212:215], v[124:127]
    v_mfma_f32_16x16x32_bf16 v[124:127], a[204:207], v[216:219], v[124:127]
    v_mfma_f32_16x16x32_bf16 v[212:215], a[80:83], a[48:51], v[204:207]
    v_mfma_f32_16x16x32_bf16 v[212:215], a[84:87], a[52:55], v[212:215]
    v_mfma_f32_16x16x32_bf16 v[212:215], a[88:91], a[56:59], v[212:215]
    v_mfma_f32_16x16x32_bf16 v[212:215], a[92:95], a[60:63], v[212:215]
    v_mfma_f32_16x16x32_bf16 v[216:219], a[96:99], a[48:51], v[204:207]
    v_mfma_f32_16x16x32_bf16 v[216:219], a[100:103], a[52:55], v[216:219]
    v_mfma_f32_16x16x32_bf16 v[216:219], a[104:107], a[56:59], v[216:219]
    v_mfma_f32_16x16x32_bf16 v[216:219], a[108:111], a[60:63], v[216:219]
    v_mfma_f32_16x16x32_bf16 v[220:223], a[112:115], a[48:51], v[204:207]
    v_mfma_f32_16x16x32_bf16 v[220:223], a[116:119], a[52:55], v[220:223]
    v_mfma_f32_16x16x32_bf16 v[220:223], a[120:123], a[56:59], v[220:223]
    v_mfma_f32_16x16x32_bf16 v[220:223], a[124:127], a[60:63], v[220:223]
    v_mfma_f32_16x16x32_bf16 v[224:227], a[128:131], a[48:51], v[204:207]
    v_mfma_f32_16x16x32_bf16 v[224:227], a[132:135], a[52:55], v[224:227]
    v_mfma_f32_16x16x32_bf16 v[224:227], a[136:139], a[56:59], v[224:227]
    v_mfma_f32_16x16x32_bf16 v[224:227], a[140:143], a[60:63], v[224:227]
    v_exp_f32 v212, v212
    s_nop 0
    v_add_f32 v22, v22, v212
    v_exp_f32 v213, v213
    s_nop 0
    v_add_f32 v22, v22, v213
    v_cvt_pk_bf16_f32 v212, v212, v213
    v_exp_f32 v214, v214
    s_nop 0
    v_add_f32 v22, v22, v214
    v_exp_f32 v215, v215
    s_nop 0
    v_add_f32 v22, v22, v215
    v_cvt_pk_bf16_f32 v213, v214, v215
    v_exp_f32 v216, v216
    s_nop 0
    v_add_f32 v22, v22, v216
    v_exp_f32 v217, v217
    s_nop 0
    v_add_f32 v22, v22, v217
    v_cvt_pk_bf16_f32 v214, v216, v217
    v_exp_f32 v218, v218
    s_nop 0
    v_add_f32 v22, v22, v218
    v_exp_f32 v219, v219
    s_nop 0
    v_add_f32 v22, v22, v219
    v_cvt_pk_bf16_f32 v215, v218, v219
    v_exp_f32 v220, v220
    s_nop 0
    v_add_f32 v22, v22, v220
    v_exp_f32 v221, v221
    s_nop 0
    v_add_f32 v22, v22, v221
    v_cvt_pk_bf16_f32 v216, v220, v221
    v_exp_f32 v222, v222
    s_nop 0
    v_add_f32 v22, v22, v222
    v_exp_f32 v223, v223
    s_nop 0
    v_add_f32 v22, v22, v223
    v_cvt_pk_bf16_f32 v217, v222, v223
    v_exp_f32 v224, v224
    s_nop 0
    v_add_f32 v22, v22, v224
    v_exp_f32 v225, v225
    s_nop 0
    v_add_f32 v22, v22, v225
    v_cvt_pk_bf16_f32 v218, v224, v225
    v_exp_f32 v226, v226
    s_nop 0
    v_add_f32 v22, v22, v226
    v_exp_f32 v227, v227
    s_nop 0
    v_add_f32 v22, v22, v227
    v_cvt_pk_bf16_f32 v219, v226, v227
    v_mfma_f32_16x16x32_bf16 v[128:131], a[144:147], v[212:215], v[128:131]
    s_nop 0
    v_mfma_f32_16x16x32_bf16 v[128:131], a[176:179], v[216:219], v[128:131]
    v_mfma_f32_16x16x32_bf16 v[132:135], a[148:151], v[212:215], v[132:135]
    v_mfma_f32_16x16x32_bf16 v[132:135], a[180:183], v[216:219], v[132:135]
    v_mfma_f32_16x16x32_bf16 v[136:139], a[152:155], v[212:215], v[136:139]
    v_mfma_f32_16x16x32_bf16 v[136:139], a[184:187], v[216:219], v[136:139]
    v_mfma_f32_16x16x32_bf16 v[140:143], a[156:159], v[212:215], v[140:143]
    v_mfma_f32_16x16x32_bf16 v[140:143], a[188:191], v[216:219], v[140:143]
    v_mfma_f32_16x16x32_bf16 v[144:147], a[160:163], v[212:215], v[144:147]
    v_mfma_f32_16x16x32_bf16 v[144:147], a[192:195], v[216:219], v[144:147]
    v_mfma_f32_16x16x32_bf16 v[148:151], a[164:167], v[212:215], v[148:151]
    v_mfma_f32_16x16x32_bf16 v[148:151], a[196:199], v[216:219], v[148:151]
    v_mfma_f32_16x16x32_bf16 v[152:155], a[168:171], v[212:215], v[152:155]
    v_mfma_f32_16x16x32_bf16 v[152:155], a[200:203], v[216:219], v[152:155]
    v_mfma_f32_16x16x32_bf16 v[156:159], a[172:175], v[212:215], v[156:159]
    v_mfma_f32_16x16x32_bf16 v[156:159], a[204:207], v[216:219], v[156:159]
    v_mfma_f32_16x16x32_bf16 v[212:215], a[80:83], a[64:67], v[208:211]
    v_mfma_f32_16x16x32_bf16 v[212:215], a[84:87], a[68:71], v[212:215]
    v_mfma_f32_16x16x32_bf16 v[212:215], a[88:91], a[72:75], v[212:215]
    v_mfma_f32_16x16x32_bf16 v[212:215], a[92:95], a[76:79], v[212:215]
    v_mfma_f32_16x16x32_bf16 v[216:219], a[96:99], a[64:67], v[208:211]
    v_mfma_f32_16x16x32_bf16 v[216:219], a[100:103], a[68:71], v[216:219]
    v_mfma_f32_16x16x32_bf16 v[216:219], a[104:107], a[72:75], v[216:219]
    v_mfma_f32_16x16x32_bf16 v[216:219], a[108:111], a[76:79], v[216:219]
    v_mfma_f32_16x16x32_bf16 v[220:223], a[112:115], a[64:67], v[208:211]
    v_mfma_f32_16x16x32_bf16 v[220:223], a[116:119], a[68:71], v[220:223]
    v_mfma_f32_16x16x32_bf16 v[220:223], a[120:123], a[72:75], v[220:223]
    v_mfma_f32_16x16x32_bf16 v[220:223], a[124:127], a[76:79], v[220:223]
    v_mfma_f32_16x16x32_bf16 v[224:227], a[128:131], a[64:67], v[208:211]
    v_mfma_f32_16x16x32_bf16 v[224:227], a[132:135], a[68:71], v[224:227]
    v_mfma_f32_16x16x32_bf16 v[224:227], a[136:139], a[72:75], v[224:227]
    v_mfma_f32_16x16x32_bf16 v[224:227], a[140:143], a[76:79], v[224:227]
    v_exp_f32 v212, v212
    s_nop 0
    v_add_f32 v23, v23, v212
    v_exp_f32 v213, v213
    s_nop 0
    v_add_f32 v23, v23, v213
    v_cvt_pk_bf16_f32 v212, v212, v213
    v_exp_f32 v214, v214
    s_nop 0
    v_add_f32 v23, v23, v214
    v_exp_f32 v215, v215
    s_nop 0
    v_add_f32 v23, v23, v215
    v_cvt_pk_bf16_f32 v213, v214, v215
    v_exp_f32 v216, v216
    s_nop 0
    v_add_f32 v23, v23, v216
    v_exp_f32 v217, v217
    s_nop 0
    v_add_f32 v23, v23, v217
    v_cvt_pk_bf16_f32 v214, v216, v217
    v_exp_f32 v218, v218
    s_nop 0
    v_add_f32 v23, v23, v218
    v_exp_f32 v219, v219
    s_nop 0
    v_add_f32 v23, v23, v219
    v_cvt_pk_bf16_f32 v215, v218, v219
    v_exp_f32 v220, v220
    s_nop 0
    v_add_f32 v23, v23, v220
    v_exp_f32 v221, v221
    s_nop 0
    v_add_f32 v23, v23, v221
    v_cvt_pk_bf16_f32 v216, v220, v221
    v_exp_f32 v222, v222
    s_nop 0
    v_add_f32 v23, v23, v222
    v_exp_f32 v223, v223
    s_nop 0
    v_add_f32 v23, v23, v223
    v_cvt_pk_bf16_f32 v217, v222, v223
    v_exp_f32 v224, v224
    s_nop 0
    v_add_f32 v23, v23, v224
    v_exp_f32 v225, v225
    s_nop 0
    v_add_f32 v23, v23, v225
    v_cvt_pk_bf16_f32 v218, v224, v225
    v_exp_f32 v226, v226
    s_nop 0
    v_add_f32 v23, v23, v226
    v_exp_f32 v227, v227
    s_nop 0
    v_add_f32 v23, v23, v227
    v_cvt_pk_bf16_f32 v219, v226, v227
    v_mfma_f32_16x16x32_bf16 v[160:163], a[144:147], v[212:215], v[160:163]
    s_nop 0
    v_mfma_f32_16x16x32_bf16 v[160:163], a[176:179], v[216:219], v[160:163]
    v_mfma_f32_16x16x32_bf16 v[164:167], a[148:151], v[212:215], v[164:167]
    v_mfma_f32_16x16x32_bf16 v[164:167], a[180:183], v[216:219], v[164:167]
    v_mfma_f32_16x16x32_bf16 v[168:171], a[152:155], v[212:215], v[168:171]
    v_mfma_f32_16x16x32_bf16 v[168:171], a[184:187], v[216:219], v[168:171]
    v_mfma_f32_16x16x32_bf16 v[172:175], a[156:159], v[212:215], v[172:175]
    v_mfma_f32_16x16x32_bf16 v[172:175], a[188:191], v[216:219], v[172:175]
    v_mfma_f32_16x16x32_bf16 v[176:179], a[160:163], v[212:215], v[176:179]
    v_mfma_f32_16x16x32_bf16 v[176:179], a[192:195], v[216:219], v[176:179]
    v_mfma_f32_16x16x32_bf16 v[180:183], a[164:167], v[212:215], v[180:183]
    v_mfma_f32_16x16x32_bf16 v[180:183], a[196:199], v[216:219], v[180:183]
    v_mfma_f32_16x16x32_bf16 v[184:187], a[168:171], v[212:215], v[184:187]
    v_mfma_f32_16x16x32_bf16 v[184:187], a[200:203], v[216:219], v[184:187]
    v_mfma_f32_16x16x32_bf16 v[188:191], a[172:175], v[212:215], v[188:191]
    v_mfma_f32_16x16x32_bf16 v[188:191], a[204:207], v[216:219], v[188:191]
    s_add_u32 s28, s28, 16384
    s_sub_u32 s30, s30, 1
    s_cmp_lg_u32 s30, 0
    s_cbranch_scc1 L_sp2
    v_mov_b32 v30, v19
    s_nop 1
    v_permlane16_swap_b32 v19, v30
    v_add_f32 v19, v19, v30
    v_mov_b32 v30, v19
    s_nop 1
    v_permlane32_swap_b32 v19, v30
    v_add_f32 v19, v19, v30
    v_rcp_f32 v28, v19
    s_nop 0
    v_pk_mul_f32 v[32:33], v[32:33], v[28:29] op_sel_hi:[1,0]
    v_pk_mul_f32 v[34:35], v[34:35], v[28:29] op_sel_hi:[1,0]
    v_pk_mul_f32 v[36:37], v[36:37], v[28:29] op_sel_hi:[1,0]
    v_pk_mul_f32 v[38:39], v[38:39], v[28:29] op_sel_hi:[1,0]
    v_pk_mul_f32 v[40:41], v[40:41], v[28:29] op_sel_hi:[1,0]
    v_pk_mul_f32 v[42:43], v[42:43], v[28:29] op_sel_hi:[1,0]
    v_pk_mul_f32 v[44:45], v[44:45], v[28:29] op_sel_hi:[1,0]
    v_pk_mul_f32 v[46:47], v[46:47], v[28:29] op_sel_hi:[1,0]
    v_cvt_pk_bf16_f32 v32, v32, v33
    v_cvt_pk_bf16_f32 v33, v34, v35
    v_cvt_pk_bf16_f32 v36, v36, v37
    v_cvt_pk_bf16_f32 v37, v38, v39
    v_cvt_pk_bf16_f32 v40, v40, v41
    v_cvt_pk_bf16_f32 v41, v42, v43
    v_cvt_pk_bf16_f32 v44, v44, v45
    v_cvt_pk_bf16_f32 v45, v46, v47
    v_pk_mul_f32 v[48:49], v[48:49], v[28:29] op_sel_hi:[1,0]
    v_pk_mul_f32 v[50:51], v[50:51], v[28:29] op_sel_hi:[1,0]
    v_pk_mul_f32 v[52:53], v[52:53], v[28:29] op_sel_hi:[1,0]
    v_pk_mul_f32 v[54:55], v[54:55], v[28:29] op_sel_hi:[1,0]
    v_pk_mul_f32 v[56:57], v[56:57], v[28:29] op_sel_hi:[1,0]
    v_pk_mul_f32 v[58:59], v[58:59], v[28:29] op_sel_hi:[1,0]
    v_pk_mul_f32 v[60:61], v[60:61], v[28:29] op_sel_hi:[1,0]
    v_pk_mul_f32 v[62:63], v[62:63], v[28:29] op_sel_hi:[1,0]
    v_cvt_pk_bf16_f32 v48, v48, v49
    v_cvt_pk_bf16_f32 v49, v50, v51
    v_cvt_pk_bf16_f32 v52, v52, v53
    v_cvt_pk_bf16_f32 v53, v54, v55
    v_cvt_pk_bf16_f32 v56, v56, v57
    v_cvt_pk_bf16_f32 v57, v58, v59
    v_cvt_pk_bf16_f32 v60, v60, v61
    v_cvt_pk_bf16_f32 v61, v62, v63
    ds_write_b64 v24, v[32:33] offset:0
    ds_write_b64 v24, v[36:37] offset:32
    ds_write_b64 v24, v[40:41] offset:64
    ds_write_b64 v24, v[44:45] offset:96
    ds_write_b64 v24, v[48:49] offset:128
    ds_write_b64 v24, v[52:53] offset:160
    ds_write_b64 v24, v[56:57] offset:192
    ds_write_b64 v24, v[60:61] offset:224
    ds_read_b128 v[32:35], v25 offset:0
    ds_read_b128 v[36:39], v25 offset:1088
    ds_read_b128 v[40:43], v25 offset:2176
    ds_read_b128 v[44:47], v25 offset:3264
    s_add_u32 s101, s100, 0
    s_waitcnt lgkmcnt(3)
    buffer_store_dwordx4 v[32:35], v26, s[24:27], s101 offen offset:0
    s_waitcnt lgkmcnt(2)
    buffer_store_dwordx4 v[36:39], v26, s[24:27], s101 offen offset:1024
    s_waitcnt lgkmcnt(1)
    buffer_store_dwordx4 v[40:43], v26, s[24:27], s101 offen offset:2048
    s_waitcnt lgkmcnt(0)
    buffer_store_dwordx4 v[44:47], v26, s[24:27], s101 offen offset:3072
    v_mov_b32 v30, v20
    s_nop 1
    v_permlane16_swap_b32 v20, v30
    v_add_f32 v20, v20, v30
    v_mov_b32 v30, v20
    s_nop 1
    v_permlane32_swap_b32 v20, v30
    v_add_f32 v20, v20, v30
    v_rcp_f32 v28, v20
    s_nop 0
    v_pk_mul_f32 v[64:65], v[64:65], v[28:29] op_sel_hi:[1,0]
    v_pk_mul_f32 v[66:67], v[66:67], v[28:29] op_sel_hi:[1,0]
    v_pk_mul_f32 v[68:69], v[68:69], v[28:29] op_sel_hi:[1,0]
    v_pk_mul_f32 v[70:71], v[70:71], v[28:29] op_sel_hi:[1,0]
    v_pk_mul_f32 v[72:73], v[72:73], v[28:29] op_sel_hi:[1,0]
    v_pk_mul_f32 v[74:75], v[74:75], v[28:29] op_sel_hi:[1,0]
    v_pk_mul_f32 v[76:77], v[76:77], v[28:29] op_sel_hi:[1,0]
    v_pk_mul_f32 v[78:79], v[78:79], v[28:29] op_sel_hi:[1,0]
    v_cvt_pk_bf16_f32 v64, v64, v65
    v_cvt_pk_bf16_f32 v65, v66, v67
    v_cvt_pk_bf16_f32 v68, v68, v69
    v_cvt_pk_bf16_f32 v69, v70, v71
    v_cvt_pk_bf16_f32 v72, v72, v73
    v_cvt_pk_bf16_f32 v73, v74, v75
    v_cvt_pk_bf16_f32 v76, v76, v77
    v_cvt_pk_bf16_f32 v77, v78, v79
    v_pk_mul_f32 v[80:81], v[80:81], v[28:29] op_sel_hi:[1,0]
    v_pk_mul_f32 v[82:83], v[82:83], v[28:29] op_sel_hi:[1,0]
    v_pk_mul_f32 v[84:85], v[84:85], v[28:29] op_sel_hi:[1,0]
    v_pk_mul_f32 v[86:87], v[86:87], v[28:29] op_sel_hi:[1,0]
    v_pk_mul_f32 v[88:89], v[88:89], v[28:29] op_sel_hi:[1,0]
    v_pk_mul_f32 v[90:91], v[90:91], v[28:29] op_sel_hi:[1,0]
    v_pk_mul_f32 v[92:93], v[92:93], v[28:29] op_sel_hi:[1,0]
    v_pk_mul_f32 v[94:95], v[94:95], v[28:29] op_sel_hi:[1,0]
    v_cvt_pk_bf16_f32 v80, v80, v81
    v_cvt_pk_bf16_f32 v81, v82, v83
    v_cvt_pk_bf16_f32 v84, v84, v85
    v_cvt_pk_bf16_f32 v85, v86, v87
    v_cvt_pk_bf16_f32 v88, v88, v89
    v_cvt_pk_bf16_f32 v89, v90, v91
    v_cvt_pk_bf16_f32 v92, v92, v93
    v_cvt_pk_bf16_f32 v93, v94, v95
    ds_write_b64 v24, v[64:65] offset:0
    ds_write_b64 v24, v[68:69] offset:32
    ds_write_b64 v24, v[72:73] offset:64
    ds_write_b64 v24, v[76:77] offset:96
    ds_write_b64 v24, v[80:81] offset:128
    ds_write_b64 v24, v[84:85] offset:160
    ds_write_b64 v24, v[88:89] offset:192
    ds_write_b64 v24, v[92:93] offset:224
    ds_read_b128 v[64:67], v25 offset:0
    ds_read_b128 v[68:71], v25 offset:1088
    ds_read_b128 v[72:75], v25 offset:2176
    ds_read_b128 v[76:79], v25 offset:3264
    s_add_u32 s101, s100, 4096
    s_waitcnt lgkmcnt(3)
    buffer_store_dwordx4 v[64:67], v26, s[24:27], s101 offen offset:0
    s_waitcnt lgkmcnt(2)
    buffer_store_dwordx4 v[68:71], v26, s[24:27], s101 offen offset:1024
    s_waitcnt lgkmcnt(1)
    buffer_store_dwordx4 v[72:75], v26, s[24:27], s101 offen offset:2048
    s_waitcnt lgkmcnt(0)
    buffer_store_dwordx4 v[76:79], v26, s[24:27], s101 offen offset:3072
    v_mov_b32 v30, v21
    s_nop 1
    v_permlane16_swap_b32 v21, v30
    v_add_f32 v21, v21, v30
    v_mov_b32 v30, v21
    s_nop 1
    v_permlane32_swap_b32 v21, v30
    v_add_f32 v21, v21, v30
    v_rcp_f32 v28, v21
    s_nop 0
    v_pk_mul_f32 v[96:97], v[96:97], v[28:29] op_sel_hi:[1,0]
    v_pk_mul_f32 v[98:99], v[98:99], v[28:29] op_sel_hi:[1,0]
    v_pk_mul_f32 v[100:101], v[100:101], v[28:29] op_sel_hi:[1,0]
    v_pk_mul_f32 v[102:103], v[102:103], v[28:29] op_sel_hi:[1,0]
    v_pk_mul_f32 v[104:105], v[104:105], v[28:29] op_sel_hi:[1,0]
    v_pk_mul_f32 v[106:107], v[106:107], v[28:29] op_sel_hi:[1,0]
    v_pk_mul_f32 v[108:109], v[108:109], v[28:29] op_sel_hi:[1,0]
    v_pk_mul_f32 v[110:111], v[110:111], v[28:29] op_sel_hi:[1,0]
    v_cvt_pk_bf16_f32 v96, v96, v97
    v_cvt_pk_bf16_f32 v97, v98, v99
    v_cvt_pk_bf16_f32 v100, v100, v101
    v_cvt_pk_bf16_f32 v101, v102, v103
    v_cvt_pk_bf16_f32 v104, v104, v105
    v_cvt_pk_bf16_f32 v105, v106, v107
    v_cvt_pk_bf16_f32 v108, v108, v109
    v_cvt_pk_bf16_f32 v109, v110, v111
    v_pk_mul_f32 v[112:113], v[112:113], v[28:29] op_sel_hi:[1,0]
    v_pk_mul_f32 v[114:115], v[114:115], v[28:29] op_sel_hi:[1,0]
    v_pk_mul_f32 v[116:117], v[116:117], v[28:29] op_sel_hi:[1,0]
    v_pk_mul_f32 v[118:119], v[118:119], v[28:29] op_sel_hi:[1,0]
    v_pk_mul_f32 v[120:121], v[120:121], v[28:29] op_sel_hi:[1,0]
    v_pk_mul_f32 v[122:123], v[122:123], v[28:29] op_sel_hi:[1,0]
    v_pk_mul_f32 v[124:125], v[124:125], v[28:29] op_sel_hi:[1,0]
    v_pk_mul_f32 v[126:127], v[126:127], v[28:29] op_sel_hi:[1,0]
    v_cvt_pk_bf16_f32 v112, v112, v113
    v_cvt_pk_bf16_f32 v113, v114, v115
    v_cvt_pk_bf16_f32 v116, v116, v117
    v_cvt_pk_bf16_f32 v117, v118, v119
    v_cvt_pk_bf16_f32 v120, v120, v121
    v_cvt_pk_bf16_f32 v121, v122, v123
    v_cvt_pk_bf16_f32 v124, v124, v125
    v_cvt_pk_bf16_f32 v125, v126, v127
    ds_write_b64 v24, v[96:97] offset:0
    ds_write_b64 v24, v[100:101] offset:32
    ds_write_b64 v24, v[104:105] offset:64
    ds_write_b64 v24, v[108:109] offset:96
    ds_write_b64 v24, v[112:113] offset:128
    ds_write_b64 v24, v[116:117] offset:160
    ds_write_b64 v24, v[120:121] offset:192
    ds_write_b64 v24, v[124:125] offset:224
    ds_read_b128 v[96:99], v25 offset:0
    ds_read_b128 v[100:103], v25 offset:1088
    ds_read_b128 v[104:107], v25 offset:2176
    ds_read_b128 v[108:111], v25 offset:3264
    s_add_u32 s101, s100, 8192
    s_waitcnt lgkmcnt(3)
    buffer_store_dwordx4 v[96:99], v26, s[24:27], s101 offen offset:0
    s_waitcnt lgkmcnt(2)
    buffer_store_dwordx4 v[100:103], v26, s[24:27], s101 offen offset:1024
    s_waitcnt lgkmcnt(1)
    buffer_store_dwordx4 v[104:107], v26, s[24:27], s101 offen offset:2048
    s_waitcnt lgkmcnt(0)
    buffer_store_dwordx4 v[108:111], v26, s[24:27], s101 offen offset:3072
    v_mov_b32 v30, v22
    s_nop 1
    v_permlane16_swap_b32 v22, v30
    v_add_f32 v22, v22, v30
    v_mov_b32 v30, v22
    s_nop 1
    v_permlane32_swap_b32 v22, v30
    v_add_f32 v22, v22, v30
    v_rcp_f32 v28, v22
    s_nop 0
    v_pk_mul_f32 v[128:129], v[128:129], v[28:29] op_sel_hi:[1,0]
    v_pk_mul_f32 v[130:131], v[130:131], v[28:29] op_sel_hi:[1,0]
    v_pk_mul_f32 v[132:133], v[132:133], v[28:29] op_sel_hi:[1,0]
    v_pk_mul_f32 v[134:135], v[134:135], v[28:29] op_sel_hi:[1,0]
    v_pk_mul_f32 v[136:137], v[136:137], v[28:29] op_sel_hi:[1,0]
    v_pk_mul_f32 v[138:139], v[138:139], v[28:29] op_sel_hi:[1,0]
    v_pk_mul_f32 v[140:141], v[140:141], v[28:29] op_sel_hi:[1,0]
    v_pk_mul_f32 v[142:143], v[142:143], v[28:29] op_sel_hi:[1,0]
    v_cvt_pk_bf16_f32 v128, v128, v129
    v_cvt_pk_bf16_f32 v129, v130, v131
    v_cvt_pk_bf16_f32 v132, v132, v133
    v_cvt_pk_bf16_f32 v133, v134, v135
    v_cvt_pk_bf16_f32 v136, v136, v137
    v_cvt_pk_bf16_f32 v137, v138, v139
    v_cvt_pk_bf16_f32 v140, v140, v141
    v_cvt_pk_bf16_f32 v141, v142, v143
    v_pk_mul_f32 v[144:145], v[144:145], v[28:29] op_sel_hi:[1,0]
    v_pk_mul_f32 v[146:147], v[146:147], v[28:29] op_sel_hi:[1,0]
    v_pk_mul_f32 v[148:149], v[148:149], v[28:29] op_sel_hi:[1,0]
    v_pk_mul_f32 v[150:151], v[150:151], v[28:29] op_sel_hi:[1,0]
    v_pk_mul_f32 v[152:153], v[152:153], v[28:29] op_sel_hi:[1,0]
    v_pk_mul_f32 v[154:155], v[154:155], v[28:29] op_sel_hi:[1,0]
    v_pk_mul_f32 v[156:157], v[156:157], v[28:29] op_sel_hi:[1,0]
    v_pk_mul_f32 v[158:159], v[158:159], v[28:29] op_sel_hi:[1,0]
    v_cvt_pk_bf16_f32 v144, v144, v145
    v_cvt_pk_bf16_f32 v145, v146, v147
    v_cvt_pk_bf16_f32 v148, v148, v149
    v_cvt_pk_bf16_f32 v149, v150, v151
    v_cvt_pk_bf16_f32 v152, v152, v153
    v_cvt_pk_bf16_f32 v153, v154, v155
    v_cvt_pk_bf16_f32 v156, v156, v157
    v_cvt_pk_bf16_f32 v157, v158, v159
    ds_write_b64 v24, v[128:129] offset:0
    ds_write_b64 v24, v[132:133] offset:32
    ds_write_b64 v24, v[136:137] offset:64
    ds_write_b64 v24, v[140:141] offset:96
    ds_write_b64 v24, v[144:145] offset:128
    ds_write_b64 v24, v[148:149] offset:160
    ds_write_b64 v24, v[152:153] offset:192
    ds_write_b64 v24, v[156:157] offset:224
    ds_read_b128 v[128:131], v25 offset:0
    ds_read_b128 v[132:135], v25 offset:1088
    ds_read_b128 v[136:139], v25 offset:2176
    ds_read_b128 v[140:143], v25 offset:3264
    s_add_u32 s101, s100, 12288
    s_waitcnt lgkmcnt(3)
    buffer_store_dwordx4 v[128:131], v26, s[24:27], s101 offen offset:0
    s_waitcnt lgkmcnt(2)
    buffer_store_dwordx4 v[132:135], v26, s[24:27], s101 offen offset:1024
    s_waitcnt lgkmcnt(1)
    buffer_store_dwordx4 v[136:139], v26, s[24:27], s101 offen offset:2048
    s_waitcnt lgkmcnt(0)
    buffer_store_dwordx4 v[140:143], v26, s[24:27], s101 offen offset:3072
    v_mov_b32 v30, v23
    s_nop 1
    v_permlane16_swap_b32 v23, v30
    v_add_f32 v23, v23, v30
    v_mov_b32 v30, v23
    s_nop 1
    v_permlane32_swap_b32 v23, v30
    v_add_f32 v23, v23, v30
    v_rcp_f32 v28, v23
    s_nop 0
    v_pk_mul_f32 v[160:161], v[160:161], v[28:29] op_sel_hi:[1,0]
    v_pk_mul_f32 v[162:163], v[162:163], v[28:29] op_sel_hi:[1,0]
    v_pk_mul_f32 v[164:165], v[164:165], v[28:29] op_sel_hi:[1,0]
    v_pk_mul_f32 v[166:167], v[166:167], v[28:29] op_sel_hi:[1,0]
    v_pk_mul_f32 v[168:169], v[168:169], v[28:29] op_sel_hi:[1,0]
    v_pk_mul_f32 v[170:171], v[170:171], v[28:29] op_sel_hi:[1,0]
    v_pk_mul_f32 v[172:173], v[172:173], v[28:29] op_sel_hi:[1,0]
    v_pk_mul_f32 v[174:175], v[174:175], v[28:29] op_sel_hi:[1,0]
    v_cvt_pk_bf16_f32 v160, v160, v161
    v_cvt_pk_bf16_f32 v161, v162, v163
    v_cvt_pk_bf16_f32 v164, v164, v165
    v_cvt_pk_bf16_f32 v165, v166, v167
    v_cvt_pk_bf16_f32 v168, v168, v169
    v_cvt_pk_bf16_f32 v169, v170, v171
    v_cvt_pk_bf16_f32 v172, v172, v173
    v_cvt_pk_bf16_f32 v173, v174, v175
    v_pk_mul_f32 v[176:177], v[176:177], v[28:29] op_sel_hi:[1,0]
    v_pk_mul_f32 v[178:179], v[178:179], v[28:29] op_sel_hi:[1,0]
    v_pk_mul_f32 v[180:181], v[180:181], v[28:29] op_sel_hi:[1,0]
    v_pk_mul_f32 v[182:183], v[182:183], v[28:29] op_sel_hi:[1,0]
    v_pk_mul_f32 v[184:185], v[184:185], v[28:29] op_sel_hi:[1,0]
    v_pk_mul_f32 v[186:187], v[186:187], v[28:29] op_sel_hi:[1,0]
    v_pk_mul_f32 v[188:189], v[188:189], v[28:29] op_sel_hi:[1,0]
    v_pk_mul_f32 v[190:191], v[190:191], v[28:29] op_sel_hi:[1,0]
    v_cvt_pk_bf16_f32 v176, v176, v177
    v_cvt_pk_bf16_f32 v177, v178, v179
    v_cvt_pk_bf16_f32 v180, v180, v181
    v_cvt_pk_bf16_f32 v181, v182, v183
    v_cvt_pk_bf16_f32 v184, v184, v185
    v_cvt_pk_bf16_f32 v185, v186, v187
    v_cvt_pk_bf16_f32 v188, v188, v189
    v_cvt_pk_bf16_f32 v189, v190, v191
    ds_write_b64 v24, v[160:161] offset:0
    ds_write_b64 v24, v[164:165] offset:32
    ds_write_b64 v24, v[168:169] offset:64
    ds_write_b64 v24, v[172:173] offset:96
    ds_write_b64 v24, v[176:177] offset:128
    ds_write_b64 v24, v[180:181] offset:160
    ds_write_b64 v24, v[184:185] offset:192
    ds_write_b64 v24, v[188:189] offset:224
    ds_read_b128 v[160:163], v25 offset:0
    ds_read_b128 v[164:167], v25 offset:1088
    ds_read_b128 v[168:171], v25 offset:2176
    ds_read_b128 v[172:175], v25 offset:3264
    s_add_u32 s101, s100, 16384
    s_waitcnt lgkmcnt(3)
    buffer_store_dwordx4 v[160:163], v26, s[24:27], s101 offen offset:0
    s_waitcnt lgkmcnt(2)
    buffer_store_dwordx4 v[164:167], v26, s[24:27], s101 offen offset:1024
    s_waitcnt lgkmcnt(1)
    buffer_store_dwordx4 v[168:171], v26, s[24:27], s101 offen offset:2048
    s_waitcnt lgkmcnt(0)
    buffer_store_dwordx4 v[172:175], v26, s[24:27], s101 offen offset:3072
    s_waitcnt vmcnt(0)
L_sp_next:
    s_add_u32 s31, s31, 1
    s_cmp_lt_u32 s31, 2
    s_cbranch_scc1 L_sp_head
    s_branch L_fin
L_fin:
L_end:
    s_endpgm
.section .rodata,"a"
.p2align 6
.amdhsa_kernel standalone__mha_softmax__near_ridge_kernel
  .amdhsa_next_free_vgpr 512
  .amdhsa_next_free_sgpr 102
  .amdhsa_accum_offset 256
  .amdhsa_group_segment_fixed_size 0
  .amdhsa_kernarg_size 48
  .amdhsa_user_sgpr_count 2
  .amdhsa_user_sgpr_kernarg_segment_ptr 1
  .amdhsa_system_sgpr_workgroup_id_x 1
.end_amdhsa_kernel
```
